```python
import torch

def _softmax(x, axis=-1):
    return torch.softmax(x, dim=axis)
def _gelu(x):
    return torch.nn.functional.gelu(x, approximate="tanh")
def _silu(x):
    return torch.nn.functional.silu(x)
def _sigmoid(x):
    return torch.sigmoid(x)
def _layernorm(x, axis=-1, eps=1e-5):
    m = x.mean(dim=axis, keepdim=True)
    v = x.var(dim=axis, keepdim=True, unbiased=False)
    return (x - m) / torch.sqrt(v + eps)
def _scatter_add(tgt, idx, src, axis=0):
    return tgt.clone().index_add_(axis, idx, src)
def _segment_sum(src, seg, n):
    out = torch.zeros((n,) + src.shape[1:], dtype=src.dtype)
    return out.index_add_(0, seg, src)
def _pad(x, pw):
    flat = tuple(v for pair in reversed(pw) for v in pair)
    return torch.nn.functional.pad(x, flat)

kernel_name = 'recurrent_scan__sliding_block__dense_activation_squared_relu__prompt'

def setup_inputs():

    _w = (lambda a: (lambda t: t.to(torch.bfloat16) if t.is_floating_point() else t)(torch.as_tensor(a)))
    def _A_setup():
        B, S, D = 1, 2048, 1024
        return {
            "x": _w((lambda *s: torch.randn(*s, dtype=torch.bfloat16) * 0.05)(B, S, D)),
            "wqkv": _w((lambda *s: torch.randn(*s, dtype=torch.bfloat16) * 0.05)(D, 3 * D)),
            "wo": _w((lambda *s: torch.randn(*s, dtype=torch.bfloat16) * 0.05)(D, D)),
        }
    _A_in = _A_setup()

    def _B_setup():
        B, S, D, F = 1, 2048, 1024, 3584
        return {
            "x": _w((lambda *s: torch.randn(*s, dtype=torch.bfloat16) * 0.05)(B, S, D)),
            "w1": _w((lambda *s: torch.randn(*s, dtype=torch.bfloat16) * 0.05)(D, F)),
            "b1": _w((lambda *s: torch.randn(*s, dtype=torch.bfloat16) * 0.4)(F)),
            "w2": _w((lambda *s: torch.randn(*s, dtype=torch.bfloat16) * 0.05)(F, D)),
            "b2": _w((lambda *s: torch.randn(*s, dtype=torch.bfloat16) * 3.2)(D)),
        }
    _B_in = _B_setup()

    return {
        "A_x": _A_in["x"],
        "A_wqkv": _A_in["wqkv"],
        "A_wo": _A_in["wo"],
        "B_x": _B_in["x"],
        "B_w1": _B_in["w1"],
        "B_b1": _B_in["b1"],
        "B_w2": _B_in["w2"],
        "B_b2": _B_in["b2"],
    }

def reference(A_x, A_wqkv, A_wo, B_x, B_w1, B_b1, B_w2, B_b2):
    def _A_ref(x, wqkv, wo):
        B, S, D = x.shape
        H = 32; Dh = D // H; W = 256
        qkv = (lambda x, *d: x.permute(*d))((x @ wqkv).reshape(B, S, 3, H, Dh), 2, 0, 3, 1, 4)
        q, k, v = qkv[0], qkv[1], qkv[2]
        scores = torch.einsum("bhqd,bhkd->bhqk", q, k) * (Dh ** -0.5)
        idx = torch.arange(S)
        mask = (idx[:, None] - idx[None, :] >= 0) & (idx[:, None] - idx[None, :] < W)
        scores = torch.where(mask[None, None], scores, -1e9)
        p = _softmax(scores, axis=-1)
        o = torch.einsum("bhqk,bhkd->bhqd", p, v)
        return (lambda x, *d: x.permute(*d))(o, 0, 2, 1, 3).reshape(B, S, D) @ wo

    def _B_ref(x, w1, b1, w2, b2):
        h = torch.einsum("bsd,df->bsf", x, w1) + b1
        zero = torch.zeros_like(h)
        r = torch.where(h > zero, h, zero)
        h = r * r
        out = torch.einsum("bsf,fd->bsd", h, w2) + b2
        return out

    x = A_x
    xn = _layernorm(x, axis=-1)
    s = _A_ref(xn, A_wqkv, A_wo)
    g = _silu(_B_ref(xn, B_w1, B_b1, B_w2, B_b2))
    return x + s * g
```

```asm
; @launch grid=(256,1,1) block=(256,1,1) lds=163840
.amdgcn_target "amdgcn-amd-amdhsa--gfx950"
.text
.p2align 12
.p2align 8
.globl recurrent_scan__sliding_block__dense_activation_squared_relu__prompt_kernel
.type recurrent_scan__sliding_block__dense_activation_squared_relu__prompt_kernel,@function
recurrent_scan__sliding_block__dense_activation_squared_relu__prompt_kernel:
fk:
s_cmp_ge_u32 s2, 256
s_cbranch_scc1 fk_end
s_load_dwordx2 s[50:51], s[0:1], 0
s_load_dwordx2 s[48:49], s[0:1], 80
s_load_dwordx2 s[94:95], s[0:1], 72
s_memrealtime s[92:93]
s_lshr_b32 s79, s2, 3
s_and_b32 s44, s2, 1
s_cmp_eq_u32 s44, 0
s_cselect_b32 s45, 32, 8
s_load_dwordx2 s[60:61], s[0:1], s45
s_load_dwordx2 s[88:89], s[0:1], 40
s_load_dwordx2 s[96:97], s[0:1], 32
s_load_dwordx2 s[52:53], s[0:1], 16
s_load_dwordx2 s[54:55], s[0:1], 48
s_load_dwordx2 s[56:57], s[0:1], 56
s_load_dwordx2 s[58:59], s[0:1], 64
v_lshrrev_b32 v27, 6, v0
v_and_b32 v28, 63, v0
v_readfirstlane_b32 s3, v27
v_lshlrev_b32 v1, 4, v28
v_lshlrev_b32 v24, 2, v28
v_mov_b32 v25, 0
s_mov_b32 s85, 0
s_mov_b32 s40, 0
s_mov_b32 s41, 0
v_bfe_u32 v27, v1, 4, 3
v_bfe_u32 v28, v1, 7, 1
v_bfe_u32 v29, v1, 8, 1
v_lshrrev_b32 v30, 9, v1
v_lshlrev_b32 v64, 11, v27
v_lshl_add_u32 v64, v28, 6, v64
v_lshl_add_u32 v64, v29, 5, v64
v_lshl_add_u32 v64, v30, 4, v64
v_and_b32 v66, 0x370, v1
v_lshl_add_u32 v66, v28, 14, v66
v_lshlrev_b32 v68, 4, v27
s_waitcnt lgkmcnt(0)
s_mov_b32 s28, s50
s_and_b32 s29, s51, 0xffff
s_mov_b32 s30, 4194304
s_mov_b32 s31, 0x00020000
s_lshl_b32 s46, s2, 14
s_lshl_b32 s47, s3, 9
s_add_u32 s46, s46, s47
buffer_load_dwordx4 v[32:35], v64, s[28:31], s46 offen offset:0
buffer_load_dwordx4 v[36:39], v64, s[28:31], s46 offen offset:128
buffer_load_dwordx4 v[40:43], v64, s[28:31], s46 offen offset:256
buffer_load_dwordx4 v[44:47], v64, s[28:31], s46 offen offset:384
s_mov_b32 s12, s48
s_and_b32 s13, s49, 0xffff
s_mov_b32 s14, 268435456
s_mov_b32 s15, 0x00020000
s_mov_b32 s36, s94
s_and_b32 s37, s95, 0xffff
s_mov_b32 s38, 256
s_mov_b32 s39, 0x00020000
s_or_b32 s47, s2, s3
s_cmp_lg_u32 s47, 0
s_cbranch_scc1 fk_ln_nn
s_or_b32 s47, s92, 1
v_mov_b32 v70, s47
v_mov_b32 v71, 0
v_lshlrev_b32 v72, 4, v1
buffer_atomic_cmpswap v[70:71], v72, s[36:39], 0 offen sc1
fk_ln_nn:
s_mov_b32 s16, s88
s_and_b32 s17, s89, 0xffff
s_mov_b32 s18, 7168
s_mov_b32 s19, 0x00020000
s_sub_u32 s52, s52, 4096
s_subb_u32 s53, s53, 0
s_mov_b32 s24, s52
s_and_b32 s25, s53, 0xffff
s_mov_b32 s26, 2101248
s_mov_b32 s27, 0x00020000
s_sub_u32 s54, s54, 4096
s_subb_u32 s55, s55, 0
s_mov_b32 s20, s54
s_and_b32 s21, s55, 0xffff
s_mov_b32 s22, 7344128
s_mov_b32 s23, 0x00020000
s_mov_b32 s32, s56
s_and_b32 s33, s57, 0xffff
s_mov_b32 s34, 2048
s_mov_b32 s35, 0x00020000
s_getpc_b64 s[88:89]
fk_pc91:
s_sub_u32 s88, s88, fk_pc91-fk
s_subb_u32 s89, s89, 0
s_mov_b32 s52, s88
s_and_b32 s53, s89, 0xffff
s_mov_b32 s54, fk_end-fk
s_mov_b32 s55, 0x00020000
s_lshl_b32 s44, s79, 2
s_add_u32 s44, s44, s3
s_lshl_b32 s56, s44, 10
buffer_load_dwordx4 a[252:255], v1, s[52:55], s56 offen
s_mul_i32 s44, s2, 4352
s_add_u32 s44, s44, 36175872
s_cmp_lt_u32 s2, 128
s_cselect_b32 s44, s44, 0x40000000
buffer_load_dword v0, v24, s[12:15], s44 offen sc1
v_lshlrev_b32 v65, 3, v1
buffer_load_dword a250, v65, s[16:19], 0 offen
buffer_load_dword a250, v65, s[32:35], 0 offen
s_bfe_u32 s44, s2, 0x20001
s_lshl_b32 s44, s44, 2
s_bfe_u32 s45, s2, 0x20003
s_add_u32 s44, s44, s45
s_lshr_b32 s45, s2, 5
s_and_b32 s46, s2, 1
s_lshl_b32 s73, s45, 8
s_lshl_b32 s47, s46, 7
s_add_u32 s73, s73, s47
s_lshl_b32 s47, s44, 3
s_add_u32 s47, s47, s45
s_lshl_b32 s47, s47, 1
s_add_u32 s47, s47, s46
s_lshl_b32 s47, s47, 2
s_add_u32 s47, s47, s3
s_lshl_b32 s76, s47, 12
s_xor_b32 s78, s76, 16384
s_add_u32 s76, s76, 37748736
s_add_u32 s78, s78, 37748736
s_lshr_b32 s81, s47, 5
s_mul_i32 s81, s81, 4352
s_and_b32 s80, s47, 31
s_lshl_b32 s80, s80, 2
s_add_u32 s80, s80, s81
s_add_u32 s80, s80, 36419584
s_xor_b32 s81, s80, 16
s_lshl_b32 s74, s44, 18
s_lshl_b32 s47, s3, 16
s_add_u32 s74, s74, s47
s_add_u32 s74, s74, s73
s_add_u32 s75, s74, 32768
s_lshl_b32 s47, s44, 1
s_lshr_b32 s45, s3, 1
s_add_u32 s47, s47, s45
s_lshr_b32 s47, s44, 1
s_mul_i32 s83, s47, 4352
s_add_u32 s83, s83, 36245504
s_mul_i32 s82, s44, 4352
s_add_u32 s82, s82, 36175872
s_lshl_b32 s47, s46, 3
s_lshl_b32 s87, 0x00ff00ff, s47
s_and_b32 s47, s44, 1
s_lshl_b32 s47, s47, 13
s_lshl_b32 s45, s3, 11
s_add_u32 s47, s47, s45
s_lshr_b32 s44, s44, 1
s_lshl_b32 s70, s44, 19
s_add_u32 s70, s70, s47
s_add_u32 s70, s70, 16777216
s_mul_i32 s69, s44, 112
s_mul_i32 s45, s46, 64
s_add_u32 s69, s69, s45
s_lshl_b32 s69, s69, 14
s_add_u32 s69, s69, s47
s_add_u32 s69, s69, 20971520
s_mul_i32 s71, s46, 4194304
s_mov_b32 s72, 0
v_lshrrev_b32 v27, 7, v1
v_bfe_u32 v28, v1, 4, 3
v_and_b32 v29, 6, v27
v_xor_b32 v28, v28, v29
s_lshl_b32 s44, s3, 3
v_add_u32 v27, s44, v27
v_mul_u32_u24 v27, 2048, v27
v_lshl_add_u32 v30, v28, 4, v27
s_xor_b32 s44, s73, 0
s_add_u32 s44, s44, 4096
v_add_u32 v14, s44, v30
s_xor_b32 s44, s73, 128
s_add_u32 s44, s44, 3072
v_add_u32 v15, s44, v30
s_xor_b32 s44, s73, 0
s_add_u32 s44, s44, 67584
v_add_u32 v16, s44, v30
s_xor_b32 s44, s73, 128
s_add_u32 s44, s44, 66560
v_add_u32 v17, s44, v30
s_sub_u32 s60, s60, 4096
s_subb_u32 s61, s61, 0
s_bitcmp0_b32 s2, 0
s_mov_b32 s45, 6295552
s_cselect_b32 s45, 7344128, s45
s_mov_b32 s8, s60
s_and_b32 s9, s61, 0xffff
s_mov_b32 s10, s45
s_mov_b32 s11, 0x00020000
s_lshr_b32 s91, s2, 1
s_lshl_b32 s91, s91, 2
s_add_u32 s91, s91, s3
s_mul_i32 s45, s91, 8192
s_add_u32 s45, s45, 4096
v_lshlrev_b32 v65, 3, v1
v_min_u32 v65, 8064, v65
buffer_load_dword a251, v65, s[8:11], s45 offen
s_mov_b32 s90, 0xffff0000
s_bitcmp0_b32 s2, 0
s_cselect_b32 s44, 65536, 0
s_add_u32 s44, s44, 65536
v_add_u32 v68, s44, v68
s_lshl_b32 s44, s3, 2
v_add_u32 v67, s44, v68
s_waitcnt vmcnt(8)
v_lshlrev_b32 v72, 16, v32
v_and_b32 v73, s90, v32
v_lshlrev_b32 v74, 16, v33
v_and_b32 v75, s90, v33
v_lshlrev_b32 v76, 16, v34
v_and_b32 v77, s90, v34
v_lshlrev_b32 v78, 16, v35
v_and_b32 v79, s90, v35
s_waitcnt vmcnt(7)
v_lshlrev_b32 v80, 16, v36
v_and_b32 v81, s90, v36
v_lshlrev_b32 v82, 16, v37
v_and_b32 v83, s90, v37
v_lshlrev_b32 v84, 16, v38
v_and_b32 v85, s90, v38
v_lshlrev_b32 v86, 16, v39
v_and_b32 v87, s90, v39
s_waitcnt vmcnt(6)
v_lshlrev_b32 v88, 16, v40
v_and_b32 v89, s90, v40
v_lshlrev_b32 v90, 16, v41
v_and_b32 v91, s90, v41
v_lshlrev_b32 v92, 16, v42
v_and_b32 v93, s90, v42
v_lshlrev_b32 v94, 16, v43
v_and_b32 v95, s90, v43
s_waitcnt vmcnt(5)
v_lshlrev_b32 v96, 16, v44
v_and_b32 v97, s90, v44
v_lshlrev_b32 v98, 16, v45
v_and_b32 v99, s90, v45
v_lshlrev_b32 v100, 16, v46
v_and_b32 v101, s90, v46
v_lshlrev_b32 v102, 16, v47
v_and_b32 v103, s90, v47
v_pk_add_f32 v[48:49], v[72:73], v[80:81]
v_pk_add_f32 v[50:51], v[74:75], v[82:83]
v_pk_add_f32 v[52:53], v[76:77], v[84:85]
v_pk_add_f32 v[54:55], v[78:79], v[86:87]
v_pk_add_f32 v[48:49], v[48:49], v[88:89]
v_pk_add_f32 v[50:51], v[50:51], v[90:91]
v_pk_add_f32 v[52:53], v[52:53], v[92:93]
v_pk_add_f32 v[54:55], v[54:55], v[94:95]
v_pk_add_f32 v[48:49], v[48:49], v[96:97]
v_pk_add_f32 v[50:51], v[50:51], v[98:99]
v_pk_add_f32 v[52:53], v[52:53], v[100:101]
v_pk_add_f32 v[54:55], v[54:55], v[102:103]
v_pk_add_f32 v[48:49], v[48:49], v[50:51]
v_pk_add_f32 v[52:53], v[52:53], v[54:55]
v_pk_add_f32 v[48:49], v[48:49], v[52:53]
v_add_f32 v48, v48, v49
s_nop 1
v_add_f32_dpp v48, v48, v48 row_ror:8 row_mask:0xf bank_mask:0xf
v_mov_b32 v49, v48
s_nop 1
v_permlane32_swap_b32 v48, v49
v_add_f32 v48, v48, v49
v_mov_b32 v49, v48
s_nop 1
v_permlane16_swap_b32 v48, v49
v_add_f32 v48, v48, v49
ds_write_b32 v67, v48 offset:0
s_waitcnt lgkmcnt(0)
s_barrier
ds_read_b128 v[48:51], v68 offset:0
s_waitcnt lgkmcnt(0)
v_pk_add_f32 v[48:49], v[48:49], v[50:51]
v_add_f32 v48, v48, v49
v_mul_f32 v56, 0x3a800000, v48
buffer_load_dword v26, v25, s[36:39], 0 offen sc1
v_mov_b32 v57, v56
v_pk_add_f32 v[104:105], v[72:73], v[56:57] neg_lo:[0,1] neg_hi:[0,1]
v_pk_add_f32 v[106:107], v[74:75], v[56:57] neg_lo:[0,1] neg_hi:[0,1]
v_pk_add_f32 v[108:109], v[76:77], v[56:57] neg_lo:[0,1] neg_hi:[0,1]
v_pk_add_f32 v[110:111], v[78:79], v[56:57] neg_lo:[0,1] neg_hi:[0,1]
v_pk_add_f32 v[112:113], v[80:81], v[56:57] neg_lo:[0,1] neg_hi:[0,1]
v_pk_add_f32 v[114:115], v[82:83], v[56:57] neg_lo:[0,1] neg_hi:[0,1]
v_pk_add_f32 v[116:117], v[84:85], v[56:57] neg_lo:[0,1] neg_hi:[0,1]
v_pk_add_f32 v[118:119], v[86:87], v[56:57] neg_lo:[0,1] neg_hi:[0,1]
v_pk_add_f32 v[120:121], v[88:89], v[56:57] neg_lo:[0,1] neg_hi:[0,1]
v_pk_add_f32 v[122:123], v[90:91], v[56:57] neg_lo:[0,1] neg_hi:[0,1]
v_pk_add_f32 v[124:125], v[92:93], v[56:57] neg_lo:[0,1] neg_hi:[0,1]
v_pk_add_f32 v[126:127], v[94:95], v[56:57] neg_lo:[0,1] neg_hi:[0,1]
v_pk_add_f32 v[128:129], v[96:97], v[56:57] neg_lo:[0,1] neg_hi:[0,1]
v_pk_add_f32 v[130:131], v[98:99], v[56:57] neg_lo:[0,1] neg_hi:[0,1]
v_pk_add_f32 v[132:133], v[100:101], v[56:57] neg_lo:[0,1] neg_hi:[0,1]
v_pk_add_f32 v[134:135], v[102:103], v[56:57] neg_lo:[0,1] neg_hi:[0,1]
v_pk_mul_f32 v[48:49], v[104:105], v[104:105]
v_pk_mul_f32 v[50:51], v[106:107], v[106:107]
v_pk_mul_f32 v[52:53], v[108:109], v[108:109]
v_pk_mul_f32 v[54:55], v[110:111], v[110:111]
v_pk_fma_f32 v[48:49], v[112:113], v[112:113], v[48:49]
v_pk_fma_f32 v[50:51], v[114:115], v[114:115], v[50:51]
v_pk_fma_f32 v[52:53], v[116:117], v[116:117], v[52:53]
v_pk_fma_f32 v[54:55], v[118:119], v[118:119], v[54:55]
v_pk_fma_f32 v[48:49], v[120:121], v[120:121], v[48:49]
v_pk_fma_f32 v[50:51], v[122:123], v[122:123], v[50:51]
v_pk_fma_f32 v[52:53], v[124:125], v[124:125], v[52:53]
v_pk_fma_f32 v[54:55], v[126:127], v[126:127], v[54:55]
v_pk_fma_f32 v[48:49], v[128:129], v[128:129], v[48:49]
v_pk_fma_f32 v[50:51], v[130:131], v[130:131], v[50:51]
v_pk_fma_f32 v[52:53], v[132:133], v[132:133], v[52:53]
v_pk_fma_f32 v[54:55], v[134:135], v[134:135], v[54:55]
v_cvt_pk_bf16_f32 v56, v56, v56
v_lshlrev_b32 v56, 16, v56
v_mov_b32 v57, v56
v_pk_add_f32 v[48:49], v[48:49], v[50:51]
v_pk_add_f32 v[52:53], v[52:53], v[54:55]
v_pk_add_f32 v[48:49], v[48:49], v[52:53]
v_add_f32 v48, v48, v49
s_nop 1
v_add_f32_dpp v48, v48, v48 row_ror:8 row_mask:0xf bank_mask:0xf
v_mov_b32 v49, v48
s_nop 1
v_permlane32_swap_b32 v48, v49
v_add_f32 v48, v48, v49
v_mov_b32 v49, v48
s_nop 1
v_permlane16_swap_b32 v48, v49
v_add_f32 v48, v48, v49
ds_write_b32 v67, v48 offset:128
v_pk_add_f32 v[72:73], v[72:73], v[56:57] neg_lo:[0,1] neg_hi:[0,1]
v_pk_add_f32 v[74:75], v[74:75], v[56:57] neg_lo:[0,1] neg_hi:[0,1]
v_pk_add_f32 v[76:77], v[76:77], v[56:57] neg_lo:[0,1] neg_hi:[0,1]
v_pk_add_f32 v[78:79], v[78:79], v[56:57] neg_lo:[0,1] neg_hi:[0,1]
v_pk_add_f32 v[80:81], v[80:81], v[56:57] neg_lo:[0,1] neg_hi:[0,1]
v_pk_add_f32 v[82:83], v[82:83], v[56:57] neg_lo:[0,1] neg_hi:[0,1]
v_pk_add_f32 v[84:85], v[84:85], v[56:57] neg_lo:[0,1] neg_hi:[0,1]
v_pk_add_f32 v[86:87], v[86:87], v[56:57] neg_lo:[0,1] neg_hi:[0,1]
v_pk_add_f32 v[88:89], v[88:89], v[56:57] neg_lo:[0,1] neg_hi:[0,1]
v_pk_add_f32 v[90:91], v[90:91], v[56:57] neg_lo:[0,1] neg_hi:[0,1]
v_pk_add_f32 v[92:93], v[92:93], v[56:57] neg_lo:[0,1] neg_hi:[0,1]
v_pk_add_f32 v[94:95], v[94:95], v[56:57] neg_lo:[0,1] neg_hi:[0,1]
v_pk_add_f32 v[96:97], v[96:97], v[56:57] neg_lo:[0,1] neg_hi:[0,1]
v_pk_add_f32 v[98:99], v[98:99], v[56:57] neg_lo:[0,1] neg_hi:[0,1]
v_pk_add_f32 v[100:101], v[100:101], v[56:57] neg_lo:[0,1] neg_hi:[0,1]
v_pk_add_f32 v[102:103], v[102:103], v[56:57] neg_lo:[0,1] neg_hi:[0,1]
v_cvt_pk_bf16_f32 v32, v72, v73
v_cvt_pk_bf16_f32 v33, v74, v75
v_cvt_pk_bf16_f32 v34, v76, v77
v_cvt_pk_bf16_f32 v35, v78, v79
v_cvt_pk_bf16_f32 v36, v80, v81
v_cvt_pk_bf16_f32 v37, v82, v83
v_cvt_pk_bf16_f32 v38, v84, v85
v_cvt_pk_bf16_f32 v39, v86, v87
v_cvt_pk_bf16_f32 v40, v88, v89
v_cvt_pk_bf16_f32 v41, v90, v91
v_cvt_pk_bf16_f32 v42, v92, v93
v_cvt_pk_bf16_f32 v43, v94, v95
v_cvt_pk_bf16_f32 v44, v96, v97
v_cvt_pk_bf16_f32 v45, v98, v99
v_cvt_pk_bf16_f32 v46, v100, v101
v_cvt_pk_bf16_f32 v47, v102, v103
s_waitcnt lgkmcnt(0)
s_barrier
ds_read_b128 v[48:51], v68 offset:128
v_lshlrev_b32 v72, 16, v32
v_and_b32 v73, s90, v32
v_lshlrev_b32 v74, 16, v33
v_and_b32 v75, s90, v33
v_lshlrev_b32 v76, 16, v34
v_and_b32 v77, s90, v34
v_lshlrev_b32 v78, 16, v35
v_and_b32 v79, s90, v35
v_lshlrev_b32 v80, 16, v36
v_and_b32 v81, s90, v36
v_lshlrev_b32 v82, 16, v37
v_and_b32 v83, s90, v37
v_lshlrev_b32 v84, 16, v38
v_and_b32 v85, s90, v38
v_lshlrev_b32 v86, 16, v39
v_and_b32 v87, s90, v39
v_lshlrev_b32 v88, 16, v40
v_and_b32 v89, s90, v40
v_lshlrev_b32 v90, 16, v41
v_and_b32 v91, s90, v41
v_lshlrev_b32 v92, 16, v42
v_and_b32 v93, s90, v42
v_lshlrev_b32 v94, 16, v43
v_and_b32 v95, s90, v43
v_lshlrev_b32 v96, 16, v44
v_and_b32 v97, s90, v44
v_lshlrev_b32 v98, 16, v45
v_and_b32 v99, s90, v45
v_lshlrev_b32 v100, 16, v46
v_and_b32 v101, s90, v46
v_lshlrev_b32 v102, 16, v47
v_and_b32 v103, s90, v47
s_waitcnt lgkmcnt(0)
v_pk_add_f32 v[48:49], v[48:49], v[50:51]
v_add_f32 v48, v48, v49
v_mul_f32 v58, 0x3a800000, v48
v_cvt_pk_bf16_f32 v58, v58, v58
v_lshlrev_b32 v58, 16, v58
v_add_f32 v58, 0x3727c5ac, v58
v_cvt_pk_bf16_f32 v58, v58, v58
v_lshlrev_b32 v58, 16, v58
v_sqrt_f32 v58, v58
s_nop 0
v_cvt_pk_bf16_f32 v58, v58, v58
v_lshlrev_b32 v58, 16, v58
v_rcp_f32 v58, v58
s_lshr_b32 s44, s2, 5
s_lshl_b32 s44, s44, 19
s_bfe_u32 s45, s2, 0x40001
s_lshl_b32 s45, s45, 10
s_add_u32 s44, s44, s45
s_and_b32 s45, s2, 1
s_lshl_b32 s45, s45, 7
s_add_u32 s44, s44, s45
s_lshl_b32 s45, s3, 17
s_add_u32 s44, s44, s45
v_mov_b32 v59, v58
v_pk_mul_f32 v[72:73], v[72:73], v[58:59]
v_pk_mul_f32 v[74:75], v[74:75], v[58:59]
v_pk_mul_f32 v[76:77], v[76:77], v[58:59]
v_pk_mul_f32 v[78:79], v[78:79], v[58:59]
v_cvt_pk_bf16_f32 v32, v72, v73
v_cvt_pk_bf16_f32 v33, v74, v75
v_cvt_pk_bf16_f32 v34, v76, v77
v_cvt_pk_bf16_f32 v35, v78, v79
s_nop 0
v_permlane16_swap_b32 v32, v34
v_permlane16_swap_b32 v33, v35
buffer_store_dwordx4 v[32:35], v66, s[12:15], s44 offen sc1
s_add_u32 s44, s44, 32768
v_pk_mul_f32 v[80:81], v[80:81], v[58:59]
v_pk_mul_f32 v[82:83], v[82:83], v[58:59]
v_pk_mul_f32 v[84:85], v[84:85], v[58:59]
v_pk_mul_f32 v[86:87], v[86:87], v[58:59]
v_cvt_pk_bf16_f32 v36, v80, v81
v_cvt_pk_bf16_f32 v37, v82, v83
v_cvt_pk_bf16_f32 v38, v84, v85
v_cvt_pk_bf16_f32 v39, v86, v87
s_nop 0
v_permlane16_swap_b32 v36, v38
v_permlane16_swap_b32 v37, v39
buffer_store_dwordx4 v[36:39], v66, s[12:15], s44 offen sc1
s_add_u32 s44, s44, 32768
v_pk_mul_f32 v[88:89], v[88:89], v[58:59]
v_pk_mul_f32 v[90:91], v[90:91], v[58:59]
v_pk_mul_f32 v[92:93], v[92:93], v[58:59]
v_pk_mul_f32 v[94:95], v[94:95], v[58:59]
v_cvt_pk_bf16_f32 v40, v88, v89
v_cvt_pk_bf16_f32 v41, v90, v91
v_cvt_pk_bf16_f32 v42, v92, v93
v_cvt_pk_bf16_f32 v43, v94, v95
s_nop 0
v_permlane16_swap_b32 v40, v42
v_permlane16_swap_b32 v41, v43
buffer_store_dwordx4 v[40:43], v66, s[12:15], s44 offen sc1
s_add_u32 s44, s44, 32768
v_pk_mul_f32 v[96:97], v[96:97], v[58:59]
v_pk_mul_f32 v[98:99], v[98:99], v[58:59]
v_pk_mul_f32 v[100:101], v[100:101], v[58:59]
v_pk_mul_f32 v[102:103], v[102:103], v[58:59]
v_cvt_pk_bf16_f32 v44, v96, v97
v_cvt_pk_bf16_f32 v45, v98, v99
v_cvt_pk_bf16_f32 v46, v100, v101
v_cvt_pk_bf16_f32 v47, v102, v103
s_nop 0
v_permlane16_swap_b32 v44, v46
v_permlane16_swap_b32 v45, v47
buffer_store_dwordx4 v[44:47], v66, s[12:15], s44 offen sc1
s_lshr_b32 s44, s2, 6
s_mul_i32 s44, s44, 4352
s_and_b32 s45, s2, 63
s_lshl_b32 s45, s45, 2
s_add_u32 s44, s44, s45
s_add_u32 s44, s44, 36558848
v_bfe_u32 v65, v1, 4, 3
v_mul_u32_u24 v65, 17408, v65
s_waitcnt vmcnt(4)
s_mov_b32 s86, 0
fk_ln_nchk:
v_readfirstlane_b32 s45, v26
s_cmp_lg_u32 s45, 0
s_cbranch_scc1 fk_ln_nok
s_add_u32 s86, s86, 1
s_cmp_gt_u32 s86, 0x8000
s_cbranch_scc1 fk_ln_nok
buffer_load_dword v26, v25, s[36:39], 0 offen sc1
s_waitcnt vmcnt(0)
s_branch fk_ln_nchk
fk_ln_nok:
s_bitcmp0_b32 s2, 0
s_cbranch_scc1 fk_ln_ns2
s_mov_b32 s28, s96
s_and_b32 s29, s97, 0xffff
s_mov_b32 s30, 7340032
s_mov_b32 s31, 0x00020000
s_mul_i32 s46, s91, 6144
s_add_u32 s46, s46, 4194304
s_add_u32 s47, s46, 4096
v_lshlrev_b32 v64, 3, v1
v_min_u32 v64, 6016, v64
buffer_load_dword a250, v64, s[28:31], s46 offen
buffer_load_dword a250, v64, s[8:11], s47 offen
fk_ln_ns2:
s_and_b32 s45, s2, 1
s_lshl_b32 s45, s45, 2
s_add_u32 s45, s45, s3
s_mov_b64 exec, 0
s_cmp_eq_u32 s45, 0
s_cbranch_scc1 PG1
s_cmp_eq_u32 s45, 1
s_cbranch_scc1 PG2
s_cmp_eq_u32 s45, 2
s_cbranch_scc1 PG3
s_cmp_eq_u32 s45, 3
s_cbranch_scc1 PG4
s_cmp_eq_u32 s45, 4
s_cbranch_scc1 PG1019
s_cmp_eq_u32 s45, 5
s_cbranch_scc1 PG10
s_cmp_eq_u32 s45, 6
s_cbranch_scc1 PG11
s_branch PG12
fk_tret:
s_mov_b64 exec, -1
s_bitcmp0_b32 s2, 0
s_cbranch_scc1 fk_ln_w0
s_waitcnt vmcnt(2)
s_branch fk_ln_w2
fk_ln_w0:
s_waitcnt vmcnt(0)
fk_ln_w2:
s_barrier
s_cmp_lg_u32 s3, 0
s_cbranch_scc1 fk_ln_nf
buffer_store_dword v26, v65, s[12:15], s44 offen sc1
fk_ln_nf:
s_mov_b32 s36, s58
s_and_b32 s37, s59, 0xffff
s_mov_b32 s38, 4194304
s_mov_b32 s39, 0x00020000
s_bitcmp0_b32 s2, 0
s_cbranch_scc0 fk_b
s_bfe_u32 s62, s2, 0x10001
s_lshl_b32 s62, s62, 2
s_bfe_u32 s44, s2, 0x20003
s_add_u32 s62, s62, s44
s_bfe_u32 s63, s2, 0x10002
s_lshl_b32 s63, s63, 3
s_lshr_b32 s44, s2, 5
s_add_u32 s63, s63, s44
s_mul_i32 s45, s63, 448
s_and_b32 s64, s63, 1
s_lshl_b32 s65, s64, 6
s_add_u32 s65, s65, s45
s_cmp_eq_u32 s64, 0
s_cselect_b32 s68, 384, 0
s_add_u32 s68, s68, s45
v_lshrrev_b32 v27, 7, v1
v_bfe_u32 v28, v1, 4, 3
v_and_b32 v29, 6, v27
v_xor_b32 v28, v28, v29
s_lshl_b32 s44, s3, 3
v_add_u32 v27, s44, v27
v_mul_u32_u24 v27, 7168, v27
v_lshl_add_u32 v30, v28, 4, v27
s_add_u32 s44, s65, 4096
v_add_u32 v2, s44, v30
s_add_u32 s44, s65, 3200
v_add_u32 v3, s44, v30
s_add_u32 s44, s65, 2304
v_add_u32 v4, s44, v30
v_lshrrev_b32 v27, 6, v1
v_bfe_u32 v28, v1, 4, 2
v_lshrrev_b32 v29, 7, v1
v_and_b32 v29, 2, v29
v_xor_b32 v28, v28, v29
s_lshl_b32 s44, s3, 3
v_add_u32 v27, s44, v27
v_mul_u32_u24 v27, 7168, v27
v_lshl_add_u32 v27, v28, 4, v27
v_lshrrev_b32 v28, 9, v1
v_lshlrev_b32 v28, 31, v28
v_or_b32 v30, v27, v28
s_add_u32 s44, s68, 1024
v_add_u32 v5, s44, v30
s_lshl_b32 s42, s3, 12
v_add_u32 v12, s42, v1
v_lshrrev_b32 v13, 8, v1
v_lshlrev_b32 v13, 3, v13
s_lshl_b32 s45, s62, 19
s_add_u32 s46, s48, s45
s_addc_u32 s47, s49, 0
s_mov_b32 s4, s46
s_and_b32 s5, s47, 0xffff
s_mov_b32 s6, 524288
s_mov_b32 s7, 0x00020000
buffer_load_dwordx2 a[0:1], v13, s[16:19], s65 offen offset:0
buffer_load_dwordx2 a[2:3], v13, s[16:19], s65 offen offset:32
buffer_load_dwordx2 a[4:5], v13, s[16:19], s65 offen offset:64
buffer_load_dwordx2 a[6:7], v13, s[16:19], s65 offen offset:96
buffer_load_dwordx2 a[8:9], v13, s[16:19], s65 offen offset:128
buffer_load_dwordx2 a[10:11], v13, s[16:19], s65 offen offset:160
buffer_load_dwordx2 a[12:13], v13, s[16:19], s65 offen offset:192
buffer_load_dwordx2 a[14:15], v13, s[16:19], s65 offen offset:224
buffer_load_dwordx2 a[16:17], v13, s[16:19], s65 offen offset:256
buffer_load_dwordx2 a[18:19], v13, s[16:19], s65 offen offset:288
buffer_load_dwordx2 a[20:21], v13, s[16:19], s65 offen offset:320
buffer_load_dwordx2 a[22:23], v13, s[16:19], s65 offen offset:352
buffer_load_dwordx2 a[24:25], v13, s[16:19], s68 offen offset:0
buffer_load_dwordx2 a[26:27], v13, s[16:19], s68 offen offset:32
v_lshrrev_b32 v27, 6, v1
v_and_b32 v27, 7, v27
v_lshrrev_b32 v28, 9, v1
v_mul_u32_u24 v28, 4096, v28
v_bfe_u32 v29, v1, 4, 2
v_lshl_add_u32 v28, v29, 3, v28
v_lshl_add_u32 v29, v27, 7, v28
v_lshrrev_b32 v30, 1, v27
v_xor_b32 v6, 0, v30
v_lshl_add_u32 v6, v6, 5, v29
v_xor_b32 v7, 1, v30
v_lshl_add_u32 v7, v7, 5, v29
v_xor_b32 v8, 2, v30
v_lshl_add_u32 v8, v8, 5, v29
v_xor_b32 v9, 3, v30
v_lshl_add_u32 v9, v9, 5, v29
v_lshl_add_u32 v29, v27, 6, v28
v_lshrrev_b32 v30, 2, v27
v_xor_b32 v10, 0, v30
v_lshl_add_u32 v10, v10, 5, v29
v_xor_b32 v11, 1, v30
v_lshl_add_u32 v11, v11, 5, v29
v_add_u32 v18, 65536, v6
v_add_u32 v19, 65536, v7
v_add_u32 v20, 65536, v8
v_add_u32 v21, 65536, v9
v_add_u32 v22, 65536, v10
v_add_u32 v23, 65536, v11
s_mul_i32 s44, s62, 112
s_mul_i32 s45, s63, 7
s_add_u32 s44, s44, s45
s_add_u32 s96, s44, s64
s_cmp_eq_u32 s64, 0
s_cselect_b32 s97, 6, 0
s_add_u32 s97, s97, s44
s_lshl_b32 s96, s96, 14
s_add_u32 s96, s96, 20971520
s_lshl_b32 s97, s97, 14
s_add_u32 s97, s97, 20971520
s_lshl_b32 s98, s62, 2
s_add_u32 s98, s98, s3
s_lshl_b32 s98, s98, 4
s_add_u32 s98, s98, s63
s_lshr_b32 s44, s98, 5
s_mul_i32 s44, s44, 4352
s_and_b32 s98, s98, 31
s_lshl_b32 s98, s98, 2
s_add_u32 s98, s98, s44
s_add_u32 s98, s98, 36175872
s_add_u32 m0, s42, 0
s_nop 0
buffer_load_dwordx4 v2, s[8:11], s41 offen offset:0 lds
buffer_load_dwordx4 v3, s[8:11], s41 offen offset:1024 lds
buffer_load_dwordx4 v4, s[8:11], s41 offen offset:2048 lds
buffer_load_dwordx4 v5, s[8:11], s41 offen offset:3072 lds
s_add_u32 m0, s42, 16384
s_add_u32 s41, s41, 229376
buffer_load_dwordx4 v2, s[8:11], s41 offen offset:0 lds
buffer_load_dwordx4 v3, s[8:11], s41 offen offset:1024 lds
buffer_load_dwordx4 v4, s[8:11], s41 offen offset:2048 lds
buffer_load_dwordx4 v5, s[8:11], s41 offen offset:3072 lds
s_add_u32 m0, s42, 32768
s_add_u32 s41, s41, 229376
buffer_load_dwordx4 v2, s[8:11], s41 offen offset:0 lds
buffer_load_dwordx4 v3, s[8:11], s41 offen offset:1024 lds
buffer_load_dwordx4 v4, s[8:11], s41 offen offset:2048 lds
buffer_load_dwordx4 v5, s[8:11], s41 offen offset:3072 lds
s_add_u32 m0, s42, 49152
s_add_u32 s41, s41, 229376
buffer_load_dwordx4 v2, s[8:11], s41 offen offset:0 lds
buffer_load_dwordx4 v3, s[8:11], s41 offen offset:1024 lds
buffer_load_dwordx4 v4, s[8:11], s41 offen offset:2048 lds
buffer_load_dwordx4 v5, s[8:11], s41 offen offset:3072 lds
s_add_u32 s41, s41, 229376
s_waitcnt vmcnt(16)
v_accvgpr_read_b32 v45, a0
v_accvgpr_read_b32 v47, a1
v_lshlrev_b32 v44, 16, v45
v_lshlrev_b32 v46, 16, v47
v_and_b32 v45, s90, v45
v_and_b32 v47, s90, v47
v_accvgpr_read_b32 v61, a2
v_accvgpr_read_b32 v63, a3
v_lshlrev_b32 v60, 16, v61
PG1:
s_cbranch_execz PG5
v_lshlrev_b32 v62, 16, v63
v_and_b32 v61, s90, v61
v_and_b32 v63, s90, v63
v_accvgpr_read_b32 v77, a4
v_accvgpr_read_b32 v79, a5
v_lshlrev_b32 v76, 16, v77
v_lshlrev_b32 v78, 16, v79
v_and_b32 v77, s90, v77
v_and_b32 v79, s90, v79
v_accvgpr_read_b32 v93, a6
v_accvgpr_read_b32 v95, a7
v_lshlrev_b32 v92, 16, v93
v_lshlrev_b32 v94, 16, v95
v_and_b32 v93, s90, v93
v_and_b32 v95, s90, v95
v_accvgpr_read_b32 v109, a8
v_accvgpr_read_b32 v111, a9
v_lshlrev_b32 v108, 16, v109
v_lshlrev_b32 v110, 16, v111
v_and_b32 v109, s90, v109
v_and_b32 v111, s90, v111
v_accvgpr_read_b32 v125, a10
v_accvgpr_read_b32 v127, a11
v_lshlrev_b32 v124, 16, v125
v_lshlrev_b32 v126, 16, v127
v_and_b32 v125, s90, v125
v_and_b32 v127, s90, v127
v_accvgpr_read_b32 v141, a12
v_accvgpr_read_b32 v143, a13
v_lshlrev_b32 v140, 16, v141
v_lshlrev_b32 v142, 16, v143
v_and_b32 v141, s90, v141
v_and_b32 v143, s90, v143
v_accvgpr_read_b32 v157, a14
v_accvgpr_read_b32 v159, a15
v_lshlrev_b32 v156, 16, v157
v_lshlrev_b32 v158, 16, v159
v_and_b32 v157, s90, v157
v_and_b32 v159, s90, v159
v_accvgpr_read_b32 v173, a16
v_accvgpr_read_b32 v175, a17
v_lshlrev_b32 v172, 16, v173
v_lshlrev_b32 v174, 16, v175
v_and_b32 v173, s90, v173
v_and_b32 v175, s90, v175
v_accvgpr_read_b32 v189, a18
v_accvgpr_read_b32 v191, a19
v_lshlrev_b32 v188, 16, v189
v_lshlrev_b32 v190, 16, v191
v_and_b32 v189, s90, v189
v_and_b32 v191, s90, v191
v_accvgpr_read_b32 v205, a20
v_accvgpr_read_b32 v207, a21
v_lshlrev_b32 v204, 16, v205
v_lshlrev_b32 v206, 16, v207
v_and_b32 v205, s90, v205
v_and_b32 v207, s90, v207
v_accvgpr_read_b32 v221, a22
v_accvgpr_read_b32 v223, a23
v_lshlrev_b32 v220, 16, v221
v_lshlrev_b32 v222, 16, v223
v_and_b32 v221, s90, v221
v_and_b32 v223, s90, v223
v_accvgpr_read_b32 v237, a24
v_accvgpr_read_b32 v239, a25
v_lshlrev_b32 v236, 16, v237
v_lshlrev_b32 v238, 16, v239
v_and_b32 v237, s90, v237
v_and_b32 v239, s90, v239
v_accvgpr_read_b32 v253, a26
v_accvgpr_read_b32 v255, a27
v_lshlrev_b32 v252, 16, v253
v_lshlrev_b32 v254, 16, v255
v_and_b32 v253, s90, v253
v_and_b32 v255, s90, v255
s_waitcnt vmcnt(8)
s_barrier
ds_read_b64_tr_b16 a[0:1], v6 offset:0
ds_read_b64_tr_b16 a[2:3], v6 offset:8192
ds_read_b64_tr_b16 a[4:5], v6 offset:16384
ds_read_b64_tr_b16 a[6:7], v6 offset:24576
ds_read_b64_tr_b16 a[8:9], v7 offset:0
ds_read_b64_tr_b16 a[10:11], v7 offset:8192
ds_read_b64_tr_b16 a[12:13], v7 offset:16384
ds_read_b64_tr_b16 a[14:15], v7 offset:24576
ds_read_b64_tr_b16 a[16:17], v8 offset:0
ds_read_b64_tr_b16 a[18:19], v8 offset:8192
ds_read_b64_tr_b16 a[20:21], v8 offset:16384
ds_read_b64_tr_b16 a[22:23], v8 offset:24576
ds_read_b64_tr_b16 a[24:25], v9 offset:0
ds_read_b64_tr_b16 a[26:27], v9 offset:8192
ds_read_b64_tr_b16 a[28:29], v9 offset:16384
ds_read_b64_tr_b16 a[30:31], v9 offset:24576
ds_read_b64_tr_b16 a[32:33], v6 offset:1024
ds_read_b64_tr_b16 a[34:35], v6 offset:9216
ds_read_b64_tr_b16 a[36:37], v6 offset:17408
ds_read_b64_tr_b16 a[38:39], v6 offset:25600
ds_read_b64_tr_b16 a[40:41], v7 offset:1024
ds_read_b64_tr_b16 a[42:43], v7 offset:9216
ds_read_b64_tr_b16 a[44:45], v7 offset:17408
ds_read_b64_tr_b16 a[46:47], v7 offset:25600
ds_read_b64_tr_b16 a[48:49], v8 offset:1024
ds_read_b64_tr_b16 a[50:51], v8 offset:9216
ds_read_b64_tr_b16 a[52:53], v8 offset:17408
ds_read_b64_tr_b16 a[54:55], v8 offset:25600
s_lshr_b32 s46, s62, 1
s_and_b32 s47, s62, 1
s_sub_u32 s45, s47, 1
s_sub_u32 s47, 0, s47
s_cmp_lg_u32 s3, 0
s_cbranch_scc1 fk_lna_lf_ok
s_lshr_b32 s44, s2, 5
s_lshl_b32 s44, s44, 2
s_add_u32 s44, s44, s46
s_mul_i32 s44, s44, 4352
s_add_u32 s44, s44, 36558848
s_mov_b32 s84, s45
s_mov_b32 s85, s47
s_mov_b32 s86, 0
s_branch fk_lna_lf_ld
fk_lna_lf_chk:
v_cmp_eq_u32 vcc, v26, v0
s_nop 1
s_andn2_b64 s[88:89], s[84:85], vcc
s_cbranch_scc0 fk_lna_lf_ok
s_add_u32 s86, s86, 1
s_cmp_gt_u32 s86, 0x8000
s_cbranch_scc1 fk_lna_lf_ok
s_sleep 0
fk_lna_lf_ld:
buffer_load_dword v0, v24, s[12:15], s44 offen sc1
s_waitcnt vmcnt(0)
s_branch fk_lna_lf_chk
fk_lna_lf_ok:
s_barrier
s_mov_b32 s85, 0
s_nop 0
buffer_load_dwordx4 a[112:115], v12, s[4:7], s40 offen offset:0 sc1
buffer_load_dwordx4 a[116:119], v12, s[4:7], s40 offen offset:1024 sc1
buffer_load_dwordx4 a[120:123], v12, s[4:7], s40 offen offset:2048 sc1
buffer_load_dwordx4 a[124:127], v12, s[4:7], s40 offen offset:3072 sc1
s_add_u32 s40, s40, 16384
buffer_load_dwordx4 a[128:131], v12, s[4:7], s40 offen offset:0 sc1
buffer_load_dwordx4 a[132:135], v12, s[4:7], s40 offen offset:1024 sc1
buffer_load_dwordx4 a[136:139], v12, s[4:7], s40 offen offset:2048 sc1
buffer_load_dwordx4 a[140:143], v12, s[4:7], s40 offen offset:3072 sc1
s_add_u32 s40, s40, 16384
s_nop 0
buffer_load_dwordx4 a[144:147], v12, s[4:7], s40 offen offset:0 sc1
buffer_load_dwordx4 a[148:151], v12, s[4:7], s40 offen offset:1024 sc1
buffer_load_dwordx4 a[152:155], v12, s[4:7], s40 offen offset:2048 sc1
buffer_load_dwordx4 a[156:159], v12, s[4:7], s40 offen offset:3072 sc1
s_add_u32 s40, s40, 16384
buffer_load_dwordx4 a[160:163], v12, s[4:7], s40 offen offset:0 sc1
buffer_load_dwordx4 a[164:167], v12, s[4:7], s40 offen offset:1024 sc1
buffer_load_dwordx4 a[168:171], v12, s[4:7], s40 offen offset:2048 sc1
buffer_load_dwordx4 a[172:175], v12, s[4:7], s40 offen offset:3072 sc1
s_add_u32 s40, s40, 16384
s_add_u32 m0, s42, 65536
s_nop 0
buffer_load_dwordx4 v2, s[8:11], s41 offen offset:0 lds
buffer_load_dwordx4 v3, s[8:11], s41 offen offset:1024 lds
buffer_load_dwordx4 v4, s[8:11], s41 offen offset:2048 lds
buffer_load_dwordx4 v5, s[8:11], s41 offen offset:3072 lds
s_add_u32 m0, s42, 81920
s_add_u32 s41, s41, 229376
buffer_load_dwordx4 v2, s[8:11], s41 offen offset:0 lds
buffer_load_dwordx4 v3, s[8:11], s41 offen offset:1024 lds
buffer_load_dwordx4 v4, s[8:11], s41 offen offset:2048 lds
buffer_load_dwordx4 v5, s[8:11], s41 offen offset:3072 lds
s_add_u32 s41, s41, 229376
s_add_u32 s99, s98, 174080
s_add_u32 s100, s82, 174080
s_waitcnt vmcnt(16) lgkmcnt(0)
v_mfma_f32_16x16x32_bf16 v[32:35], a[0:3], a[112:115], v[44:47]
ds_read_b64_tr_b16 a[56:57], v9 offset:1024
v_mfma_f32_16x16x32_bf16 v[32:35], a[4:7], a[128:131], v[32:35]
buffer_load_dwordx4 a[176:179], v12, s[4:7], s40 offen offset:0 sc1
v_mfma_f32_16x16x32_bf16 v[36:39], a[0:3], a[116:119], v[44:47]
ds_read_b64_tr_b16 a[58:59], v9 offset:9216
v_mfma_f32_16x16x32_bf16 v[36:39], a[4:7], a[132:135], v[36:39]
ds_read_b64_tr_b16 a[60:61], v9 offset:17408
v_mfma_f32_16x16x32_bf16 v[40:43], a[0:3], a[120:123], v[44:47]
v_mfma_f32_16x16x32_bf16 v[40:43], a[4:7], a[136:139], v[40:43]
buffer_load_dwordx4 a[180:183], v12, s[4:7], s40 offen offset:1024 sc1
v_mfma_f32_16x16x32_bf16 v[44:47], a[0:3], a[124:127], v[44:47]
ds_read_b64_tr_b16 a[62:63], v9 offset:25600
v_mfma_f32_16x16x32_bf16 v[44:47], a[4:7], a[140:143], v[44:47]
ds_read_b64_tr_b16 a[64:65], v6 offset:2048
v_mfma_f32_16x16x32_bf16 v[48:51], a[8:11], a[112:115], v[60:63]
buffer_load_dwordx4 a[184:187], v12, s[4:7], s40 offen offset:2048 sc1
v_mfma_f32_16x16x32_bf16 v[48:51], a[12:15], a[128:131], v[48:51]
v_mfma_f32_16x16x32_bf16 v[52:55], a[8:11], a[116:119], v[60:63]
ds_read_b64_tr_b16 a[66:67], v6 offset:10240
v_mfma_f32_16x16x32_bf16 v[52:55], a[12:15], a[132:135], v[52:55]
ds_read_b64_tr_b16 a[68:69], v6 offset:18432
v_mfma_f32_16x16x32_bf16 v[56:59], a[8:11], a[120:123], v[60:63]
ds_read_b64_tr_b16 a[70:71], v6 offset:26624
v_mfma_f32_16x16x32_bf16 v[56:59], a[12:15], a[136:139], v[56:59]
buffer_load_dwordx4 a[188:191], v12, s[4:7], s40 offen offset:3072 sc1
s_add_u32 s40, s40, 16384
v_mfma_f32_16x16x32_bf16 v[60:63], a[8:11], a[124:127], v[60:63]
v_mfma_f32_16x16x32_bf16 v[60:63], a[12:15], a[140:143], v[60:63]
ds_read_b64_tr_b16 a[72:73], v7 offset:2048
v_mfma_f32_16x16x32_bf16 v[64:67], a[16:19], a[112:115], v[76:79]
ds_read_b64_tr_b16 a[74:75], v7 offset:10240
v_mfma_f32_16x16x32_bf16 v[64:67], a[20:23], a[128:131], v[64:67]
buffer_load_dwordx4 a[192:195], v12, s[4:7], s40 offen offset:0 sc1
v_mfma_f32_16x16x32_bf16 v[68:71], a[16:19], a[116:119], v[76:79]
ds_read_b64_tr_b16 a[76:77], v7 offset:18432
v_mfma_f32_16x16x32_bf16 v[68:71], a[20:23], a[132:135], v[68:71]
v_mfma_f32_16x16x32_bf16 v[72:75], a[16:19], a[120:123], v[76:79]
ds_read_b64_tr_b16 a[78:79], v7 offset:26624
v_mfma_f32_16x16x32_bf16 v[72:75], a[20:23], a[136:139], v[72:75]
buffer_load_dwordx4 a[196:199], v12, s[4:7], s40 offen offset:1024 sc1
v_mfma_f32_16x16x32_bf16 v[76:79], a[16:19], a[124:127], v[76:79]
ds_read_b64_tr_b16 a[80:81], v8 offset:2048
v_mfma_f32_16x16x32_bf16 v[76:79], a[20:23], a[140:143], v[76:79]
ds_read_b64_tr_b16 a[82:83], v8 offset:10240
v_mfma_f32_16x16x32_bf16 v[80:83], a[24:27], a[112:115], v[92:95]
v_mfma_f32_16x16x32_bf16 v[80:83], a[28:31], a[128:131], v[80:83]
ds_read_b64_tr_b16 a[84:85], v8 offset:18432
v_mfma_f32_16x16x32_bf16 v[84:87], a[24:27], a[116:119], v[92:95]
buffer_load_dwordx4 a[200:203], v12, s[4:7], s40 offen offset:2048 sc1
v_mfma_f32_16x16x32_bf16 v[84:87], a[28:31], a[132:135], v[84:87]
ds_read_b64_tr_b16 a[86:87], v8 offset:26624
v_mfma_f32_16x16x32_bf16 v[88:91], a[24:27], a[120:123], v[92:95]
ds_read_b64_tr_b16 a[88:89], v9 offset:2048
v_mfma_f32_16x16x32_bf16 v[88:91], a[28:31], a[136:139], v[88:91]
v_mfma_f32_16x16x32_bf16 v[92:95], a[24:27], a[124:127], v[92:95]
buffer_load_dwordx4 a[204:207], v12, s[4:7], s40 offen offset:3072 sc1
s_add_u32 s40, s40, 16384
v_mfma_f32_16x16x32_bf16 v[92:95], a[28:31], a[140:143], v[92:95]
ds_read_b64_tr_b16 a[90:91], v9 offset:10240
v_mfma_f32_16x16x32_bf16 v[96:99], a[32:35], a[112:115], v[108:111]
ds_read_b64_tr_b16 a[92:93], v9 offset:18432
v_mfma_f32_16x16x32_bf16 v[96:99], a[36:39], a[128:131], v[96:99]
buffer_load_dwordx4 a[208:211], v12, s[4:7], s40 offen offset:0 sc1
v_mfma_f32_16x16x32_bf16 v[100:103], a[32:35], a[116:119], v[108:111]
v_mfma_f32_16x16x32_bf16 v[100:103], a[36:39], a[132:135], v[100:103]
ds_read_b64_tr_b16 a[94:95], v9 offset:26624
v_mfma_f32_16x16x32_bf16 v[104:107], a[32:35], a[120:123], v[108:111]
ds_read_b64_tr_b16 a[96:97], v10 offset:3072
v_mfma_f32_16x16x32_bf16 v[104:107], a[36:39], a[136:139], v[104:107]
ds_read_b64_tr_b16 a[98:99], v10 offset:11264
v_mfma_f32_16x16x32_bf16 v[108:111], a[32:35], a[124:127], v[108:111]
buffer_load_dwordx4 a[212:215], v12, s[4:7], s40 offen offset:1024 sc1
v_mfma_f32_16x16x32_bf16 v[108:111], a[36:39], a[140:143], v[108:111]
v_mfma_f32_16x16x32_bf16 v[112:115], a[40:43], a[112:115], v[124:127]
ds_read_b64_tr_b16 a[100:101], v10 offset:19456
v_mfma_f32_16x16x32_bf16 v[112:115], a[44:47], a[128:131], v[112:115]
ds_read_b64_tr_b16 a[102:103], v10 offset:27648
v_mfma_f32_16x16x32_bf16 v[116:119], a[40:43], a[116:119], v[124:127]
buffer_load_dwordx4 a[216:219], v12, s[4:7], s40 offen offset:2048 sc1
v_mfma_f32_16x16x32_bf16 v[116:119], a[44:47], a[132:135], v[116:119]
ds_read_b64_tr_b16 a[104:105], v11 offset:3072
v_mfma_f32_16x16x32_bf16 v[120:123], a[40:43], a[120:123], v[124:127]
v_mfma_f32_16x16x32_bf16 v[120:123], a[44:47], a[136:139], v[120:123]
ds_read_b64_tr_b16 a[106:107], v11 offset:11264
v_mfma_f32_16x16x32_bf16 v[124:127], a[40:43], a[124:127], v[124:127]
buffer_load_dwordx4 a[220:223], v12, s[4:7], s40 offen offset:3072 sc1
s_add_u32 s40, s40, 16384
v_mfma_f32_16x16x32_bf16 v[124:127], a[44:47], a[140:143], v[124:127]
ds_read_b64_tr_b16 a[108:109], v11 offset:19456
v_mfma_f32_16x16x32_bf16 v[128:131], a[48:51], a[112:115], v[140:143]
ds_read_b64_tr_b16 a[110:111], v11 offset:27648
v_mfma_f32_16x16x32_bf16 v[128:131], a[52:55], a[128:131], v[128:131]
v_mfma_f32_16x16x32_bf16 v[132:135], a[48:51], a[116:119], v[140:143]
v_mfma_f32_16x16x32_bf16 v[132:135], a[52:55], a[132:135], v[132:135]
v_mfma_f32_16x16x32_bf16 v[136:139], a[48:51], a[120:123], v[140:143]
v_mfma_f32_16x16x32_bf16 v[136:139], a[52:55], a[136:139], v[136:139]
v_mfma_f32_16x16x32_bf16 v[140:143], a[48:51], a[124:127], v[140:143]
v_mfma_f32_16x16x32_bf16 v[140:143], a[52:55], a[140:143], v[140:143]
s_waitcnt lgkmcnt(0)
v_mfma_f32_16x16x32_bf16 v[144:147], a[56:59], a[112:115], v[156:159]
v_mfma_f32_16x16x32_bf16 v[144:147], a[60:63], a[128:131], v[144:147]
s_barrier
v_mfma_f32_16x16x32_bf16 v[148:151], a[56:59], a[116:119], v[156:159]
ds_read_b64_tr_b16 a[0:1], v6 offset:32768
s_add_u32 m0, s42, 98304
v_mfma_f32_16x16x32_bf16 v[148:151], a[60:63], a[132:135], v[148:151]
buffer_load_dwordx4 v2, s[8:11], s41 offen offset:0 lds
v_mfma_f32_16x16x32_bf16 v[152:155], a[56:59], a[120:123], v[156:159]
ds_read_b64_tr_b16 a[2:3], v6 offset:40960
v_mfma_f32_16x16x32_bf16 v[152:155], a[60:63], a[136:139], v[152:155]
ds_read_b64_tr_b16 a[4:5], v6 offset:49152
v_mfma_f32_16x16x32_bf16 v[156:159], a[56:59], a[124:127], v[156:159]
buffer_load_dwordx4 v3, s[8:11], s41 offen offset:1024 lds
v_mfma_f32_16x16x32_bf16 v[156:159], a[60:63], a[140:143], v[156:159]
v_mfma_f32_16x16x32_bf16 v[160:163], a[64:67], a[112:115], v[172:175]
ds_read_b64_tr_b16 a[6:7], v6 offset:57344
v_mfma_f32_16x16x32_bf16 v[160:163], a[68:71], a[128:131], v[160:163]
ds_read_b64_tr_b16 a[8:9], v7 offset:32768
v_mfma_f32_16x16x32_bf16 v[164:167], a[64:67], a[116:119], v[172:175]
buffer_load_dwordx4 v4, s[8:11], s41 offen offset:2048 lds
v_mfma_f32_16x16x32_bf16 v[164:167], a[68:71], a[132:135], v[164:167]
ds_read_b64_tr_b16 a[10:11], v7 offset:40960
v_mfma_f32_16x16x32_bf16 v[168:171], a[64:67], a[120:123], v[172:175]
ds_read_b64_tr_b16 a[12:13], v7 offset:49152
v_mfma_f32_16x16x32_bf16 v[168:171], a[68:71], a[136:139], v[168:171]
v_mfma_f32_16x16x32_bf16 v[172:175], a[64:67], a[124:127], v[172:175]
ds_read_b64_tr_b16 a[14:15], v7 offset:57344
v_mfma_f32_16x16x32_bf16 v[172:175], a[68:71], a[140:143], v[172:175]
buffer_load_dwordx4 v5, s[8:11], s41 offen offset:3072 lds
s_add_u32 s41, s41, 229376
v_mfma_f32_16x16x32_bf16 v[176:179], a[72:75], a[112:115], v[188:191]
ds_read_b64_tr_b16 a[16:17], v8 offset:32768
v_mfma_f32_16x16x32_bf16 v[176:179], a[76:79], a[128:131], v[176:179]
ds_read_b64_tr_b16 a[18:19], v8 offset:40960
s_add_u32 m0, s42, 114688
v_mfma_f32_16x16x32_bf16 v[180:183], a[72:75], a[116:119], v[188:191]
buffer_load_dwordx4 v2, s[8:11], s41 offen offset:0 lds
v_mfma_f32_16x16x32_bf16 v[180:183], a[76:79], a[132:135], v[180:183]
v_mfma_f32_16x16x32_bf16 v[184:187], a[72:75], a[120:123], v[188:191]
ds_read_b64_tr_b16 a[20:21], v8 offset:49152
v_mfma_f32_16x16x32_bf16 v[184:187], a[76:79], a[136:139], v[184:187]
ds_read_b64_tr_b16 a[22:23], v8 offset:57344
v_mfma_f32_16x16x32_bf16 v[188:191], a[72:75], a[124:127], v[188:191]
buffer_load_dwordx4 v3, s[8:11], s41 offen offset:1024 lds
v_mfma_f32_16x16x32_bf16 v[188:191], a[76:79], a[140:143], v[188:191]
ds_read_b64_tr_b16 a[24:25], v9 offset:32768
v_mfma_f32_16x16x32_bf16 v[192:195], a[80:83], a[112:115], v[204:207]
ds_read_b64_tr_b16 a[26:27], v9 offset:40960
v_mfma_f32_16x16x32_bf16 v[192:195], a[84:87], a[128:131], v[192:195]
v_mfma_f32_16x16x32_bf16 v[196:199], a[80:83], a[116:119], v[204:207]
ds_read_b64_tr_b16 a[28:29], v9 offset:49152
v_mfma_f32_16x16x32_bf16 v[196:199], a[84:87], a[132:135], v[196:199]
buffer_load_dwordx4 v4, s[8:11], s41 offen offset:2048 lds
v_mfma_f32_16x16x32_bf16 v[200:203], a[80:83], a[120:123], v[204:207]
ds_read_b64_tr_b16 a[30:31], v9 offset:57344
v_mfma_f32_16x16x32_bf16 v[200:203], a[84:87], a[136:139], v[200:203]
ds_read_b64_tr_b16 a[32:33], v6 offset:33792
v_mfma_f32_16x16x32_bf16 v[204:207], a[80:83], a[124:127], v[204:207]
buffer_load_dwordx4 v5, s[8:11], s41 offen offset:3072 lds
s_add_u32 s41, s41, 229376
v_mfma_f32_16x16x32_bf16 v[204:207], a[84:87], a[140:143], v[204:207]
v_mfma_f32_16x16x32_bf16 v[208:211], a[88:91], a[112:115], v[220:223]
ds_read_b64_tr_b16 a[34:35], v6 offset:41984
v_mfma_f32_16x16x32_bf16 v[208:211], a[92:95], a[128:131], v[208:211]
ds_read_b64_tr_b16 a[36:37], v6 offset:50176
s_add_u32 m0, s42, 0
v_mfma_f32_16x16x32_bf16 v[212:215], a[88:91], a[116:119], v[220:223]
buffer_load_dwordx4 v2, s[8:11], s41 offen offset:0 lds
v_mfma_f32_16x16x32_bf16 v[212:215], a[92:95], a[132:135], v[212:215]
ds_read_b64_tr_b16 a[38:39], v6 offset:58368
v_mfma_f32_16x16x32_bf16 v[216:219], a[88:91], a[120:123], v[220:223]
ds_read_b64_tr_b16 a[40:41], v7 offset:33792
v_mfma_f32_16x16x32_bf16 v[216:219], a[92:95], a[136:139], v[216:219]
v_mfma_f32_16x16x32_bf16 v[220:223], a[88:91], a[124:127], v[220:223]
ds_read_b64_tr_b16 a[42:43], v7 offset:41984
v_mfma_f32_16x16x32_bf16 v[220:223], a[92:95], a[140:143], v[220:223]
buffer_load_dwordx4 v3, s[8:11], s41 offen offset:1024 lds
v_mfma_f32_16x16x32_bf16 v[224:227], a[96:99], a[112:115], v[236:239]
ds_read_b64_tr_b16 a[44:45], v7 offset:50176
v_mfma_f32_16x16x32_bf16 v[224:227], a[100:103], a[128:131], v[224:227]
ds_read_b64_tr_b16 a[46:47], v7 offset:58368
v_mfma_f32_16x16x32_bf16 v[228:231], a[96:99], a[116:119], v[236:239]
buffer_load_dwordx4 v4, s[8:11], s41 offen offset:2048 lds
v_mfma_f32_16x16x32_bf16 v[228:231], a[100:103], a[132:135], v[228:231]
v_mfma_f32_16x16x32_bf16 v[232:235], a[96:99], a[120:123], v[236:239]
ds_read_b64_tr_b16 a[48:49], v8 offset:33792
v_mfma_f32_16x16x32_bf16 v[232:235], a[100:103], a[136:139], v[232:235]
ds_read_b64_tr_b16 a[50:51], v8 offset:41984
v_mfma_f32_16x16x32_bf16 v[236:239], a[96:99], a[124:127], v[236:239]
buffer_load_dwordx4 v5, s[8:11], s41 offen offset:3072 lds
s_add_u32 s41, s41, 229376
v_mfma_f32_16x16x32_bf16 v[236:239], a[100:103], a[140:143], v[236:239]
ds_read_b64_tr_b16 a[52:53], v8 offset:50176
v_mfma_f32_16x16x32_bf16 v[240:243], a[104:107], a[112:115], v[252:255]
ds_read_b64_tr_b16 a[54:55], v8 offset:58368
v_mfma_f32_16x16x32_bf16 v[240:243], a[108:111], a[128:131], v[240:243]
v_mfma_f32_16x16x32_bf16 v[244:247], a[104:107], a[116:119], v[252:255]
v_mfma_f32_16x16x32_bf16 v[244:247], a[108:111], a[132:135], v[244:247]
v_mfma_f32_16x16x32_bf16 v[248:251], a[104:107], a[120:123], v[252:255]
v_mfma_f32_16x16x32_bf16 v[248:251], a[108:111], a[136:139], v[248:251]
v_mfma_f32_16x16x32_bf16 v[252:255], a[104:107], a[124:127], v[252:255]
v_mfma_f32_16x16x32_bf16 v[252:255], a[108:111], a[140:143], v[252:255]
s_waitcnt vmcnt(32) lgkmcnt(0)
v_mfma_f32_16x16x32_bf16 v[32:35], a[0:3], a[144:147], v[32:35]
ds_read_b64_tr_b16 a[56:57], v9 offset:33792
v_mfma_f32_16x16x32_bf16 v[32:35], a[4:7], a[160:163], v[32:35]
buffer_load_dwordx4 a[224:227], v12, s[4:7], s40 offen offset:0 sc1
v_mfma_f32_16x16x32_bf16 v[36:39], a[4:7], a[164:167], v[36:39]
ds_read_b64_tr_b16 a[58:59], v9 offset:41984
v_mfma_f32_16x16x32_bf16 v[36:39], a[0:3], a[148:151], v[36:39]
ds_read_b64_tr_b16 a[60:61], v9 offset:50176
v_mfma_f32_16x16x32_bf16 v[40:43], a[0:3], a[152:155], v[40:43]
v_mfma_f32_16x16x32_bf16 v[40:43], a[4:7], a[168:171], v[40:43]
buffer_load_dwordx4 a[228:231], v12, s[4:7], s40 offen offset:1024 sc1
v_mfma_f32_16x16x32_bf16 v[44:47], a[4:7], a[172:175], v[44:47]
ds_read_b64_tr_b16 a[62:63], v9 offset:58368
v_mfma_f32_16x16x32_bf16 v[44:47], a[0:3], a[156:159], v[44:47]
ds_read_b64_tr_b16 a[64:65], v6 offset:34816
v_mfma_f32_16x16x32_bf16 v[48:51], a[8:11], a[144:147], v[48:51]
buffer_load_dwordx4 a[232:235], v12, s[4:7], s40 offen offset:2048 sc1
v_mfma_f32_16x16x32_bf16 v[48:51], a[12:15], a[160:163], v[48:51]
v_mfma_f32_16x16x32_bf16 v[52:55], a[12:15], a[164:167], v[52:55]
ds_read_b64_tr_b16 a[66:67], v6 offset:43008
v_mfma_f32_16x16x32_bf16 v[52:55], a[8:11], a[148:151], v[52:55]
ds_read_b64_tr_b16 a[68:69], v6 offset:51200
v_mfma_f32_16x16x32_bf16 v[56:59], a[8:11], a[152:155], v[56:59]
ds_read_b64_tr_b16 a[70:71], v6 offset:59392
v_mfma_f32_16x16x32_bf16 v[56:59], a[12:15], a[168:171], v[56:59]
buffer_load_dwordx4 a[236:239], v12, s[4:7], s40 offen offset:3072 sc1
s_add_u32 s40, s40, 16384
v_mfma_f32_16x16x32_bf16 v[60:63], a[12:15], a[172:175], v[60:63]
v_mfma_f32_16x16x32_bf16 v[60:63], a[8:11], a[156:159], v[60:63]
ds_read_b64_tr_b16 a[72:73], v7 offset:34816
v_mfma_f32_16x16x32_bf16 v[64:67], a[16:19], a[144:147], v[64:67]
ds_read_b64_tr_b16 a[74:75], v7 offset:43008
v_mfma_f32_16x16x32_bf16 v[64:67], a[20:23], a[160:163], v[64:67]
buffer_load_dwordx4 a[112:115], v12, s[4:7], s40 offen offset:0 sc1
v_mfma_f32_16x16x32_bf16 v[68:71], a[20:23], a[164:167], v[68:71]
ds_read_b64_tr_b16 a[76:77], v7 offset:51200
v_mfma_f32_16x16x32_bf16 v[68:71], a[16:19], a[148:151], v[68:71]
v_mfma_f32_16x16x32_bf16 v[72:75], a[16:19], a[152:155], v[72:75]
ds_read_b64_tr_b16 a[78:79], v7 offset:59392
v_mfma_f32_16x16x32_bf16 v[72:75], a[20:23], a[168:171], v[72:75]
buffer_load_dwordx4 a[116:119], v12, s[4:7], s40 offen offset:1024 sc1
v_mfma_f32_16x16x32_bf16 v[76:79], a[20:23], a[172:175], v[76:79]
ds_read_b64_tr_b16 a[80:81], v8 offset:34816
v_mfma_f32_16x16x32_bf16 v[76:79], a[16:19], a[156:159], v[76:79]
ds_read_b64_tr_b16 a[82:83], v8 offset:43008
v_mfma_f32_16x16x32_bf16 v[80:83], a[24:27], a[144:147], v[80:83]
v_mfma_f32_16x16x32_bf16 v[80:83], a[28:31], a[160:163], v[80:83]
ds_read_b64_tr_b16 a[84:85], v8 offset:51200
v_mfma_f32_16x16x32_bf16 v[84:87], a[28:31], a[164:167], v[84:87]
buffer_load_dwordx4 a[120:123], v12, s[4:7], s40 offen offset:2048 sc1
v_mfma_f32_16x16x32_bf16 v[84:87], a[24:27], a[148:151], v[84:87]
ds_read_b64_tr_b16 a[86:87], v8 offset:59392
v_mfma_f32_16x16x32_bf16 v[88:91], a[24:27], a[152:155], v[88:91]
ds_read_b64_tr_b16 a[88:89], v9 offset:34816
v_mfma_f32_16x16x32_bf16 v[88:91], a[28:31], a[168:171], v[88:91]
v_mfma_f32_16x16x32_bf16 v[92:95], a[28:31], a[172:175], v[92:95]
buffer_load_dwordx4 a[124:127], v12, s[4:7], s40 offen offset:3072 sc1
s_add_u32 s40, s40, 16384
v_mfma_f32_16x16x32_bf16 v[92:95], a[24:27], a[156:159], v[92:95]
ds_read_b64_tr_b16 a[90:91], v9 offset:43008
v_mfma_f32_16x16x32_bf16 v[96:99], a[32:35], a[144:147], v[96:99]
ds_read_b64_tr_b16 a[92:93], v9 offset:51200
v_mfma_f32_16x16x32_bf16 v[96:99], a[36:39], a[160:163], v[96:99]
buffer_load_dwordx4 a[128:131], v12, s[4:7], s40 offen offset:0 sc1
v_mfma_f32_16x16x32_bf16 v[100:103], a[36:39], a[164:167], v[100:103]
v_mfma_f32_16x16x32_bf16 v[100:103], a[32:35], a[148:151], v[100:103]
ds_read_b64_tr_b16 a[94:95], v9 offset:59392
v_mfma_f32_16x16x32_bf16 v[104:107], a[32:35], a[152:155], v[104:107]
ds_read_b64_tr_b16 a[96:97], v10 offset:35840
v_mfma_f32_16x16x32_bf16 v[104:107], a[36:39], a[168:171], v[104:107]
ds_read_b64_tr_b16 a[98:99], v10 offset:44032
v_mfma_f32_16x16x32_bf16 v[108:111], a[36:39], a[172:175], v[108:111]
buffer_load_dwordx4 a[132:135], v12, s[4:7], s40 offen offset:1024 sc1
v_mfma_f32_16x16x32_bf16 v[108:111], a[32:35], a[156:159], v[108:111]
v_mfma_f32_16x16x32_bf16 v[112:115], a[40:43], a[144:147], v[112:115]
ds_read_b64_tr_b16 a[100:101], v10 offset:52224
v_mfma_f32_16x16x32_bf16 v[112:115], a[44:47], a[160:163], v[112:115]
ds_read_b64_tr_b16 a[102:103], v10 offset:60416
v_mfma_f32_16x16x32_bf16 v[116:119], a[44:47], a[164:167], v[116:119]
buffer_load_dwordx4 a[136:139], v12, s[4:7], s40 offen offset:2048 sc1
v_mfma_f32_16x16x32_bf16 v[116:119], a[40:43], a[148:151], v[116:119]
ds_read_b64_tr_b16 a[104:105], v11 offset:35840
v_mfma_f32_16x16x32_bf16 v[120:123], a[40:43], a[152:155], v[120:123]
v_mfma_f32_16x16x32_bf16 v[120:123], a[44:47], a[168:171], v[120:123]
ds_read_b64_tr_b16 a[106:107], v11 offset:44032
v_mfma_f32_16x16x32_bf16 v[124:127], a[44:47], a[172:175], v[124:127]
buffer_load_dwordx4 a[140:143], v12, s[4:7], s40 offen offset:3072 sc1
s_add_u32 s40, s40, 16384
v_mfma_f32_16x16x32_bf16 v[124:127], a[40:43], a[156:159], v[124:127]
ds_read_b64_tr_b16 a[108:109], v11 offset:52224
v_mfma_f32_16x16x32_bf16 v[128:131], a[48:51], a[144:147], v[128:131]
ds_read_b64_tr_b16 a[110:111], v11 offset:60416
v_mfma_f32_16x16x32_bf16 v[128:131], a[52:55], a[160:163], v[128:131]
v_mfma_f32_16x16x32_bf16 v[132:135], a[52:55], a[164:167], v[132:135]
v_mfma_f32_16x16x32_bf16 v[132:135], a[48:51], a[148:151], v[132:135]
v_mfma_f32_16x16x32_bf16 v[136:139], a[48:51], a[152:155], v[136:139]
v_mfma_f32_16x16x32_bf16 v[136:139], a[52:55], a[168:171], v[136:139]
v_mfma_f32_16x16x32_bf16 v[140:143], a[52:55], a[172:175], v[140:143]
v_mfma_f32_16x16x32_bf16 v[140:143], a[48:51], a[156:159], v[140:143]
s_waitcnt vmcnt(36) lgkmcnt(0)
v_mfma_f32_16x16x32_bf16 v[144:147], a[56:59], a[144:147], v[144:147]
v_mfma_f32_16x16x32_bf16 v[144:147], a[60:63], a[160:163], v[144:147]
s_barrier
v_mfma_f32_16x16x32_bf16 v[148:151], a[60:63], a[164:167], v[148:151]
ds_read_b64_tr_b16 a[0:1], v18 offset:0
s_add_u32 m0, s42, 16384
v_mfma_f32_16x16x32_bf16 v[148:151], a[56:59], a[148:151], v[148:151]
buffer_load_dwordx4 v2, s[8:11], s41 offen offset:0 lds
v_mfma_f32_16x16x32_bf16 v[152:155], a[56:59], a[152:155], v[152:155]
ds_read_b64_tr_b16 a[2:3], v18 offset:8192
v_mfma_f32_16x16x32_bf16 v[152:155], a[60:63], a[168:171], v[152:155]
ds_read_b64_tr_b16 a[4:5], v18 offset:16384
v_mfma_f32_16x16x32_bf16 v[156:159], a[60:63], a[172:175], v[156:159]
buffer_load_dwordx4 v3, s[8:11], s41 offen offset:1024 lds
v_mfma_f32_16x16x32_bf16 v[156:159], a[56:59], a[156:159], v[156:159]
v_mfma_f32_16x16x32_bf16 v[160:163], a[64:67], a[144:147], v[160:163]
ds_read_b64_tr_b16 a[6:7], v18 offset:24576
v_mfma_f32_16x16x32_bf16 v[160:163], a[68:71], a[160:163], v[160:163]
ds_read_b64_tr_b16 a[8:9], v19 offset:0
v_mfma_f32_16x16x32_bf16 v[164:167], a[68:71], a[164:167], v[164:167]
buffer_load_dwordx4 v4, s[8:11], s41 offen offset:2048 lds
v_mfma_f32_16x16x32_bf16 v[164:167], a[64:67], a[148:151], v[164:167]
ds_read_b64_tr_b16 a[10:11], v19 offset:8192
v_mfma_f32_16x16x32_bf16 v[168:171], a[64:67], a[152:155], v[168:171]
ds_read_b64_tr_b16 a[12:13], v19 offset:16384
v_mfma_f32_16x16x32_bf16 v[168:171], a[68:71], a[168:171], v[168:171]
v_mfma_f32_16x16x32_bf16 v[172:175], a[68:71], a[172:175], v[172:175]
ds_read_b64_tr_b16 a[14:15], v19 offset:24576
v_mfma_f32_16x16x32_bf16 v[172:175], a[64:67], a[156:159], v[172:175]
buffer_load_dwordx4 v5, s[8:11], s41 offen offset:3072 lds
s_add_u32 s41, s41, 229376
v_mfma_f32_16x16x32_bf16 v[176:179], a[72:75], a[144:147], v[176:179]
ds_read_b64_tr_b16 a[16:17], v20 offset:0
v_mfma_f32_16x16x32_bf16 v[176:179], a[76:79], a[160:163], v[176:179]
ds_read_b64_tr_b16 a[18:19], v20 offset:8192
s_add_u32 m0, s42, 32768
v_mfma_f32_16x16x32_bf16 v[180:183], a[76:79], a[164:167], v[180:183]
buffer_load_dwordx4 v2, s[8:11], s41 offen offset:0 lds
v_mfma_f32_16x16x32_bf16 v[180:183], a[72:75], a[148:151], v[180:183]
v_mfma_f32_16x16x32_bf16 v[184:187], a[72:75], a[152:155], v[184:187]
ds_read_b64_tr_b16 a[20:21], v20 offset:16384
v_mfma_f32_16x16x32_bf16 v[184:187], a[76:79], a[168:171], v[184:187]
ds_read_b64_tr_b16 a[22:23], v20 offset:24576
v_mfma_f32_16x16x32_bf16 v[188:191], a[76:79], a[172:175], v[188:191]
buffer_load_dwordx4 v3, s[8:11], s41 offen offset:1024 lds
v_mfma_f32_16x16x32_bf16 v[188:191], a[72:75], a[156:159], v[188:191]
ds_read_b64_tr_b16 a[24:25], v21 offset:0
v_mfma_f32_16x16x32_bf16 v[192:195], a[80:83], a[144:147], v[192:195]
ds_read_b64_tr_b16 a[26:27], v21 offset:8192
v_mfma_f32_16x16x32_bf16 v[192:195], a[84:87], a[160:163], v[192:195]
v_mfma_f32_16x16x32_bf16 v[196:199], a[84:87], a[164:167], v[196:199]
ds_read_b64_tr_b16 a[28:29], v21 offset:16384
v_mfma_f32_16x16x32_bf16 v[196:199], a[80:83], a[148:151], v[196:199]
buffer_load_dwordx4 v4, s[8:11], s41 offen offset:2048 lds
v_mfma_f32_16x16x32_bf16 v[200:203], a[80:83], a[152:155], v[200:203]
ds_read_b64_tr_b16 a[30:31], v21 offset:24576
v_mfma_f32_16x16x32_bf16 v[200:203], a[84:87], a[168:171], v[200:203]
ds_read_b64_tr_b16 a[32:33], v18 offset:1024
v_mfma_f32_16x16x32_bf16 v[204:207], a[84:87], a[172:175], v[204:207]
buffer_load_dwordx4 v5, s[8:11], s41 offen offset:3072 lds
s_add_u32 s41, s41, 229376
v_mfma_f32_16x16x32_bf16 v[204:207], a[80:83], a[156:159], v[204:207]
v_mfma_f32_16x16x32_bf16 v[208:211], a[88:91], a[144:147], v[208:211]
ds_read_b64_tr_b16 a[34:35], v18 offset:9216
v_mfma_f32_16x16x32_bf16 v[208:211], a[92:95], a[160:163], v[208:211]
ds_read_b64_tr_b16 a[36:37], v18 offset:17408
s_add_u32 m0, s42, 49152
v_mfma_f32_16x16x32_bf16 v[212:215], a[92:95], a[164:167], v[212:215]
buffer_load_dwordx4 v2, s[8:11], s41 offen offset:0 lds
v_mfma_f32_16x16x32_bf16 v[212:215], a[88:91], a[148:151], v[212:215]
ds_read_b64_tr_b16 a[38:39], v18 offset:25600
v_mfma_f32_16x16x32_bf16 v[216:219], a[88:91], a[152:155], v[216:219]
ds_read_b64_tr_b16 a[40:41], v19 offset:1024
v_mfma_f32_16x16x32_bf16 v[216:219], a[92:95], a[168:171], v[216:219]
v_mfma_f32_16x16x32_bf16 v[220:223], a[92:95], a[172:175], v[220:223]
ds_read_b64_tr_b16 a[42:43], v19 offset:9216
v_mfma_f32_16x16x32_bf16 v[220:223], a[88:91], a[156:159], v[220:223]
buffer_load_dwordx4 v3, s[8:11], s41 offen offset:1024 lds
v_mfma_f32_16x16x32_bf16 v[224:227], a[96:99], a[144:147], v[224:227]
ds_read_b64_tr_b16 a[44:45], v19 offset:17408
PG2:
s_cbranch_execz PG6
v_mfma_f32_16x16x32_bf16 v[224:227], a[100:103], a[160:163], v[224:227]
ds_read_b64_tr_b16 a[46:47], v19 offset:25600
v_mfma_f32_16x16x32_bf16 v[228:231], a[100:103], a[164:167], v[228:231]
buffer_load_dwordx4 v4, s[8:11], s41 offen offset:2048 lds
v_mfma_f32_16x16x32_bf16 v[228:231], a[96:99], a[148:151], v[228:231]
v_mfma_f32_16x16x32_bf16 v[232:235], a[96:99], a[152:155], v[232:235]
ds_read_b64_tr_b16 a[48:49], v20 offset:1024
v_mfma_f32_16x16x32_bf16 v[232:235], a[100:103], a[168:171], v[232:235]
ds_read_b64_tr_b16 a[50:51], v20 offset:9216
v_mfma_f32_16x16x32_bf16 v[236:239], a[100:103], a[172:175], v[236:239]
buffer_load_dwordx4 v5, s[8:11], s41 offen offset:3072 lds
s_add_u32 s41, s41, 229376
v_mfma_f32_16x16x32_bf16 v[236:239], a[96:99], a[156:159], v[236:239]
ds_read_b64_tr_b16 a[52:53], v20 offset:17408
v_mfma_f32_16x16x32_bf16 v[240:243], a[104:107], a[144:147], v[240:243]
ds_read_b64_tr_b16 a[54:55], v20 offset:25600
v_mfma_f32_16x16x32_bf16 v[240:243], a[108:111], a[160:163], v[240:243]
v_mfma_f32_16x16x32_bf16 v[244:247], a[108:111], a[164:167], v[244:247]
v_mfma_f32_16x16x32_bf16 v[244:247], a[104:107], a[148:151], v[244:247]
v_mfma_f32_16x16x32_bf16 v[248:251], a[104:107], a[152:155], v[248:251]
v_mfma_f32_16x16x32_bf16 v[248:251], a[108:111], a[168:171], v[248:251]
v_mfma_f32_16x16x32_bf16 v[252:255], a[108:111], a[172:175], v[252:255]
v_mfma_f32_16x16x32_bf16 v[252:255], a[104:107], a[156:159], v[252:255]
s_waitcnt vmcnt(40) lgkmcnt(0)
v_mfma_f32_16x16x32_bf16 v[32:35], a[0:3], a[176:179], v[32:35]
ds_read_b64_tr_b16 a[56:57], v21 offset:1024
v_mfma_f32_16x16x32_bf16 v[32:35], a[4:7], a[192:195], v[32:35]
buffer_load_dwordx4 a[144:147], v12, s[4:7], s40 offen offset:0 sc1
v_mfma_f32_16x16x32_bf16 v[36:39], a[4:7], a[196:199], v[36:39]
ds_read_b64_tr_b16 a[58:59], v21 offset:9216
v_mfma_f32_16x16x32_bf16 v[36:39], a[0:3], a[180:183], v[36:39]
v_mfma_f32_16x16x32_bf16 v[40:43], a[0:3], a[184:187], v[40:43]
ds_read_b64_tr_b16 a[60:61], v21 offset:17408
v_mfma_f32_16x16x32_bf16 v[40:43], a[4:7], a[200:203], v[40:43]
ds_read_b64_tr_b16 a[62:63], v21 offset:25600
v_mfma_f32_16x16x32_bf16 v[44:47], a[4:7], a[204:207], v[44:47]
buffer_load_dwordx4 a[148:151], v12, s[4:7], s40 offen offset:1024 sc1
v_mfma_f32_16x16x32_bf16 v[44:47], a[0:3], a[188:191], v[44:47]
v_mfma_f32_16x16x32_bf16 v[48:51], a[8:11], a[176:179], v[48:51]
ds_read_b64_tr_b16 a[64:65], v18 offset:2048
v_mfma_f32_16x16x32_bf16 v[48:51], a[12:15], a[192:195], v[48:51]
ds_read_b64_tr_b16 a[66:67], v18 offset:10240
v_mfma_f32_16x16x32_bf16 v[52:55], a[12:15], a[196:199], v[52:55]
v_mfma_f32_16x16x32_bf16 v[52:55], a[8:11], a[180:183], v[52:55]
ds_read_b64_tr_b16 a[68:69], v18 offset:18432
v_mfma_f32_16x16x32_bf16 v[56:59], a[8:11], a[184:187], v[56:59]
ds_read_b64_tr_b16 a[70:71], v18 offset:26624
v_mfma_f32_16x16x32_bf16 v[56:59], a[12:15], a[200:203], v[56:59]
buffer_load_dwordx4 a[152:155], v12, s[4:7], s40 offen offset:2048 sc1
v_mfma_f32_16x16x32_bf16 v[60:63], a[12:15], a[204:207], v[60:63]
v_mfma_f32_16x16x32_bf16 v[60:63], a[8:11], a[188:191], v[60:63]
ds_read_b64_tr_b16 a[72:73], v19 offset:2048
v_mfma_f32_16x16x32_bf16 v[64:67], a[16:19], a[176:179], v[64:67]
ds_read_b64_tr_b16 a[74:75], v19 offset:10240
v_mfma_f32_16x16x32_bf16 v[64:67], a[20:23], a[192:195], v[64:67]
v_mfma_f32_16x16x32_bf16 v[68:71], a[20:23], a[196:199], v[68:71]
ds_read_b64_tr_b16 a[76:77], v19 offset:18432
v_mfma_f32_16x16x32_bf16 v[68:71], a[16:19], a[180:183], v[68:71]
buffer_load_dwordx4 a[156:159], v12, s[4:7], s40 offen offset:3072 sc1
s_add_u32 s40, s40, 16384
v_mfma_f32_16x16x32_bf16 v[72:75], a[16:19], a[184:187], v[72:75]
ds_read_b64_tr_b16 a[78:79], v19 offset:26624
v_mfma_f32_16x16x32_bf16 v[72:75], a[20:23], a[200:203], v[72:75]
v_mfma_f32_16x16x32_bf16 v[76:79], a[20:23], a[204:207], v[76:79]
ds_read_b64_tr_b16 a[80:81], v20 offset:2048
v_mfma_f32_16x16x32_bf16 v[76:79], a[16:19], a[188:191], v[76:79]
ds_read_b64_tr_b16 a[82:83], v20 offset:10240
v_mfma_f32_16x16x32_bf16 v[80:83], a[24:27], a[176:179], v[80:83]
v_mfma_f32_16x16x32_bf16 v[80:83], a[28:31], a[192:195], v[80:83]
ds_read_b64_tr_b16 a[84:85], v20 offset:18432
v_mfma_f32_16x16x32_bf16 v[84:87], a[28:31], a[196:199], v[84:87]
buffer_load_dwordx4 a[160:163], v12, s[4:7], s40 offen offset:0 sc1
v_mfma_f32_16x16x32_bf16 v[84:87], a[24:27], a[180:183], v[84:87]
ds_read_b64_tr_b16 a[86:87], v20 offset:26624
v_mfma_f32_16x16x32_bf16 v[88:91], a[24:27], a[184:187], v[88:91]
v_mfma_f32_16x16x32_bf16 v[88:91], a[28:31], a[200:203], v[88:91]
ds_read_b64_tr_b16 a[88:89], v21 offset:2048
v_mfma_f32_16x16x32_bf16 v[92:95], a[28:31], a[204:207], v[92:95]
ds_read_b64_tr_b16 a[90:91], v21 offset:10240
v_mfma_f32_16x16x32_bf16 v[92:95], a[24:27], a[188:191], v[92:95]
buffer_load_dwordx4 a[164:167], v12, s[4:7], s40 offen offset:1024 sc1
v_mfma_f32_16x16x32_bf16 v[96:99], a[32:35], a[176:179], v[96:99]
v_mfma_f32_16x16x32_bf16 v[96:99], a[36:39], a[192:195], v[96:99]
ds_read_b64_tr_b16 a[92:93], v21 offset:18432
v_mfma_f32_16x16x32_bf16 v[100:103], a[36:39], a[196:199], v[100:103]
ds_read_b64_tr_b16 a[94:95], v21 offset:26624
v_mfma_f32_16x16x32_bf16 v[100:103], a[32:35], a[180:183], v[100:103]
v_mfma_f32_16x16x32_bf16 v[104:107], a[32:35], a[184:187], v[104:107]
ds_read_b64_tr_b16 a[96:97], v22 offset:3072
v_mfma_f32_16x16x32_bf16 v[104:107], a[36:39], a[200:203], v[104:107]
ds_read_b64_tr_b16 a[98:99], v22 offset:11264
v_mfma_f32_16x16x32_bf16 v[108:111], a[36:39], a[204:207], v[108:111]
buffer_load_dwordx4 a[168:171], v12, s[4:7], s40 offen offset:2048 sc1
v_mfma_f32_16x16x32_bf16 v[108:111], a[32:35], a[188:191], v[108:111]
v_mfma_f32_16x16x32_bf16 v[112:115], a[40:43], a[176:179], v[112:115]
ds_read_b64_tr_b16 a[100:101], v22 offset:19456
v_mfma_f32_16x16x32_bf16 v[112:115], a[44:47], a[192:195], v[112:115]
ds_read_b64_tr_b16 a[102:103], v22 offset:27648
v_mfma_f32_16x16x32_bf16 v[116:119], a[44:47], a[196:199], v[116:119]
v_mfma_f32_16x16x32_bf16 v[116:119], a[40:43], a[180:183], v[116:119]
ds_read_b64_tr_b16 a[104:105], v23 offset:3072
v_mfma_f32_16x16x32_bf16 v[120:123], a[40:43], a[184:187], v[120:123]
buffer_load_dwordx4 a[172:175], v12, s[4:7], s40 offen offset:3072 sc1
s_add_u32 s40, s40, 16384
v_mfma_f32_16x16x32_bf16 v[120:123], a[44:47], a[200:203], v[120:123]
ds_read_b64_tr_b16 a[106:107], v23 offset:11264
v_mfma_f32_16x16x32_bf16 v[124:127], a[44:47], a[204:207], v[124:127]
v_mfma_f32_16x16x32_bf16 v[124:127], a[40:43], a[188:191], v[124:127]
ds_read_b64_tr_b16 a[108:109], v23 offset:19456
v_mfma_f32_16x16x32_bf16 v[128:131], a[48:51], a[176:179], v[128:131]
ds_read_b64_tr_b16 a[110:111], v23 offset:27648
v_mfma_f32_16x16x32_bf16 v[128:131], a[52:55], a[192:195], v[128:131]
v_mfma_f32_16x16x32_bf16 v[132:135], a[52:55], a[196:199], v[132:135]
v_mfma_f32_16x16x32_bf16 v[132:135], a[48:51], a[180:183], v[132:135]
v_mfma_f32_16x16x32_bf16 v[136:139], a[48:51], a[184:187], v[136:139]
v_mfma_f32_16x16x32_bf16 v[136:139], a[52:55], a[200:203], v[136:139]
v_mfma_f32_16x16x32_bf16 v[140:143], a[52:55], a[204:207], v[140:143]
v_mfma_f32_16x16x32_bf16 v[140:143], a[48:51], a[188:191], v[140:143]
s_waitcnt vmcnt(36) lgkmcnt(0)
v_mfma_f32_16x16x32_bf16 v[144:147], a[56:59], a[176:179], v[144:147]
v_mfma_f32_16x16x32_bf16 v[144:147], a[60:63], a[192:195], v[144:147]
s_barrier
v_mfma_f32_16x16x32_bf16 v[148:151], a[60:63], a[196:199], v[148:151]
ds_read_b64_tr_b16 a[0:1], v18 offset:32768
s_add_u32 m0, s42, 65536
v_mfma_f32_16x16x32_bf16 v[148:151], a[56:59], a[180:183], v[148:151]
buffer_load_dwordx4 v2, s[8:11], s41 offen offset:0 lds
v_mfma_f32_16x16x32_bf16 v[152:155], a[56:59], a[184:187], v[152:155]
ds_read_b64_tr_b16 a[2:3], v18 offset:40960
v_mfma_f32_16x16x32_bf16 v[152:155], a[60:63], a[200:203], v[152:155]
v_mfma_f32_16x16x32_bf16 v[156:159], a[60:63], a[204:207], v[156:159]
ds_read_b64_tr_b16 a[4:5], v18 offset:49152
v_mfma_f32_16x16x32_bf16 v[156:159], a[56:59], a[188:191], v[156:159]
ds_read_b64_tr_b16 a[6:7], v18 offset:57344
v_mfma_f32_16x16x32_bf16 v[160:163], a[64:67], a[176:179], v[160:163]
buffer_load_dwordx4 v3, s[8:11], s41 offen offset:1024 lds
v_mfma_f32_16x16x32_bf16 v[160:163], a[68:71], a[192:195], v[160:163]
v_mfma_f32_16x16x32_bf16 v[164:167], a[68:71], a[196:199], v[164:167]
ds_read_b64_tr_b16 a[8:9], v19 offset:32768
v_mfma_f32_16x16x32_bf16 v[164:167], a[64:67], a[180:183], v[164:167]
ds_read_b64_tr_b16 a[10:11], v19 offset:40960
v_mfma_f32_16x16x32_bf16 v[168:171], a[64:67], a[184:187], v[168:171]
ds_read_b64_tr_b16 a[12:13], v19 offset:49152
v_mfma_f32_16x16x32_bf16 v[168:171], a[68:71], a[200:203], v[168:171]
v_mfma_f32_16x16x32_bf16 v[172:175], a[68:71], a[204:207], v[172:175]
ds_read_b64_tr_b16 a[14:15], v19 offset:57344
v_mfma_f32_16x16x32_bf16 v[172:175], a[64:67], a[188:191], v[172:175]
buffer_load_dwordx4 v4, s[8:11], s41 offen offset:2048 lds
v_mfma_f32_16x16x32_bf16 v[176:179], a[72:75], a[176:179], v[176:179]
ds_read_b64_tr_b16 a[16:17], v20 offset:32768
v_mfma_f32_16x16x32_bf16 v[176:179], a[76:79], a[192:195], v[176:179]
v_mfma_f32_16x16x32_bf16 v[180:183], a[76:79], a[196:199], v[180:183]
ds_read_b64_tr_b16 a[18:19], v20 offset:40960
v_mfma_f32_16x16x32_bf16 v[180:183], a[72:75], a[180:183], v[180:183]
ds_read_b64_tr_b16 a[20:21], v20 offset:49152
v_mfma_f32_16x16x32_bf16 v[184:187], a[72:75], a[184:187], v[184:187]
buffer_load_dwordx4 v5, s[8:11], s41 offen offset:3072 lds
s_add_u32 s41, s41, 229376
v_mfma_f32_16x16x32_bf16 v[184:187], a[76:79], a[200:203], v[184:187]
v_mfma_f32_16x16x32_bf16 v[188:191], a[76:79], a[204:207], v[188:191]
ds_read_b64_tr_b16 a[22:23], v20 offset:57344
v_mfma_f32_16x16x32_bf16 v[188:191], a[72:75], a[188:191], v[188:191]
ds_read_b64_tr_b16 a[24:25], v21 offset:32768
v_mfma_f32_16x16x32_bf16 v[192:195], a[80:83], a[176:179], v[192:195]
ds_read_b64_tr_b16 a[26:27], v21 offset:40960
v_mfma_f32_16x16x32_bf16 v[192:195], a[84:87], a[192:195], v[192:195]
v_mfma_f32_16x16x32_bf16 v[196:199], a[84:87], a[196:199], v[196:199]
ds_read_b64_tr_b16 a[28:29], v21 offset:49152
s_add_u32 m0, s42, 81920
v_mfma_f32_16x16x32_bf16 v[196:199], a[80:83], a[180:183], v[196:199]
buffer_load_dwordx4 v2, s[8:11], s41 offen offset:0 lds
v_mfma_f32_16x16x32_bf16 v[200:203], a[80:83], a[184:187], v[200:203]
ds_read_b64_tr_b16 a[30:31], v21 offset:57344
v_mfma_f32_16x16x32_bf16 v[200:203], a[84:87], a[200:203], v[200:203]
v_mfma_f32_16x16x32_bf16 v[204:207], a[84:87], a[204:207], v[204:207]
ds_read_b64_tr_b16 a[32:33], v18 offset:33792
v_mfma_f32_16x16x32_bf16 v[204:207], a[80:83], a[188:191], v[204:207]
ds_read_b64_tr_b16 a[34:35], v18 offset:41984
v_mfma_f32_16x16x32_bf16 v[208:211], a[88:91], a[176:179], v[208:211]
buffer_load_dwordx4 v3, s[8:11], s41 offen offset:1024 lds
v_mfma_f32_16x16x32_bf16 v[208:211], a[92:95], a[192:195], v[208:211]
v_mfma_f32_16x16x32_bf16 v[212:215], a[92:95], a[196:199], v[212:215]
ds_read_b64_tr_b16 a[36:37], v18 offset:50176
v_mfma_f32_16x16x32_bf16 v[212:215], a[88:91], a[180:183], v[212:215]
ds_read_b64_tr_b16 a[38:39], v18 offset:58368
v_mfma_f32_16x16x32_bf16 v[216:219], a[88:91], a[184:187], v[216:219]
ds_read_b64_tr_b16 a[40:41], v19 offset:33792
v_mfma_f32_16x16x32_bf16 v[216:219], a[92:95], a[200:203], v[216:219]
v_mfma_f32_16x16x32_bf16 v[220:223], a[92:95], a[204:207], v[220:223]
ds_read_b64_tr_b16 a[42:43], v19 offset:41984
v_mfma_f32_16x16x32_bf16 v[220:223], a[88:91], a[188:191], v[220:223]
buffer_load_dwordx4 v4, s[8:11], s41 offen offset:2048 lds
v_mfma_f32_16x16x32_bf16 v[224:227], a[96:99], a[176:179], v[224:227]
ds_read_b64_tr_b16 a[44:45], v19 offset:50176
v_mfma_f32_16x16x32_bf16 v[224:227], a[100:103], a[192:195], v[224:227]
v_mfma_f32_16x16x32_bf16 v[228:231], a[100:103], a[196:199], v[228:231]
ds_read_b64_tr_b16 a[46:47], v19 offset:58368
v_mfma_f32_16x16x32_bf16 v[228:231], a[96:99], a[180:183], v[228:231]
ds_read_b64_tr_b16 a[48:49], v20 offset:33792
v_mfma_f32_16x16x32_bf16 v[232:235], a[96:99], a[184:187], v[232:235]
buffer_load_dwordx4 v5, s[8:11], s41 offen offset:3072 lds
s_add_u32 s41, s41, 229376
v_mfma_f32_16x16x32_bf16 v[232:235], a[100:103], a[200:203], v[232:235]
v_mfma_f32_16x16x32_bf16 v[236:239], a[100:103], a[204:207], v[236:239]
ds_read_b64_tr_b16 a[50:51], v20 offset:41984
v_mfma_f32_16x16x32_bf16 v[236:239], a[96:99], a[188:191], v[236:239]
ds_read_b64_tr_b16 a[52:53], v20 offset:50176
v_mfma_f32_16x16x32_bf16 v[240:243], a[104:107], a[176:179], v[240:243]
ds_read_b64_tr_b16 a[54:55], v20 offset:58368
v_mfma_f32_16x16x32_bf16 v[240:243], a[108:111], a[192:195], v[240:243]
v_mfma_f32_16x16x32_bf16 v[244:247], a[108:111], a[196:199], v[244:247]
v_mfma_f32_16x16x32_bf16 v[244:247], a[104:107], a[180:183], v[244:247]
v_mfma_f32_16x16x32_bf16 v[248:251], a[104:107], a[184:187], v[248:251]
v_mfma_f32_16x16x32_bf16 v[248:251], a[108:111], a[200:203], v[248:251]
v_mfma_f32_16x16x32_bf16 v[252:255], a[108:111], a[204:207], v[252:255]
v_mfma_f32_16x16x32_bf16 v[252:255], a[104:107], a[188:191], v[252:255]
s_waitcnt vmcnt(36) lgkmcnt(0)
v_mfma_f32_16x16x32_bf16 v[32:35], a[0:3], a[208:211], v[32:35]
ds_read_b64_tr_b16 a[56:57], v21 offset:33792
v_mfma_f32_16x16x32_bf16 v[32:35], a[4:7], a[224:227], v[32:35]
buffer_load_dwordx4 a[176:179], v12, s[4:7], s40 offen offset:0 sc1
v_mfma_f32_16x16x32_bf16 v[36:39], a[4:7], a[228:231], v[36:39]
ds_read_b64_tr_b16 a[58:59], v21 offset:41984
v_mfma_f32_16x16x32_bf16 v[36:39], a[0:3], a[212:215], v[36:39]
v_mfma_f32_16x16x32_bf16 v[40:43], a[0:3], a[216:219], v[40:43]
ds_read_b64_tr_b16 a[60:61], v21 offset:50176
v_mfma_f32_16x16x32_bf16 v[40:43], a[4:7], a[232:235], v[40:43]
ds_read_b64_tr_b16 a[62:63], v21 offset:58368
v_mfma_f32_16x16x32_bf16 v[44:47], a[4:7], a[236:239], v[44:47]
buffer_load_dwordx4 a[180:183], v12, s[4:7], s40 offen offset:1024 sc1
v_mfma_f32_16x16x32_bf16 v[44:47], a[0:3], a[220:223], v[44:47]
v_mfma_f32_16x16x32_bf16 v[48:51], a[8:11], a[208:211], v[48:51]
ds_read_b64_tr_b16 a[64:65], v18 offset:34816
v_mfma_f32_16x16x32_bf16 v[48:51], a[12:15], a[224:227], v[48:51]
ds_read_b64_tr_b16 a[66:67], v18 offset:43008
v_mfma_f32_16x16x32_bf16 v[52:55], a[12:15], a[228:231], v[52:55]
v_mfma_f32_16x16x32_bf16 v[52:55], a[8:11], a[212:215], v[52:55]
ds_read_b64_tr_b16 a[68:69], v18 offset:51200
v_mfma_f32_16x16x32_bf16 v[56:59], a[8:11], a[216:219], v[56:59]
ds_read_b64_tr_b16 a[70:71], v18 offset:59392
v_mfma_f32_16x16x32_bf16 v[56:59], a[12:15], a[232:235], v[56:59]
buffer_load_dwordx4 a[184:187], v12, s[4:7], s40 offen offset:2048 sc1
v_mfma_f32_16x16x32_bf16 v[60:63], a[12:15], a[236:239], v[60:63]
v_mfma_f32_16x16x32_bf16 v[60:63], a[8:11], a[220:223], v[60:63]
ds_read_b64_tr_b16 a[72:73], v19 offset:34816
v_mfma_f32_16x16x32_bf16 v[64:67], a[16:19], a[208:211], v[64:67]
ds_read_b64_tr_b16 a[74:75], v19 offset:43008
v_mfma_f32_16x16x32_bf16 v[64:67], a[20:23], a[224:227], v[64:67]
v_mfma_f32_16x16x32_bf16 v[68:71], a[20:23], a[228:231], v[68:71]
ds_read_b64_tr_b16 a[76:77], v19 offset:51200
v_mfma_f32_16x16x32_bf16 v[68:71], a[16:19], a[212:215], v[68:71]
buffer_load_dwordx4 a[188:191], v12, s[4:7], s40 offen offset:3072 sc1
s_add_u32 s40, s40, 16384
v_mfma_f32_16x16x32_bf16 v[72:75], a[16:19], a[216:219], v[72:75]
ds_read_b64_tr_b16 a[78:79], v19 offset:59392
v_mfma_f32_16x16x32_bf16 v[72:75], a[20:23], a[232:235], v[72:75]
v_mfma_f32_16x16x32_bf16 v[76:79], a[20:23], a[236:239], v[76:79]
ds_read_b64_tr_b16 a[80:81], v20 offset:34816
v_mfma_f32_16x16x32_bf16 v[76:79], a[16:19], a[220:223], v[76:79]
ds_read_b64_tr_b16 a[82:83], v20 offset:43008
v_mfma_f32_16x16x32_bf16 v[80:83], a[24:27], a[208:211], v[80:83]
v_mfma_f32_16x16x32_bf16 v[80:83], a[28:31], a[224:227], v[80:83]
ds_read_b64_tr_b16 a[84:85], v20 offset:51200
v_mfma_f32_16x16x32_bf16 v[84:87], a[28:31], a[228:231], v[84:87]
buffer_load_dwordx4 a[192:195], v12, s[4:7], s40 offen offset:0 sc1
v_mfma_f32_16x16x32_bf16 v[84:87], a[24:27], a[212:215], v[84:87]
ds_read_b64_tr_b16 a[86:87], v20 offset:59392
v_mfma_f32_16x16x32_bf16 v[88:91], a[24:27], a[216:219], v[88:91]
v_mfma_f32_16x16x32_bf16 v[88:91], a[28:31], a[232:235], v[88:91]
ds_read_b64_tr_b16 a[88:89], v21 offset:34816
v_mfma_f32_16x16x32_bf16 v[92:95], a[28:31], a[236:239], v[92:95]
ds_read_b64_tr_b16 a[90:91], v21 offset:43008
v_mfma_f32_16x16x32_bf16 v[92:95], a[24:27], a[220:223], v[92:95]
buffer_load_dwordx4 a[196:199], v12, s[4:7], s40 offen offset:1024 sc1
v_mfma_f32_16x16x32_bf16 v[96:99], a[32:35], a[208:211], v[96:99]
v_mfma_f32_16x16x32_bf16 v[96:99], a[36:39], a[224:227], v[96:99]
ds_read_b64_tr_b16 a[92:93], v21 offset:51200
v_mfma_f32_16x16x32_bf16 v[100:103], a[36:39], a[228:231], v[100:103]
ds_read_b64_tr_b16 a[94:95], v21 offset:59392
v_mfma_f32_16x16x32_bf16 v[100:103], a[32:35], a[212:215], v[100:103]
v_mfma_f32_16x16x32_bf16 v[104:107], a[32:35], a[216:219], v[104:107]
ds_read_b64_tr_b16 a[96:97], v22 offset:35840
v_mfma_f32_16x16x32_bf16 v[104:107], a[36:39], a[232:235], v[104:107]
ds_read_b64_tr_b16 a[98:99], v22 offset:44032
v_mfma_f32_16x16x32_bf16 v[108:111], a[36:39], a[236:239], v[108:111]
buffer_load_dwordx4 a[200:203], v12, s[4:7], s40 offen offset:2048 sc1
v_mfma_f32_16x16x32_bf16 v[108:111], a[32:35], a[220:223], v[108:111]
v_mfma_f32_16x16x32_bf16 v[112:115], a[40:43], a[208:211], v[112:115]
ds_read_b64_tr_b16 a[100:101], v22 offset:52224
v_mfma_f32_16x16x32_bf16 v[112:115], a[44:47], a[224:227], v[112:115]
ds_read_b64_tr_b16 a[102:103], v22 offset:60416
v_mfma_f32_16x16x32_bf16 v[116:119], a[44:47], a[228:231], v[116:119]
v_mfma_f32_16x16x32_bf16 v[116:119], a[40:43], a[212:215], v[116:119]
ds_read_b64_tr_b16 a[104:105], v23 offset:35840
v_mfma_f32_16x16x32_bf16 v[120:123], a[40:43], a[216:219], v[120:123]
buffer_load_dwordx4 a[204:207], v12, s[4:7], s40 offen offset:3072 sc1
s_add_u32 s40, s40, 16384
v_mfma_f32_16x16x32_bf16 v[120:123], a[44:47], a[232:235], v[120:123]
ds_read_b64_tr_b16 a[106:107], v23 offset:44032
v_mfma_f32_16x16x32_bf16 v[124:127], a[44:47], a[236:239], v[124:127]
v_mfma_f32_16x16x32_bf16 v[124:127], a[40:43], a[220:223], v[124:127]
ds_read_b64_tr_b16 a[108:109], v23 offset:52224
v_mfma_f32_16x16x32_bf16 v[128:131], a[48:51], a[208:211], v[128:131]
ds_read_b64_tr_b16 a[110:111], v23 offset:60416
v_mfma_f32_16x16x32_bf16 v[128:131], a[52:55], a[224:227], v[128:131]
v_mfma_f32_16x16x32_bf16 v[132:135], a[52:55], a[228:231], v[132:135]
v_mfma_f32_16x16x32_bf16 v[132:135], a[48:51], a[212:215], v[132:135]
v_mfma_f32_16x16x32_bf16 v[136:139], a[48:51], a[216:219], v[136:139]
v_mfma_f32_16x16x32_bf16 v[136:139], a[52:55], a[232:235], v[136:139]
v_mfma_f32_16x16x32_bf16 v[140:143], a[52:55], a[236:239], v[140:143]
v_mfma_f32_16x16x32_bf16 v[140:143], a[48:51], a[220:223], v[140:143]
s_waitcnt vmcnt(32) lgkmcnt(0)
v_mfma_f32_16x16x32_bf16 v[144:147], a[56:59], a[208:211], v[144:147]
v_mfma_f32_16x16x32_bf16 v[144:147], a[60:63], a[224:227], v[144:147]
s_barrier
v_mfma_f32_16x16x32_bf16 v[148:151], a[60:63], a[228:231], v[148:151]
ds_read_b64_tr_b16 a[0:1], v6 offset:0
s_add_u32 m0, s42, 98304
v_mfma_f32_16x16x32_bf16 v[148:151], a[56:59], a[212:215], v[148:151]
buffer_load_dwordx4 v2, s[8:11], s41 offen offset:0 lds
v_mfma_f32_16x16x32_bf16 v[152:155], a[56:59], a[216:219], v[152:155]
ds_read_b64_tr_b16 a[2:3], v6 offset:8192
v_mfma_f32_16x16x32_bf16 v[152:155], a[60:63], a[232:235], v[152:155]
v_mfma_f32_16x16x32_bf16 v[156:159], a[60:63], a[236:239], v[156:159]
ds_read_b64_tr_b16 a[4:5], v6 offset:16384
v_mfma_f32_16x16x32_bf16 v[156:159], a[56:59], a[220:223], v[156:159]
ds_read_b64_tr_b16 a[6:7], v6 offset:24576
v_mfma_f32_16x16x32_bf16 v[160:163], a[64:67], a[208:211], v[160:163]
buffer_load_dwordx4 v3, s[8:11], s41 offen offset:1024 lds
v_mfma_f32_16x16x32_bf16 v[160:163], a[68:71], a[224:227], v[160:163]
v_mfma_f32_16x16x32_bf16 v[164:167], a[68:71], a[228:231], v[164:167]
ds_read_b64_tr_b16 a[8:9], v7 offset:0
v_mfma_f32_16x16x32_bf16 v[164:167], a[64:67], a[212:215], v[164:167]
ds_read_b64_tr_b16 a[10:11], v7 offset:8192
v_mfma_f32_16x16x32_bf16 v[168:171], a[64:67], a[216:219], v[168:171]
ds_read_b64_tr_b16 a[12:13], v7 offset:16384
v_mfma_f32_16x16x32_bf16 v[168:171], a[68:71], a[232:235], v[168:171]
v_mfma_f32_16x16x32_bf16 v[172:175], a[68:71], a[236:239], v[172:175]
ds_read_b64_tr_b16 a[14:15], v7 offset:24576
v_mfma_f32_16x16x32_bf16 v[172:175], a[64:67], a[220:223], v[172:175]
buffer_load_dwordx4 v4, s[8:11], s41 offen offset:2048 lds
v_mfma_f32_16x16x32_bf16 v[176:179], a[72:75], a[208:211], v[176:179]
ds_read_b64_tr_b16 a[16:17], v8 offset:0
v_mfma_f32_16x16x32_bf16 v[176:179], a[76:79], a[224:227], v[176:179]
v_mfma_f32_16x16x32_bf16 v[180:183], a[76:79], a[228:231], v[180:183]
ds_read_b64_tr_b16 a[18:19], v8 offset:8192
v_mfma_f32_16x16x32_bf16 v[180:183], a[72:75], a[212:215], v[180:183]
ds_read_b64_tr_b16 a[20:21], v8 offset:16384
v_mfma_f32_16x16x32_bf16 v[184:187], a[72:75], a[216:219], v[184:187]
buffer_load_dwordx4 v5, s[8:11], s41 offen offset:3072 lds
s_add_u32 s41, s41, 229376
v_mfma_f32_16x16x32_bf16 v[184:187], a[76:79], a[232:235], v[184:187]
v_mfma_f32_16x16x32_bf16 v[188:191], a[76:79], a[236:239], v[188:191]
ds_read_b64_tr_b16 a[22:23], v8 offset:24576
v_mfma_f32_16x16x32_bf16 v[188:191], a[72:75], a[220:223], v[188:191]
ds_read_b64_tr_b16 a[24:25], v9 offset:0
v_mfma_f32_16x16x32_bf16 v[192:195], a[80:83], a[208:211], v[192:195]
ds_read_b64_tr_b16 a[26:27], v9 offset:8192
v_mfma_f32_16x16x32_bf16 v[192:195], a[84:87], a[224:227], v[192:195]
v_mfma_f32_16x16x32_bf16 v[196:199], a[84:87], a[228:231], v[196:199]
ds_read_b64_tr_b16 a[28:29], v9 offset:16384
s_add_u32 m0, s42, 114688
v_mfma_f32_16x16x32_bf16 v[196:199], a[80:83], a[212:215], v[196:199]
buffer_load_dwordx4 v2, s[8:11], s41 offen offset:0 lds
v_mfma_f32_16x16x32_bf16 v[200:203], a[80:83], a[216:219], v[200:203]
ds_read_b64_tr_b16 a[30:31], v9 offset:24576
v_mfma_f32_16x16x32_bf16 v[200:203], a[84:87], a[232:235], v[200:203]
v_mfma_f32_16x16x32_bf16 v[204:207], a[84:87], a[236:239], v[204:207]
ds_read_b64_tr_b16 a[32:33], v6 offset:1024
v_mfma_f32_16x16x32_bf16 v[204:207], a[80:83], a[220:223], v[204:207]
ds_read_b64_tr_b16 a[34:35], v6 offset:9216
v_mfma_f32_16x16x32_bf16 v[208:211], a[88:91], a[208:211], v[208:211]
buffer_load_dwordx4 v3, s[8:11], s41 offen offset:1024 lds
v_mfma_f32_16x16x32_bf16 v[208:211], a[92:95], a[224:227], v[208:211]
v_mfma_f32_16x16x32_bf16 v[212:215], a[92:95], a[228:231], v[212:215]
ds_read_b64_tr_b16 a[36:37], v6 offset:17408
v_mfma_f32_16x16x32_bf16 v[212:215], a[88:91], a[212:215], v[212:215]
ds_read_b64_tr_b16 a[38:39], v6 offset:25600
v_mfma_f32_16x16x32_bf16 v[216:219], a[88:91], a[216:219], v[216:219]
ds_read_b64_tr_b16 a[40:41], v7 offset:1024
v_mfma_f32_16x16x32_bf16 v[216:219], a[92:95], a[232:235], v[216:219]
v_mfma_f32_16x16x32_bf16 v[220:223], a[92:95], a[236:239], v[220:223]
ds_read_b64_tr_b16 a[42:43], v7 offset:9216
v_mfma_f32_16x16x32_bf16 v[220:223], a[88:91], a[220:223], v[220:223]
buffer_load_dwordx4 v4, s[8:11], s41 offen offset:2048 lds
v_mfma_f32_16x16x32_bf16 v[224:227], a[96:99], a[208:211], v[224:227]
ds_read_b64_tr_b16 a[44:45], v7 offset:17408
v_mfma_f32_16x16x32_bf16 v[224:227], a[100:103], a[224:227], v[224:227]
v_mfma_f32_16x16x32_bf16 v[228:231], a[100:103], a[228:231], v[228:231]
ds_read_b64_tr_b16 a[46:47], v7 offset:25600
v_mfma_f32_16x16x32_bf16 v[228:231], a[96:99], a[212:215], v[228:231]
ds_read_b64_tr_b16 a[48:49], v8 offset:1024
v_mfma_f32_16x16x32_bf16 v[232:235], a[96:99], a[216:219], v[232:235]
buffer_load_dwordx4 v5, s[8:11], s41 offen offset:3072 lds
s_add_u32 s41, s41, 229376
v_mfma_f32_16x16x32_bf16 v[232:235], a[100:103], a[232:235], v[232:235]
v_mfma_f32_16x16x32_bf16 v[236:239], a[100:103], a[236:239], v[236:239]
ds_read_b64_tr_b16 a[50:51], v8 offset:9216
v_mfma_f32_16x16x32_bf16 v[236:239], a[96:99], a[220:223], v[236:239]
ds_read_b64_tr_b16 a[52:53], v8 offset:17408
v_mfma_f32_16x16x32_bf16 v[240:243], a[104:107], a[208:211], v[240:243]
ds_read_b64_tr_b16 a[54:55], v8 offset:25600
v_mfma_f32_16x16x32_bf16 v[240:243], a[108:111], a[224:227], v[240:243]
v_mfma_f32_16x16x32_bf16 v[244:247], a[108:111], a[228:231], v[244:247]
v_mfma_f32_16x16x32_bf16 v[244:247], a[104:107], a[212:215], v[244:247]
v_mfma_f32_16x16x32_bf16 v[248:251], a[104:107], a[216:219], v[248:251]
v_mfma_f32_16x16x32_bf16 v[248:251], a[108:111], a[232:235], v[248:251]
v_mfma_f32_16x16x32_bf16 v[252:255], a[108:111], a[236:239], v[252:255]
v_mfma_f32_16x16x32_bf16 v[252:255], a[104:107], a[220:223], v[252:255]
s_waitcnt lgkmcnt(0)
v_mfma_f32_16x16x32_bf16 v[32:35], a[0:3], a[112:115], v[32:35]
ds_read_b64_tr_b16 a[56:57], v9 offset:1024
v_mfma_f32_16x16x32_bf16 v[32:35], a[4:7], a[128:131], v[32:35]
buffer_load_dwordx4 a[208:211], v12, s[4:7], s40 offen offset:0 sc1
v_mfma_f32_16x16x32_bf16 v[36:39], a[4:7], a[132:135], v[36:39]
ds_read_b64_tr_b16 a[58:59], v9 offset:9216
v_mfma_f32_16x16x32_bf16 v[36:39], a[0:3], a[116:119], v[36:39]
v_mfma_f32_16x16x32_bf16 v[40:43], a[0:3], a[120:123], v[40:43]
ds_read_b64_tr_b16 a[60:61], v9 offset:17408
v_mfma_f32_16x16x32_bf16 v[40:43], a[4:7], a[136:139], v[40:43]
ds_read_b64_tr_b16 a[62:63], v9 offset:25600
v_mfma_f32_16x16x32_bf16 v[44:47], a[4:7], a[140:143], v[44:47]
buffer_load_dwordx4 a[212:215], v12, s[4:7], s40 offen offset:1024 sc1
v_mfma_f32_16x16x32_bf16 v[44:47], a[0:3], a[124:127], v[44:47]
v_mfma_f32_16x16x32_bf16 v[48:51], a[8:11], a[112:115], v[48:51]
ds_read_b64_tr_b16 a[64:65], v6 offset:2048
v_mfma_f32_16x16x32_bf16 v[48:51], a[12:15], a[128:131], v[48:51]
ds_read_b64_tr_b16 a[66:67], v6 offset:10240
v_mfma_f32_16x16x32_bf16 v[52:55], a[12:15], a[132:135], v[52:55]
v_mfma_f32_16x16x32_bf16 v[52:55], a[8:11], a[116:119], v[52:55]
ds_read_b64_tr_b16 a[68:69], v6 offset:18432
v_mfma_f32_16x16x32_bf16 v[56:59], a[8:11], a[120:123], v[56:59]
ds_read_b64_tr_b16 a[70:71], v6 offset:26624
v_mfma_f32_16x16x32_bf16 v[56:59], a[12:15], a[136:139], v[56:59]
buffer_load_dwordx4 a[216:219], v12, s[4:7], s40 offen offset:2048 sc1
v_mfma_f32_16x16x32_bf16 v[60:63], a[12:15], a[140:143], v[60:63]
v_mfma_f32_16x16x32_bf16 v[60:63], a[8:11], a[124:127], v[60:63]
ds_read_b64_tr_b16 a[72:73], v7 offset:2048
v_mfma_f32_16x16x32_bf16 v[64:67], a[16:19], a[112:115], v[64:67]
ds_read_b64_tr_b16 a[74:75], v7 offset:10240
v_mfma_f32_16x16x32_bf16 v[64:67], a[20:23], a[128:131], v[64:67]
v_mfma_f32_16x16x32_bf16 v[68:71], a[20:23], a[132:135], v[68:71]
ds_read_b64_tr_b16 a[76:77], v7 offset:18432
v_mfma_f32_16x16x32_bf16 v[68:71], a[16:19], a[116:119], v[68:71]
buffer_load_dwordx4 a[220:223], v12, s[4:7], s40 offen offset:3072 sc1
s_add_u32 s40, s40, 16384
v_mfma_f32_16x16x32_bf16 v[72:75], a[16:19], a[120:123], v[72:75]
ds_read_b64_tr_b16 a[78:79], v7 offset:26624
v_mfma_f32_16x16x32_bf16 v[72:75], a[20:23], a[136:139], v[72:75]
v_mfma_f32_16x16x32_bf16 v[76:79], a[20:23], a[140:143], v[76:79]
ds_read_b64_tr_b16 a[80:81], v8 offset:2048
v_mfma_f32_16x16x32_bf16 v[76:79], a[16:19], a[124:127], v[76:79]
ds_read_b64_tr_b16 a[82:83], v8 offset:10240
v_mfma_f32_16x16x32_bf16 v[80:83], a[24:27], a[112:115], v[80:83]
v_mfma_f32_16x16x32_bf16 v[80:83], a[28:31], a[128:131], v[80:83]
ds_read_b64_tr_b16 a[84:85], v8 offset:18432
v_mfma_f32_16x16x32_bf16 v[84:87], a[28:31], a[132:135], v[84:87]
buffer_load_dwordx4 a[224:227], v12, s[4:7], s40 offen offset:0 sc1
v_mfma_f32_16x16x32_bf16 v[84:87], a[24:27], a[116:119], v[84:87]
ds_read_b64_tr_b16 a[86:87], v8 offset:26624
v_mfma_f32_16x16x32_bf16 v[88:91], a[24:27], a[120:123], v[88:91]
v_mfma_f32_16x16x32_bf16 v[88:91], a[28:31], a[136:139], v[88:91]
ds_read_b64_tr_b16 a[88:89], v9 offset:2048
v_mfma_f32_16x16x32_bf16 v[92:95], a[28:31], a[140:143], v[92:95]
ds_read_b64_tr_b16 a[90:91], v9 offset:10240
v_mfma_f32_16x16x32_bf16 v[92:95], a[24:27], a[124:127], v[92:95]
buffer_load_dwordx4 a[228:231], v12, s[4:7], s40 offen offset:1024 sc1
v_mfma_f32_16x16x32_bf16 v[96:99], a[32:35], a[112:115], v[96:99]
v_mfma_f32_16x16x32_bf16 v[96:99], a[36:39], a[128:131], v[96:99]
ds_read_b64_tr_b16 a[92:93], v9 offset:18432
v_mfma_f32_16x16x32_bf16 v[100:103], a[36:39], a[132:135], v[100:103]
ds_read_b64_tr_b16 a[94:95], v9 offset:26624
v_mfma_f32_16x16x32_bf16 v[100:103], a[32:35], a[116:119], v[100:103]
v_mfma_f32_16x16x32_bf16 v[104:107], a[32:35], a[120:123], v[104:107]
ds_read_b64_tr_b16 a[96:97], v10 offset:3072
v_mfma_f32_16x16x32_bf16 v[104:107], a[36:39], a[136:139], v[104:107]
ds_read_b64_tr_b16 a[98:99], v10 offset:11264
v_mfma_f32_16x16x32_bf16 v[108:111], a[36:39], a[140:143], v[108:111]
buffer_load_dwordx4 a[232:235], v12, s[4:7], s40 offen offset:2048 sc1
v_mfma_f32_16x16x32_bf16 v[108:111], a[32:35], a[124:127], v[108:111]
v_mfma_f32_16x16x32_bf16 v[112:115], a[40:43], a[112:115], v[112:115]
ds_read_b64_tr_b16 a[100:101], v10 offset:19456
v_mfma_f32_16x16x32_bf16 v[112:115], a[44:47], a[128:131], v[112:115]
ds_read_b64_tr_b16 a[102:103], v10 offset:27648
v_mfma_f32_16x16x32_bf16 v[116:119], a[44:47], a[132:135], v[116:119]
v_mfma_f32_16x16x32_bf16 v[116:119], a[40:43], a[116:119], v[116:119]
ds_read_b64_tr_b16 a[104:105], v11 offset:3072
v_mfma_f32_16x16x32_bf16 v[120:123], a[40:43], a[120:123], v[120:123]
buffer_load_dwordx4 a[236:239], v12, s[4:7], s40 offen offset:3072 sc1
s_add_u32 s40, s40, 16384
v_mfma_f32_16x16x32_bf16 v[120:123], a[44:47], a[136:139], v[120:123]
ds_read_b64_tr_b16 a[106:107], v11 offset:11264
v_mfma_f32_16x16x32_bf16 v[124:127], a[44:47], a[140:143], v[124:127]
v_mfma_f32_16x16x32_bf16 v[124:127], a[40:43], a[124:127], v[124:127]
ds_read_b64_tr_b16 a[108:109], v11 offset:19456
v_mfma_f32_16x16x32_bf16 v[128:131], a[48:51], a[112:115], v[128:131]
ds_read_b64_tr_b16 a[110:111], v11 offset:27648
v_mfma_f32_16x16x32_bf16 v[128:131], a[52:55], a[128:131], v[128:131]
v_mfma_f32_16x16x32_bf16 v[132:135], a[52:55], a[132:135], v[132:135]
v_mfma_f32_16x16x32_bf16 v[132:135], a[48:51], a[116:119], v[132:135]
v_mfma_f32_16x16x32_bf16 v[136:139], a[48:51], a[120:123], v[136:139]
v_mfma_f32_16x16x32_bf16 v[136:139], a[52:55], a[136:139], v[136:139]
v_mfma_f32_16x16x32_bf16 v[140:143], a[52:55], a[140:143], v[140:143]
v_mfma_f32_16x16x32_bf16 v[140:143], a[48:51], a[124:127], v[140:143]
s_waitcnt vmcnt(40) lgkmcnt(0)
v_mfma_f32_16x16x32_bf16 v[144:147], a[56:59], a[112:115], v[144:147]
v_mfma_f32_16x16x32_bf16 v[144:147], a[60:63], a[128:131], v[144:147]
s_barrier
v_mfma_f32_16x16x32_bf16 v[148:151], a[60:63], a[132:135], v[148:151]
ds_read_b64_tr_b16 a[0:1], v6 offset:32768
s_add_u32 m0, s42, 0
v_mfma_f32_16x16x32_bf16 v[148:151], a[56:59], a[116:119], v[148:151]
buffer_load_dwordx4 v2, s[8:11], s41 offen offset:0 lds
v_mfma_f32_16x16x32_bf16 v[152:155], a[56:59], a[120:123], v[152:155]
ds_read_b64_tr_b16 a[2:3], v6 offset:40960
v_mfma_f32_16x16x32_bf16 v[152:155], a[60:63], a[136:139], v[152:155]
ds_read_b64_tr_b16 a[4:5], v6 offset:49152
PG3:
s_cbranch_execz PG7
v_mfma_f32_16x16x32_bf16 v[156:159], a[60:63], a[140:143], v[156:159]
v_mfma_f32_16x16x32_bf16 v[156:159], a[56:59], a[124:127], v[156:159]
ds_read_b64_tr_b16 a[6:7], v6 offset:57344
v_mfma_f32_16x16x32_bf16 v[160:163], a[64:67], a[112:115], v[160:163]
buffer_load_dwordx4 v3, s[8:11], s41 offen offset:1024 lds
v_mfma_f32_16x16x32_bf16 v[160:163], a[68:71], a[128:131], v[160:163]
ds_read_b64_tr_b16 a[8:9], v7 offset:32768
v_mfma_f32_16x16x32_bf16 v[164:167], a[68:71], a[132:135], v[164:167]
v_mfma_f32_16x16x32_bf16 v[164:167], a[64:67], a[116:119], v[164:167]
ds_read_b64_tr_b16 a[10:11], v7 offset:40960
v_mfma_f32_16x16x32_bf16 v[168:171], a[64:67], a[120:123], v[168:171]
ds_read_b64_tr_b16 a[12:13], v7 offset:49152
v_mfma_f32_16x16x32_bf16 v[168:171], a[68:71], a[136:139], v[168:171]
buffer_load_dwordx4 v4, s[8:11], s41 offen offset:2048 lds
v_mfma_f32_16x16x32_bf16 v[172:175], a[68:71], a[140:143], v[172:175]
ds_read_b64_tr_b16 a[14:15], v7 offset:57344
v_mfma_f32_16x16x32_bf16 v[172:175], a[64:67], a[124:127], v[172:175]
v_mfma_f32_16x16x32_bf16 v[176:179], a[72:75], a[112:115], v[176:179]
ds_read_b64_tr_b16 a[16:17], v8 offset:32768
v_mfma_f32_16x16x32_bf16 v[176:179], a[76:79], a[128:131], v[176:179]
ds_read_b64_tr_b16 a[18:19], v8 offset:40960
v_mfma_f32_16x16x32_bf16 v[180:183], a[76:79], a[132:135], v[180:183]
buffer_load_dwordx4 v5, s[8:11], s41 offen offset:3072 lds
s_add_u32 s41, s41, 229376
v_mfma_f32_16x16x32_bf16 v[180:183], a[72:75], a[116:119], v[180:183]
v_mfma_f32_16x16x32_bf16 v[184:187], a[72:75], a[120:123], v[184:187]
ds_read_b64_tr_b16 a[20:21], v8 offset:49152
v_mfma_f32_16x16x32_bf16 v[184:187], a[76:79], a[136:139], v[184:187]
ds_read_b64_tr_b16 a[22:23], v8 offset:57344
v_mfma_f32_16x16x32_bf16 v[188:191], a[76:79], a[140:143], v[188:191]
ds_read_b64_tr_b16 a[24:25], v9 offset:32768
v_mfma_f32_16x16x32_bf16 v[188:191], a[72:75], a[124:127], v[188:191]
s_add_u32 m0, s42, 16384
v_mfma_f32_16x16x32_bf16 v[192:195], a[80:83], a[112:115], v[192:195]
buffer_load_dwordx4 v2, s[8:11], s41 offen offset:0 lds
v_mfma_f32_16x16x32_bf16 v[192:195], a[84:87], a[128:131], v[192:195]
ds_read_b64_tr_b16 a[26:27], v9 offset:40960
v_mfma_f32_16x16x32_bf16 v[196:199], a[84:87], a[132:135], v[196:199]
ds_read_b64_tr_b16 a[28:29], v9 offset:49152
v_mfma_f32_16x16x32_bf16 v[196:199], a[80:83], a[116:119], v[196:199]
ds_read_b64_tr_b16 a[30:31], v9 offset:57344
v_mfma_f32_16x16x32_bf16 v[200:203], a[80:83], a[120:123], v[200:203]
v_mfma_f32_16x16x32_bf16 v[200:203], a[84:87], a[136:139], v[200:203]
buffer_load_dwordx4 v3, s[8:11], s41 offen offset:1024 lds
v_mfma_f32_16x16x32_bf16 v[204:207], a[84:87], a[140:143], v[204:207]
ds_read_b64_tr_b16 a[32:33], v6 offset:33792
v_mfma_f32_16x16x32_bf16 v[204:207], a[80:83], a[124:127], v[204:207]
ds_read_b64_tr_b16 a[34:35], v6 offset:41984
v_mfma_f32_16x16x32_bf16 v[208:211], a[88:91], a[112:115], v[208:211]
v_mfma_f32_16x16x32_bf16 v[208:211], a[92:95], a[128:131], v[208:211]
ds_read_b64_tr_b16 a[36:37], v6 offset:50176
v_mfma_f32_16x16x32_bf16 v[212:215], a[92:95], a[132:135], v[212:215]
buffer_load_dwordx4 v4, s[8:11], s41 offen offset:2048 lds
v_mfma_f32_16x16x32_bf16 v[212:215], a[88:91], a[116:119], v[212:215]
ds_read_b64_tr_b16 a[38:39], v6 offset:58368
v_mfma_f32_16x16x32_bf16 v[216:219], a[88:91], a[120:123], v[216:219]
v_mfma_f32_16x16x32_bf16 v[216:219], a[92:95], a[136:139], v[216:219]
ds_read_b64_tr_b16 a[40:41], v7 offset:33792
v_mfma_f32_16x16x32_bf16 v[220:223], a[92:95], a[140:143], v[220:223]
ds_read_b64_tr_b16 a[42:43], v7 offset:41984
v_mfma_f32_16x16x32_bf16 v[220:223], a[88:91], a[124:127], v[220:223]
buffer_load_dwordx4 v5, s[8:11], s41 offen offset:3072 lds
s_add_u32 s41, s41, 229376
v_mfma_f32_16x16x32_bf16 v[224:227], a[96:99], a[112:115], v[224:227]
ds_read_b64_tr_b16 a[44:45], v7 offset:50176
v_mfma_f32_16x16x32_bf16 v[224:227], a[100:103], a[128:131], v[224:227]
v_mfma_f32_16x16x32_bf16 v[228:231], a[100:103], a[132:135], v[228:231]
ds_read_b64_tr_b16 a[46:47], v7 offset:58368
v_mfma_f32_16x16x32_bf16 v[228:231], a[96:99], a[116:119], v[228:231]
ds_read_b64_tr_b16 a[48:49], v8 offset:33792
v_mfma_f32_16x16x32_bf16 v[232:235], a[96:99], a[120:123], v[232:235]
buffer_load_dwordx4 a[252:255], v1, s[52:55], s56 offen
v_mfma_f32_16x16x32_bf16 v[232:235], a[100:103], a[136:139], v[232:235]
v_mfma_f32_16x16x32_bf16 v[236:239], a[100:103], a[140:143], v[236:239]
ds_read_b64_tr_b16 a[50:51], v8 offset:41984
v_mfma_f32_16x16x32_bf16 v[236:239], a[96:99], a[124:127], v[236:239]
ds_read_b64_tr_b16 a[52:53], v8 offset:50176
v_mfma_f32_16x16x32_bf16 v[240:243], a[104:107], a[112:115], v[240:243]
ds_read_b64_tr_b16 a[54:55], v8 offset:58368
v_mfma_f32_16x16x32_bf16 v[240:243], a[108:111], a[128:131], v[240:243]
v_mfma_f32_16x16x32_bf16 v[244:247], a[108:111], a[132:135], v[244:247]
v_mfma_f32_16x16x32_bf16 v[244:247], a[104:107], a[116:119], v[244:247]
v_mfma_f32_16x16x32_bf16 v[248:251], a[104:107], a[120:123], v[248:251]
v_mfma_f32_16x16x32_bf16 v[248:251], a[108:111], a[136:139], v[248:251]
v_mfma_f32_16x16x32_bf16 v[252:255], a[108:111], a[140:143], v[252:255]
v_mfma_f32_16x16x32_bf16 v[252:255], a[104:107], a[124:127], v[252:255]
s_waitcnt vmcnt(41) lgkmcnt(0)
v_mfma_f32_16x16x32_bf16 v[32:35], a[0:3], a[144:147], v[32:35]
ds_read_b64_tr_b16 a[56:57], v9 offset:33792
v_mfma_f32_16x16x32_bf16 v[32:35], a[4:7], a[160:163], v[32:35]
buffer_load_dwordx4 a[112:115], v12, s[4:7], s40 offen offset:0 sc1
v_mfma_f32_16x16x32_bf16 v[36:39], a[4:7], a[164:167], v[36:39]
ds_read_b64_tr_b16 a[58:59], v9 offset:41984
v_mfma_f32_16x16x32_bf16 v[36:39], a[0:3], a[148:151], v[36:39]
v_mfma_f32_16x16x32_bf16 v[40:43], a[0:3], a[152:155], v[40:43]
ds_read_b64_tr_b16 a[60:61], v9 offset:50176
v_mfma_f32_16x16x32_bf16 v[40:43], a[4:7], a[168:171], v[40:43]
ds_read_b64_tr_b16 a[62:63], v9 offset:58368
v_mfma_f32_16x16x32_bf16 v[44:47], a[4:7], a[172:175], v[44:47]
buffer_load_dwordx4 a[116:119], v12, s[4:7], s40 offen offset:1024 sc1
v_mfma_f32_16x16x32_bf16 v[44:47], a[0:3], a[156:159], v[44:47]
v_mfma_f32_16x16x32_bf16 v[48:51], a[8:11], a[144:147], v[48:51]
ds_read_b64_tr_b16 a[64:65], v6 offset:34816
v_mfma_f32_16x16x32_bf16 v[48:51], a[12:15], a[160:163], v[48:51]
ds_read_b64_tr_b16 a[66:67], v6 offset:43008
v_mfma_f32_16x16x32_bf16 v[52:55], a[12:15], a[164:167], v[52:55]
v_mfma_f32_16x16x32_bf16 v[52:55], a[8:11], a[148:151], v[52:55]
ds_read_b64_tr_b16 a[68:69], v6 offset:51200
v_mfma_f32_16x16x32_bf16 v[56:59], a[8:11], a[152:155], v[56:59]
ds_read_b64_tr_b16 a[70:71], v6 offset:59392
v_mfma_f32_16x16x32_bf16 v[56:59], a[12:15], a[168:171], v[56:59]
buffer_load_dwordx4 a[120:123], v12, s[4:7], s40 offen offset:2048 sc1
v_mfma_f32_16x16x32_bf16 v[60:63], a[12:15], a[172:175], v[60:63]
v_mfma_f32_16x16x32_bf16 v[60:63], a[8:11], a[156:159], v[60:63]
ds_read_b64_tr_b16 a[72:73], v7 offset:34816
v_mfma_f32_16x16x32_bf16 v[64:67], a[16:19], a[144:147], v[64:67]
ds_read_b64_tr_b16 a[74:75], v7 offset:43008
v_mfma_f32_16x16x32_bf16 v[64:67], a[20:23], a[160:163], v[64:67]
v_mfma_f32_16x16x32_bf16 v[68:71], a[20:23], a[164:167], v[68:71]
ds_read_b64_tr_b16 a[76:77], v7 offset:51200
v_mfma_f32_16x16x32_bf16 v[68:71], a[16:19], a[148:151], v[68:71]
buffer_load_dwordx4 a[124:127], v12, s[4:7], s40 offen offset:3072 sc1
s_add_u32 s40, s40, 16384
v_mfma_f32_16x16x32_bf16 v[72:75], a[16:19], a[152:155], v[72:75]
ds_read_b64_tr_b16 a[78:79], v7 offset:59392
v_mfma_f32_16x16x32_bf16 v[72:75], a[20:23], a[168:171], v[72:75]
v_mfma_f32_16x16x32_bf16 v[76:79], a[20:23], a[172:175], v[76:79]
ds_read_b64_tr_b16 a[80:81], v8 offset:34816
v_mfma_f32_16x16x32_bf16 v[76:79], a[16:19], a[156:159], v[76:79]
ds_read_b64_tr_b16 a[82:83], v8 offset:43008
v_mfma_f32_16x16x32_bf16 v[80:83], a[24:27], a[144:147], v[80:83]
v_mfma_f32_16x16x32_bf16 v[80:83], a[28:31], a[160:163], v[80:83]
ds_read_b64_tr_b16 a[84:85], v8 offset:51200
v_mfma_f32_16x16x32_bf16 v[84:87], a[28:31], a[164:167], v[84:87]
buffer_load_dwordx4 a[128:131], v12, s[4:7], s40 offen offset:0 sc1
v_mfma_f32_16x16x32_bf16 v[84:87], a[24:27], a[148:151], v[84:87]
ds_read_b64_tr_b16 a[86:87], v8 offset:59392
v_mfma_f32_16x16x32_bf16 v[88:91], a[24:27], a[152:155], v[88:91]
v_mfma_f32_16x16x32_bf16 v[88:91], a[28:31], a[168:171], v[88:91]
ds_read_b64_tr_b16 a[88:89], v9 offset:34816
v_mfma_f32_16x16x32_bf16 v[92:95], a[28:31], a[172:175], v[92:95]
ds_read_b64_tr_b16 a[90:91], v9 offset:43008
v_mfma_f32_16x16x32_bf16 v[92:95], a[24:27], a[156:159], v[92:95]
buffer_load_dwordx4 a[132:135], v12, s[4:7], s40 offen offset:1024 sc1
v_mfma_f32_16x16x32_bf16 v[96:99], a[32:35], a[144:147], v[96:99]
v_mfma_f32_16x16x32_bf16 v[96:99], a[36:39], a[160:163], v[96:99]
ds_read_b64_tr_b16 a[92:93], v9 offset:51200
v_mfma_f32_16x16x32_bf16 v[100:103], a[36:39], a[164:167], v[100:103]
ds_read_b64_tr_b16 a[94:95], v9 offset:59392
v_mfma_f32_16x16x32_bf16 v[100:103], a[32:35], a[148:151], v[100:103]
v_mfma_f32_16x16x32_bf16 v[104:107], a[32:35], a[152:155], v[104:107]
ds_read_b64_tr_b16 a[96:97], v10 offset:35840
v_mfma_f32_16x16x32_bf16 v[104:107], a[36:39], a[168:171], v[104:107]
ds_read_b64_tr_b16 a[98:99], v10 offset:44032
v_mfma_f32_16x16x32_bf16 v[108:111], a[36:39], a[172:175], v[108:111]
buffer_load_dwordx4 a[136:139], v12, s[4:7], s40 offen offset:2048 sc1
v_mfma_f32_16x16x32_bf16 v[108:111], a[32:35], a[156:159], v[108:111]
v_mfma_f32_16x16x32_bf16 v[112:115], a[40:43], a[144:147], v[112:115]
ds_read_b64_tr_b16 a[100:101], v10 offset:52224
v_mfma_f32_16x16x32_bf16 v[112:115], a[44:47], a[160:163], v[112:115]
ds_read_b64_tr_b16 a[102:103], v10 offset:60416
v_mfma_f32_16x16x32_bf16 v[116:119], a[44:47], a[164:167], v[116:119]
v_mfma_f32_16x16x32_bf16 v[116:119], a[40:43], a[148:151], v[116:119]
ds_read_b64_tr_b16 a[104:105], v11 offset:35840
v_mfma_f32_16x16x32_bf16 v[120:123], a[40:43], a[152:155], v[120:123]
buffer_load_dwordx4 a[140:143], v12, s[4:7], s40 offen offset:3072 sc1
s_add_u32 s40, s40, 16384
v_mfma_f32_16x16x32_bf16 v[120:123], a[44:47], a[168:171], v[120:123]
ds_read_b64_tr_b16 a[106:107], v11 offset:44032
v_mfma_f32_16x16x32_bf16 v[124:127], a[44:47], a[172:175], v[124:127]
v_mfma_f32_16x16x32_bf16 v[124:127], a[40:43], a[156:159], v[124:127]
ds_read_b64_tr_b16 a[108:109], v11 offset:52224
v_mfma_f32_16x16x32_bf16 v[128:131], a[48:51], a[144:147], v[128:131]
ds_read_b64_tr_b16 a[110:111], v11 offset:60416
v_mfma_f32_16x16x32_bf16 v[128:131], a[52:55], a[160:163], v[128:131]
v_mfma_f32_16x16x32_bf16 v[132:135], a[52:55], a[164:167], v[132:135]
v_mfma_f32_16x16x32_bf16 v[132:135], a[48:51], a[148:151], v[132:135]
v_mfma_f32_16x16x32_bf16 v[136:139], a[48:51], a[152:155], v[136:139]
v_mfma_f32_16x16x32_bf16 v[136:139], a[52:55], a[168:171], v[136:139]
v_mfma_f32_16x16x32_bf16 v[140:143], a[52:55], a[172:175], v[140:143]
v_mfma_f32_16x16x32_bf16 v[140:143], a[48:51], a[156:159], v[140:143]
s_waitcnt vmcnt(41) lgkmcnt(0)
v_mfma_f32_16x16x32_bf16 v[144:147], a[56:59], a[144:147], v[144:147]
v_mfma_f32_16x16x32_bf16 v[144:147], a[60:63], a[160:163], v[144:147]
s_barrier
v_mfma_f32_16x16x32_bf16 v[148:151], a[60:63], a[164:167], v[148:151]
ds_read_b64_tr_b16 a[0:1], v18 offset:0
s_add_u32 m0, s42, 32768
v_mfma_f32_16x16x32_bf16 v[148:151], a[56:59], a[148:151], v[148:151]
buffer_load_dwordx4 v2, s[8:11], s41 offen offset:0 lds
v_mfma_f32_16x16x32_bf16 v[152:155], a[56:59], a[152:155], v[152:155]
ds_read_b64_tr_b16 a[2:3], v18 offset:8192
v_mfma_f32_16x16x32_bf16 v[152:155], a[60:63], a[168:171], v[152:155]
v_mfma_f32_16x16x32_bf16 v[156:159], a[60:63], a[172:175], v[156:159]
ds_read_b64_tr_b16 a[4:5], v18 offset:16384
v_mfma_f32_16x16x32_bf16 v[156:159], a[56:59], a[156:159], v[156:159]
ds_read_b64_tr_b16 a[6:7], v18 offset:24576
v_mfma_f32_16x16x32_bf16 v[160:163], a[64:67], a[144:147], v[160:163]
buffer_load_dwordx4 v3, s[8:11], s41 offen offset:1024 lds
v_mfma_f32_16x16x32_bf16 v[160:163], a[68:71], a[160:163], v[160:163]
v_mfma_f32_16x16x32_bf16 v[164:167], a[68:71], a[164:167], v[164:167]
ds_read_b64_tr_b16 a[8:9], v19 offset:0
v_mfma_f32_16x16x32_bf16 v[164:167], a[64:67], a[148:151], v[164:167]
ds_read_b64_tr_b16 a[10:11], v19 offset:8192
v_mfma_f32_16x16x32_bf16 v[168:171], a[64:67], a[152:155], v[168:171]
ds_read_b64_tr_b16 a[12:13], v19 offset:16384
v_mfma_f32_16x16x32_bf16 v[168:171], a[68:71], a[168:171], v[168:171]
v_mfma_f32_16x16x32_bf16 v[172:175], a[68:71], a[172:175], v[172:175]
ds_read_b64_tr_b16 a[14:15], v19 offset:24576
v_mfma_f32_16x16x32_bf16 v[172:175], a[64:67], a[156:159], v[172:175]
buffer_load_dwordx4 v4, s[8:11], s41 offen offset:2048 lds
v_mfma_f32_16x16x32_bf16 v[176:179], a[72:75], a[144:147], v[176:179]
ds_read_b64_tr_b16 a[16:17], v20 offset:0
v_mfma_f32_16x16x32_bf16 v[176:179], a[76:79], a[160:163], v[176:179]
v_mfma_f32_16x16x32_bf16 v[180:183], a[76:79], a[164:167], v[180:183]
ds_read_b64_tr_b16 a[18:19], v20 offset:8192
v_mfma_f32_16x16x32_bf16 v[180:183], a[72:75], a[148:151], v[180:183]
ds_read_b64_tr_b16 a[20:21], v20 offset:16384
v_mfma_f32_16x16x32_bf16 v[184:187], a[72:75], a[152:155], v[184:187]
buffer_load_dwordx4 v5, s[8:11], s41 offen offset:3072 lds
s_add_u32 s41, s41, 229376
v_mfma_f32_16x16x32_bf16 v[184:187], a[76:79], a[168:171], v[184:187]
v_mfma_f32_16x16x32_bf16 v[188:191], a[76:79], a[172:175], v[188:191]
ds_read_b64_tr_b16 a[22:23], v20 offset:24576
v_mfma_f32_16x16x32_bf16 v[188:191], a[72:75], a[156:159], v[188:191]
ds_read_b64_tr_b16 a[24:25], v21 offset:0
v_mfma_f32_16x16x32_bf16 v[192:195], a[80:83], a[144:147], v[192:195]
ds_read_b64_tr_b16 a[26:27], v21 offset:8192
v_mfma_f32_16x16x32_bf16 v[192:195], a[84:87], a[160:163], v[192:195]
v_mfma_f32_16x16x32_bf16 v[196:199], a[84:87], a[164:167], v[196:199]
ds_read_b64_tr_b16 a[28:29], v21 offset:16384
s_add_u32 m0, s42, 49152
v_mfma_f32_16x16x32_bf16 v[196:199], a[80:83], a[148:151], v[196:199]
buffer_load_dwordx4 v2, s[8:11], s41 offen offset:0 lds
v_mfma_f32_16x16x32_bf16 v[200:203], a[80:83], a[152:155], v[200:203]
ds_read_b64_tr_b16 a[30:31], v21 offset:24576
v_mfma_f32_16x16x32_bf16 v[200:203], a[84:87], a[168:171], v[200:203]
v_mfma_f32_16x16x32_bf16 v[204:207], a[84:87], a[172:175], v[204:207]
ds_read_b64_tr_b16 a[32:33], v18 offset:1024
v_mfma_f32_16x16x32_bf16 v[204:207], a[80:83], a[156:159], v[204:207]
ds_read_b64_tr_b16 a[34:35], v18 offset:9216
v_mfma_f32_16x16x32_bf16 v[208:211], a[88:91], a[144:147], v[208:211]
buffer_load_dwordx4 v3, s[8:11], s41 offen offset:1024 lds
v_mfma_f32_16x16x32_bf16 v[208:211], a[92:95], a[160:163], v[208:211]
v_mfma_f32_16x16x32_bf16 v[212:215], a[92:95], a[164:167], v[212:215]
ds_read_b64_tr_b16 a[36:37], v18 offset:17408
v_mfma_f32_16x16x32_bf16 v[212:215], a[88:91], a[148:151], v[212:215]
ds_read_b64_tr_b16 a[38:39], v18 offset:25600
v_mfma_f32_16x16x32_bf16 v[216:219], a[88:91], a[152:155], v[216:219]
ds_read_b64_tr_b16 a[40:41], v19 offset:1024
v_mfma_f32_16x16x32_bf16 v[216:219], a[92:95], a[168:171], v[216:219]
v_mfma_f32_16x16x32_bf16 v[220:223], a[92:95], a[172:175], v[220:223]
ds_read_b64_tr_b16 a[42:43], v19 offset:9216
v_mfma_f32_16x16x32_bf16 v[220:223], a[88:91], a[156:159], v[220:223]
buffer_load_dwordx4 v4, s[8:11], s41 offen offset:2048 lds
v_mfma_f32_16x16x32_bf16 v[224:227], a[96:99], a[144:147], v[224:227]
ds_read_b64_tr_b16 a[44:45], v19 offset:17408
v_mfma_f32_16x16x32_bf16 v[224:227], a[100:103], a[160:163], v[224:227]
v_mfma_f32_16x16x32_bf16 v[228:231], a[100:103], a[164:167], v[228:231]
ds_read_b64_tr_b16 a[46:47], v19 offset:25600
v_mfma_f32_16x16x32_bf16 v[228:231], a[96:99], a[148:151], v[228:231]
ds_read_b64_tr_b16 a[48:49], v20 offset:1024
v_mfma_f32_16x16x32_bf16 v[232:235], a[96:99], a[152:155], v[232:235]
buffer_load_dwordx4 v5, s[8:11], s41 offen offset:3072 lds
s_add_u32 s41, s41, 229376
v_mfma_f32_16x16x32_bf16 v[232:235], a[100:103], a[168:171], v[232:235]
v_mfma_f32_16x16x32_bf16 v[236:239], a[100:103], a[172:175], v[236:239]
ds_read_b64_tr_b16 a[50:51], v20 offset:9216
v_mfma_f32_16x16x32_bf16 v[236:239], a[96:99], a[156:159], v[236:239]
ds_read_b64_tr_b16 a[52:53], v20 offset:17408
v_mfma_f32_16x16x32_bf16 v[240:243], a[104:107], a[144:147], v[240:243]
ds_read_b64_tr_b16 a[54:55], v20 offset:25600
v_mfma_f32_16x16x32_bf16 v[240:243], a[108:111], a[160:163], v[240:243]
v_mfma_f32_16x16x32_bf16 v[244:247], a[108:111], a[164:167], v[244:247]
v_mfma_f32_16x16x32_bf16 v[244:247], a[104:107], a[148:151], v[244:247]
v_mfma_f32_16x16x32_bf16 v[248:251], a[104:107], a[152:155], v[248:251]
v_mfma_f32_16x16x32_bf16 v[248:251], a[108:111], a[168:171], v[248:251]
v_mfma_f32_16x16x32_bf16 v[252:255], a[108:111], a[172:175], v[252:255]
v_mfma_f32_16x16x32_bf16 v[252:255], a[104:107], a[156:159], v[252:255]
s_waitcnt vmcnt(41) lgkmcnt(0)
v_mfma_f32_16x16x32_bf16 v[32:35], a[0:3], a[176:179], v[32:35]
ds_read_b64_tr_b16 a[56:57], v21 offset:1024
v_mfma_f32_16x16x32_bf16 v[32:35], a[4:7], a[192:195], v[32:35]
buffer_load_dwordx4 a[144:147], v12, s[4:7], s40 offen offset:0 sc1
v_mfma_f32_16x16x32_bf16 v[36:39], a[4:7], a[196:199], v[36:39]
ds_read_b64_tr_b16 a[58:59], v21 offset:9216
v_mfma_f32_16x16x32_bf16 v[36:39], a[0:3], a[180:183], v[36:39]
v_mfma_f32_16x16x32_bf16 v[40:43], a[0:3], a[184:187], v[40:43]
ds_read_b64_tr_b16 a[60:61], v21 offset:17408
v_mfma_f32_16x16x32_bf16 v[40:43], a[4:7], a[200:203], v[40:43]
ds_read_b64_tr_b16 a[62:63], v21 offset:25600
v_mfma_f32_16x16x32_bf16 v[44:47], a[4:7], a[204:207], v[44:47]
buffer_load_dwordx4 a[148:151], v12, s[4:7], s40 offen offset:1024 sc1
v_mfma_f32_16x16x32_bf16 v[44:47], a[0:3], a[188:191], v[44:47]
v_mfma_f32_16x16x32_bf16 v[48:51], a[8:11], a[176:179], v[48:51]
ds_read_b64_tr_b16 a[64:65], v18 offset:2048
v_mfma_f32_16x16x32_bf16 v[48:51], a[12:15], a[192:195], v[48:51]
ds_read_b64_tr_b16 a[66:67], v18 offset:10240
v_mfma_f32_16x16x32_bf16 v[52:55], a[12:15], a[196:199], v[52:55]
v_mfma_f32_16x16x32_bf16 v[52:55], a[8:11], a[180:183], v[52:55]
ds_read_b64_tr_b16 a[68:69], v18 offset:18432
v_mfma_f32_16x16x32_bf16 v[56:59], a[8:11], a[184:187], v[56:59]
ds_read_b64_tr_b16 a[70:71], v18 offset:26624
v_mfma_f32_16x16x32_bf16 v[56:59], a[12:15], a[200:203], v[56:59]
buffer_load_dwordx4 a[152:155], v12, s[4:7], s40 offen offset:2048 sc1
v_mfma_f32_16x16x32_bf16 v[60:63], a[12:15], a[204:207], v[60:63]
v_mfma_f32_16x16x32_bf16 v[60:63], a[8:11], a[188:191], v[60:63]
ds_read_b64_tr_b16 a[72:73], v19 offset:2048
v_mfma_f32_16x16x32_bf16 v[64:67], a[16:19], a[176:179], v[64:67]
ds_read_b64_tr_b16 a[74:75], v19 offset:10240
v_mfma_f32_16x16x32_bf16 v[64:67], a[20:23], a[192:195], v[64:67]
v_mfma_f32_16x16x32_bf16 v[68:71], a[20:23], a[196:199], v[68:71]
ds_read_b64_tr_b16 a[76:77], v19 offset:18432
v_mfma_f32_16x16x32_bf16 v[68:71], a[16:19], a[180:183], v[68:71]
buffer_load_dwordx4 a[156:159], v12, s[4:7], s40 offen offset:3072 sc1
s_add_u32 s40, s40, 16384
v_mfma_f32_16x16x32_bf16 v[72:75], a[16:19], a[184:187], v[72:75]
ds_read_b64_tr_b16 a[78:79], v19 offset:26624
v_mfma_f32_16x16x32_bf16 v[72:75], a[20:23], a[200:203], v[72:75]
v_mfma_f32_16x16x32_bf16 v[76:79], a[20:23], a[204:207], v[76:79]
ds_read_b64_tr_b16 a[80:81], v20 offset:2048
v_mfma_f32_16x16x32_bf16 v[76:79], a[16:19], a[188:191], v[76:79]
ds_read_b64_tr_b16 a[82:83], v20 offset:10240
v_mfma_f32_16x16x32_bf16 v[80:83], a[24:27], a[176:179], v[80:83]
v_mfma_f32_16x16x32_bf16 v[80:83], a[28:31], a[192:195], v[80:83]
ds_read_b64_tr_b16 a[84:85], v20 offset:18432
v_mfma_f32_16x16x32_bf16 v[84:87], a[28:31], a[196:199], v[84:87]
buffer_load_dwordx4 a[160:163], v12, s[4:7], s40 offen offset:0 sc1
v_mfma_f32_16x16x32_bf16 v[84:87], a[24:27], a[180:183], v[84:87]
ds_read_b64_tr_b16 a[86:87], v20 offset:26624
v_mfma_f32_16x16x32_bf16 v[88:91], a[24:27], a[184:187], v[88:91]
v_mfma_f32_16x16x32_bf16 v[88:91], a[28:31], a[200:203], v[88:91]
ds_read_b64_tr_b16 a[88:89], v21 offset:2048
v_mfma_f32_16x16x32_bf16 v[92:95], a[28:31], a[204:207], v[92:95]
ds_read_b64_tr_b16 a[90:91], v21 offset:10240
v_mfma_f32_16x16x32_bf16 v[92:95], a[24:27], a[188:191], v[92:95]
buffer_load_dwordx4 a[164:167], v12, s[4:7], s40 offen offset:1024 sc1
v_mfma_f32_16x16x32_bf16 v[96:99], a[32:35], a[176:179], v[96:99]
v_mfma_f32_16x16x32_bf16 v[96:99], a[36:39], a[192:195], v[96:99]
ds_read_b64_tr_b16 a[92:93], v21 offset:18432
v_mfma_f32_16x16x32_bf16 v[100:103], a[36:39], a[196:199], v[100:103]
ds_read_b64_tr_b16 a[94:95], v21 offset:26624
v_mfma_f32_16x16x32_bf16 v[100:103], a[32:35], a[180:183], v[100:103]
v_mfma_f32_16x16x32_bf16 v[104:107], a[32:35], a[184:187], v[104:107]
ds_read_b64_tr_b16 a[96:97], v22 offset:3072
v_mfma_f32_16x16x32_bf16 v[104:107], a[36:39], a[200:203], v[104:107]
ds_read_b64_tr_b16 a[98:99], v22 offset:11264
v_mfma_f32_16x16x32_bf16 v[108:111], a[36:39], a[204:207], v[108:111]
buffer_load_dwordx4 a[168:171], v12, s[4:7], s40 offen offset:2048 sc1
v_mfma_f32_16x16x32_bf16 v[108:111], a[32:35], a[188:191], v[108:111]
v_mfma_f32_16x16x32_bf16 v[112:115], a[40:43], a[176:179], v[112:115]
ds_read_b64_tr_b16 a[100:101], v22 offset:19456
v_mfma_f32_16x16x32_bf16 v[112:115], a[44:47], a[192:195], v[112:115]
ds_read_b64_tr_b16 a[102:103], v22 offset:27648
v_mfma_f32_16x16x32_bf16 v[116:119], a[44:47], a[196:199], v[116:119]
v_mfma_f32_16x16x32_bf16 v[116:119], a[40:43], a[180:183], v[116:119]
ds_read_b64_tr_b16 a[104:105], v23 offset:3072
v_mfma_f32_16x16x32_bf16 v[120:123], a[40:43], a[184:187], v[120:123]
buffer_load_dwordx4 a[172:175], v12, s[4:7], s40 offen offset:3072 sc1
s_add_u32 s40, s40, 16384
v_mfma_f32_16x16x32_bf16 v[120:123], a[44:47], a[200:203], v[120:123]
ds_read_b64_tr_b16 a[106:107], v23 offset:11264
v_mfma_f32_16x16x32_bf16 v[124:127], a[44:47], a[204:207], v[124:127]
v_mfma_f32_16x16x32_bf16 v[124:127], a[40:43], a[188:191], v[124:127]
ds_read_b64_tr_b16 a[108:109], v23 offset:19456
v_mfma_f32_16x16x32_bf16 v[128:131], a[48:51], a[176:179], v[128:131]
ds_read_b64_tr_b16 a[110:111], v23 offset:27648
v_mfma_f32_16x16x32_bf16 v[128:131], a[52:55], a[192:195], v[128:131]
v_mfma_f32_16x16x32_bf16 v[132:135], a[52:55], a[196:199], v[132:135]
v_mfma_f32_16x16x32_bf16 v[132:135], a[48:51], a[180:183], v[132:135]
v_mfma_f32_16x16x32_bf16 v[136:139], a[48:51], a[184:187], v[136:139]
v_mfma_f32_16x16x32_bf16 v[136:139], a[52:55], a[200:203], v[136:139]
v_mfma_f32_16x16x32_bf16 v[140:143], a[52:55], a[204:207], v[140:143]
v_mfma_f32_16x16x32_bf16 v[140:143], a[48:51], a[188:191], v[140:143]
s_waitcnt vmcnt(41) lgkmcnt(0)
v_mfma_f32_16x16x32_bf16 v[144:147], a[56:59], a[176:179], v[144:147]
v_mfma_f32_16x16x32_bf16 v[144:147], a[60:63], a[192:195], v[144:147]
s_barrier
v_mfma_f32_16x16x32_bf16 v[148:151], a[60:63], a[196:199], v[148:151]
ds_read_b64_tr_b16 a[0:1], v18 offset:32768
s_add_u32 m0, s42, 65536
v_mfma_f32_16x16x32_bf16 v[148:151], a[56:59], a[180:183], v[148:151]
buffer_load_dwordx4 v2, s[8:11], s41 offen offset:0 lds
v_mfma_f32_16x16x32_bf16 v[152:155], a[56:59], a[184:187], v[152:155]
ds_read_b64_tr_b16 a[2:3], v18 offset:40960
v_mfma_f32_16x16x32_bf16 v[152:155], a[60:63], a[200:203], v[152:155]
v_mfma_f32_16x16x32_bf16 v[156:159], a[60:63], a[204:207], v[156:159]
ds_read_b64_tr_b16 a[4:5], v18 offset:49152
v_mfma_f32_16x16x32_bf16 v[156:159], a[56:59], a[188:191], v[156:159]
ds_read_b64_tr_b16 a[6:7], v18 offset:57344
v_mfma_f32_16x16x32_bf16 v[160:163], a[64:67], a[176:179], v[160:163]
buffer_load_dwordx4 v3, s[8:11], s41 offen offset:1024 lds
v_mfma_f32_16x16x32_bf16 v[160:163], a[68:71], a[192:195], v[160:163]
v_mfma_f32_16x16x32_bf16 v[164:167], a[68:71], a[196:199], v[164:167]
ds_read_b64_tr_b16 a[8:9], v19 offset:32768
v_mfma_f32_16x16x32_bf16 v[164:167], a[64:67], a[180:183], v[164:167]
ds_read_b64_tr_b16 a[10:11], v19 offset:40960
v_mfma_f32_16x16x32_bf16 v[168:171], a[64:67], a[184:187], v[168:171]
ds_read_b64_tr_b16 a[12:13], v19 offset:49152
v_mfma_f32_16x16x32_bf16 v[168:171], a[68:71], a[200:203], v[168:171]
v_mfma_f32_16x16x32_bf16 v[172:175], a[68:71], a[204:207], v[172:175]
ds_read_b64_tr_b16 a[14:15], v19 offset:57344
v_mfma_f32_16x16x32_bf16 v[172:175], a[64:67], a[188:191], v[172:175]
buffer_load_dwordx4 v4, s[8:11], s41 offen offset:2048 lds
v_mfma_f32_16x16x32_bf16 v[176:179], a[72:75], a[176:179], v[176:179]
ds_read_b64_tr_b16 a[16:17], v20 offset:32768
v_mfma_f32_16x16x32_bf16 v[176:179], a[76:79], a[192:195], v[176:179]
v_mfma_f32_16x16x32_bf16 v[180:183], a[76:79], a[196:199], v[180:183]
ds_read_b64_tr_b16 a[18:19], v20 offset:40960
v_mfma_f32_16x16x32_bf16 v[180:183], a[72:75], a[180:183], v[180:183]
ds_read_b64_tr_b16 a[20:21], v20 offset:49152
v_mfma_f32_16x16x32_bf16 v[184:187], a[72:75], a[184:187], v[184:187]
buffer_load_dwordx4 v5, s[8:11], s41 offen offset:3072 lds
s_add_u32 s41, s41, 229376
v_mfma_f32_16x16x32_bf16 v[184:187], a[76:79], a[200:203], v[184:187]
v_mfma_f32_16x16x32_bf16 v[188:191], a[76:79], a[204:207], v[188:191]
ds_read_b64_tr_b16 a[22:23], v20 offset:57344
v_mfma_f32_16x16x32_bf16 v[188:191], a[72:75], a[188:191], v[188:191]
ds_read_b64_tr_b16 a[24:25], v21 offset:32768
v_mfma_f32_16x16x32_bf16 v[192:195], a[80:83], a[176:179], v[192:195]
ds_read_b64_tr_b16 a[26:27], v21 offset:40960
v_mfma_f32_16x16x32_bf16 v[192:195], a[84:87], a[192:195], v[192:195]
v_mfma_f32_16x16x32_bf16 v[196:199], a[84:87], a[196:199], v[196:199]
ds_read_b64_tr_b16 a[28:29], v21 offset:49152
s_add_u32 m0, s42, 81920
v_mfma_f32_16x16x32_bf16 v[196:199], a[80:83], a[180:183], v[196:199]
buffer_load_dwordx4 v2, s[8:11], s41 offen offset:0 lds
v_mfma_f32_16x16x32_bf16 v[200:203], a[80:83], a[184:187], v[200:203]
ds_read_b64_tr_b16 a[30:31], v21 offset:57344
v_mfma_f32_16x16x32_bf16 v[200:203], a[84:87], a[200:203], v[200:203]
v_mfma_f32_16x16x32_bf16 v[204:207], a[84:87], a[204:207], v[204:207]
ds_read_b64_tr_b16 a[32:33], v18 offset:33792
v_mfma_f32_16x16x32_bf16 v[204:207], a[80:83], a[188:191], v[204:207]
ds_read_b64_tr_b16 a[34:35], v18 offset:41984
v_mfma_f32_16x16x32_bf16 v[208:211], a[88:91], a[176:179], v[208:211]
buffer_load_dwordx4 v3, s[8:11], s41 offen offset:1024 lds
v_mfma_f32_16x16x32_bf16 v[208:211], a[92:95], a[192:195], v[208:211]
v_mfma_f32_16x16x32_bf16 v[212:215], a[92:95], a[196:199], v[212:215]
ds_read_b64_tr_b16 a[36:37], v18 offset:50176
v_mfma_f32_16x16x32_bf16 v[212:215], a[88:91], a[180:183], v[212:215]
ds_read_b64_tr_b16 a[38:39], v18 offset:58368
v_mfma_f32_16x16x32_bf16 v[216:219], a[88:91], a[184:187], v[216:219]
ds_read_b64_tr_b16 a[40:41], v19 offset:33792
v_mfma_f32_16x16x32_bf16 v[216:219], a[92:95], a[200:203], v[216:219]
v_mfma_f32_16x16x32_bf16 v[220:223], a[92:95], a[204:207], v[220:223]
ds_read_b64_tr_b16 a[42:43], v19 offset:41984
v_mfma_f32_16x16x32_bf16 v[220:223], a[88:91], a[188:191], v[220:223]
buffer_load_dwordx4 v4, s[8:11], s41 offen offset:2048 lds
v_mfma_f32_16x16x32_bf16 v[224:227], a[96:99], a[176:179], v[224:227]
ds_read_b64_tr_b16 a[44:45], v19 offset:50176
v_mfma_f32_16x16x32_bf16 v[224:227], a[100:103], a[192:195], v[224:227]
v_mfma_f32_16x16x32_bf16 v[228:231], a[100:103], a[196:199], v[228:231]
ds_read_b64_tr_b16 a[46:47], v19 offset:58368
v_mfma_f32_16x16x32_bf16 v[228:231], a[96:99], a[180:183], v[228:231]
ds_read_b64_tr_b16 a[48:49], v20 offset:33792
v_mfma_f32_16x16x32_bf16 v[232:235], a[96:99], a[184:187], v[232:235]
buffer_load_dwordx4 v5, s[8:11], s41 offen offset:3072 lds
s_add_u32 s41, s41, 229376
v_mfma_f32_16x16x32_bf16 v[232:235], a[100:103], a[200:203], v[232:235]
v_mfma_f32_16x16x32_bf16 v[236:239], a[100:103], a[204:207], v[236:239]
ds_read_b64_tr_b16 a[50:51], v20 offset:41984
v_mfma_f32_16x16x32_bf16 v[236:239], a[96:99], a[188:191], v[236:239]
ds_read_b64_tr_b16 a[52:53], v20 offset:50176
v_mfma_f32_16x16x32_bf16 v[240:243], a[104:107], a[176:179], v[240:243]
ds_read_b64_tr_b16 a[54:55], v20 offset:58368
v_mfma_f32_16x16x32_bf16 v[240:243], a[108:111], a[192:195], v[240:243]
v_mfma_f32_16x16x32_bf16 v[244:247], a[108:111], a[196:199], v[244:247]
v_mfma_f32_16x16x32_bf16 v[244:247], a[104:107], a[180:183], v[244:247]
v_mfma_f32_16x16x32_bf16 v[248:251], a[104:107], a[184:187], v[248:251]
v_mfma_f32_16x16x32_bf16 v[248:251], a[108:111], a[200:203], v[248:251]
v_mfma_f32_16x16x32_bf16 v[252:255], a[108:111], a[204:207], v[252:255]
v_mfma_f32_16x16x32_bf16 v[252:255], a[104:107], a[188:191], v[252:255]
s_waitcnt vmcnt(41) lgkmcnt(0)
v_mfma_f32_16x16x32_bf16 v[32:35], a[0:3], a[208:211], v[32:35]
ds_read_b64_tr_b16 a[56:57], v21 offset:33792
v_mfma_f32_16x16x32_bf16 v[32:35], a[4:7], a[224:227], v[32:35]
buffer_load_dwordx4 a[176:179], v12, s[4:7], s40 offen offset:0 sc1
v_mfma_f32_16x16x32_bf16 v[36:39], a[4:7], a[228:231], v[36:39]
ds_read_b64_tr_b16 a[58:59], v21 offset:41984
v_mfma_f32_16x16x32_bf16 v[36:39], a[0:3], a[212:215], v[36:39]
v_mfma_f32_16x16x32_bf16 v[40:43], a[0:3], a[216:219], v[40:43]
ds_read_b64_tr_b16 a[60:61], v21 offset:50176
v_mfma_f32_16x16x32_bf16 v[40:43], a[4:7], a[232:235], v[40:43]
ds_read_b64_tr_b16 a[62:63], v21 offset:58368
v_mfma_f32_16x16x32_bf16 v[44:47], a[4:7], a[236:239], v[44:47]
buffer_load_dwordx4 a[180:183], v12, s[4:7], s40 offen offset:1024 sc1
v_mfma_f32_16x16x32_bf16 v[44:47], a[0:3], a[220:223], v[44:47]
v_mfma_f32_16x16x32_bf16 v[48:51], a[8:11], a[208:211], v[48:51]
ds_read_b64_tr_b16 a[64:65], v18 offset:34816
v_mfma_f32_16x16x32_bf16 v[48:51], a[12:15], a[224:227], v[48:51]
ds_read_b64_tr_b16 a[66:67], v18 offset:43008
v_mfma_f32_16x16x32_bf16 v[52:55], a[12:15], a[228:231], v[52:55]
v_mfma_f32_16x16x32_bf16 v[52:55], a[8:11], a[212:215], v[52:55]
ds_read_b64_tr_b16 a[68:69], v18 offset:51200
v_mfma_f32_16x16x32_bf16 v[56:59], a[8:11], a[216:219], v[56:59]
ds_read_b64_tr_b16 a[70:71], v18 offset:59392
v_mfma_f32_16x16x32_bf16 v[56:59], a[12:15], a[232:235], v[56:59]
buffer_load_dwordx4 a[184:187], v12, s[4:7], s40 offen offset:2048 sc1
v_mfma_f32_16x16x32_bf16 v[60:63], a[12:15], a[236:239], v[60:63]
v_mfma_f32_16x16x32_bf16 v[60:63], a[8:11], a[220:223], v[60:63]
ds_read_b64_tr_b16 a[72:73], v19 offset:34816
v_mfma_f32_16x16x32_bf16 v[64:67], a[16:19], a[208:211], v[64:67]
ds_read_b64_tr_b16 a[74:75], v19 offset:43008
v_mfma_f32_16x16x32_bf16 v[64:67], a[20:23], a[224:227], v[64:67]
v_mfma_f32_16x16x32_bf16 v[68:71], a[20:23], a[228:231], v[68:71]
ds_read_b64_tr_b16 a[76:77], v19 offset:51200
v_mfma_f32_16x16x32_bf16 v[68:71], a[16:19], a[212:215], v[68:71]
buffer_load_dwordx4 a[188:191], v12, s[4:7], s40 offen offset:3072 sc1
s_add_u32 s40, s40, 16384
v_mfma_f32_16x16x32_bf16 v[72:75], a[16:19], a[216:219], v[72:75]
ds_read_b64_tr_b16 a[78:79], v19 offset:59392
v_mfma_f32_16x16x32_bf16 v[72:75], a[20:23], a[232:235], v[72:75]
v_mfma_f32_16x16x32_bf16 v[76:79], a[20:23], a[236:239], v[76:79]
ds_read_b64_tr_b16 a[80:81], v20 offset:34816
v_mfma_f32_16x16x32_bf16 v[76:79], a[16:19], a[220:223], v[76:79]
PG4:
s_cbranch_execz PG8
ds_read_b64_tr_b16 a[82:83], v20 offset:43008
v_mfma_f32_16x16x32_bf16 v[80:83], a[24:27], a[208:211], v[80:83]
v_mfma_f32_16x16x32_bf16 v[80:83], a[28:31], a[224:227], v[80:83]
ds_read_b64_tr_b16 a[84:85], v20 offset:51200
v_mfma_f32_16x16x32_bf16 v[84:87], a[28:31], a[228:231], v[84:87]
buffer_load_dwordx4 a[192:195], v12, s[4:7], s40 offen offset:0 sc1
v_mfma_f32_16x16x32_bf16 v[84:87], a[24:27], a[212:215], v[84:87]
ds_read_b64_tr_b16 a[86:87], v20 offset:59392
v_mfma_f32_16x16x32_bf16 v[88:91], a[24:27], a[216:219], v[88:91]
v_mfma_f32_16x16x32_bf16 v[88:91], a[28:31], a[232:235], v[88:91]
ds_read_b64_tr_b16 a[88:89], v21 offset:34816
v_mfma_f32_16x16x32_bf16 v[92:95], a[28:31], a[236:239], v[92:95]
ds_read_b64_tr_b16 a[90:91], v21 offset:43008
v_mfma_f32_16x16x32_bf16 v[92:95], a[24:27], a[220:223], v[92:95]
buffer_load_dwordx4 a[196:199], v12, s[4:7], s40 offen offset:1024 sc1
v_mfma_f32_16x16x32_bf16 v[96:99], a[32:35], a[208:211], v[96:99]
v_mfma_f32_16x16x32_bf16 v[96:99], a[36:39], a[224:227], v[96:99]
ds_read_b64_tr_b16 a[92:93], v21 offset:51200
v_mfma_f32_16x16x32_bf16 v[100:103], a[36:39], a[228:231], v[100:103]
ds_read_b64_tr_b16 a[94:95], v21 offset:59392
v_mfma_f32_16x16x32_bf16 v[100:103], a[32:35], a[212:215], v[100:103]
v_mfma_f32_16x16x32_bf16 v[104:107], a[32:35], a[216:219], v[104:107]
ds_read_b64_tr_b16 a[96:97], v22 offset:35840
v_mfma_f32_16x16x32_bf16 v[104:107], a[36:39], a[232:235], v[104:107]
ds_read_b64_tr_b16 a[98:99], v22 offset:44032
v_mfma_f32_16x16x32_bf16 v[108:111], a[36:39], a[236:239], v[108:111]
buffer_load_dwordx4 a[200:203], v12, s[4:7], s40 offen offset:2048 sc1
v_mfma_f32_16x16x32_bf16 v[108:111], a[32:35], a[220:223], v[108:111]
v_mfma_f32_16x16x32_bf16 v[112:115], a[40:43], a[208:211], v[112:115]
ds_read_b64_tr_b16 a[100:101], v22 offset:52224
v_mfma_f32_16x16x32_bf16 v[112:115], a[44:47], a[224:227], v[112:115]
ds_read_b64_tr_b16 a[102:103], v22 offset:60416
v_mfma_f32_16x16x32_bf16 v[116:119], a[44:47], a[228:231], v[116:119]
v_mfma_f32_16x16x32_bf16 v[116:119], a[40:43], a[212:215], v[116:119]
ds_read_b64_tr_b16 a[104:105], v23 offset:35840
v_mfma_f32_16x16x32_bf16 v[120:123], a[40:43], a[216:219], v[120:123]
buffer_load_dwordx4 a[204:207], v12, s[4:7], s40 offen offset:3072 sc1
s_add_u32 s40, s40, 16384
v_mfma_f32_16x16x32_bf16 v[120:123], a[44:47], a[232:235], v[120:123]
ds_read_b64_tr_b16 a[106:107], v23 offset:44032
v_mfma_f32_16x16x32_bf16 v[124:127], a[44:47], a[236:239], v[124:127]
v_mfma_f32_16x16x32_bf16 v[124:127], a[40:43], a[220:223], v[124:127]
ds_read_b64_tr_b16 a[108:109], v23 offset:52224
v_mfma_f32_16x16x32_bf16 v[128:131], a[48:51], a[208:211], v[128:131]
ds_read_b64_tr_b16 a[110:111], v23 offset:60416
v_mfma_f32_16x16x32_bf16 v[128:131], a[52:55], a[224:227], v[128:131]
v_mfma_f32_16x16x32_bf16 v[132:135], a[52:55], a[228:231], v[132:135]
v_mfma_f32_16x16x32_bf16 v[132:135], a[48:51], a[212:215], v[132:135]
v_mfma_f32_16x16x32_bf16 v[136:139], a[48:51], a[216:219], v[136:139]
v_mfma_f32_16x16x32_bf16 v[136:139], a[52:55], a[232:235], v[136:139]
v_mfma_f32_16x16x32_bf16 v[140:143], a[52:55], a[236:239], v[140:143]
v_mfma_f32_16x16x32_bf16 v[140:143], a[48:51], a[220:223], v[140:143]
s_waitcnt vmcnt(41) lgkmcnt(0)
v_mfma_f32_16x16x32_bf16 v[144:147], a[56:59], a[208:211], v[144:147]
v_mfma_f32_16x16x32_bf16 v[144:147], a[60:63], a[224:227], v[144:147]
s_barrier
v_mfma_f32_16x16x32_bf16 v[148:151], a[60:63], a[228:231], v[148:151]
ds_read_b64_tr_b16 a[0:1], v6 offset:0
s_add_u32 m0, s42, 98304
v_mfma_f32_16x16x32_bf16 v[148:151], a[56:59], a[212:215], v[148:151]
buffer_load_dwordx4 v2, s[8:11], s41 offen offset:0 lds
v_mfma_f32_16x16x32_bf16 v[152:155], a[56:59], a[216:219], v[152:155]
ds_read_b64_tr_b16 a[2:3], v6 offset:8192
v_mfma_f32_16x16x32_bf16 v[152:155], a[60:63], a[232:235], v[152:155]
v_mfma_f32_16x16x32_bf16 v[156:159], a[60:63], a[236:239], v[156:159]
ds_read_b64_tr_b16 a[4:5], v6 offset:16384
v_mfma_f32_16x16x32_bf16 v[156:159], a[56:59], a[220:223], v[156:159]
ds_read_b64_tr_b16 a[6:7], v6 offset:24576
v_mfma_f32_16x16x32_bf16 v[160:163], a[64:67], a[208:211], v[160:163]
buffer_load_dwordx4 v3, s[8:11], s41 offen offset:1024 lds
v_mfma_f32_16x16x32_bf16 v[160:163], a[68:71], a[224:227], v[160:163]
v_mfma_f32_16x16x32_bf16 v[164:167], a[68:71], a[228:231], v[164:167]
ds_read_b64_tr_b16 a[8:9], v7 offset:0
v_mfma_f32_16x16x32_bf16 v[164:167], a[64:67], a[212:215], v[164:167]
ds_read_b64_tr_b16 a[10:11], v7 offset:8192
v_mfma_f32_16x16x32_bf16 v[168:171], a[64:67], a[216:219], v[168:171]
ds_read_b64_tr_b16 a[12:13], v7 offset:16384
v_mfma_f32_16x16x32_bf16 v[168:171], a[68:71], a[232:235], v[168:171]
v_mfma_f32_16x16x32_bf16 v[172:175], a[68:71], a[236:239], v[172:175]
ds_read_b64_tr_b16 a[14:15], v7 offset:24576
v_mfma_f32_16x16x32_bf16 v[172:175], a[64:67], a[220:223], v[172:175]
buffer_load_dwordx4 v4, s[8:11], s41 offen offset:2048 lds
v_mfma_f32_16x16x32_bf16 v[176:179], a[72:75], a[208:211], v[176:179]
ds_read_b64_tr_b16 a[16:17], v8 offset:0
v_mfma_f32_16x16x32_bf16 v[176:179], a[76:79], a[224:227], v[176:179]
v_mfma_f32_16x16x32_bf16 v[180:183], a[76:79], a[228:231], v[180:183]
ds_read_b64_tr_b16 a[18:19], v8 offset:8192
v_mfma_f32_16x16x32_bf16 v[180:183], a[72:75], a[212:215], v[180:183]
ds_read_b64_tr_b16 a[20:21], v8 offset:16384
v_mfma_f32_16x16x32_bf16 v[184:187], a[72:75], a[216:219], v[184:187]
buffer_load_dwordx4 v5, s[8:11], s41 offen offset:3072 lds
s_add_u32 s41, s41, 229376
v_mfma_f32_16x16x32_bf16 v[184:187], a[76:79], a[232:235], v[184:187]
v_mfma_f32_16x16x32_bf16 v[188:191], a[76:79], a[236:239], v[188:191]
ds_read_b64_tr_b16 a[22:23], v8 offset:24576
v_mfma_f32_16x16x32_bf16 v[188:191], a[72:75], a[220:223], v[188:191]
ds_read_b64_tr_b16 a[24:25], v9 offset:0
v_mfma_f32_16x16x32_bf16 v[192:195], a[80:83], a[208:211], v[192:195]
ds_read_b64_tr_b16 a[26:27], v9 offset:8192
v_mfma_f32_16x16x32_bf16 v[192:195], a[84:87], a[224:227], v[192:195]
v_mfma_f32_16x16x32_bf16 v[196:199], a[84:87], a[228:231], v[196:199]
ds_read_b64_tr_b16 a[28:29], v9 offset:16384
s_add_u32 m0, s42, 114688
v_mfma_f32_16x16x32_bf16 v[196:199], a[80:83], a[212:215], v[196:199]
buffer_load_dwordx4 v2, s[8:11], s41 offen offset:0 lds
v_mfma_f32_16x16x32_bf16 v[200:203], a[80:83], a[216:219], v[200:203]
ds_read_b64_tr_b16 a[30:31], v9 offset:24576
v_mfma_f32_16x16x32_bf16 v[200:203], a[84:87], a[232:235], v[200:203]
v_mfma_f32_16x16x32_bf16 v[204:207], a[84:87], a[236:239], v[204:207]
ds_read_b64_tr_b16 a[32:33], v6 offset:1024
v_mfma_f32_16x16x32_bf16 v[204:207], a[80:83], a[220:223], v[204:207]
ds_read_b64_tr_b16 a[34:35], v6 offset:9216
v_mfma_f32_16x16x32_bf16 v[208:211], a[88:91], a[208:211], v[208:211]
buffer_load_dwordx4 v3, s[8:11], s41 offen offset:1024 lds
v_mfma_f32_16x16x32_bf16 v[208:211], a[92:95], a[224:227], v[208:211]
v_mfma_f32_16x16x32_bf16 v[212:215], a[92:95], a[228:231], v[212:215]
ds_read_b64_tr_b16 a[36:37], v6 offset:17408
v_mfma_f32_16x16x32_bf16 v[212:215], a[88:91], a[212:215], v[212:215]
ds_read_b64_tr_b16 a[38:39], v6 offset:25600
v_mfma_f32_16x16x32_bf16 v[216:219], a[88:91], a[216:219], v[216:219]
ds_read_b64_tr_b16 a[40:41], v7 offset:1024
v_mfma_f32_16x16x32_bf16 v[216:219], a[92:95], a[232:235], v[216:219]
v_mfma_f32_16x16x32_bf16 v[220:223], a[92:95], a[236:239], v[220:223]
ds_read_b64_tr_b16 a[42:43], v7 offset:9216
v_mfma_f32_16x16x32_bf16 v[220:223], a[88:91], a[220:223], v[220:223]
buffer_load_dwordx4 v4, s[8:11], s41 offen offset:2048 lds
v_mfma_f32_16x16x32_bf16 v[224:227], a[96:99], a[208:211], v[224:227]
ds_read_b64_tr_b16 a[44:45], v7 offset:17408
v_mfma_f32_16x16x32_bf16 v[224:227], a[100:103], a[224:227], v[224:227]
v_mfma_f32_16x16x32_bf16 v[228:231], a[100:103], a[228:231], v[228:231]
ds_read_b64_tr_b16 a[46:47], v7 offset:25600
v_mfma_f32_16x16x32_bf16 v[228:231], a[96:99], a[212:215], v[228:231]
ds_read_b64_tr_b16 a[48:49], v8 offset:1024
v_mfma_f32_16x16x32_bf16 v[232:235], a[96:99], a[216:219], v[232:235]
buffer_load_dwordx4 v5, s[8:11], s41 offen offset:3072 lds
s_add_u32 s41, s41, 229376
v_mfma_f32_16x16x32_bf16 v[232:235], a[100:103], a[232:235], v[232:235]
v_mfma_f32_16x16x32_bf16 v[236:239], a[100:103], a[236:239], v[236:239]
ds_read_b64_tr_b16 a[50:51], v8 offset:9216
v_mfma_f32_16x16x32_bf16 v[236:239], a[96:99], a[220:223], v[236:239]
ds_read_b64_tr_b16 a[52:53], v8 offset:17408
v_mfma_f32_16x16x32_bf16 v[240:243], a[104:107], a[208:211], v[240:243]
ds_read_b64_tr_b16 a[54:55], v8 offset:25600
v_mfma_f32_16x16x32_bf16 v[240:243], a[108:111], a[224:227], v[240:243]
v_mfma_f32_16x16x32_bf16 v[244:247], a[108:111], a[228:231], v[244:247]
v_mfma_f32_16x16x32_bf16 v[244:247], a[104:107], a[212:215], v[244:247]
v_mfma_f32_16x16x32_bf16 v[248:251], a[104:107], a[216:219], v[248:251]
v_mfma_f32_16x16x32_bf16 v[248:251], a[108:111], a[232:235], v[248:251]
v_mfma_f32_16x16x32_bf16 v[252:255], a[108:111], a[236:239], v[252:255]
v_mfma_f32_16x16x32_bf16 v[252:255], a[104:107], a[220:223], v[252:255]
s_waitcnt vmcnt(40) lgkmcnt(0)
v_mfma_f32_16x16x32_bf16 v[32:35], a[0:3], a[112:115], v[32:35]
ds_read_b64_tr_b16 a[56:57], v9 offset:1024
v_mfma_f32_16x16x32_bf16 v[32:35], a[4:7], a[128:131], v[32:35]
buffer_load_dwordx4 a[208:211], v12, s[4:7], s40 offen offset:0 sc1
v_mfma_f32_16x16x32_bf16 v[36:39], a[4:7], a[132:135], v[36:39]
ds_read_b64_tr_b16 a[58:59], v9 offset:9216
v_mfma_f32_16x16x32_bf16 v[36:39], a[0:3], a[116:119], v[36:39]
v_mfma_f32_16x16x32_bf16 v[40:43], a[0:3], a[120:123], v[40:43]
ds_read_b64_tr_b16 a[60:61], v9 offset:17408
v_mfma_f32_16x16x32_bf16 v[40:43], a[4:7], a[136:139], v[40:43]
ds_read_b64_tr_b16 a[62:63], v9 offset:25600
v_mfma_f32_16x16x32_bf16 v[44:47], a[4:7], a[140:143], v[44:47]
buffer_load_dwordx4 a[212:215], v12, s[4:7], s40 offen offset:1024 sc1
v_mfma_f32_16x16x32_bf16 v[44:47], a[0:3], a[124:127], v[44:47]
v_mfma_f32_16x16x32_bf16 v[48:51], a[8:11], a[112:115], v[48:51]
ds_read_b64_tr_b16 a[64:65], v6 offset:2048
v_mfma_f32_16x16x32_bf16 v[48:51], a[12:15], a[128:131], v[48:51]
ds_read_b64_tr_b16 a[66:67], v6 offset:10240
v_mfma_f32_16x16x32_bf16 v[52:55], a[12:15], a[132:135], v[52:55]
v_mfma_f32_16x16x32_bf16 v[52:55], a[8:11], a[116:119], v[52:55]
ds_read_b64_tr_b16 a[68:69], v6 offset:18432
v_mfma_f32_16x16x32_bf16 v[56:59], a[8:11], a[120:123], v[56:59]
ds_read_b64_tr_b16 a[70:71], v6 offset:26624
v_mfma_f32_16x16x32_bf16 v[56:59], a[12:15], a[136:139], v[56:59]
buffer_load_dwordx4 a[216:219], v12, s[4:7], s40 offen offset:2048 sc1
v_mfma_f32_16x16x32_bf16 v[60:63], a[12:15], a[140:143], v[60:63]
v_mfma_f32_16x16x32_bf16 v[60:63], a[8:11], a[124:127], v[60:63]
ds_read_b64_tr_b16 a[72:73], v7 offset:2048
v_mfma_f32_16x16x32_bf16 v[64:67], a[16:19], a[112:115], v[64:67]
ds_read_b64_tr_b16 a[74:75], v7 offset:10240
v_mfma_f32_16x16x32_bf16 v[64:67], a[20:23], a[128:131], v[64:67]
v_mfma_f32_16x16x32_bf16 v[68:71], a[20:23], a[132:135], v[68:71]
ds_read_b64_tr_b16 a[76:77], v7 offset:18432
v_mfma_f32_16x16x32_bf16 v[68:71], a[16:19], a[116:119], v[68:71]
buffer_load_dwordx4 a[220:223], v12, s[4:7], s40 offen offset:3072 sc1
s_add_u32 s40, s40, 16384
v_mfma_f32_16x16x32_bf16 v[72:75], a[16:19], a[120:123], v[72:75]
ds_read_b64_tr_b16 a[78:79], v7 offset:26624
v_mfma_f32_16x16x32_bf16 v[72:75], a[20:23], a[136:139], v[72:75]
v_mfma_f32_16x16x32_bf16 v[76:79], a[20:23], a[140:143], v[76:79]
ds_read_b64_tr_b16 a[80:81], v8 offset:2048
v_mfma_f32_16x16x32_bf16 v[76:79], a[16:19], a[124:127], v[76:79]
ds_read_b64_tr_b16 a[82:83], v8 offset:10240
v_mfma_f32_16x16x32_bf16 v[80:83], a[24:27], a[112:115], v[80:83]
v_mfma_f32_16x16x32_bf16 v[80:83], a[28:31], a[128:131], v[80:83]
ds_read_b64_tr_b16 a[84:85], v8 offset:18432
v_mfma_f32_16x16x32_bf16 v[84:87], a[28:31], a[132:135], v[84:87]
buffer_load_dwordx4 a[224:227], v12, s[4:7], s40 offen offset:0 sc1
v_mfma_f32_16x16x32_bf16 v[84:87], a[24:27], a[116:119], v[84:87]
ds_read_b64_tr_b16 a[86:87], v8 offset:26624
v_mfma_f32_16x16x32_bf16 v[88:91], a[24:27], a[120:123], v[88:91]
v_mfma_f32_16x16x32_bf16 v[88:91], a[28:31], a[136:139], v[88:91]
ds_read_b64_tr_b16 a[88:89], v9 offset:2048
v_mfma_f32_16x16x32_bf16 v[92:95], a[28:31], a[140:143], v[92:95]
ds_read_b64_tr_b16 a[90:91], v9 offset:10240
v_mfma_f32_16x16x32_bf16 v[92:95], a[24:27], a[124:127], v[92:95]
buffer_load_dwordx4 a[228:231], v12, s[4:7], s40 offen offset:1024 sc1
v_mfma_f32_16x16x32_bf16 v[96:99], a[32:35], a[112:115], v[96:99]
v_mfma_f32_16x16x32_bf16 v[96:99], a[36:39], a[128:131], v[96:99]
ds_read_b64_tr_b16 a[92:93], v9 offset:18432
v_mfma_f32_16x16x32_bf16 v[100:103], a[36:39], a[132:135], v[100:103]
ds_read_b64_tr_b16 a[94:95], v9 offset:26624
v_mfma_f32_16x16x32_bf16 v[100:103], a[32:35], a[116:119], v[100:103]
v_mfma_f32_16x16x32_bf16 v[104:107], a[32:35], a[120:123], v[104:107]
ds_read_b64_tr_b16 a[96:97], v10 offset:3072
v_mfma_f32_16x16x32_bf16 v[104:107], a[36:39], a[136:139], v[104:107]
ds_read_b64_tr_b16 a[98:99], v10 offset:11264
v_mfma_f32_16x16x32_bf16 v[108:111], a[36:39], a[140:143], v[108:111]
buffer_load_dwordx4 a[232:235], v12, s[4:7], s40 offen offset:2048 sc1
v_mfma_f32_16x16x32_bf16 v[108:111], a[32:35], a[124:127], v[108:111]
v_mfma_f32_16x16x32_bf16 v[112:115], a[40:43], a[112:115], v[112:115]
ds_read_b64_tr_b16 a[100:101], v10 offset:19456
v_mfma_f32_16x16x32_bf16 v[112:115], a[44:47], a[128:131], v[112:115]
ds_read_b64_tr_b16 a[102:103], v10 offset:27648
v_mfma_f32_16x16x32_bf16 v[116:119], a[44:47], a[132:135], v[116:119]
v_mfma_f32_16x16x32_bf16 v[116:119], a[40:43], a[116:119], v[116:119]
ds_read_b64_tr_b16 a[104:105], v11 offset:3072
v_mfma_f32_16x16x32_bf16 v[120:123], a[40:43], a[120:123], v[120:123]
buffer_load_dwordx4 a[236:239], v12, s[4:7], s40 offen offset:3072 sc1
s_add_u32 s40, s40, 16384
v_mfma_f32_16x16x32_bf16 v[120:123], a[44:47], a[136:139], v[120:123]
ds_read_b64_tr_b16 a[106:107], v11 offset:11264
v_mfma_f32_16x16x32_bf16 v[124:127], a[44:47], a[140:143], v[124:127]
v_mfma_f32_16x16x32_bf16 v[124:127], a[40:43], a[124:127], v[124:127]
ds_read_b64_tr_b16 a[108:109], v11 offset:19456
v_mfma_f32_16x16x32_bf16 v[128:131], a[48:51], a[112:115], v[128:131]
ds_read_b64_tr_b16 a[110:111], v11 offset:27648
v_mfma_f32_16x16x32_bf16 v[128:131], a[52:55], a[128:131], v[128:131]
v_mfma_f32_16x16x32_bf16 v[132:135], a[52:55], a[132:135], v[132:135]
v_mfma_f32_16x16x32_bf16 v[132:135], a[48:51], a[116:119], v[132:135]
v_mfma_f32_16x16x32_bf16 v[136:139], a[48:51], a[120:123], v[136:139]
v_mfma_f32_16x16x32_bf16 v[136:139], a[52:55], a[136:139], v[136:139]
v_mfma_f32_16x16x32_bf16 v[140:143], a[52:55], a[140:143], v[140:143]
v_mfma_f32_16x16x32_bf16 v[140:143], a[48:51], a[124:127], v[140:143]
s_waitcnt vmcnt(40) lgkmcnt(0)
v_mfma_f32_16x16x32_bf16 v[144:147], a[56:59], a[112:115], v[144:147]
v_mfma_f32_16x16x32_bf16 v[144:147], a[60:63], a[128:131], v[144:147]
s_barrier
v_mfma_f32_16x16x32_bf16 v[148:151], a[60:63], a[132:135], v[148:151]
ds_read_b64_tr_b16 a[0:1], v6 offset:32768
s_add_u32 m0, s42, 0
v_mfma_f32_16x16x32_bf16 v[148:151], a[56:59], a[116:119], v[148:151]
buffer_load_dwordx4 v2, s[8:11], s41 offen offset:0 lds
v_mfma_f32_16x16x32_bf16 v[152:155], a[56:59], a[120:123], v[152:155]
ds_read_b64_tr_b16 a[2:3], v6 offset:40960
v_mfma_f32_16x16x32_bf16 v[152:155], a[60:63], a[136:139], v[152:155]
ds_read_b64_tr_b16 a[4:5], v6 offset:49152
v_mfma_f32_16x16x32_bf16 v[156:159], a[60:63], a[140:143], v[156:159]
v_mfma_f32_16x16x32_bf16 v[156:159], a[56:59], a[124:127], v[156:159]
ds_read_b64_tr_b16 a[6:7], v6 offset:57344
v_mfma_f32_16x16x32_bf16 v[160:163], a[64:67], a[112:115], v[160:163]
buffer_load_dwordx4 v3, s[8:11], s41 offen offset:1024 lds
v_mfma_f32_16x16x32_bf16 v[160:163], a[68:71], a[128:131], v[160:163]
ds_read_b64_tr_b16 a[8:9], v7 offset:32768
v_mfma_f32_16x16x32_bf16 v[164:167], a[68:71], a[132:135], v[164:167]
v_mfma_f32_16x16x32_bf16 v[164:167], a[64:67], a[116:119], v[164:167]
ds_read_b64_tr_b16 a[10:11], v7 offset:40960
v_mfma_f32_16x16x32_bf16 v[168:171], a[64:67], a[120:123], v[168:171]
ds_read_b64_tr_b16 a[12:13], v7 offset:49152
v_mfma_f32_16x16x32_bf16 v[168:171], a[68:71], a[136:139], v[168:171]
buffer_load_dwordx4 v4, s[8:11], s41 offen offset:2048 lds
v_mfma_f32_16x16x32_bf16 v[172:175], a[68:71], a[140:143], v[172:175]
ds_read_b64_tr_b16 a[14:15], v7 offset:57344
v_mfma_f32_16x16x32_bf16 v[172:175], a[64:67], a[124:127], v[172:175]
v_mfma_f32_16x16x32_bf16 v[176:179], a[72:75], a[112:115], v[176:179]
ds_read_b64_tr_b16 a[16:17], v8 offset:32768
v_mfma_f32_16x16x32_bf16 v[176:179], a[76:79], a[128:131], v[176:179]
ds_read_b64_tr_b16 a[18:19], v8 offset:40960
v_mfma_f32_16x16x32_bf16 v[180:183], a[76:79], a[132:135], v[180:183]
buffer_load_dwordx4 v5, s[8:11], s41 offen offset:3072 lds
s_add_u32 s41, s41, 229376
v_mfma_f32_16x16x32_bf16 v[180:183], a[72:75], a[116:119], v[180:183]
v_mfma_f32_16x16x32_bf16 v[184:187], a[72:75], a[120:123], v[184:187]
ds_read_b64_tr_b16 a[20:21], v8 offset:49152
v_mfma_f32_16x16x32_bf16 v[184:187], a[76:79], a[136:139], v[184:187]
ds_read_b64_tr_b16 a[22:23], v8 offset:57344
v_mfma_f32_16x16x32_bf16 v[188:191], a[76:79], a[140:143], v[188:191]
ds_read_b64_tr_b16 a[24:25], v9 offset:32768
v_mfma_f32_16x16x32_bf16 v[188:191], a[72:75], a[124:127], v[188:191]
s_add_u32 m0, s42, 16384
v_mfma_f32_16x16x32_bf16 v[192:195], a[80:83], a[112:115], v[192:195]
buffer_load_dwordx4 v2, s[8:11], s41 offen offset:0 lds
v_mfma_f32_16x16x32_bf16 v[192:195], a[84:87], a[128:131], v[192:195]
ds_read_b64_tr_b16 a[26:27], v9 offset:40960
v_mfma_f32_16x16x32_bf16 v[196:199], a[84:87], a[132:135], v[196:199]
ds_read_b64_tr_b16 a[28:29], v9 offset:49152
v_mfma_f32_16x16x32_bf16 v[196:199], a[80:83], a[116:119], v[196:199]
ds_read_b64_tr_b16 a[30:31], v9 offset:57344
v_mfma_f32_16x16x32_bf16 v[200:203], a[80:83], a[120:123], v[200:203]
v_mfma_f32_16x16x32_bf16 v[200:203], a[84:87], a[136:139], v[200:203]
buffer_load_dwordx4 v3, s[8:11], s41 offen offset:1024 lds
v_mfma_f32_16x16x32_bf16 v[204:207], a[84:87], a[140:143], v[204:207]
ds_read_b64_tr_b16 a[32:33], v6 offset:33792
v_mfma_f32_16x16x32_bf16 v[204:207], a[80:83], a[124:127], v[204:207]
ds_read_b64_tr_b16 a[34:35], v6 offset:41984
v_mfma_f32_16x16x32_bf16 v[208:211], a[88:91], a[112:115], v[208:211]
v_mfma_f32_16x16x32_bf16 v[208:211], a[92:95], a[128:131], v[208:211]
ds_read_b64_tr_b16 a[36:37], v6 offset:50176
v_mfma_f32_16x16x32_bf16 v[212:215], a[92:95], a[132:135], v[212:215]
buffer_load_dwordx4 v4, s[8:11], s41 offen offset:2048 lds
v_mfma_f32_16x16x32_bf16 v[212:215], a[88:91], a[116:119], v[212:215]
ds_read_b64_tr_b16 a[38:39], v6 offset:58368
v_mfma_f32_16x16x32_bf16 v[216:219], a[88:91], a[120:123], v[216:219]
v_mfma_f32_16x16x32_bf16 v[216:219], a[92:95], a[136:139], v[216:219]
ds_read_b64_tr_b16 a[40:41], v7 offset:33792
v_mfma_f32_16x16x32_bf16 v[220:223], a[92:95], a[140:143], v[220:223]
ds_read_b64_tr_b16 a[42:43], v7 offset:41984
v_mfma_f32_16x16x32_bf16 v[220:223], a[88:91], a[124:127], v[220:223]
buffer_load_dwordx4 v5, s[8:11], s41 offen offset:3072 lds
s_add_u32 s41, s41, 229376
v_mfma_f32_16x16x32_bf16 v[224:227], a[96:99], a[112:115], v[224:227]
ds_read_b64_tr_b16 a[44:45], v7 offset:50176
v_mfma_f32_16x16x32_bf16 v[224:227], a[100:103], a[128:131], v[224:227]
v_mfma_f32_16x16x32_bf16 v[228:231], a[100:103], a[132:135], v[228:231]
ds_read_b64_tr_b16 a[46:47], v7 offset:58368
v_mfma_f32_16x16x32_bf16 v[228:231], a[96:99], a[116:119], v[228:231]
ds_read_b64_tr_b16 a[48:49], v8 offset:33792
v_mfma_f32_16x16x32_bf16 v[232:235], a[96:99], a[120:123], v[232:235]
buffer_load_dwordx4 a[252:255], v1, s[52:55], s56 offen
v_mfma_f32_16x16x32_bf16 v[232:235], a[100:103], a[136:139], v[232:235]
v_mfma_f32_16x16x32_bf16 v[236:239], a[100:103], a[140:143], v[236:239]
ds_read_b64_tr_b16 a[50:51], v8 offset:41984
v_mfma_f32_16x16x32_bf16 v[236:239], a[96:99], a[124:127], v[236:239]
ds_read_b64_tr_b16 a[52:53], v8 offset:50176
v_mfma_f32_16x16x32_bf16 v[240:243], a[104:107], a[112:115], v[240:243]
ds_read_b64_tr_b16 a[54:55], v8 offset:58368
v_mfma_f32_16x16x32_bf16 v[240:243], a[108:111], a[128:131], v[240:243]
v_mfma_f32_16x16x32_bf16 v[244:247], a[108:111], a[132:135], v[244:247]
v_mfma_f32_16x16x32_bf16 v[244:247], a[104:107], a[116:119], v[244:247]
v_mfma_f32_16x16x32_bf16 v[248:251], a[104:107], a[120:123], v[248:251]
v_mfma_f32_16x16x32_bf16 v[248:251], a[108:111], a[136:139], v[248:251]
v_mfma_f32_16x16x32_bf16 v[252:255], a[108:111], a[140:143], v[252:255]
v_mfma_f32_16x16x32_bf16 v[252:255], a[104:107], a[124:127], v[252:255]
s_waitcnt vmcnt(41) lgkmcnt(0)
v_mfma_f32_16x16x32_bf16 v[32:35], a[0:3], a[144:147], v[32:35]
ds_read_b64_tr_b16 a[56:57], v9 offset:33792
v_mfma_f32_16x16x32_bf16 v[32:35], a[4:7], a[160:163], v[32:35]
buffer_load_dwordx4 a[112:115], v12, s[4:7], s40 offen offset:0 sc1
v_mfma_f32_16x16x32_bf16 v[36:39], a[4:7], a[164:167], v[36:39]
ds_read_b64_tr_b16 a[58:59], v9 offset:41984
v_mfma_f32_16x16x32_bf16 v[36:39], a[0:3], a[148:151], v[36:39]
v_mfma_f32_16x16x32_bf16 v[40:43], a[0:3], a[152:155], v[40:43]
ds_read_b64_tr_b16 a[60:61], v9 offset:50176
v_mfma_f32_16x16x32_bf16 v[40:43], a[4:7], a[168:171], v[40:43]
ds_read_b64_tr_b16 a[62:63], v9 offset:58368
v_mfma_f32_16x16x32_bf16 v[44:47], a[4:7], a[172:175], v[44:47]
buffer_load_dwordx4 a[116:119], v12, s[4:7], s40 offen offset:1024 sc1
v_mfma_f32_16x16x32_bf16 v[44:47], a[0:3], a[156:159], v[44:47]
v_mfma_f32_16x16x32_bf16 v[48:51], a[8:11], a[144:147], v[48:51]
ds_read_b64_tr_b16 a[64:65], v6 offset:34816
v_mfma_f32_16x16x32_bf16 v[48:51], a[12:15], a[160:163], v[48:51]
ds_read_b64_tr_b16 a[66:67], v6 offset:43008
v_mfma_f32_16x16x32_bf16 v[52:55], a[12:15], a[164:167], v[52:55]
v_mfma_f32_16x16x32_bf16 v[52:55], a[8:11], a[148:151], v[52:55]
ds_read_b64_tr_b16 a[68:69], v6 offset:51200
v_mfma_f32_16x16x32_bf16 v[56:59], a[8:11], a[152:155], v[56:59]
ds_read_b64_tr_b16 a[70:71], v6 offset:59392
v_mfma_f32_16x16x32_bf16 v[56:59], a[12:15], a[168:171], v[56:59]
buffer_load_dwordx4 a[120:123], v12, s[4:7], s40 offen offset:2048 sc1
v_mfma_f32_16x16x32_bf16 v[60:63], a[12:15], a[172:175], v[60:63]
v_mfma_f32_16x16x32_bf16 v[60:63], a[8:11], a[156:159], v[60:63]
ds_read_b64_tr_b16 a[72:73], v7 offset:34816
v_mfma_f32_16x16x32_bf16 v[64:67], a[16:19], a[144:147], v[64:67]
ds_read_b64_tr_b16 a[74:75], v7 offset:43008
v_mfma_f32_16x16x32_bf16 v[64:67], a[20:23], a[160:163], v[64:67]
v_mfma_f32_16x16x32_bf16 v[68:71], a[20:23], a[164:167], v[68:71]
ds_read_b64_tr_b16 a[76:77], v7 offset:51200
v_mfma_f32_16x16x32_bf16 v[68:71], a[16:19], a[148:151], v[68:71]
buffer_load_dwordx4 a[124:127], v12, s[4:7], s40 offen offset:3072 sc1
s_add_u32 s40, s40, 16384
v_mfma_f32_16x16x32_bf16 v[72:75], a[16:19], a[152:155], v[72:75]
ds_read_b64_tr_b16 a[78:79], v7 offset:59392
v_mfma_f32_16x16x32_bf16 v[72:75], a[20:23], a[168:171], v[72:75]
v_mfma_f32_16x16x32_bf16 v[76:79], a[20:23], a[172:175], v[76:79]
ds_read_b64_tr_b16 a[80:81], v8 offset:34816
v_mfma_f32_16x16x32_bf16 v[76:79], a[16:19], a[156:159], v[76:79]
ds_read_b64_tr_b16 a[82:83], v8 offset:43008
v_mfma_f32_16x16x32_bf16 v[80:83], a[24:27], a[144:147], v[80:83]
v_mfma_f32_16x16x32_bf16 v[80:83], a[28:31], a[160:163], v[80:83]
ds_read_b64_tr_b16 a[84:85], v8 offset:51200
v_mfma_f32_16x16x32_bf16 v[84:87], a[28:31], a[164:167], v[84:87]
buffer_load_dwordx4 a[128:131], v12, s[4:7], s40 offen offset:0 sc1
v_mfma_f32_16x16x32_bf16 v[84:87], a[24:27], a[148:151], v[84:87]
ds_read_b64_tr_b16 a[86:87], v8 offset:59392
v_mfma_f32_16x16x32_bf16 v[88:91], a[24:27], a[152:155], v[88:91]
v_mfma_f32_16x16x32_bf16 v[88:91], a[28:31], a[168:171], v[88:91]
ds_read_b64_tr_b16 a[88:89], v9 offset:34816
v_mfma_f32_16x16x32_bf16 v[92:95], a[28:31], a[172:175], v[92:95]
ds_read_b64_tr_b16 a[90:91], v9 offset:43008
v_mfma_f32_16x16x32_bf16 v[92:95], a[24:27], a[156:159], v[92:95]
buffer_load_dwordx4 a[132:135], v12, s[4:7], s40 offen offset:1024 sc1
v_mfma_f32_16x16x32_bf16 v[96:99], a[32:35], a[144:147], v[96:99]
v_mfma_f32_16x16x32_bf16 v[96:99], a[36:39], a[160:163], v[96:99]
ds_read_b64_tr_b16 a[92:93], v9 offset:51200
v_mfma_f32_16x16x32_bf16 v[100:103], a[36:39], a[164:167], v[100:103]
ds_read_b64_tr_b16 a[94:95], v9 offset:59392
v_mfma_f32_16x16x32_bf16 v[100:103], a[32:35], a[148:151], v[100:103]
v_mfma_f32_16x16x32_bf16 v[104:107], a[32:35], a[152:155], v[104:107]
ds_read_b64_tr_b16 a[96:97], v10 offset:35840
v_mfma_f32_16x16x32_bf16 v[104:107], a[36:39], a[168:171], v[104:107]
ds_read_b64_tr_b16 a[98:99], v10 offset:44032
v_mfma_f32_16x16x32_bf16 v[108:111], a[36:39], a[172:175], v[108:111]
buffer_load_dwordx4 a[136:139], v12, s[4:7], s40 offen offset:2048 sc1
v_mfma_f32_16x16x32_bf16 v[108:111], a[32:35], a[156:159], v[108:111]
v_mfma_f32_16x16x32_bf16 v[112:115], a[40:43], a[144:147], v[112:115]
ds_read_b64_tr_b16 a[100:101], v10 offset:52224
v_mfma_f32_16x16x32_bf16 v[112:115], a[44:47], a[160:163], v[112:115]
ds_read_b64_tr_b16 a[102:103], v10 offset:60416
v_mfma_f32_16x16x32_bf16 v[116:119], a[44:47], a[164:167], v[116:119]
v_mfma_f32_16x16x32_bf16 v[116:119], a[40:43], a[148:151], v[116:119]
ds_read_b64_tr_b16 a[104:105], v11 offset:35840
v_mfma_f32_16x16x32_bf16 v[120:123], a[40:43], a[152:155], v[120:123]
buffer_load_dwordx4 a[140:143], v12, s[4:7], s40 offen offset:3072 sc1
s_add_u32 s40, s40, 16384
v_mfma_f32_16x16x32_bf16 v[120:123], a[44:47], a[168:171], v[120:123]
ds_read_b64_tr_b16 a[106:107], v11 offset:44032
v_mfma_f32_16x16x32_bf16 v[124:127], a[44:47], a[172:175], v[124:127]
v_mfma_f32_16x16x32_bf16 v[124:127], a[40:43], a[156:159], v[124:127]
ds_read_b64_tr_b16 a[108:109], v11 offset:52224
v_mfma_f32_16x16x32_bf16 v[128:131], a[48:51], a[144:147], v[128:131]
ds_read_b64_tr_b16 a[110:111], v11 offset:60416
v_mfma_f32_16x16x32_bf16 v[128:131], a[52:55], a[160:163], v[128:131]
v_mfma_f32_16x16x32_bf16 v[132:135], a[52:55], a[164:167], v[132:135]
v_mfma_f32_16x16x32_bf16 v[132:135], a[48:51], a[148:151], v[132:135]
v_mfma_f32_16x16x32_bf16 v[136:139], a[48:51], a[152:155], v[136:139]
v_mfma_f32_16x16x32_bf16 v[136:139], a[52:55], a[168:171], v[136:139]
v_mfma_f32_16x16x32_bf16 v[140:143], a[52:55], a[172:175], v[140:143]
v_mfma_f32_16x16x32_bf16 v[140:143], a[48:51], a[156:159], v[140:143]
s_waitcnt vmcnt(41) lgkmcnt(0)
v_mfma_f32_16x16x32_bf16 v[144:147], a[56:59], a[144:147], v[144:147]
v_mfma_f32_16x16x32_bf16 v[144:147], a[60:63], a[160:163], v[144:147]
s_barrier
v_mfma_f32_16x16x32_bf16 v[148:151], a[60:63], a[164:167], v[148:151]
ds_read_b64_tr_b16 a[0:1], v18 offset:0
s_add_u32 m0, s42, 32768
v_mfma_f32_16x16x32_bf16 v[148:151], a[56:59], a[148:151], v[148:151]
buffer_load_dwordx4 v2, s[8:11], s41 offen offset:0 lds
v_mfma_f32_16x16x32_bf16 v[152:155], a[56:59], a[152:155], v[152:155]
ds_read_b64_tr_b16 a[2:3], v18 offset:8192
v_mfma_f32_16x16x32_bf16 v[152:155], a[60:63], a[168:171], v[152:155]
v_mfma_f32_16x16x32_bf16 v[156:159], a[60:63], a[172:175], v[156:159]
ds_read_b64_tr_b16 a[4:5], v18 offset:16384
v_mfma_f32_16x16x32_bf16 v[156:159], a[56:59], a[156:159], v[156:159]
ds_read_b64_tr_b16 a[6:7], v18 offset:24576
v_mfma_f32_16x16x32_bf16 v[160:163], a[64:67], a[144:147], v[160:163]
buffer_load_dwordx4 v3, s[8:11], s41 offen offset:1024 lds
v_mfma_f32_16x16x32_bf16 v[160:163], a[68:71], a[160:163], v[160:163]
v_mfma_f32_16x16x32_bf16 v[164:167], a[68:71], a[164:167], v[164:167]
ds_read_b64_tr_b16 a[8:9], v19 offset:0
v_mfma_f32_16x16x32_bf16 v[164:167], a[64:67], a[148:151], v[164:167]
ds_read_b64_tr_b16 a[10:11], v19 offset:8192
v_mfma_f32_16x16x32_bf16 v[168:171], a[64:67], a[152:155], v[168:171]
ds_read_b64_tr_b16 a[12:13], v19 offset:16384
v_mfma_f32_16x16x32_bf16 v[168:171], a[68:71], a[168:171], v[168:171]
v_mfma_f32_16x16x32_bf16 v[172:175], a[68:71], a[172:175], v[172:175]
ds_read_b64_tr_b16 a[14:15], v19 offset:24576
v_mfma_f32_16x16x32_bf16 v[172:175], a[64:67], a[156:159], v[172:175]
buffer_load_dwordx4 v4, s[8:11], s41 offen offset:2048 lds
v_mfma_f32_16x16x32_bf16 v[176:179], a[72:75], a[144:147], v[176:179]
ds_read_b64_tr_b16 a[16:17], v20 offset:0
v_mfma_f32_16x16x32_bf16 v[176:179], a[76:79], a[160:163], v[176:179]
v_mfma_f32_16x16x32_bf16 v[180:183], a[76:79], a[164:167], v[180:183]
ds_read_b64_tr_b16 a[18:19], v20 offset:8192
v_mfma_f32_16x16x32_bf16 v[180:183], a[72:75], a[148:151], v[180:183]
ds_read_b64_tr_b16 a[20:21], v20 offset:16384
v_mfma_f32_16x16x32_bf16 v[184:187], a[72:75], a[152:155], v[184:187]
buffer_load_dwordx4 v5, s[8:11], s41 offen offset:3072 lds
s_add_u32 s41, s41, 229376
v_mfma_f32_16x16x32_bf16 v[184:187], a[76:79], a[168:171], v[184:187]
v_mfma_f32_16x16x32_bf16 v[188:191], a[76:79], a[172:175], v[188:191]
ds_read_b64_tr_b16 a[22:23], v20 offset:24576
v_mfma_f32_16x16x32_bf16 v[188:191], a[72:75], a[156:159], v[188:191]
ds_read_b64_tr_b16 a[24:25], v21 offset:0
v_mfma_f32_16x16x32_bf16 v[192:195], a[80:83], a[144:147], v[192:195]
ds_read_b64_tr_b16 a[26:27], v21 offset:8192
v_mfma_f32_16x16x32_bf16 v[192:195], a[84:87], a[160:163], v[192:195]
v_mfma_f32_16x16x32_bf16 v[196:199], a[84:87], a[164:167], v[196:199]
ds_read_b64_tr_b16 a[28:29], v21 offset:16384
s_add_u32 m0, s42, 49152
v_mfma_f32_16x16x32_bf16 v[196:199], a[80:83], a[148:151], v[196:199]
buffer_load_dwordx4 v2, s[8:11], s41 offen offset:0 lds
v_mfma_f32_16x16x32_bf16 v[200:203], a[80:83], a[152:155], v[200:203]
ds_read_b64_tr_b16 a[30:31], v21 offset:24576
v_mfma_f32_16x16x32_bf16 v[200:203], a[84:87], a[168:171], v[200:203]
v_mfma_f32_16x16x32_bf16 v[204:207], a[84:87], a[172:175], v[204:207]
ds_read_b64_tr_b16 a[32:33], v18 offset:1024
v_mfma_f32_16x16x32_bf16 v[204:207], a[80:83], a[156:159], v[204:207]
ds_read_b64_tr_b16 a[34:35], v18 offset:9216
v_mfma_f32_16x16x32_bf16 v[208:211], a[88:91], a[144:147], v[208:211]
buffer_load_dwordx4 v3, s[8:11], s41 offen offset:1024 lds
v_mfma_f32_16x16x32_bf16 v[208:211], a[92:95], a[160:163], v[208:211]
v_mfma_f32_16x16x32_bf16 v[212:215], a[92:95], a[164:167], v[212:215]
ds_read_b64_tr_b16 a[36:37], v18 offset:17408
v_mfma_f32_16x16x32_bf16 v[212:215], a[88:91], a[148:151], v[212:215]
ds_read_b64_tr_b16 a[38:39], v18 offset:25600
v_mfma_f32_16x16x32_bf16 v[216:219], a[88:91], a[152:155], v[216:219]
ds_read_b64_tr_b16 a[40:41], v19 offset:1024
v_mfma_f32_16x16x32_bf16 v[216:219], a[92:95], a[168:171], v[216:219]
v_mfma_f32_16x16x32_bf16 v[220:223], a[92:95], a[172:175], v[220:223]
ds_read_b64_tr_b16 a[42:43], v19 offset:9216
v_mfma_f32_16x16x32_bf16 v[220:223], a[88:91], a[156:159], v[220:223]
buffer_load_dwordx4 v4, s[8:11], s41 offen offset:2048 lds
v_mfma_f32_16x16x32_bf16 v[224:227], a[96:99], a[144:147], v[224:227]
ds_read_b64_tr_b16 a[44:45], v19 offset:17408
v_mfma_f32_16x16x32_bf16 v[224:227], a[100:103], a[160:163], v[224:227]
PG5:
s_cbranch_execz PG9
v_mfma_f32_16x16x32_bf16 v[228:231], a[100:103], a[164:167], v[228:231]
ds_read_b64_tr_b16 a[46:47], v19 offset:25600
v_mfma_f32_16x16x32_bf16 v[228:231], a[96:99], a[148:151], v[228:231]
ds_read_b64_tr_b16 a[48:49], v20 offset:1024
v_mfma_f32_16x16x32_bf16 v[232:235], a[96:99], a[152:155], v[232:235]
buffer_load_dwordx4 v5, s[8:11], s41 offen offset:3072 lds
s_add_u32 s41, s41, 229376
v_mfma_f32_16x16x32_bf16 v[232:235], a[100:103], a[168:171], v[232:235]
v_mfma_f32_16x16x32_bf16 v[236:239], a[100:103], a[172:175], v[236:239]
ds_read_b64_tr_b16 a[50:51], v20 offset:9216
v_mfma_f32_16x16x32_bf16 v[236:239], a[96:99], a[156:159], v[236:239]
ds_read_b64_tr_b16 a[52:53], v20 offset:17408
v_mfma_f32_16x16x32_bf16 v[240:243], a[104:107], a[144:147], v[240:243]
ds_read_b64_tr_b16 a[54:55], v20 offset:25600
v_mfma_f32_16x16x32_bf16 v[240:243], a[108:111], a[160:163], v[240:243]
v_mfma_f32_16x16x32_bf16 v[244:247], a[108:111], a[164:167], v[244:247]
v_mfma_f32_16x16x32_bf16 v[244:247], a[104:107], a[148:151], v[244:247]
v_mfma_f32_16x16x32_bf16 v[248:251], a[104:107], a[152:155], v[248:251]
v_mfma_f32_16x16x32_bf16 v[248:251], a[108:111], a[168:171], v[248:251]
v_mfma_f32_16x16x32_bf16 v[252:255], a[108:111], a[172:175], v[252:255]
v_mfma_f32_16x16x32_bf16 v[252:255], a[104:107], a[156:159], v[252:255]
s_waitcnt vmcnt(41) lgkmcnt(0)
v_mfma_f32_16x16x32_bf16 v[32:35], a[0:3], a[176:179], v[32:35]
ds_read_b64_tr_b16 a[56:57], v21 offset:1024
v_mfma_f32_16x16x32_bf16 v[32:35], a[4:7], a[192:195], v[32:35]
buffer_load_dwordx4 a[144:147], v12, s[4:7], s40 offen offset:0 sc1
v_mfma_f32_16x16x32_bf16 v[36:39], a[4:7], a[196:199], v[36:39]
ds_read_b64_tr_b16 a[58:59], v21 offset:9216
v_mfma_f32_16x16x32_bf16 v[36:39], a[0:3], a[180:183], v[36:39]
v_mfma_f32_16x16x32_bf16 v[40:43], a[0:3], a[184:187], v[40:43]
ds_read_b64_tr_b16 a[60:61], v21 offset:17408
v_mfma_f32_16x16x32_bf16 v[40:43], a[4:7], a[200:203], v[40:43]
ds_read_b64_tr_b16 a[62:63], v21 offset:25600
v_mfma_f32_16x16x32_bf16 v[44:47], a[4:7], a[204:207], v[44:47]
buffer_load_dwordx4 a[148:151], v12, s[4:7], s40 offen offset:1024 sc1
v_mfma_f32_16x16x32_bf16 v[44:47], a[0:3], a[188:191], v[44:47]
v_mfma_f32_16x16x32_bf16 v[48:51], a[8:11], a[176:179], v[48:51]
ds_read_b64_tr_b16 a[64:65], v18 offset:2048
v_mfma_f32_16x16x32_bf16 v[48:51], a[12:15], a[192:195], v[48:51]
ds_read_b64_tr_b16 a[66:67], v18 offset:10240
v_mfma_f32_16x16x32_bf16 v[52:55], a[12:15], a[196:199], v[52:55]
v_mfma_f32_16x16x32_bf16 v[52:55], a[8:11], a[180:183], v[52:55]
ds_read_b64_tr_b16 a[68:69], v18 offset:18432
v_mfma_f32_16x16x32_bf16 v[56:59], a[8:11], a[184:187], v[56:59]
ds_read_b64_tr_b16 a[70:71], v18 offset:26624
v_mfma_f32_16x16x32_bf16 v[56:59], a[12:15], a[200:203], v[56:59]
buffer_load_dwordx4 a[152:155], v12, s[4:7], s40 offen offset:2048 sc1
v_mfma_f32_16x16x32_bf16 v[60:63], a[12:15], a[204:207], v[60:63]
v_mfma_f32_16x16x32_bf16 v[60:63], a[8:11], a[188:191], v[60:63]
ds_read_b64_tr_b16 a[72:73], v19 offset:2048
v_mfma_f32_16x16x32_bf16 v[64:67], a[16:19], a[176:179], v[64:67]
ds_read_b64_tr_b16 a[74:75], v19 offset:10240
v_mfma_f32_16x16x32_bf16 v[64:67], a[20:23], a[192:195], v[64:67]
v_mfma_f32_16x16x32_bf16 v[68:71], a[20:23], a[196:199], v[68:71]
ds_read_b64_tr_b16 a[76:77], v19 offset:18432
v_mfma_f32_16x16x32_bf16 v[68:71], a[16:19], a[180:183], v[68:71]
buffer_load_dwordx4 a[156:159], v12, s[4:7], s40 offen offset:3072 sc1
s_add_u32 s40, s40, 16384
v_mfma_f32_16x16x32_bf16 v[72:75], a[16:19], a[184:187], v[72:75]
ds_read_b64_tr_b16 a[78:79], v19 offset:26624
v_mfma_f32_16x16x32_bf16 v[72:75], a[20:23], a[200:203], v[72:75]
v_mfma_f32_16x16x32_bf16 v[76:79], a[20:23], a[204:207], v[76:79]
ds_read_b64_tr_b16 a[80:81], v20 offset:2048
v_mfma_f32_16x16x32_bf16 v[76:79], a[16:19], a[188:191], v[76:79]
ds_read_b64_tr_b16 a[82:83], v20 offset:10240
v_mfma_f32_16x16x32_bf16 v[80:83], a[24:27], a[176:179], v[80:83]
v_mfma_f32_16x16x32_bf16 v[80:83], a[28:31], a[192:195], v[80:83]
ds_read_b64_tr_b16 a[84:85], v20 offset:18432
v_mfma_f32_16x16x32_bf16 v[84:87], a[28:31], a[196:199], v[84:87]
buffer_load_dwordx4 a[160:163], v12, s[4:7], s40 offen offset:0 sc1
v_mfma_f32_16x16x32_bf16 v[84:87], a[24:27], a[180:183], v[84:87]
ds_read_b64_tr_b16 a[86:87], v20 offset:26624
v_mfma_f32_16x16x32_bf16 v[88:91], a[24:27], a[184:187], v[88:91]
v_mfma_f32_16x16x32_bf16 v[88:91], a[28:31], a[200:203], v[88:91]
ds_read_b64_tr_b16 a[88:89], v21 offset:2048
v_mfma_f32_16x16x32_bf16 v[92:95], a[28:31], a[204:207], v[92:95]
ds_read_b64_tr_b16 a[90:91], v21 offset:10240
v_mfma_f32_16x16x32_bf16 v[92:95], a[24:27], a[188:191], v[92:95]
buffer_load_dwordx4 a[164:167], v12, s[4:7], s40 offen offset:1024 sc1
v_mfma_f32_16x16x32_bf16 v[96:99], a[32:35], a[176:179], v[96:99]
v_mfma_f32_16x16x32_bf16 v[96:99], a[36:39], a[192:195], v[96:99]
ds_read_b64_tr_b16 a[92:93], v21 offset:18432
v_mfma_f32_16x16x32_bf16 v[100:103], a[36:39], a[196:199], v[100:103]
ds_read_b64_tr_b16 a[94:95], v21 offset:26624
v_mfma_f32_16x16x32_bf16 v[100:103], a[32:35], a[180:183], v[100:103]
v_mfma_f32_16x16x32_bf16 v[104:107], a[32:35], a[184:187], v[104:107]
ds_read_b64_tr_b16 a[96:97], v22 offset:3072
v_mfma_f32_16x16x32_bf16 v[104:107], a[36:39], a[200:203], v[104:107]
ds_read_b64_tr_b16 a[98:99], v22 offset:11264
v_mfma_f32_16x16x32_bf16 v[108:111], a[36:39], a[204:207], v[108:111]
buffer_load_dwordx4 a[168:171], v12, s[4:7], s40 offen offset:2048 sc1
v_mfma_f32_16x16x32_bf16 v[108:111], a[32:35], a[188:191], v[108:111]
v_mfma_f32_16x16x32_bf16 v[112:115], a[40:43], a[176:179], v[112:115]
ds_read_b64_tr_b16 a[100:101], v22 offset:19456
v_mfma_f32_16x16x32_bf16 v[112:115], a[44:47], a[192:195], v[112:115]
ds_read_b64_tr_b16 a[102:103], v22 offset:27648
v_mfma_f32_16x16x32_bf16 v[116:119], a[44:47], a[196:199], v[116:119]
v_mfma_f32_16x16x32_bf16 v[116:119], a[40:43], a[180:183], v[116:119]
ds_read_b64_tr_b16 a[104:105], v23 offset:3072
v_mfma_f32_16x16x32_bf16 v[120:123], a[40:43], a[184:187], v[120:123]
buffer_load_dwordx4 a[172:175], v12, s[4:7], s40 offen offset:3072 sc1
s_add_u32 s40, s40, 16384
v_mfma_f32_16x16x32_bf16 v[120:123], a[44:47], a[200:203], v[120:123]
ds_read_b64_tr_b16 a[106:107], v23 offset:11264
v_mfma_f32_16x16x32_bf16 v[124:127], a[44:47], a[204:207], v[124:127]
v_mfma_f32_16x16x32_bf16 v[124:127], a[40:43], a[188:191], v[124:127]
ds_read_b64_tr_b16 a[108:109], v23 offset:19456
v_mfma_f32_16x16x32_bf16 v[128:131], a[48:51], a[176:179], v[128:131]
ds_read_b64_tr_b16 a[110:111], v23 offset:27648
v_mfma_f32_16x16x32_bf16 v[128:131], a[52:55], a[192:195], v[128:131]
v_mfma_f32_16x16x32_bf16 v[132:135], a[52:55], a[196:199], v[132:135]
v_mfma_f32_16x16x32_bf16 v[132:135], a[48:51], a[180:183], v[132:135]
v_mfma_f32_16x16x32_bf16 v[136:139], a[48:51], a[184:187], v[136:139]
v_mfma_f32_16x16x32_bf16 v[136:139], a[52:55], a[200:203], v[136:139]
v_mfma_f32_16x16x32_bf16 v[140:143], a[52:55], a[204:207], v[140:143]
v_mfma_f32_16x16x32_bf16 v[140:143], a[48:51], a[188:191], v[140:143]
s_waitcnt vmcnt(41) lgkmcnt(0)
v_mfma_f32_16x16x32_bf16 v[144:147], a[56:59], a[176:179], v[144:147]
v_mfma_f32_16x16x32_bf16 v[144:147], a[60:63], a[192:195], v[144:147]
s_barrier
v_mfma_f32_16x16x32_bf16 v[148:151], a[60:63], a[196:199], v[148:151]
ds_read_b64_tr_b16 a[0:1], v18 offset:32768
s_add_u32 m0, s42, 65536
v_mfma_f32_16x16x32_bf16 v[148:151], a[56:59], a[180:183], v[148:151]
buffer_load_dwordx4 v2, s[8:11], s41 offen offset:0 lds
v_mfma_f32_16x16x32_bf16 v[152:155], a[56:59], a[184:187], v[152:155]
ds_read_b64_tr_b16 a[2:3], v18 offset:40960
v_mfma_f32_16x16x32_bf16 v[152:155], a[60:63], a[200:203], v[152:155]
v_mfma_f32_16x16x32_bf16 v[156:159], a[60:63], a[204:207], v[156:159]
ds_read_b64_tr_b16 a[4:5], v18 offset:49152
v_mfma_f32_16x16x32_bf16 v[156:159], a[56:59], a[188:191], v[156:159]
ds_read_b64_tr_b16 a[6:7], v18 offset:57344
v_mfma_f32_16x16x32_bf16 v[160:163], a[64:67], a[176:179], v[160:163]
buffer_load_dwordx4 v3, s[8:11], s41 offen offset:1024 lds
v_mfma_f32_16x16x32_bf16 v[160:163], a[68:71], a[192:195], v[160:163]
v_mfma_f32_16x16x32_bf16 v[164:167], a[68:71], a[196:199], v[164:167]
ds_read_b64_tr_b16 a[8:9], v19 offset:32768
v_mfma_f32_16x16x32_bf16 v[164:167], a[64:67], a[180:183], v[164:167]
ds_read_b64_tr_b16 a[10:11], v19 offset:40960
v_mfma_f32_16x16x32_bf16 v[168:171], a[64:67], a[184:187], v[168:171]
ds_read_b64_tr_b16 a[12:13], v19 offset:49152
v_mfma_f32_16x16x32_bf16 v[168:171], a[68:71], a[200:203], v[168:171]
v_mfma_f32_16x16x32_bf16 v[172:175], a[68:71], a[204:207], v[172:175]
ds_read_b64_tr_b16 a[14:15], v19 offset:57344
v_mfma_f32_16x16x32_bf16 v[172:175], a[64:67], a[188:191], v[172:175]
buffer_load_dwordx4 v4, s[8:11], s41 offen offset:2048 lds
v_mfma_f32_16x16x32_bf16 v[176:179], a[72:75], a[176:179], v[176:179]
ds_read_b64_tr_b16 a[16:17], v20 offset:32768
v_mfma_f32_16x16x32_bf16 v[176:179], a[76:79], a[192:195], v[176:179]
v_mfma_f32_16x16x32_bf16 v[180:183], a[76:79], a[196:199], v[180:183]
ds_read_b64_tr_b16 a[18:19], v20 offset:40960
v_mfma_f32_16x16x32_bf16 v[180:183], a[72:75], a[180:183], v[180:183]
ds_read_b64_tr_b16 a[20:21], v20 offset:49152
v_mfma_f32_16x16x32_bf16 v[184:187], a[72:75], a[184:187], v[184:187]
buffer_load_dwordx4 v5, s[8:11], s41 offen offset:3072 lds
s_add_u32 s41, s41, 229376
v_mfma_f32_16x16x32_bf16 v[184:187], a[76:79], a[200:203], v[184:187]
v_mfma_f32_16x16x32_bf16 v[188:191], a[76:79], a[204:207], v[188:191]
ds_read_b64_tr_b16 a[22:23], v20 offset:57344
v_mfma_f32_16x16x32_bf16 v[188:191], a[72:75], a[188:191], v[188:191]
ds_read_b64_tr_b16 a[24:25], v21 offset:32768
v_mfma_f32_16x16x32_bf16 v[192:195], a[80:83], a[176:179], v[192:195]
ds_read_b64_tr_b16 a[26:27], v21 offset:40960
v_mfma_f32_16x16x32_bf16 v[192:195], a[84:87], a[192:195], v[192:195]
v_mfma_f32_16x16x32_bf16 v[196:199], a[84:87], a[196:199], v[196:199]
ds_read_b64_tr_b16 a[28:29], v21 offset:49152
s_add_u32 m0, s42, 81920
v_mfma_f32_16x16x32_bf16 v[196:199], a[80:83], a[180:183], v[196:199]
buffer_load_dwordx4 v2, s[8:11], s41 offen offset:0 lds
v_mfma_f32_16x16x32_bf16 v[200:203], a[80:83], a[184:187], v[200:203]
ds_read_b64_tr_b16 a[30:31], v21 offset:57344
v_mfma_f32_16x16x32_bf16 v[200:203], a[84:87], a[200:203], v[200:203]
v_mfma_f32_16x16x32_bf16 v[204:207], a[84:87], a[204:207], v[204:207]
ds_read_b64_tr_b16 a[32:33], v18 offset:33792
v_mfma_f32_16x16x32_bf16 v[204:207], a[80:83], a[188:191], v[204:207]
ds_read_b64_tr_b16 a[34:35], v18 offset:41984
v_mfma_f32_16x16x32_bf16 v[208:211], a[88:91], a[176:179], v[208:211]
buffer_load_dwordx4 v3, s[8:11], s41 offen offset:1024 lds
v_mfma_f32_16x16x32_bf16 v[208:211], a[92:95], a[192:195], v[208:211]
v_mfma_f32_16x16x32_bf16 v[212:215], a[92:95], a[196:199], v[212:215]
ds_read_b64_tr_b16 a[36:37], v18 offset:50176
v_mfma_f32_16x16x32_bf16 v[212:215], a[88:91], a[180:183], v[212:215]
ds_read_b64_tr_b16 a[38:39], v18 offset:58368
v_mfma_f32_16x16x32_bf16 v[216:219], a[88:91], a[184:187], v[216:219]
ds_read_b64_tr_b16 a[40:41], v19 offset:33792
v_mfma_f32_16x16x32_bf16 v[216:219], a[92:95], a[200:203], v[216:219]
v_mfma_f32_16x16x32_bf16 v[220:223], a[92:95], a[204:207], v[220:223]
ds_read_b64_tr_b16 a[42:43], v19 offset:41984
v_mfma_f32_16x16x32_bf16 v[220:223], a[88:91], a[188:191], v[220:223]
buffer_load_dwordx4 v4, s[8:11], s41 offen offset:2048 lds
v_mfma_f32_16x16x32_bf16 v[224:227], a[96:99], a[176:179], v[224:227]
ds_read_b64_tr_b16 a[44:45], v19 offset:50176
v_mfma_f32_16x16x32_bf16 v[224:227], a[100:103], a[192:195], v[224:227]
v_mfma_f32_16x16x32_bf16 v[228:231], a[100:103], a[196:199], v[228:231]
ds_read_b64_tr_b16 a[46:47], v19 offset:58368
v_mfma_f32_16x16x32_bf16 v[228:231], a[96:99], a[180:183], v[228:231]
ds_read_b64_tr_b16 a[48:49], v20 offset:33792
v_mfma_f32_16x16x32_bf16 v[232:235], a[96:99], a[184:187], v[232:235]
buffer_load_dwordx4 v5, s[8:11], s41 offen offset:3072 lds
s_add_u32 s41, s41, 229376
v_mfma_f32_16x16x32_bf16 v[232:235], a[100:103], a[200:203], v[232:235]
v_mfma_f32_16x16x32_bf16 v[236:239], a[100:103], a[204:207], v[236:239]
ds_read_b64_tr_b16 a[50:51], v20 offset:41984
v_mfma_f32_16x16x32_bf16 v[236:239], a[96:99], a[188:191], v[236:239]
ds_read_b64_tr_b16 a[52:53], v20 offset:50176
v_mfma_f32_16x16x32_bf16 v[240:243], a[104:107], a[176:179], v[240:243]
ds_read_b64_tr_b16 a[54:55], v20 offset:58368
v_mfma_f32_16x16x32_bf16 v[240:243], a[108:111], a[192:195], v[240:243]
v_mfma_f32_16x16x32_bf16 v[244:247], a[108:111], a[196:199], v[244:247]
v_mfma_f32_16x16x32_bf16 v[244:247], a[104:107], a[180:183], v[244:247]
v_mfma_f32_16x16x32_bf16 v[248:251], a[104:107], a[184:187], v[248:251]
v_mfma_f32_16x16x32_bf16 v[248:251], a[108:111], a[200:203], v[248:251]
v_mfma_f32_16x16x32_bf16 v[252:255], a[108:111], a[204:207], v[252:255]
v_mfma_f32_16x16x32_bf16 v[252:255], a[104:107], a[188:191], v[252:255]
s_waitcnt vmcnt(41) lgkmcnt(0)
v_mfma_f32_16x16x32_bf16 v[32:35], a[0:3], a[208:211], v[32:35]
ds_read_b64_tr_b16 a[56:57], v21 offset:33792
v_mfma_f32_16x16x32_bf16 v[32:35], a[4:7], a[224:227], v[32:35]
buffer_load_dwordx4 a[176:179], v12, s[4:7], s40 offen offset:0 sc1
v_mfma_f32_16x16x32_bf16 v[36:39], a[4:7], a[228:231], v[36:39]
ds_read_b64_tr_b16 a[58:59], v21 offset:41984
v_mfma_f32_16x16x32_bf16 v[36:39], a[0:3], a[212:215], v[36:39]
v_mfma_f32_16x16x32_bf16 v[40:43], a[0:3], a[216:219], v[40:43]
ds_read_b64_tr_b16 a[60:61], v21 offset:50176
v_mfma_f32_16x16x32_bf16 v[40:43], a[4:7], a[232:235], v[40:43]
ds_read_b64_tr_b16 a[62:63], v21 offset:58368
v_mfma_f32_16x16x32_bf16 v[44:47], a[4:7], a[236:239], v[44:47]
buffer_load_dwordx4 a[180:183], v12, s[4:7], s40 offen offset:1024 sc1
v_mfma_f32_16x16x32_bf16 v[44:47], a[0:3], a[220:223], v[44:47]
v_mfma_f32_16x16x32_bf16 v[48:51], a[8:11], a[208:211], v[48:51]
ds_read_b64_tr_b16 a[64:65], v18 offset:34816
v_mfma_f32_16x16x32_bf16 v[48:51], a[12:15], a[224:227], v[48:51]
ds_read_b64_tr_b16 a[66:67], v18 offset:43008
v_mfma_f32_16x16x32_bf16 v[52:55], a[12:15], a[228:231], v[52:55]
v_mfma_f32_16x16x32_bf16 v[52:55], a[8:11], a[212:215], v[52:55]
ds_read_b64_tr_b16 a[68:69], v18 offset:51200
v_mfma_f32_16x16x32_bf16 v[56:59], a[8:11], a[216:219], v[56:59]
ds_read_b64_tr_b16 a[70:71], v18 offset:59392
v_mfma_f32_16x16x32_bf16 v[56:59], a[12:15], a[232:235], v[56:59]
buffer_load_dwordx4 a[184:187], v12, s[4:7], s40 offen offset:2048 sc1
v_mfma_f32_16x16x32_bf16 v[60:63], a[12:15], a[236:239], v[60:63]
v_mfma_f32_16x16x32_bf16 v[60:63], a[8:11], a[220:223], v[60:63]
ds_read_b64_tr_b16 a[72:73], v19 offset:34816
v_mfma_f32_16x16x32_bf16 v[64:67], a[16:19], a[208:211], v[64:67]
ds_read_b64_tr_b16 a[74:75], v19 offset:43008
v_mfma_f32_16x16x32_bf16 v[64:67], a[20:23], a[224:227], v[64:67]
v_mfma_f32_16x16x32_bf16 v[68:71], a[20:23], a[228:231], v[68:71]
ds_read_b64_tr_b16 a[76:77], v19 offset:51200
v_mfma_f32_16x16x32_bf16 v[68:71], a[16:19], a[212:215], v[68:71]
buffer_load_dwordx4 a[188:191], v12, s[4:7], s40 offen offset:3072 sc1
s_add_u32 s40, s40, 16384
v_mfma_f32_16x16x32_bf16 v[72:75], a[16:19], a[216:219], v[72:75]
ds_read_b64_tr_b16 a[78:79], v19 offset:59392
v_mfma_f32_16x16x32_bf16 v[72:75], a[20:23], a[232:235], v[72:75]
v_mfma_f32_16x16x32_bf16 v[76:79], a[20:23], a[236:239], v[76:79]
ds_read_b64_tr_b16 a[80:81], v20 offset:34816
v_mfma_f32_16x16x32_bf16 v[76:79], a[16:19], a[220:223], v[76:79]
ds_read_b64_tr_b16 a[82:83], v20 offset:43008
v_mfma_f32_16x16x32_bf16 v[80:83], a[24:27], a[208:211], v[80:83]
v_mfma_f32_16x16x32_bf16 v[80:83], a[28:31], a[224:227], v[80:83]
ds_read_b64_tr_b16 a[84:85], v20 offset:51200
v_mfma_f32_16x16x32_bf16 v[84:87], a[28:31], a[228:231], v[84:87]
buffer_load_dwordx4 a[192:195], v12, s[4:7], s40 offen offset:0 sc1
v_mfma_f32_16x16x32_bf16 v[84:87], a[24:27], a[212:215], v[84:87]
ds_read_b64_tr_b16 a[86:87], v20 offset:59392
v_mfma_f32_16x16x32_bf16 v[88:91], a[24:27], a[216:219], v[88:91]
v_mfma_f32_16x16x32_bf16 v[88:91], a[28:31], a[232:235], v[88:91]
ds_read_b64_tr_b16 a[88:89], v21 offset:34816
v_mfma_f32_16x16x32_bf16 v[92:95], a[28:31], a[236:239], v[92:95]
ds_read_b64_tr_b16 a[90:91], v21 offset:43008
v_mfma_f32_16x16x32_bf16 v[92:95], a[24:27], a[220:223], v[92:95]
buffer_load_dwordx4 a[196:199], v12, s[4:7], s40 offen offset:1024 sc1
v_mfma_f32_16x16x32_bf16 v[96:99], a[32:35], a[208:211], v[96:99]
v_mfma_f32_16x16x32_bf16 v[96:99], a[36:39], a[224:227], v[96:99]
ds_read_b64_tr_b16 a[92:93], v21 offset:51200
v_mfma_f32_16x16x32_bf16 v[100:103], a[36:39], a[228:231], v[100:103]
ds_read_b64_tr_b16 a[94:95], v21 offset:59392
v_mfma_f32_16x16x32_bf16 v[100:103], a[32:35], a[212:215], v[100:103]
v_mfma_f32_16x16x32_bf16 v[104:107], a[32:35], a[216:219], v[104:107]
ds_read_b64_tr_b16 a[96:97], v22 offset:35840
v_mfma_f32_16x16x32_bf16 v[104:107], a[36:39], a[232:235], v[104:107]
ds_read_b64_tr_b16 a[98:99], v22 offset:44032
v_mfma_f32_16x16x32_bf16 v[108:111], a[36:39], a[236:239], v[108:111]
buffer_load_dwordx4 a[200:203], v12, s[4:7], s40 offen offset:2048 sc1
v_mfma_f32_16x16x32_bf16 v[108:111], a[32:35], a[220:223], v[108:111]
v_mfma_f32_16x16x32_bf16 v[112:115], a[40:43], a[208:211], v[112:115]
ds_read_b64_tr_b16 a[100:101], v22 offset:52224
v_mfma_f32_16x16x32_bf16 v[112:115], a[44:47], a[224:227], v[112:115]
ds_read_b64_tr_b16 a[102:103], v22 offset:60416
v_mfma_f32_16x16x32_bf16 v[116:119], a[44:47], a[228:231], v[116:119]
v_mfma_f32_16x16x32_bf16 v[116:119], a[40:43], a[212:215], v[116:119]
ds_read_b64_tr_b16 a[104:105], v23 offset:35840
v_mfma_f32_16x16x32_bf16 v[120:123], a[40:43], a[216:219], v[120:123]
buffer_load_dwordx4 a[204:207], v12, s[4:7], s40 offen offset:3072 sc1
s_add_u32 s40, s40, 16384
v_mfma_f32_16x16x32_bf16 v[120:123], a[44:47], a[232:235], v[120:123]
ds_read_b64_tr_b16 a[106:107], v23 offset:44032
v_mfma_f32_16x16x32_bf16 v[124:127], a[44:47], a[236:239], v[124:127]
v_mfma_f32_16x16x32_bf16 v[124:127], a[40:43], a[220:223], v[124:127]
ds_read_b64_tr_b16 a[108:109], v23 offset:52224
v_mfma_f32_16x16x32_bf16 v[128:131], a[48:51], a[208:211], v[128:131]
ds_read_b64_tr_b16 a[110:111], v23 offset:60416
v_mfma_f32_16x16x32_bf16 v[128:131], a[52:55], a[224:227], v[128:131]
v_mfma_f32_16x16x32_bf16 v[132:135], a[52:55], a[228:231], v[132:135]
v_mfma_f32_16x16x32_bf16 v[132:135], a[48:51], a[212:215], v[132:135]
v_mfma_f32_16x16x32_bf16 v[136:139], a[48:51], a[216:219], v[136:139]
v_mfma_f32_16x16x32_bf16 v[136:139], a[52:55], a[232:235], v[136:139]
v_mfma_f32_16x16x32_bf16 v[140:143], a[52:55], a[236:239], v[140:143]
v_mfma_f32_16x16x32_bf16 v[140:143], a[48:51], a[220:223], v[140:143]
s_waitcnt vmcnt(41) lgkmcnt(0)
v_mfma_f32_16x16x32_bf16 v[144:147], a[56:59], a[208:211], v[144:147]
v_mfma_f32_16x16x32_bf16 v[144:147], a[60:63], a[224:227], v[144:147]
s_barrier
v_mfma_f32_16x16x32_bf16 v[148:151], a[60:63], a[228:231], v[148:151]
ds_read_b64_tr_b16 a[0:1], v6 offset:0
s_add_u32 m0, s42, 98304
v_mfma_f32_16x16x32_bf16 v[148:151], a[56:59], a[212:215], v[148:151]
buffer_load_dwordx4 v2, s[8:11], s41 offen offset:0 lds
v_mfma_f32_16x16x32_bf16 v[152:155], a[56:59], a[216:219], v[152:155]
ds_read_b64_tr_b16 a[2:3], v6 offset:8192
v_mfma_f32_16x16x32_bf16 v[152:155], a[60:63], a[232:235], v[152:155]
v_mfma_f32_16x16x32_bf16 v[156:159], a[60:63], a[236:239], v[156:159]
ds_read_b64_tr_b16 a[4:5], v6 offset:16384
v_mfma_f32_16x16x32_bf16 v[156:159], a[56:59], a[220:223], v[156:159]
ds_read_b64_tr_b16 a[6:7], v6 offset:24576
v_mfma_f32_16x16x32_bf16 v[160:163], a[64:67], a[208:211], v[160:163]
buffer_load_dwordx4 v3, s[8:11], s41 offen offset:1024 lds
v_mfma_f32_16x16x32_bf16 v[160:163], a[68:71], a[224:227], v[160:163]
v_mfma_f32_16x16x32_bf16 v[164:167], a[68:71], a[228:231], v[164:167]
ds_read_b64_tr_b16 a[8:9], v7 offset:0
v_mfma_f32_16x16x32_bf16 v[164:167], a[64:67], a[212:215], v[164:167]
ds_read_b64_tr_b16 a[10:11], v7 offset:8192
v_mfma_f32_16x16x32_bf16 v[168:171], a[64:67], a[216:219], v[168:171]
ds_read_b64_tr_b16 a[12:13], v7 offset:16384
v_mfma_f32_16x16x32_bf16 v[168:171], a[68:71], a[232:235], v[168:171]
v_mfma_f32_16x16x32_bf16 v[172:175], a[68:71], a[236:239], v[172:175]
ds_read_b64_tr_b16 a[14:15], v7 offset:24576
v_mfma_f32_16x16x32_bf16 v[172:175], a[64:67], a[220:223], v[172:175]
buffer_load_dwordx4 v4, s[8:11], s41 offen offset:2048 lds
v_mfma_f32_16x16x32_bf16 v[176:179], a[72:75], a[208:211], v[176:179]
ds_read_b64_tr_b16 a[16:17], v8 offset:0
v_mfma_f32_16x16x32_bf16 v[176:179], a[76:79], a[224:227], v[176:179]
v_mfma_f32_16x16x32_bf16 v[180:183], a[76:79], a[228:231], v[180:183]
ds_read_b64_tr_b16 a[18:19], v8 offset:8192
v_mfma_f32_16x16x32_bf16 v[180:183], a[72:75], a[212:215], v[180:183]
ds_read_b64_tr_b16 a[20:21], v8 offset:16384
v_mfma_f32_16x16x32_bf16 v[184:187], a[72:75], a[216:219], v[184:187]
buffer_load_dwordx4 v5, s[8:11], s41 offen offset:3072 lds
s_add_u32 s41, s41, 229376
v_mfma_f32_16x16x32_bf16 v[184:187], a[76:79], a[232:235], v[184:187]
v_mfma_f32_16x16x32_bf16 v[188:191], a[76:79], a[236:239], v[188:191]
ds_read_b64_tr_b16 a[22:23], v8 offset:24576
v_mfma_f32_16x16x32_bf16 v[188:191], a[72:75], a[220:223], v[188:191]
ds_read_b64_tr_b16 a[24:25], v9 offset:0
v_mfma_f32_16x16x32_bf16 v[192:195], a[80:83], a[208:211], v[192:195]
ds_read_b64_tr_b16 a[26:27], v9 offset:8192
v_mfma_f32_16x16x32_bf16 v[192:195], a[84:87], a[224:227], v[192:195]
v_mfma_f32_16x16x32_bf16 v[196:199], a[84:87], a[228:231], v[196:199]
ds_read_b64_tr_b16 a[28:29], v9 offset:16384
s_add_u32 m0, s42, 114688
v_mfma_f32_16x16x32_bf16 v[196:199], a[80:83], a[212:215], v[196:199]
buffer_load_dwordx4 v2, s[8:11], s41 offen offset:0 lds
v_mfma_f32_16x16x32_bf16 v[200:203], a[80:83], a[216:219], v[200:203]
ds_read_b64_tr_b16 a[30:31], v9 offset:24576
v_mfma_f32_16x16x32_bf16 v[200:203], a[84:87], a[232:235], v[200:203]
v_mfma_f32_16x16x32_bf16 v[204:207], a[84:87], a[236:239], v[204:207]
ds_read_b64_tr_b16 a[32:33], v6 offset:1024
v_mfma_f32_16x16x32_bf16 v[204:207], a[80:83], a[220:223], v[204:207]
ds_read_b64_tr_b16 a[34:35], v6 offset:9216
v_mfma_f32_16x16x32_bf16 v[208:211], a[88:91], a[208:211], v[208:211]
buffer_load_dwordx4 v3, s[8:11], s41 offen offset:1024 lds
v_mfma_f32_16x16x32_bf16 v[208:211], a[92:95], a[224:227], v[208:211]
v_mfma_f32_16x16x32_bf16 v[212:215], a[92:95], a[228:231], v[212:215]
ds_read_b64_tr_b16 a[36:37], v6 offset:17408
v_mfma_f32_16x16x32_bf16 v[212:215], a[88:91], a[212:215], v[212:215]
ds_read_b64_tr_b16 a[38:39], v6 offset:25600
v_mfma_f32_16x16x32_bf16 v[216:219], a[88:91], a[216:219], v[216:219]
ds_read_b64_tr_b16 a[40:41], v7 offset:1024
v_mfma_f32_16x16x32_bf16 v[216:219], a[92:95], a[232:235], v[216:219]
v_mfma_f32_16x16x32_bf16 v[220:223], a[92:95], a[236:239], v[220:223]
ds_read_b64_tr_b16 a[42:43], v7 offset:9216
v_mfma_f32_16x16x32_bf16 v[220:223], a[88:91], a[220:223], v[220:223]
buffer_load_dwordx4 v4, s[8:11], s41 offen offset:2048 lds
v_mfma_f32_16x16x32_bf16 v[224:227], a[96:99], a[208:211], v[224:227]
ds_read_b64_tr_b16 a[44:45], v7 offset:17408
v_mfma_f32_16x16x32_bf16 v[224:227], a[100:103], a[224:227], v[224:227]
v_mfma_f32_16x16x32_bf16 v[228:231], a[100:103], a[228:231], v[228:231]
ds_read_b64_tr_b16 a[46:47], v7 offset:25600
v_mfma_f32_16x16x32_bf16 v[228:231], a[96:99], a[212:215], v[228:231]
ds_read_b64_tr_b16 a[48:49], v8 offset:1024
v_mfma_f32_16x16x32_bf16 v[232:235], a[96:99], a[216:219], v[232:235]
buffer_load_dwordx4 v5, s[8:11], s41 offen offset:3072 lds
s_add_u32 s41, s41, 229376
v_mfma_f32_16x16x32_bf16 v[232:235], a[100:103], a[232:235], v[232:235]
v_mfma_f32_16x16x32_bf16 v[236:239], a[100:103], a[236:239], v[236:239]
ds_read_b64_tr_b16 a[50:51], v8 offset:9216
v_mfma_f32_16x16x32_bf16 v[236:239], a[96:99], a[220:223], v[236:239]
ds_read_b64_tr_b16 a[52:53], v8 offset:17408
v_mfma_f32_16x16x32_bf16 v[240:243], a[104:107], a[208:211], v[240:243]
ds_read_b64_tr_b16 a[54:55], v8 offset:25600
v_mfma_f32_16x16x32_bf16 v[240:243], a[108:111], a[224:227], v[240:243]
v_mfma_f32_16x16x32_bf16 v[244:247], a[108:111], a[228:231], v[244:247]
v_mfma_f32_16x16x32_bf16 v[244:247], a[104:107], a[212:215], v[244:247]
v_mfma_f32_16x16x32_bf16 v[248:251], a[104:107], a[216:219], v[248:251]
v_mfma_f32_16x16x32_bf16 v[248:251], a[108:111], a[232:235], v[248:251]
v_mfma_f32_16x16x32_bf16 v[252:255], a[108:111], a[236:239], v[252:255]
v_mfma_f32_16x16x32_bf16 v[252:255], a[104:107], a[220:223], v[252:255]
s_waitcnt vmcnt(40) lgkmcnt(0)
v_mfma_f32_16x16x32_bf16 v[32:35], a[0:3], a[112:115], v[32:35]
ds_read_b64_tr_b16 a[56:57], v9 offset:1024
v_mfma_f32_16x16x32_bf16 v[32:35], a[4:7], a[128:131], v[32:35]
buffer_load_dwordx4 a[208:211], v12, s[4:7], s40 offen offset:0 sc1
v_mfma_f32_16x16x32_bf16 v[36:39], a[4:7], a[132:135], v[36:39]
ds_read_b64_tr_b16 a[58:59], v9 offset:9216
v_mfma_f32_16x16x32_bf16 v[36:39], a[0:3], a[116:119], v[36:39]
ds_read_b64_tr_b16 a[60:61], v9 offset:17408
v_mfma_f32_16x16x32_bf16 v[40:43], a[0:3], a[120:123], v[40:43]
v_mfma_f32_16x16x32_bf16 v[40:43], a[4:7], a[136:139], v[40:43]
buffer_load_dwordx4 a[212:215], v12, s[4:7], s40 offen offset:1024 sc1
v_mfma_f32_16x16x32_bf16 v[44:47], a[4:7], a[140:143], v[44:47]
ds_read_b64_tr_b16 a[62:63], v9 offset:25600
v_mfma_f32_16x16x32_bf16 v[44:47], a[0:3], a[124:127], v[44:47]
ds_read_b64_tr_b16 a[64:65], v6 offset:2048
v_mfma_f32_16x16x32_bf16 v[48:51], a[8:11], a[112:115], v[48:51]
buffer_load_dwordx4 a[216:219], v12, s[4:7], s40 offen offset:2048 sc1
v_mfma_f32_16x16x32_bf16 v[48:51], a[12:15], a[128:131], v[48:51]
v_mfma_f32_16x16x32_bf16 v[52:55], a[12:15], a[132:135], v[52:55]
ds_read_b64_tr_b16 a[66:67], v6 offset:10240
v_mfma_f32_16x16x32_bf16 v[52:55], a[8:11], a[116:119], v[52:55]
ds_read_b64_tr_b16 a[68:69], v6 offset:18432
v_mfma_f32_16x16x32_bf16 v[56:59], a[8:11], a[120:123], v[56:59]
ds_read_b64_tr_b16 a[70:71], v6 offset:26624
v_mfma_f32_16x16x32_bf16 v[56:59], a[12:15], a[136:139], v[56:59]
buffer_load_dwordx4 a[220:223], v12, s[4:7], s40 offen offset:3072 sc1
s_add_u32 s40, s40, 16384
v_mfma_f32_16x16x32_bf16 v[60:63], a[12:15], a[140:143], v[60:63]
v_mfma_f32_16x16x32_bf16 v[60:63], a[8:11], a[124:127], v[60:63]
ds_read_b64_tr_b16 a[72:73], v7 offset:2048
v_mfma_f32_16x16x32_bf16 v[64:67], a[16:19], a[112:115], v[64:67]
ds_read_b64_tr_b16 a[74:75], v7 offset:10240
v_mfma_f32_16x16x32_bf16 v[64:67], a[20:23], a[128:131], v[64:67]
buffer_load_dwordx4 a[224:227], v12, s[4:7], s40 offen offset:0 sc1
v_mfma_f32_16x16x32_bf16 v[68:71], a[20:23], a[132:135], v[68:71]
ds_read_b64_tr_b16 a[76:77], v7 offset:18432
v_mfma_f32_16x16x32_bf16 v[68:71], a[16:19], a[116:119], v[68:71]
v_mfma_f32_16x16x32_bf16 v[72:75], a[16:19], a[120:123], v[72:75]
ds_read_b64_tr_b16 a[78:79], v7 offset:26624
v_mfma_f32_16x16x32_bf16 v[72:75], a[20:23], a[136:139], v[72:75]
buffer_load_dwordx4 a[228:231], v12, s[4:7], s40 offen offset:1024 sc1
v_mfma_f32_16x16x32_bf16 v[76:79], a[20:23], a[140:143], v[76:79]
ds_read_b64_tr_b16 a[80:81], v8 offset:2048
v_mfma_f32_16x16x32_bf16 v[76:79], a[16:19], a[124:127], v[76:79]
ds_read_b64_tr_b16 a[82:83], v8 offset:10240
v_mfma_f32_16x16x32_bf16 v[80:83], a[24:27], a[112:115], v[80:83]
v_mfma_f32_16x16x32_bf16 v[80:83], a[28:31], a[128:131], v[80:83]
ds_read_b64_tr_b16 a[84:85], v8 offset:18432
v_mfma_f32_16x16x32_bf16 v[84:87], a[28:31], a[132:135], v[84:87]
buffer_load_dwordx4 a[232:235], v12, s[4:7], s40 offen offset:2048 sc1
v_mfma_f32_16x16x32_bf16 v[84:87], a[24:27], a[116:119], v[84:87]
ds_read_b64_tr_b16 a[86:87], v8 offset:26624
v_mfma_f32_16x16x32_bf16 v[88:91], a[24:27], a[120:123], v[88:91]
ds_read_b64_tr_b16 a[88:89], v9 offset:2048
v_mfma_f32_16x16x32_bf16 v[88:91], a[28:31], a[136:139], v[88:91]
v_mfma_f32_16x16x32_bf16 v[92:95], a[28:31], a[140:143], v[92:95]
buffer_load_dwordx4 a[236:239], v12, s[4:7], s40 offen offset:3072 sc1
s_add_u32 s40, s40, 16384
v_mfma_f32_16x16x32_bf16 v[92:95], a[24:27], a[124:127], v[92:95]
ds_read_b64_tr_b16 a[90:91], v9 offset:10240
v_mfma_f32_16x16x32_bf16 v[96:99], a[32:35], a[112:115], v[96:99]
ds_read_b64_tr_b16 a[92:93], v9 offset:18432
v_mfma_f32_16x16x32_bf16 v[96:99], a[36:39], a[128:131], v[96:99]
v_add_u32 v2, 0, v14
v_mfma_f32_16x16x32_bf16 v[100:103], a[36:39], a[132:135], v[100:103]
v_mfma_f32_16x16x32_bf16 v[100:103], a[32:35], a[116:119], v[100:103]
ds_read_b64_tr_b16 a[94:95], v9 offset:26624
v_mfma_f32_16x16x32_bf16 v[104:107], a[32:35], a[120:123], v[104:107]
ds_read_b64_tr_b16 a[96:97], v10 offset:3072
v_mfma_f32_16x16x32_bf16 v[104:107], a[36:39], a[136:139], v[104:107]
ds_read_b64_tr_b16 a[98:99], v10 offset:11264
v_mfma_f32_16x16x32_bf16 v[108:111], a[36:39], a[140:143], v[108:111]
v_add_u32 v3, 64512, v14
v_mfma_f32_16x16x32_bf16 v[108:111], a[32:35], a[124:127], v[108:111]
v_mfma_f32_16x16x32_bf16 v[112:115], a[40:43], a[112:115], v[112:115]
ds_read_b64_tr_b16 a[100:101], v10 offset:19456
v_mfma_f32_16x16x32_bf16 v[112:115], a[44:47], a[128:131], v[112:115]
ds_read_b64_tr_b16 a[102:103], v10 offset:27648
v_mfma_f32_16x16x32_bf16 v[116:119], a[44:47], a[132:135], v[116:119]
v_add_u32 v4, 129024, v14
v_mfma_f32_16x16x32_bf16 v[116:119], a[40:43], a[116:119], v[116:119]
ds_read_b64_tr_b16 a[104:105], v11 offset:3072
v_mfma_f32_16x16x32_bf16 v[120:123], a[40:43], a[120:123], v[120:123]
v_mfma_f32_16x16x32_bf16 v[120:123], a[44:47], a[136:139], v[120:123]
ds_read_b64_tr_b16 a[106:107], v11 offset:11264
v_mfma_f32_16x16x32_bf16 v[124:127], a[44:47], a[140:143], v[124:127]
v_add_u32 v5, 193536, v14
v_mfma_f32_16x16x32_bf16 v[124:127], a[40:43], a[124:127], v[124:127]
ds_read_b64_tr_b16 a[108:109], v11 offset:19456
v_mfma_f32_16x16x32_bf16 v[128:131], a[48:51], a[112:115], v[128:131]
ds_read_b64_tr_b16 a[110:111], v11 offset:27648
v_mfma_f32_16x16x32_bf16 v[128:131], a[52:55], a[128:131], v[128:131]
v_mfma_f32_16x16x32_bf16 v[132:135], a[52:55], a[132:135], v[132:135]
v_mfma_f32_16x16x32_bf16 v[132:135], a[48:51], a[116:119], v[132:135]
v_mfma_f32_16x16x32_bf16 v[136:139], a[48:51], a[120:123], v[136:139]
v_mfma_f32_16x16x32_bf16 v[136:139], a[52:55], a[136:139], v[136:139]
v_mfma_f32_16x16x32_bf16 v[140:143], a[52:55], a[140:143], v[140:143]
v_mfma_f32_16x16x32_bf16 v[140:143], a[48:51], a[124:127], v[140:143]
s_waitcnt vmcnt(8) lgkmcnt(0)
v_mfma_f32_16x16x32_bf16 v[144:147], a[56:59], a[112:115], v[144:147]
v_mfma_f32_16x16x32_bf16 v[144:147], a[60:63], a[128:131], v[144:147]
s_barrier
v_mfma_f32_16x16x32_bf16 v[148:151], a[60:63], a[132:135], v[148:151]
ds_read_b64_tr_b16 a[0:1], v6 offset:32768
v_mfma_f32_16x16x32_bf16 v[148:151], a[56:59], a[116:119], v[148:151]
buffer_load_dwordx4 a[252:255], v1, s[52:55], s56 offen
v_mfma_f32_16x16x32_bf16 v[152:155], a[56:59], a[120:123], v[152:155]
ds_read_b64_tr_b16 a[2:3], v6 offset:40960
PG6:
s_cbranch_execz PG1037
v_mfma_f32_16x16x32_bf16 v[152:155], a[60:63], a[136:139], v[152:155]
v_mfma_f32_16x16x32_bf16 v[156:159], a[60:63], a[140:143], v[156:159]
ds_read_b64_tr_b16 a[4:5], v7 offset:32768
s_add_u32 m0, s42, 131072
v_mfma_f32_16x16x32_bf16 v[156:159], a[56:59], a[124:127], v[156:159]
buffer_load_dwordx4 v2, s[24:27], s72 offen offset:0 lds
v_mfma_f32_16x16x32_bf16 v[160:163], a[64:67], a[112:115], v[160:163]
v_mfma_f32_16x16x32_bf16 v[160:163], a[68:71], a[128:131], v[160:163]
ds_read_b64_tr_b16 a[6:7], v7 offset:40960
v_mfma_f32_16x16x32_bf16 v[164:167], a[68:71], a[132:135], v[164:167]
ds_read_b64_tr_b16 a[8:9], v6 offset:49152
v_mfma_f32_16x16x32_bf16 v[164:167], a[64:67], a[116:119], v[164:167]
v_mfma_f32_16x16x32_bf16 v[168:171], a[64:67], a[120:123], v[168:171]
ds_read_b64_tr_b16 a[10:11], v6 offset:57344
v_mfma_f32_16x16x32_bf16 v[168:171], a[68:71], a[136:139], v[168:171]
buffer_load_dwordx4 v3, s[24:27], s72 offen offset:1024 lds
v_mfma_f32_16x16x32_bf16 v[172:175], a[68:71], a[140:143], v[172:175]
v_mfma_f32_16x16x32_bf16 v[172:175], a[64:67], a[124:127], v[172:175]
ds_read_b64_tr_b16 a[12:13], v7 offset:49152
v_mfma_f32_16x16x32_bf16 v[176:179], a[72:75], a[112:115], v[176:179]
ds_read_b64_tr_b16 a[14:15], v7 offset:57344
v_mfma_f32_16x16x32_bf16 v[176:179], a[76:79], a[128:131], v[176:179]
v_mfma_f32_16x16x32_bf16 v[180:183], a[76:79], a[132:135], v[180:183]
ds_read_b64_tr_b16 a[16:17], v18 offset:0
v_mfma_f32_16x16x32_bf16 v[180:183], a[72:75], a[116:119], v[180:183]
buffer_load_dwordx4 v4, s[24:27], s72 offen offset:2048 lds
v_mfma_f32_16x16x32_bf16 v[184:187], a[72:75], a[120:123], v[184:187]
ds_read_b64_tr_b16 a[18:19], v18 offset:8192
v_mfma_f32_16x16x32_bf16 v[184:187], a[76:79], a[136:139], v[184:187]
v_mfma_f32_16x16x32_bf16 v[188:191], a[76:79], a[140:143], v[188:191]
ds_read_b64_tr_b16 a[20:21], v19 offset:0
v_mfma_f32_16x16x32_bf16 v[188:191], a[72:75], a[124:127], v[188:191]
buffer_load_dwordx4 v5, s[24:27], s72 offen offset:3072 lds
s_add_u32 s72, s72, 262144
v_mfma_f32_16x16x32_bf16 v[192:195], a[80:83], a[112:115], v[192:195]
v_mfma_f32_16x16x32_bf16 v[192:195], a[84:87], a[128:131], v[192:195]
ds_read_b64_tr_b16 a[22:23], v19 offset:8192
v_mfma_f32_16x16x32_bf16 v[196:199], a[84:87], a[132:135], v[196:199]
ds_read_b64_tr_b16 a[24:25], v18 offset:16384
v_mfma_f32_16x16x32_bf16 v[196:199], a[80:83], a[116:119], v[196:199]
v_mfma_f32_16x16x32_bf16 v[200:203], a[80:83], a[120:123], v[200:203]
ds_read_b64_tr_b16 a[26:27], v18 offset:24576
s_add_u32 m0, s42, 147456
v_mfma_f32_16x16x32_bf16 v[200:203], a[84:87], a[136:139], v[200:203]
buffer_load_dwordx4 v2, s[24:27], s72 offen offset:0 lds
v_mfma_f32_16x16x32_bf16 v[204:207], a[84:87], a[140:143], v[204:207]
v_mfma_f32_16x16x32_bf16 v[204:207], a[80:83], a[124:127], v[204:207]
ds_read_b64_tr_b16 a[28:29], v19 offset:16384
v_mfma_f32_16x16x32_bf16 v[208:211], a[88:91], a[112:115], v[208:211]
ds_read_b64_tr_b16 a[30:31], v19 offset:24576
v_mfma_f32_16x16x32_bf16 v[208:211], a[92:95], a[128:131], v[208:211]
v_mfma_f32_16x16x32_bf16 v[212:215], a[92:95], a[132:135], v[212:215]
ds_read_b64_tr_b16 a[32:33], v18 offset:32768
v_mfma_f32_16x16x32_bf16 v[212:215], a[88:91], a[116:119], v[212:215]
buffer_load_dwordx4 v3, s[24:27], s72 offen offset:1024 lds
v_mfma_f32_16x16x32_bf16 v[216:219], a[88:91], a[120:123], v[216:219]
ds_read_b64_tr_b16 a[34:35], v18 offset:40960
v_mfma_f32_16x16x32_bf16 v[216:219], a[92:95], a[136:139], v[216:219]
v_mfma_f32_16x16x32_bf16 v[220:223], a[92:95], a[140:143], v[220:223]
ds_read_b64_tr_b16 a[36:37], v19 offset:32768
v_mfma_f32_16x16x32_bf16 v[220:223], a[88:91], a[124:127], v[220:223]
buffer_load_dwordx4 v4, s[24:27], s72 offen offset:2048 lds
v_mfma_f32_16x16x32_bf16 v[224:227], a[96:99], a[112:115], v[224:227]
v_mfma_f32_16x16x32_bf16 v[224:227], a[100:103], a[128:131], v[224:227]
ds_read_b64_tr_b16 a[38:39], v19 offset:40960
v_mfma_f32_16x16x32_bf16 v[228:231], a[100:103], a[132:135], v[228:231]
ds_read_b64_tr_b16 a[40:41], v18 offset:49152
v_mfma_f32_16x16x32_bf16 v[228:231], a[96:99], a[116:119], v[228:231]
v_mfma_f32_16x16x32_bf16 v[232:235], a[96:99], a[120:123], v[232:235]
ds_read_b64_tr_b16 a[42:43], v18 offset:57344
v_mfma_f32_16x16x32_bf16 v[232:235], a[100:103], a[136:139], v[232:235]
buffer_load_dwordx4 v5, s[24:27], s72 offen offset:3072 lds
s_add_u32 s72, s72, 262144
v_mfma_f32_16x16x32_bf16 v[236:239], a[100:103], a[140:143], v[236:239]
v_mfma_f32_16x16x32_bf16 v[236:239], a[96:99], a[124:127], v[236:239]
ds_read_b64_tr_b16 a[44:45], v19 offset:49152
v_mfma_f32_16x16x32_bf16 v[240:243], a[104:107], a[112:115], v[240:243]
ds_read_b64_tr_b16 a[46:47], v19 offset:57344
v_mfma_f32_16x16x32_bf16 v[240:243], a[108:111], a[128:131], v[240:243]
v_mfma_f32_16x16x32_bf16 v[244:247], a[108:111], a[132:135], v[244:247]
v_mfma_f32_16x16x32_bf16 v[244:247], a[104:107], a[116:119], v[244:247]
v_mfma_f32_16x16x32_bf16 v[248:251], a[104:107], a[120:123], v[248:251]
v_mfma_f32_16x16x32_bf16 v[248:251], a[108:111], a[136:139], v[248:251]
v_mfma_f32_16x16x32_bf16 v[252:255], a[108:111], a[140:143], v[252:255]
v_mfma_f32_16x16x32_bf16 v[252:255], a[104:107], a[124:127], v[252:255]
s_waitcnt vmcnt(9) lgkmcnt(0)
v_mfma_f32_16x16x32_bf16 v[32:35], a[0:3], a[144:147], v[32:35]
ds_read_b64_tr_b16 a[56:57], v8 offset:32768
v_mfma_f32_16x16x32_bf16 v[32:35], a[8:11], a[160:163], v[32:35]
ds_read_b64_tr_b16 a[58:59], v8 offset:40960
v_mfma_f32_16x16x32_bf16 v[32:35], a[16:19], a[176:179], v[32:35]
ds_read_b64_tr_b16 a[60:61], v9 offset:32768
v_mfma_f32_16x16x32_bf16 v[32:35], a[24:27], a[192:195], v[32:35]
v_mfma_f32_16x16x32_bf16 v[32:35], a[32:35], a[208:211], v[32:35]
ds_read_b64_tr_b16 a[62:63], v9 offset:40960
v_mfma_f32_16x16x32_bf16 v[32:35], a[40:43], a[224:227], v[32:35]
ds_read_b64_tr_b16 a[64:65], v8 offset:49152
v_mfma_f32_16x16x32_bf16 v[48:51], a[4:7], a[144:147], v[48:51]
ds_read_b64_tr_b16 a[66:67], v8 offset:57344
v_mfma_f32_16x16x32_bf16 v[48:51], a[12:15], a[160:163], v[48:51]
v_mfma_f32_16x16x32_bf16 v[48:51], a[20:23], a[176:179], v[48:51]
ds_read_b64_tr_b16 a[68:69], v9 offset:49152
v_mfma_f32_16x16x32_bf16 v[48:51], a[28:31], a[192:195], v[48:51]
ds_read_b64_tr_b16 a[70:71], v9 offset:57344
s_add_u32 m0, s42, 0
v_mfma_f32_16x16x32_bf16 v[48:51], a[36:39], a[208:211], v[48:51]
buffer_load_dwordx4 v2, s[24:27], s72 offen offset:0 lds
v_mfma_f32_16x16x32_bf16 v[48:51], a[44:47], a[224:227], v[48:51]
v_mfma_f32_16x16x32_bf16 v[36:39], a[0:3], a[148:151], v[36:39]
ds_read_b64_tr_b16 a[72:73], v20 offset:0
v_mfma_f32_16x16x32_bf16 v[36:39], a[8:11], a[164:167], v[36:39]
ds_read_b64_tr_b16 a[74:75], v20 offset:8192
v_mfma_f32_16x16x32_bf16 v[36:39], a[16:19], a[180:183], v[36:39]
ds_read_b64_tr_b16 a[76:77], v21 offset:0
v_mfma_f32_16x16x32_bf16 v[36:39], a[24:27], a[196:199], v[36:39]
v_mfma_f32_16x16x32_bf16 v[36:39], a[32:35], a[212:215], v[36:39]
ds_read_b64_tr_b16 a[78:79], v21 offset:8192
v_mfma_f32_16x16x32_bf16 v[36:39], a[40:43], a[228:231], v[36:39]
ds_read_b64_tr_b16 a[80:81], v20 offset:16384
v_mfma_f32_16x16x32_bf16 v[52:55], a[4:7], a[148:151], v[52:55]
ds_read_b64_tr_b16 a[82:83], v20 offset:24576
v_mfma_f32_16x16x32_bf16 v[52:55], a[12:15], a[164:167], v[52:55]
v_mfma_f32_16x16x32_bf16 v[52:55], a[20:23], a[180:183], v[52:55]
ds_read_b64_tr_b16 a[84:85], v21 offset:16384
v_mfma_f32_16x16x32_bf16 v[52:55], a[28:31], a[196:199], v[52:55]
ds_read_b64_tr_b16 a[86:87], v21 offset:24576
v_mfma_f32_16x16x32_bf16 v[52:55], a[36:39], a[212:215], v[52:55]
buffer_load_dwordx4 v3, s[24:27], s72 offen offset:1024 lds
v_mfma_f32_16x16x32_bf16 v[52:55], a[44:47], a[228:231], v[52:55]
v_mfma_f32_16x16x32_bf16 v[40:43], a[0:3], a[152:155], v[40:43]
v_mul_f32 v32, v32, abs(v32)
v_mul_f32 v33, v33, abs(v33)
v_mfma_f32_16x16x32_bf16 v[40:43], a[8:11], a[168:171], v[40:43]
ds_read_b64_tr_b16 a[88:89], v20 offset:32768
ds_read_b64_tr_b16 a[90:91], v20 offset:40960
v_mul_f32 v34, v34, abs(v34)
v_mfma_f32_16x16x32_bf16 v[40:43], a[16:19], a[184:187], v[40:43]
v_mul_f32 v35, v35, abs(v35)
v_mfma_f32_16x16x32_bf16 v[40:43], a[24:27], a[200:203], v[40:43]
ds_read_b64_tr_b16 a[92:93], v21 offset:32768
v_mul_f32 v48, v48, abs(v48)
v_mul_f32 v49, v49, abs(v49)
v_mfma_f32_16x16x32_bf16 v[40:43], a[32:35], a[216:219], v[40:43]
ds_read_b64_tr_b16 a[94:95], v21 offset:40960
v_mul_f32 v50, v50, abs(v50)
v_mfma_f32_16x16x32_bf16 v[40:43], a[40:43], a[232:235], v[40:43]
v_mul_f32 v51, v51, abs(v51)
v_mfma_f32_16x16x32_bf16 v[56:59], a[4:7], a[152:155], v[56:59]
ds_read_b64_tr_b16 a[96:97], v20 offset:49152
v_cvt_pk_bf16_f32 v32, v32, v33
v_cvt_pk_bf16_f32 v33, v34, v35
v_mfma_f32_16x16x32_bf16 v[56:59], a[12:15], a[168:171], v[56:59]
ds_read_b64_tr_b16 a[98:99], v20 offset:57344
v_cvt_pk_bf16_f32 v34, v48, v49
v_cvt_pk_bf16_f32 v35, v50, v51
v_mfma_f32_16x16x32_bf16 v[56:59], a[20:23], a[184:187], v[56:59]
ds_read_b64_tr_b16 a[100:101], v21 offset:49152
v_pk_max_i16 v32, v32, 0
v_mfma_f32_16x16x32_bf16 v[56:59], a[28:31], a[200:203], v[56:59]
v_pk_max_i16 v33, v33, 0
v_mfma_f32_16x16x32_bf16 v[56:59], a[36:39], a[216:219], v[56:59]
ds_read_b64_tr_b16 a[102:103], v21 offset:57344
v_pk_max_i16 v34, v34, 0
v_pk_max_i16 v35, v35, 0
v_mfma_f32_16x16x32_bf16 v[56:59], a[44:47], a[232:235], v[56:59]
buffer_load_dwordx4 v4, s[24:27], s72 offen offset:2048 lds
buffer_store_dwordx4 v[32:35], v12, s[12:15], s96 offen offset:0 sc1
v_mfma_f32_16x16x32_bf16 v[44:47], a[0:3], a[156:159], v[44:47]
v_mul_f32 v36, v36, abs(v36)
v_mfma_f32_16x16x32_bf16 v[44:47], a[8:11], a[172:175], v[44:47]
buffer_load_dwordx4 v5, s[24:27], s72 offen offset:3072 lds
s_add_u32 s72, s72, 262144
v_mul_f32 v37, v37, abs(v37)
v_mfma_f32_16x16x32_bf16 v[44:47], a[16:19], a[188:191], v[44:47]
v_mul_f32 v38, v38, abs(v38)
v_mul_f32 v39, v39, abs(v39)
v_mfma_f32_16x16x32_bf16 v[44:47], a[24:27], a[204:207], v[44:47]
v_mul_f32 v52, v52, abs(v52)
v_mfma_f32_16x16x32_bf16 v[44:47], a[32:35], a[220:223], v[44:47]
v_mul_f32 v53, v53, abs(v53)
v_mul_f32 v54, v54, abs(v54)
v_mfma_f32_16x16x32_bf16 v[44:47], a[40:43], a[236:239], v[44:47]
v_mul_f32 v55, v55, abs(v55)
v_mfma_f32_16x16x32_bf16 v[60:63], a[4:7], a[156:159], v[60:63]
v_cvt_pk_bf16_f32 v36, v36, v37
v_cvt_pk_bf16_f32 v37, v38, v39
v_mfma_f32_16x16x32_bf16 v[60:63], a[12:15], a[172:175], v[60:63]
v_cvt_pk_bf16_f32 v38, v52, v53
v_mfma_f32_16x16x32_bf16 v[60:63], a[20:23], a[188:191], v[60:63]
v_cvt_pk_bf16_f32 v39, v54, v55
v_pk_max_i16 v36, v36, 0
v_mfma_f32_16x16x32_bf16 v[60:63], a[28:31], a[204:207], v[60:63]
v_pk_max_i16 v37, v37, 0
v_mfma_f32_16x16x32_bf16 v[60:63], a[36:39], a[220:223], v[60:63]
v_pk_max_i16 v38, v38, 0
v_pk_max_i16 v39, v39, 0
v_mfma_f32_16x16x32_bf16 v[60:63], a[44:47], a[236:239], v[60:63]
buffer_store_dwordx4 v[36:39], v12, s[12:15], s96 offen offset:1024 sc1
s_waitcnt lgkmcnt(0)
v_mfma_f32_16x16x32_bf16 v[64:67], a[56:59], a[144:147], v[64:67]
v_mul_f32 v40, v40, abs(v40)
v_mul_f32 v41, v41, abs(v41)
v_mfma_f32_16x16x32_bf16 v[64:67], a[64:67], a[160:163], v[64:67]
ds_read_b64_tr_b16 a[0:1], v6 offset:33792
ds_read_b64_tr_b16 a[2:3], v6 offset:41984
v_mul_f32 v42, v42, abs(v42)
v_mfma_f32_16x16x32_bf16 v[64:67], a[72:75], a[176:179], v[64:67]
v_mul_f32 v43, v43, abs(v43)
v_mfma_f32_16x16x32_bf16 v[64:67], a[80:83], a[192:195], v[64:67]
ds_read_b64_tr_b16 a[4:5], v7 offset:33792
v_mul_f32 v56, v56, abs(v56)
v_mul_f32 v57, v57, abs(v57)
v_mfma_f32_16x16x32_bf16 v[64:67], a[88:91], a[208:211], v[64:67]
ds_read_b64_tr_b16 a[6:7], v7 offset:41984
v_mul_f32 v58, v58, abs(v58)
v_mfma_f32_16x16x32_bf16 v[64:67], a[96:99], a[224:227], v[64:67]
v_mul_f32 v59, v59, abs(v59)
v_mfma_f32_16x16x32_bf16 v[80:83], a[60:63], a[144:147], v[80:83]
ds_read_b64_tr_b16 a[8:9], v6 offset:50176
v_cvt_pk_bf16_f32 v40, v40, v41
v_cvt_pk_bf16_f32 v41, v42, v43
v_mfma_f32_16x16x32_bf16 v[80:83], a[68:71], a[160:163], v[80:83]
ds_read_b64_tr_b16 a[10:11], v6 offset:58368
v_cvt_pk_bf16_f32 v42, v56, v57
v_cvt_pk_bf16_f32 v43, v58, v59
v_mfma_f32_16x16x32_bf16 v[80:83], a[76:79], a[176:179], v[80:83]
ds_read_b64_tr_b16 a[12:13], v7 offset:50176
v_pk_max_i16 v40, v40, 0
v_mfma_f32_16x16x32_bf16 v[80:83], a[84:87], a[192:195], v[80:83]
v_pk_max_i16 v41, v41, 0
v_mfma_f32_16x16x32_bf16 v[80:83], a[92:95], a[208:211], v[80:83]
ds_read_b64_tr_b16 a[14:15], v7 offset:58368
v_pk_max_i16 v42, v42, 0
v_pk_max_i16 v43, v43, 0
s_add_u32 m0, s42, 16384
v_mfma_f32_16x16x32_bf16 v[80:83], a[100:103], a[224:227], v[80:83]
buffer_load_dwordx4 v2, s[24:27], s72 offen offset:0 lds
buffer_store_dwordx4 v[40:43], v12, s[12:15], s96 offen offset:2048 sc1
v_mfma_f32_16x16x32_bf16 v[68:71], a[56:59], a[148:151], v[68:71]
v_mul_f32 v44, v44, abs(v44)
v_mul_f32 v45, v45, abs(v45)
v_mfma_f32_16x16x32_bf16 v[68:71], a[64:67], a[164:167], v[68:71]
ds_read_b64_tr_b16 a[16:17], v18 offset:1024
v_mul_f32 v46, v46, abs(v46)
v_mfma_f32_16x16x32_bf16 v[68:71], a[72:75], a[180:183], v[68:71]
ds_read_b64_tr_b16 a[18:19], v18 offset:9216
v_mul_f32 v47, v47, abs(v47)
v_mul_f32 v60, v60, abs(v60)
v_mfma_f32_16x16x32_bf16 v[68:71], a[80:83], a[196:199], v[68:71]
ds_read_b64_tr_b16 a[20:21], v19 offset:1024
v_mul_f32 v61, v61, abs(v61)
v_mfma_f32_16x16x32_bf16 v[68:71], a[88:91], a[212:215], v[68:71]
v_mul_f32 v62, v62, abs(v62)
v_mul_f32 v63, v63, abs(v63)
v_mfma_f32_16x16x32_bf16 v[68:71], a[96:99], a[228:231], v[68:71]
ds_read_b64_tr_b16 a[22:23], v19 offset:9216
v_cvt_pk_bf16_f32 v44, v44, v45
v_mfma_f32_16x16x32_bf16 v[84:87], a[60:63], a[148:151], v[84:87]
ds_read_b64_tr_b16 a[24:25], v18 offset:17408
v_cvt_pk_bf16_f32 v45, v46, v47
v_cvt_pk_bf16_f32 v46, v60, v61
v_mfma_f32_16x16x32_bf16 v[84:87], a[68:71], a[164:167], v[84:87]
ds_read_b64_tr_b16 a[26:27], v18 offset:25600
v_cvt_pk_bf16_f32 v47, v62, v63
v_mfma_f32_16x16x32_bf16 v[84:87], a[76:79], a[180:183], v[84:87]
v_pk_max_i16 v44, v44, 0
v_pk_max_i16 v45, v45, 0
v_mfma_f32_16x16x32_bf16 v[84:87], a[84:87], a[196:199], v[84:87]
ds_read_b64_tr_b16 a[28:29], v19 offset:17408
v_pk_max_i16 v46, v46, 0
v_mfma_f32_16x16x32_bf16 v[84:87], a[92:95], a[212:215], v[84:87]
ds_read_b64_tr_b16 a[30:31], v19 offset:25600
v_pk_max_i16 v47, v47, 0
v_mfma_f32_16x16x32_bf16 v[84:87], a[100:103], a[228:231], v[84:87]
buffer_store_dwordx4 v[44:47], v12, s[12:15], s96 offen offset:3072 sc1
buffer_load_dwordx4 v3, s[24:27], s72 offen offset:1024 lds
s_add_u32 s96, s96, 16384
v_mfma_f32_16x16x32_bf16 v[72:75], a[56:59], a[152:155], v[72:75]
v_mul_f32 v64, v64, abs(v64)
v_mul_f32 v65, v65, abs(v65)
v_mfma_f32_16x16x32_bf16 v[72:75], a[64:67], a[168:171], v[72:75]
ds_read_b64_tr_b16 a[32:33], v18 offset:33792
ds_read_b64_tr_b16 a[34:35], v18 offset:41984
v_mul_f32 v66, v66, abs(v66)
v_mfma_f32_16x16x32_bf16 v[72:75], a[72:75], a[184:187], v[72:75]
v_mul_f32 v67, v67, abs(v67)
v_mfma_f32_16x16x32_bf16 v[72:75], a[80:83], a[200:203], v[72:75]
ds_read_b64_tr_b16 a[36:37], v19 offset:33792
v_mul_f32 v80, v80, abs(v80)
v_mul_f32 v81, v81, abs(v81)
v_mfma_f32_16x16x32_bf16 v[72:75], a[88:91], a[216:219], v[72:75]
ds_read_b64_tr_b16 a[38:39], v19 offset:41984
v_mul_f32 v82, v82, abs(v82)
v_mfma_f32_16x16x32_bf16 v[72:75], a[96:99], a[232:235], v[72:75]
v_mul_f32 v83, v83, abs(v83)
v_mfma_f32_16x16x32_bf16 v[88:91], a[60:63], a[152:155], v[88:91]
ds_read_b64_tr_b16 a[40:41], v18 offset:50176
v_cvt_pk_bf16_f32 v64, v64, v65
v_cvt_pk_bf16_f32 v65, v66, v67
v_mfma_f32_16x16x32_bf16 v[88:91], a[68:71], a[168:171], v[88:91]
ds_read_b64_tr_b16 a[42:43], v18 offset:58368
v_cvt_pk_bf16_f32 v66, v80, v81
v_cvt_pk_bf16_f32 v67, v82, v83
v_mfma_f32_16x16x32_bf16 v[88:91], a[76:79], a[184:187], v[88:91]
ds_read_b64_tr_b16 a[44:45], v19 offset:50176
v_pk_max_i16 v64, v64, 0
v_mfma_f32_16x16x32_bf16 v[88:91], a[84:87], a[200:203], v[88:91]
v_pk_max_i16 v65, v65, 0
v_mfma_f32_16x16x32_bf16 v[88:91], a[92:95], a[216:219], v[88:91]
ds_read_b64_tr_b16 a[46:47], v19 offset:58368
v_pk_max_i16 v66, v66, 0
v_pk_max_i16 v67, v67, 0
v_mfma_f32_16x16x32_bf16 v[88:91], a[100:103], a[232:235], v[88:91]
buffer_load_dwordx4 v4, s[24:27], s72 offen offset:2048 lds
buffer_store_dwordx4 v[64:67], v12, s[12:15], s96 offen offset:0 sc1
v_mfma_f32_16x16x32_bf16 v[76:79], a[56:59], a[156:159], v[76:79]
v_mul_f32 v68, v68, abs(v68)
v_mfma_f32_16x16x32_bf16 v[76:79], a[64:67], a[172:175], v[76:79]
buffer_load_dwordx4 v5, s[24:27], s72 offen offset:3072 lds
s_add_u32 s72, s72, 262144
v_mul_f32 v69, v69, abs(v69)
v_mfma_f32_16x16x32_bf16 v[76:79], a[72:75], a[188:191], v[76:79]
v_mul_f32 v70, v70, abs(v70)
v_mul_f32 v71, v71, abs(v71)
v_mfma_f32_16x16x32_bf16 v[76:79], a[80:83], a[204:207], v[76:79]
v_mul_f32 v84, v84, abs(v84)
v_mfma_f32_16x16x32_bf16 v[76:79], a[88:91], a[220:223], v[76:79]
v_mul_f32 v85, v85, abs(v85)
v_mul_f32 v86, v86, abs(v86)
v_mfma_f32_16x16x32_bf16 v[76:79], a[96:99], a[236:239], v[76:79]
v_mul_f32 v87, v87, abs(v87)
v_mfma_f32_16x16x32_bf16 v[92:95], a[60:63], a[156:159], v[92:95]
v_cvt_pk_bf16_f32 v68, v68, v69
v_cvt_pk_bf16_f32 v69, v70, v71
v_mfma_f32_16x16x32_bf16 v[92:95], a[68:71], a[172:175], v[92:95]
v_cvt_pk_bf16_f32 v70, v84, v85
v_mfma_f32_16x16x32_bf16 v[92:95], a[76:79], a[188:191], v[92:95]
v_cvt_pk_bf16_f32 v71, v86, v87
v_pk_max_i16 v68, v68, 0
v_mfma_f32_16x16x32_bf16 v[92:95], a[84:87], a[204:207], v[92:95]
v_pk_max_i16 v69, v69, 0
v_mfma_f32_16x16x32_bf16 v[92:95], a[92:95], a[220:223], v[92:95]
v_pk_max_i16 v70, v70, 0
v_pk_max_i16 v71, v71, 0
v_mfma_f32_16x16x32_bf16 v[92:95], a[100:103], a[236:239], v[92:95]
buffer_store_dwordx4 v[68:71], v12, s[12:15], s96 offen offset:1024 sc1
s_waitcnt lgkmcnt(0)
v_mfma_f32_16x16x32_bf16 v[96:99], a[0:3], a[144:147], v[96:99]
v_mul_f32 v72, v72, abs(v72)
v_mul_f32 v73, v73, abs(v73)
v_mfma_f32_16x16x32_bf16 v[96:99], a[8:11], a[160:163], v[96:99]
ds_read_b64_tr_b16 a[56:57], v8 offset:33792
v_mul_f32 v74, v74, abs(v74)
v_mfma_f32_16x16x32_bf16 v[96:99], a[16:19], a[176:179], v[96:99]
ds_read_b64_tr_b16 a[58:59], v8 offset:41984
v_mul_f32 v75, v75, abs(v75)
v_mul_f32 v88, v88, abs(v88)
v_mfma_f32_16x16x32_bf16 v[96:99], a[24:27], a[192:195], v[96:99]
ds_read_b64_tr_b16 a[60:61], v9 offset:33792
v_mul_f32 v89, v89, abs(v89)
v_mfma_f32_16x16x32_bf16 v[96:99], a[32:35], a[208:211], v[96:99]
v_mul_f32 v90, v90, abs(v90)
v_mfma_f32_16x16x32_bf16 v[96:99], a[40:43], a[224:227], v[96:99]
ds_read_b64_tr_b16 a[62:63], v9 offset:41984
v_mul_f32 v91, v91, abs(v91)
v_cvt_pk_bf16_f32 v72, v72, v73
v_mfma_f32_16x16x32_bf16 v[112:115], a[4:7], a[144:147], v[112:115]
ds_read_b64_tr_b16 a[64:65], v8 offset:50176
v_cvt_pk_bf16_f32 v73, v74, v75
v_mfma_f32_16x16x32_bf16 v[112:115], a[12:15], a[160:163], v[112:115]
v_cvt_pk_bf16_f32 v74, v88, v89
v_mfma_f32_16x16x32_bf16 v[112:115], a[20:23], a[176:179], v[112:115]
ds_read_b64_tr_b16 a[66:67], v8 offset:58368
v_cvt_pk_bf16_f32 v75, v90, v91
v_pk_max_i16 v72, v72, 0
v_mfma_f32_16x16x32_bf16 v[112:115], a[28:31], a[192:195], v[112:115]
ds_read_b64_tr_b16 a[68:69], v9 offset:50176
v_pk_max_i16 v73, v73, 0
v_mfma_f32_16x16x32_bf16 v[112:115], a[36:39], a[208:211], v[112:115]
v_pk_max_i16 v74, v74, 0
v_mfma_f32_16x16x32_bf16 v[112:115], a[44:47], a[224:227], v[112:115]
ds_read_b64_tr_b16 a[70:71], v9 offset:58368
v_pk_max_i16 v75, v75, 0
v_mfma_f32_16x16x32_bf16 v[100:103], a[0:3], a[148:151], v[100:103]
buffer_store_dwordx4 v[72:75], v12, s[12:15], s96 offen offset:2048 sc1
v_mul_f32 v76, v76, abs(v76)
v_mul_f32 v77, v77, abs(v77)
v_mfma_f32_16x16x32_bf16 v[100:103], a[8:11], a[164:167], v[100:103]
ds_read_b64_tr_b16 a[72:73], v20 offset:1024
v_mul_f32 v78, v78, abs(v78)
v_mfma_f32_16x16x32_bf16 v[100:103], a[16:19], a[180:183], v[100:103]
ds_read_b64_tr_b16 a[74:75], v20 offset:9216
v_mul_f32 v79, v79, abs(v79)
v_mul_f32 v92, v92, abs(v92)
v_mfma_f32_16x16x32_bf16 v[100:103], a[24:27], a[196:199], v[100:103]
ds_read_b64_tr_b16 a[76:77], v21 offset:1024
v_mul_f32 v93, v93, abs(v93)
v_mfma_f32_16x16x32_bf16 v[100:103], a[32:35], a[212:215], v[100:103]
v_mul_f32 v94, v94, abs(v94)
v_mfma_f32_16x16x32_bf16 v[100:103], a[40:43], a[228:231], v[100:103]
ds_read_b64_tr_b16 a[78:79], v21 offset:9216
v_mul_f32 v95, v95, abs(v95)
v_cvt_pk_bf16_f32 v76, v76, v77
v_mfma_f32_16x16x32_bf16 v[116:119], a[4:7], a[148:151], v[116:119]
v_cvt_pk_bf16_f32 v77, v78, v79
v_cvt_pk_bf16_f32 v78, v92, v93
v_mfma_f32_16x16x32_bf16 v[116:119], a[12:15], a[164:167], v[116:119]
ds_read_b64_tr_b16 a[80:81], v20 offset:17408
v_cvt_pk_bf16_f32 v79, v94, v95
v_mfma_f32_16x16x32_bf16 v[116:119], a[20:23], a[180:183], v[116:119]
ds_read_b64_tr_b16 a[82:83], v20 offset:25600
v_pk_max_i16 v76, v76, 0
v_pk_max_i16 v77, v77, 0
v_mfma_f32_16x16x32_bf16 v[116:119], a[28:31], a[196:199], v[116:119]
ds_read_b64_tr_b16 a[84:85], v21 offset:17408
v_pk_max_i16 v78, v78, 0
v_mfma_f32_16x16x32_bf16 v[116:119], a[36:39], a[212:215], v[116:119]
v_pk_max_i16 v79, v79, 0
v_mfma_f32_16x16x32_bf16 v[116:119], a[44:47], a[228:231], v[116:119]
ds_read_b64_tr_b16 a[86:87], v21 offset:25600
buffer_store_dwordx4 v[76:79], v12, s[12:15], s96 offen offset:3072 sc1
s_add_u32 s96, s96, 16384
v_mfma_f32_16x16x32_bf16 v[104:107], a[0:3], a[152:155], v[104:107]
v_mul_f32 v96, v96, abs(v96)
v_mul_f32 v97, v97, abs(v97)
v_mfma_f32_16x16x32_bf16 v[104:107], a[8:11], a[168:171], v[104:107]
ds_read_b64_tr_b16 a[88:89], v20 offset:33792
v_mul_f32 v98, v98, abs(v98)
v_mfma_f32_16x16x32_bf16 v[104:107], a[16:19], a[184:187], v[104:107]
ds_read_b64_tr_b16 a[90:91], v20 offset:41984
v_mul_f32 v99, v99, abs(v99)
v_mul_f32 v112, v112, abs(v112)
v_mfma_f32_16x16x32_bf16 v[104:107], a[24:27], a[200:203], v[104:107]
ds_read_b64_tr_b16 a[92:93], v21 offset:33792
v_mul_f32 v113, v113, abs(v113)
v_mfma_f32_16x16x32_bf16 v[104:107], a[32:35], a[216:219], v[104:107]
v_mul_f32 v114, v114, abs(v114)
v_mfma_f32_16x16x32_bf16 v[104:107], a[40:43], a[232:235], v[104:107]
ds_read_b64_tr_b16 a[94:95], v21 offset:41984
v_mul_f32 v115, v115, abs(v115)
v_cvt_pk_bf16_f32 v96, v96, v97
v_mfma_f32_16x16x32_bf16 v[120:123], a[4:7], a[152:155], v[120:123]
ds_read_b64_tr_b16 a[96:97], v20 offset:50176
v_cvt_pk_bf16_f32 v97, v98, v99
v_mfma_f32_16x16x32_bf16 v[120:123], a[12:15], a[168:171], v[120:123]
v_cvt_pk_bf16_f32 v98, v112, v113
v_mfma_f32_16x16x32_bf16 v[120:123], a[20:23], a[184:187], v[120:123]
ds_read_b64_tr_b16 a[98:99], v20 offset:58368
v_cvt_pk_bf16_f32 v99, v114, v115
v_pk_max_i16 v96, v96, 0
v_mfma_f32_16x16x32_bf16 v[120:123], a[28:31], a[200:203], v[120:123]
ds_read_b64_tr_b16 a[100:101], v21 offset:50176
v_pk_max_i16 v97, v97, 0
v_mfma_f32_16x16x32_bf16 v[120:123], a[36:39], a[216:219], v[120:123]
v_pk_max_i16 v98, v98, 0
v_mfma_f32_16x16x32_bf16 v[120:123], a[44:47], a[232:235], v[120:123]
ds_read_b64_tr_b16 a[102:103], v21 offset:58368
v_pk_max_i16 v99, v99, 0
v_mfma_f32_16x16x32_bf16 v[108:111], a[0:3], a[156:159], v[108:111]
buffer_store_dwordx4 v[96:99], v12, s[12:15], s96 offen offset:0 sc1
v_mul_f32 v100, v100, abs(v100)
v_mul_f32 v101, v101, abs(v101)
v_mfma_f32_16x16x32_bf16 v[108:111], a[8:11], a[172:175], v[108:111]
v_mul_f32 v102, v102, abs(v102)
v_mfma_f32_16x16x32_bf16 v[108:111], a[16:19], a[188:191], v[108:111]
v_mul_f32 v103, v103, abs(v103)
v_mul_f32 v116, v116, abs(v116)
v_mfma_f32_16x16x32_bf16 v[108:111], a[24:27], a[204:207], v[108:111]
v_mul_f32 v117, v117, abs(v117)
v_mfma_f32_16x16x32_bf16 v[108:111], a[32:35], a[220:223], v[108:111]
v_mul_f32 v118, v118, abs(v118)
v_mul_f32 v119, v119, abs(v119)
v_mfma_f32_16x16x32_bf16 v[108:111], a[40:43], a[236:239], v[108:111]
v_cvt_pk_bf16_f32 v100, v100, v101
v_mfma_f32_16x16x32_bf16 v[124:127], a[4:7], a[156:159], v[124:127]
v_cvt_pk_bf16_f32 v101, v102, v103
v_mfma_f32_16x16x32_bf16 v[124:127], a[12:15], a[172:175], v[124:127]
v_cvt_pk_bf16_f32 v102, v116, v117
v_cvt_pk_bf16_f32 v103, v118, v119
v_mfma_f32_16x16x32_bf16 v[124:127], a[20:23], a[188:191], v[124:127]
v_pk_max_i16 v100, v100, 0
v_mfma_f32_16x16x32_bf16 v[124:127], a[28:31], a[204:207], v[124:127]
v_pk_max_i16 v101, v101, 0
v_pk_max_i16 v102, v102, 0
v_mfma_f32_16x16x32_bf16 v[124:127], a[36:39], a[220:223], v[124:127]
v_pk_max_i16 v103, v103, 0
v_mfma_f32_16x16x32_bf16 v[124:127], a[44:47], a[236:239], v[124:127]
buffer_store_dwordx4 v[100:103], v12, s[12:15], s96 offen offset:1024 sc1
s_waitcnt lgkmcnt(0)
v_mfma_f32_16x16x32_bf16 v[128:131], a[56:59], a[144:147], v[128:131]
v_mul_f32 v104, v104, abs(v104)
v_mul_f32 v105, v105, abs(v105)
v_mfma_f32_16x16x32_bf16 v[128:131], a[64:67], a[160:163], v[128:131]
ds_read_b64_tr_b16 a[0:1], v6 offset:34816
v_mul_f32 v106, v106, abs(v106)
v_mfma_f32_16x16x32_bf16 v[128:131], a[72:75], a[176:179], v[128:131]
ds_read_b64_tr_b16 a[2:3], v6 offset:43008
v_mul_f32 v107, v107, abs(v107)
v_mul_f32 v120, v120, abs(v120)
v_mfma_f32_16x16x32_bf16 v[128:131], a[80:83], a[192:195], v[128:131]
ds_read_b64_tr_b16 a[4:5], v7 offset:34816
v_mul_f32 v121, v121, abs(v121)
v_mfma_f32_16x16x32_bf16 v[128:131], a[88:91], a[208:211], v[128:131]
v_mul_f32 v122, v122, abs(v122)
v_mfma_f32_16x16x32_bf16 v[128:131], a[96:99], a[224:227], v[128:131]
ds_read_b64_tr_b16 a[6:7], v7 offset:43008
v_mul_f32 v123, v123, abs(v123)
v_cvt_pk_bf16_f32 v104, v104, v105
v_mfma_f32_16x16x32_bf16 v[144:147], a[60:63], a[144:147], v[144:147]
ds_read_b64_tr_b16 a[8:9], v6 offset:51200
v_cvt_pk_bf16_f32 v105, v106, v107
v_mfma_f32_16x16x32_bf16 v[144:147], a[68:71], a[160:163], v[144:147]
v_cvt_pk_bf16_f32 v106, v120, v121
v_mfma_f32_16x16x32_bf16 v[144:147], a[76:79], a[176:179], v[144:147]
PG7:
s_cbranch_execz PG19
ds_read_b64_tr_b16 a[10:11], v6 offset:59392
v_cvt_pk_bf16_f32 v107, v122, v123
v_pk_max_i16 v104, v104, 0
v_mfma_f32_16x16x32_bf16 v[144:147], a[84:87], a[192:195], v[144:147]
ds_read_b64_tr_b16 a[12:13], v7 offset:51200
v_pk_max_i16 v105, v105, 0
v_mfma_f32_16x16x32_bf16 v[144:147], a[92:95], a[208:211], v[144:147]
v_pk_max_i16 v106, v106, 0
v_mfma_f32_16x16x32_bf16 v[144:147], a[100:103], a[224:227], v[144:147]
ds_read_b64_tr_b16 a[14:15], v7 offset:59392
v_pk_max_i16 v107, v107, 0
v_mfma_f32_16x16x32_bf16 v[132:135], a[56:59], a[148:151], v[132:135]
buffer_store_dwordx4 v[104:107], v12, s[12:15], s96 offen offset:2048 sc1
v_mul_f32 v108, v108, abs(v108)
v_mul_f32 v109, v109, abs(v109)
v_mfma_f32_16x16x32_bf16 v[132:135], a[64:67], a[164:167], v[132:135]
ds_read_b64_tr_b16 a[16:17], v18 offset:2048
v_mul_f32 v110, v110, abs(v110)
v_mfma_f32_16x16x32_bf16 v[132:135], a[72:75], a[180:183], v[132:135]
ds_read_b64_tr_b16 a[18:19], v18 offset:10240
v_mul_f32 v111, v111, abs(v111)
v_mul_f32 v124, v124, abs(v124)
v_mfma_f32_16x16x32_bf16 v[132:135], a[80:83], a[196:199], v[132:135]
ds_read_b64_tr_b16 a[20:21], v19 offset:2048
v_mul_f32 v125, v125, abs(v125)
v_mfma_f32_16x16x32_bf16 v[132:135], a[88:91], a[212:215], v[132:135]
v_mul_f32 v126, v126, abs(v126)
v_mfma_f32_16x16x32_bf16 v[132:135], a[96:99], a[228:231], v[132:135]
ds_read_b64_tr_b16 a[22:23], v19 offset:10240
v_mul_f32 v127, v127, abs(v127)
v_cvt_pk_bf16_f32 v108, v108, v109
v_mfma_f32_16x16x32_bf16 v[148:151], a[60:63], a[148:151], v[148:151]
v_cvt_pk_bf16_f32 v109, v110, v111
v_cvt_pk_bf16_f32 v110, v124, v125
v_mfma_f32_16x16x32_bf16 v[148:151], a[68:71], a[164:167], v[148:151]
ds_read_b64_tr_b16 a[24:25], v18 offset:18432
v_cvt_pk_bf16_f32 v111, v126, v127
v_mfma_f32_16x16x32_bf16 v[148:151], a[76:79], a[180:183], v[148:151]
ds_read_b64_tr_b16 a[26:27], v18 offset:26624
v_pk_max_i16 v108, v108, 0
v_pk_max_i16 v109, v109, 0
v_mfma_f32_16x16x32_bf16 v[148:151], a[84:87], a[196:199], v[148:151]
ds_read_b64_tr_b16 a[28:29], v19 offset:18432
v_pk_max_i16 v110, v110, 0
v_mfma_f32_16x16x32_bf16 v[148:151], a[92:95], a[212:215], v[148:151]
v_pk_max_i16 v111, v111, 0
v_mfma_f32_16x16x32_bf16 v[148:151], a[100:103], a[228:231], v[148:151]
ds_read_b64_tr_b16 a[30:31], v19 offset:26624
buffer_store_dwordx4 v[108:111], v12, s[12:15], s96 offen offset:3072 sc1
s_add_u32 s96, s96, 16384
v_mfma_f32_16x16x32_bf16 v[136:139], a[56:59], a[152:155], v[136:139]
v_mul_f32 v128, v128, abs(v128)
v_mul_f32 v129, v129, abs(v129)
v_mfma_f32_16x16x32_bf16 v[136:139], a[64:67], a[168:171], v[136:139]
ds_read_b64_tr_b16 a[32:33], v18 offset:34816
v_mul_f32 v130, v130, abs(v130)
v_mfma_f32_16x16x32_bf16 v[136:139], a[72:75], a[184:187], v[136:139]
ds_read_b64_tr_b16 a[34:35], v18 offset:43008
v_mul_f32 v131, v131, abs(v131)
v_mul_f32 v144, v144, abs(v144)
v_mfma_f32_16x16x32_bf16 v[136:139], a[80:83], a[200:203], v[136:139]
ds_read_b64_tr_b16 a[36:37], v19 offset:34816
v_mul_f32 v145, v145, abs(v145)
v_mfma_f32_16x16x32_bf16 v[136:139], a[88:91], a[216:219], v[136:139]
v_mul_f32 v146, v146, abs(v146)
v_mfma_f32_16x16x32_bf16 v[136:139], a[96:99], a[232:235], v[136:139]
ds_read_b64_tr_b16 a[38:39], v19 offset:43008
v_mul_f32 v147, v147, abs(v147)
v_cvt_pk_bf16_f32 v128, v128, v129
v_mfma_f32_16x16x32_bf16 v[152:155], a[60:63], a[152:155], v[152:155]
ds_read_b64_tr_b16 a[40:41], v18 offset:51200
v_cvt_pk_bf16_f32 v129, v130, v131
v_mfma_f32_16x16x32_bf16 v[152:155], a[68:71], a[168:171], v[152:155]
v_cvt_pk_bf16_f32 v130, v144, v145
v_mfma_f32_16x16x32_bf16 v[152:155], a[76:79], a[184:187], v[152:155]
ds_read_b64_tr_b16 a[42:43], v18 offset:59392
v_cvt_pk_bf16_f32 v131, v146, v147
v_pk_max_i16 v128, v128, 0
v_mfma_f32_16x16x32_bf16 v[152:155], a[84:87], a[200:203], v[152:155]
ds_read_b64_tr_b16 a[44:45], v19 offset:51200
v_pk_max_i16 v129, v129, 0
v_mfma_f32_16x16x32_bf16 v[152:155], a[92:95], a[216:219], v[152:155]
v_pk_max_i16 v130, v130, 0
v_mfma_f32_16x16x32_bf16 v[152:155], a[100:103], a[232:235], v[152:155]
ds_read_b64_tr_b16 a[46:47], v19 offset:59392
v_pk_max_i16 v131, v131, 0
v_mfma_f32_16x16x32_bf16 v[140:143], a[56:59], a[156:159], v[140:143]
buffer_store_dwordx4 v[128:131], v12, s[12:15], s96 offen offset:0 sc1
v_mul_f32 v132, v132, abs(v132)
v_mul_f32 v133, v133, abs(v133)
v_mfma_f32_16x16x32_bf16 v[140:143], a[64:67], a[172:175], v[140:143]
v_mul_f32 v134, v134, abs(v134)
v_mfma_f32_16x16x32_bf16 v[140:143], a[72:75], a[188:191], v[140:143]
v_mul_f32 v135, v135, abs(v135)
v_mul_f32 v148, v148, abs(v148)
v_mfma_f32_16x16x32_bf16 v[140:143], a[80:83], a[204:207], v[140:143]
v_mul_f32 v149, v149, abs(v149)
v_mfma_f32_16x16x32_bf16 v[140:143], a[88:91], a[220:223], v[140:143]
v_mul_f32 v150, v150, abs(v150)
v_mul_f32 v151, v151, abs(v151)
v_mfma_f32_16x16x32_bf16 v[140:143], a[96:99], a[236:239], v[140:143]
v_cvt_pk_bf16_f32 v132, v132, v133
v_mfma_f32_16x16x32_bf16 v[156:159], a[60:63], a[156:159], v[156:159]
v_cvt_pk_bf16_f32 v133, v134, v135
v_mfma_f32_16x16x32_bf16 v[156:159], a[68:71], a[172:175], v[156:159]
v_cvt_pk_bf16_f32 v134, v148, v149
v_cvt_pk_bf16_f32 v135, v150, v151
v_mfma_f32_16x16x32_bf16 v[156:159], a[76:79], a[188:191], v[156:159]
v_pk_max_i16 v132, v132, 0
v_mfma_f32_16x16x32_bf16 v[156:159], a[84:87], a[204:207], v[156:159]
v_pk_max_i16 v133, v133, 0
v_pk_max_i16 v134, v134, 0
v_mfma_f32_16x16x32_bf16 v[156:159], a[92:95], a[220:223], v[156:159]
v_pk_max_i16 v135, v135, 0
v_mfma_f32_16x16x32_bf16 v[156:159], a[100:103], a[236:239], v[156:159]
buffer_store_dwordx4 v[132:135], v12, s[12:15], s96 offen offset:1024 sc1
s_waitcnt lgkmcnt(0)
v_mfma_f32_16x16x32_bf16 v[160:163], a[0:3], a[144:147], v[160:163]
v_mul_f32 v136, v136, abs(v136)
v_mul_f32 v137, v137, abs(v137)
v_mfma_f32_16x16x32_bf16 v[160:163], a[8:11], a[160:163], v[160:163]
ds_read_b64_tr_b16 a[56:57], v8 offset:34816
v_mul_f32 v138, v138, abs(v138)
v_mfma_f32_16x16x32_bf16 v[160:163], a[16:19], a[176:179], v[160:163]
ds_read_b64_tr_b16 a[58:59], v8 offset:43008
v_mul_f32 v139, v139, abs(v139)
v_mul_f32 v152, v152, abs(v152)
v_mfma_f32_16x16x32_bf16 v[160:163], a[24:27], a[192:195], v[160:163]
ds_read_b64_tr_b16 a[60:61], v9 offset:34816
v_mul_f32 v153, v153, abs(v153)
v_mfma_f32_16x16x32_bf16 v[160:163], a[32:35], a[208:211], v[160:163]
v_mul_f32 v154, v154, abs(v154)
v_mfma_f32_16x16x32_bf16 v[160:163], a[40:43], a[224:227], v[160:163]
ds_read_b64_tr_b16 a[62:63], v9 offset:43008
v_mul_f32 v155, v155, abs(v155)
v_cvt_pk_bf16_f32 v136, v136, v137
v_mfma_f32_16x16x32_bf16 v[176:179], a[4:7], a[144:147], v[176:179]
ds_read_b64_tr_b16 a[64:65], v8 offset:51200
v_cvt_pk_bf16_f32 v137, v138, v139
v_mfma_f32_16x16x32_bf16 v[176:179], a[12:15], a[160:163], v[176:179]
v_cvt_pk_bf16_f32 v138, v152, v153
v_mfma_f32_16x16x32_bf16 v[176:179], a[20:23], a[176:179], v[176:179]
ds_read_b64_tr_b16 a[66:67], v8 offset:59392
v_cvt_pk_bf16_f32 v139, v154, v155
v_pk_max_i16 v136, v136, 0
v_mfma_f32_16x16x32_bf16 v[176:179], a[28:31], a[192:195], v[176:179]
ds_read_b64_tr_b16 a[68:69], v9 offset:51200
v_pk_max_i16 v137, v137, 0
v_mfma_f32_16x16x32_bf16 v[176:179], a[36:39], a[208:211], v[176:179]
v_pk_max_i16 v138, v138, 0
v_mfma_f32_16x16x32_bf16 v[176:179], a[44:47], a[224:227], v[176:179]
ds_read_b64_tr_b16 a[70:71], v9 offset:59392
v_pk_max_i16 v139, v139, 0
v_mfma_f32_16x16x32_bf16 v[164:167], a[0:3], a[148:151], v[164:167]
buffer_store_dwordx4 v[136:139], v12, s[12:15], s96 offen offset:2048 sc1
v_mul_f32 v140, v140, abs(v140)
v_mul_f32 v141, v141, abs(v141)
v_mfma_f32_16x16x32_bf16 v[164:167], a[8:11], a[164:167], v[164:167]
ds_read_b64_tr_b16 a[72:73], v20 offset:2048
v_mul_f32 v142, v142, abs(v142)
v_mfma_f32_16x16x32_bf16 v[164:167], a[16:19], a[180:183], v[164:167]
ds_read_b64_tr_b16 a[74:75], v20 offset:10240
v_mul_f32 v143, v143, abs(v143)
v_mul_f32 v156, v156, abs(v156)
v_mfma_f32_16x16x32_bf16 v[164:167], a[24:27], a[196:199], v[164:167]
ds_read_b64_tr_b16 a[76:77], v21 offset:2048
v_mul_f32 v157, v157, abs(v157)
v_mfma_f32_16x16x32_bf16 v[164:167], a[32:35], a[212:215], v[164:167]
v_mul_f32 v158, v158, abs(v158)
v_mfma_f32_16x16x32_bf16 v[164:167], a[40:43], a[228:231], v[164:167]
ds_read_b64_tr_b16 a[78:79], v21 offset:10240
v_mul_f32 v159, v159, abs(v159)
v_cvt_pk_bf16_f32 v140, v140, v141
v_mfma_f32_16x16x32_bf16 v[180:183], a[4:7], a[148:151], v[180:183]
v_cvt_pk_bf16_f32 v141, v142, v143
v_cvt_pk_bf16_f32 v142, v156, v157
v_mfma_f32_16x16x32_bf16 v[180:183], a[12:15], a[164:167], v[180:183]
ds_read_b64_tr_b16 a[80:81], v20 offset:18432
v_cvt_pk_bf16_f32 v143, v158, v159
v_mfma_f32_16x16x32_bf16 v[180:183], a[20:23], a[180:183], v[180:183]
ds_read_b64_tr_b16 a[82:83], v20 offset:26624
v_pk_max_i16 v140, v140, 0
v_pk_max_i16 v141, v141, 0
v_mfma_f32_16x16x32_bf16 v[180:183], a[28:31], a[196:199], v[180:183]
ds_read_b64_tr_b16 a[84:85], v21 offset:18432
v_pk_max_i16 v142, v142, 0
v_mfma_f32_16x16x32_bf16 v[180:183], a[36:39], a[212:215], v[180:183]
v_pk_max_i16 v143, v143, 0
v_mfma_f32_16x16x32_bf16 v[180:183], a[44:47], a[228:231], v[180:183]
ds_read_b64_tr_b16 a[86:87], v21 offset:26624
buffer_store_dwordx4 v[140:143], v12, s[12:15], s96 offen offset:3072 sc1
s_add_u32 s96, s96, 16384
s_waitcnt vmcnt(8)
buffer_store_dword v26, v25, s[12:15], s99 offen sc1
v_mfma_f32_16x16x32_bf16 v[168:171], a[0:3], a[152:155], v[168:171]
v_mul_f32 v160, v160, abs(v160)
v_mul_f32 v161, v161, abs(v161)
v_mfma_f32_16x16x32_bf16 v[168:171], a[8:11], a[168:171], v[168:171]
ds_read_b64_tr_b16 a[88:89], v20 offset:34816
v_mul_f32 v162, v162, abs(v162)
v_mfma_f32_16x16x32_bf16 v[168:171], a[16:19], a[184:187], v[168:171]
ds_read_b64_tr_b16 a[90:91], v20 offset:43008
v_mul_f32 v163, v163, abs(v163)
v_mul_f32 v176, v176, abs(v176)
v_mfma_f32_16x16x32_bf16 v[168:171], a[24:27], a[200:203], v[168:171]
ds_read_b64_tr_b16 a[92:93], v21 offset:34816
v_mul_f32 v177, v177, abs(v177)
v_mfma_f32_16x16x32_bf16 v[168:171], a[32:35], a[216:219], v[168:171]
v_mul_f32 v178, v178, abs(v178)
v_mfma_f32_16x16x32_bf16 v[168:171], a[40:43], a[232:235], v[168:171]
ds_read_b64_tr_b16 a[94:95], v21 offset:43008
v_mul_f32 v179, v179, abs(v179)
v_cvt_pk_bf16_f32 v160, v160, v161
v_mfma_f32_16x16x32_bf16 v[184:187], a[4:7], a[152:155], v[184:187]
ds_read_b64_tr_b16 a[96:97], v20 offset:51200
v_cvt_pk_bf16_f32 v161, v162, v163
v_mfma_f32_16x16x32_bf16 v[184:187], a[12:15], a[168:171], v[184:187]
v_cvt_pk_bf16_f32 v162, v176, v177
v_mfma_f32_16x16x32_bf16 v[184:187], a[20:23], a[184:187], v[184:187]
ds_read_b64_tr_b16 a[98:99], v20 offset:59392
v_cvt_pk_bf16_f32 v163, v178, v179
v_pk_max_i16 v160, v160, 0
v_mfma_f32_16x16x32_bf16 v[184:187], a[28:31], a[200:203], v[184:187]
ds_read_b64_tr_b16 a[100:101], v21 offset:51200
v_pk_max_i16 v161, v161, 0
v_mfma_f32_16x16x32_bf16 v[184:187], a[36:39], a[216:219], v[184:187]
v_pk_max_i16 v162, v162, 0
v_mfma_f32_16x16x32_bf16 v[184:187], a[44:47], a[232:235], v[184:187]
ds_read_b64_tr_b16 a[102:103], v21 offset:59392
v_pk_max_i16 v163, v163, 0
v_mfma_f32_16x16x32_bf16 v[172:175], a[0:3], a[156:159], v[172:175]
buffer_store_dwordx4 v[160:163], v12, s[12:15], s96 offen offset:0 sc1
v_mul_f32 v164, v164, abs(v164)
v_mul_f32 v165, v165, abs(v165)
v_mfma_f32_16x16x32_bf16 v[172:175], a[8:11], a[172:175], v[172:175]
v_mul_f32 v166, v166, abs(v166)
v_mfma_f32_16x16x32_bf16 v[172:175], a[16:19], a[188:191], v[172:175]
v_mul_f32 v167, v167, abs(v167)
v_mul_f32 v180, v180, abs(v180)
v_mfma_f32_16x16x32_bf16 v[172:175], a[24:27], a[204:207], v[172:175]
v_mul_f32 v181, v181, abs(v181)
v_mfma_f32_16x16x32_bf16 v[172:175], a[32:35], a[220:223], v[172:175]
v_mul_f32 v182, v182, abs(v182)
v_mul_f32 v183, v183, abs(v183)
v_mfma_f32_16x16x32_bf16 v[172:175], a[40:43], a[236:239], v[172:175]
v_cvt_pk_bf16_f32 v164, v164, v165
v_mfma_f32_16x16x32_bf16 v[188:191], a[4:7], a[156:159], v[188:191]
v_cvt_pk_bf16_f32 v165, v166, v167
v_mfma_f32_16x16x32_bf16 v[188:191], a[12:15], a[172:175], v[188:191]
v_cvt_pk_bf16_f32 v166, v180, v181
v_cvt_pk_bf16_f32 v167, v182, v183
v_mfma_f32_16x16x32_bf16 v[188:191], a[20:23], a[188:191], v[188:191]
v_pk_max_i16 v164, v164, 0
v_mfma_f32_16x16x32_bf16 v[188:191], a[28:31], a[204:207], v[188:191]
v_pk_max_i16 v165, v165, 0
v_pk_max_i16 v166, v166, 0
v_mfma_f32_16x16x32_bf16 v[188:191], a[36:39], a[220:223], v[188:191]
v_pk_max_i16 v167, v167, 0
v_mfma_f32_16x16x32_bf16 v[188:191], a[44:47], a[236:239], v[188:191]
buffer_store_dwordx4 v[164:167], v12, s[12:15], s96 offen offset:1024 sc1
s_waitcnt lgkmcnt(0)
v_mfma_f32_16x16x32_bf16 v[192:195], a[56:59], a[144:147], v[192:195]
v_mul_f32 v168, v168, abs(v168)
v_mul_f32 v169, v169, abs(v169)
v_mfma_f32_16x16x32_bf16 v[192:195], a[64:67], a[160:163], v[192:195]
ds_read_b64_tr_b16 a[0:1], v10 offset:35840
v_mul_f32 v170, v170, abs(v170)
v_mfma_f32_16x16x32_bf16 v[192:195], a[72:75], a[176:179], v[192:195]
ds_read_b64_tr_b16 a[2:3], v10 offset:44032
v_mul_f32 v171, v171, abs(v171)
v_mul_f32 v184, v184, abs(v184)
v_mfma_f32_16x16x32_bf16 v[192:195], a[80:83], a[192:195], v[192:195]
ds_read_b64_tr_b16 a[4:5], v11 offset:35840
v_mul_f32 v185, v185, abs(v185)
v_mfma_f32_16x16x32_bf16 v[192:195], a[88:91], a[208:211], v[192:195]
v_mul_f32 v186, v186, abs(v186)
v_mfma_f32_16x16x32_bf16 v[192:195], a[96:99], a[224:227], v[192:195]
ds_read_b64_tr_b16 a[6:7], v11 offset:44032
v_mul_f32 v187, v187, abs(v187)
v_cvt_pk_bf16_f32 v168, v168, v169
v_mfma_f32_16x16x32_bf16 v[208:211], a[60:63], a[144:147], v[208:211]
ds_read_b64_tr_b16 a[8:9], v10 offset:52224
v_cvt_pk_bf16_f32 v169, v170, v171
v_mfma_f32_16x16x32_bf16 v[208:211], a[68:71], a[160:163], v[208:211]
v_cvt_pk_bf16_f32 v170, v184, v185
v_mfma_f32_16x16x32_bf16 v[208:211], a[76:79], a[176:179], v[208:211]
ds_read_b64_tr_b16 a[10:11], v10 offset:60416
v_cvt_pk_bf16_f32 v171, v186, v187
v_pk_max_i16 v168, v168, 0
v_mfma_f32_16x16x32_bf16 v[208:211], a[84:87], a[192:195], v[208:211]
ds_read_b64_tr_b16 a[12:13], v11 offset:52224
v_pk_max_i16 v169, v169, 0
v_mfma_f32_16x16x32_bf16 v[208:211], a[92:95], a[208:211], v[208:211]
v_pk_max_i16 v170, v170, 0
v_mfma_f32_16x16x32_bf16 v[208:211], a[100:103], a[224:227], v[208:211]
ds_read_b64_tr_b16 a[14:15], v11 offset:60416
v_pk_max_i16 v171, v171, 0
v_mfma_f32_16x16x32_bf16 v[196:199], a[56:59], a[148:151], v[196:199]
buffer_store_dwordx4 v[168:171], v12, s[12:15], s96 offen offset:2048 sc1
v_mul_f32 v172, v172, abs(v172)
v_mul_f32 v173, v173, abs(v173)
v_mfma_f32_16x16x32_bf16 v[196:199], a[64:67], a[164:167], v[196:199]
ds_read_b64_tr_b16 a[16:17], v22 offset:3072
v_mul_f32 v174, v174, abs(v174)
v_mfma_f32_16x16x32_bf16 v[196:199], a[72:75], a[180:183], v[196:199]
ds_read_b64_tr_b16 a[18:19], v22 offset:11264
v_mul_f32 v175, v175, abs(v175)
v_mul_f32 v188, v188, abs(v188)
v_mfma_f32_16x16x32_bf16 v[196:199], a[80:83], a[196:199], v[196:199]
ds_read_b64_tr_b16 a[20:21], v23 offset:3072
v_mul_f32 v189, v189, abs(v189)
v_mfma_f32_16x16x32_bf16 v[196:199], a[88:91], a[212:215], v[196:199]
v_mul_f32 v190, v190, abs(v190)
v_mfma_f32_16x16x32_bf16 v[196:199], a[96:99], a[228:231], v[196:199]
ds_read_b64_tr_b16 a[22:23], v23 offset:11264
v_mul_f32 v191, v191, abs(v191)
v_cvt_pk_bf16_f32 v172, v172, v173
v_mfma_f32_16x16x32_bf16 v[212:215], a[60:63], a[148:151], v[212:215]
v_cvt_pk_bf16_f32 v173, v174, v175
v_cvt_pk_bf16_f32 v174, v188, v189
v_mfma_f32_16x16x32_bf16 v[212:215], a[68:71], a[164:167], v[212:215]
ds_read_b64_tr_b16 a[24:25], v22 offset:19456
v_cvt_pk_bf16_f32 v175, v190, v191
v_mfma_f32_16x16x32_bf16 v[212:215], a[76:79], a[180:183], v[212:215]
ds_read_b64_tr_b16 a[26:27], v22 offset:27648
v_pk_max_i16 v172, v172, 0
v_pk_max_i16 v173, v173, 0
v_mfma_f32_16x16x32_bf16 v[212:215], a[84:87], a[196:199], v[212:215]
ds_read_b64_tr_b16 a[28:29], v23 offset:19456
v_pk_max_i16 v174, v174, 0
v_mfma_f32_16x16x32_bf16 v[212:215], a[92:95], a[212:215], v[212:215]
v_pk_max_i16 v175, v175, 0
v_mfma_f32_16x16x32_bf16 v[212:215], a[100:103], a[228:231], v[212:215]
ds_read_b64_tr_b16 a[30:31], v23 offset:27648
buffer_store_dwordx4 v[172:175], v12, s[12:15], s96 offen offset:3072 sc1
s_add_u32 s96, s96, 16384
v_mfma_f32_16x16x32_bf16 v[200:203], a[56:59], a[152:155], v[200:203]
v_mul_f32 v192, v192, abs(v192)
v_mul_f32 v193, v193, abs(v193)
v_mfma_f32_16x16x32_bf16 v[200:203], a[64:67], a[168:171], v[200:203]
ds_read_b64_tr_b16 a[32:33], v22 offset:35840
v_mul_f32 v194, v194, abs(v194)
v_mfma_f32_16x16x32_bf16 v[200:203], a[72:75], a[184:187], v[200:203]
ds_read_b64_tr_b16 a[34:35], v22 offset:44032
v_mul_f32 v195, v195, abs(v195)
v_mul_f32 v208, v208, abs(v208)
v_mfma_f32_16x16x32_bf16 v[200:203], a[80:83], a[200:203], v[200:203]
ds_read_b64_tr_b16 a[36:37], v23 offset:35840
v_mul_f32 v209, v209, abs(v209)
v_mfma_f32_16x16x32_bf16 v[200:203], a[88:91], a[216:219], v[200:203]
v_mul_f32 v210, v210, abs(v210)
v_mfma_f32_16x16x32_bf16 v[200:203], a[96:99], a[232:235], v[200:203]
ds_read_b64_tr_b16 a[38:39], v23 offset:44032
v_mul_f32 v211, v211, abs(v211)
v_cvt_pk_bf16_f32 v192, v192, v193
v_mfma_f32_16x16x32_bf16 v[216:219], a[60:63], a[152:155], v[216:219]
ds_read_b64_tr_b16 a[40:41], v22 offset:52224
v_cvt_pk_bf16_f32 v193, v194, v195
v_mfma_f32_16x16x32_bf16 v[216:219], a[68:71], a[168:171], v[216:219]
v_cvt_pk_bf16_f32 v194, v208, v209
v_mfma_f32_16x16x32_bf16 v[216:219], a[76:79], a[184:187], v[216:219]
ds_read_b64_tr_b16 a[42:43], v22 offset:60416
v_cvt_pk_bf16_f32 v195, v210, v211
v_pk_max_i16 v192, v192, 0
v_mfma_f32_16x16x32_bf16 v[216:219], a[84:87], a[200:203], v[216:219]
ds_read_b64_tr_b16 a[44:45], v23 offset:52224
v_pk_max_i16 v193, v193, 0
v_mfma_f32_16x16x32_bf16 v[216:219], a[92:95], a[216:219], v[216:219]
v_pk_max_i16 v194, v194, 0
v_mfma_f32_16x16x32_bf16 v[216:219], a[100:103], a[232:235], v[216:219]
ds_read_b64_tr_b16 a[46:47], v23 offset:60416
v_pk_max_i16 v195, v195, 0
v_mfma_f32_16x16x32_bf16 v[204:207], a[56:59], a[156:159], v[204:207]
buffer_store_dwordx4 v[192:195], v12, s[12:15], s96 offen offset:0 sc1
v_mul_f32 v196, v196, abs(v196)
v_mul_f32 v197, v197, abs(v197)
v_mfma_f32_16x16x32_bf16 v[204:207], a[64:67], a[172:175], v[204:207]
v_mul_f32 v198, v198, abs(v198)
v_mfma_f32_16x16x32_bf16 v[204:207], a[72:75], a[188:191], v[204:207]
v_mul_f32 v199, v199, abs(v199)
v_mul_f32 v212, v212, abs(v212)
v_mfma_f32_16x16x32_bf16 v[204:207], a[80:83], a[204:207], v[204:207]
v_mul_f32 v213, v213, abs(v213)
v_mfma_f32_16x16x32_bf16 v[204:207], a[88:91], a[220:223], v[204:207]
v_mul_f32 v214, v214, abs(v214)
v_mul_f32 v215, v215, abs(v215)
v_mfma_f32_16x16x32_bf16 v[204:207], a[96:99], a[236:239], v[204:207]
v_cvt_pk_bf16_f32 v196, v196, v197
v_mfma_f32_16x16x32_bf16 v[220:223], a[60:63], a[156:159], v[220:223]
v_cvt_pk_bf16_f32 v197, v198, v199
v_mfma_f32_16x16x32_bf16 v[220:223], a[68:71], a[172:175], v[220:223]
v_cvt_pk_bf16_f32 v198, v212, v213
v_cvt_pk_bf16_f32 v199, v214, v215
v_mfma_f32_16x16x32_bf16 v[220:223], a[76:79], a[188:191], v[220:223]
v_pk_max_i16 v196, v196, 0
v_mfma_f32_16x16x32_bf16 v[220:223], a[84:87], a[204:207], v[220:223]
v_pk_max_i16 v197, v197, 0
v_pk_max_i16 v198, v198, 0
v_mfma_f32_16x16x32_bf16 v[220:223], a[92:95], a[220:223], v[220:223]
v_pk_max_i16 v199, v199, 0
v_mfma_f32_16x16x32_bf16 v[220:223], a[100:103], a[236:239], v[220:223]
buffer_store_dwordx4 v[196:199], v12, s[12:15], s96 offen offset:1024 sc1
s_waitcnt lgkmcnt(0)
v_mfma_f32_16x16x32_bf16 v[224:227], a[0:3], a[144:147], v[224:227]
v_mul_f32 v200, v200, abs(v200)
v_mul_f32 v201, v201, abs(v201)
v_mfma_f32_16x16x32_bf16 v[224:227], a[8:11], a[160:163], v[224:227]
v_mul_f32 v202, v202, abs(v202)
v_mfma_f32_16x16x32_bf16 v[224:227], a[16:19], a[176:179], v[224:227]
v_mul_f32 v203, v203, abs(v203)
v_mul_f32 v216, v216, abs(v216)
v_mfma_f32_16x16x32_bf16 v[224:227], a[24:27], a[192:195], v[224:227]
v_mul_f32 v217, v217, abs(v217)
v_mfma_f32_16x16x32_bf16 v[224:227], a[32:35], a[208:211], v[224:227]
v_mul_f32 v218, v218, abs(v218)
v_mul_f32 v219, v219, abs(v219)
v_mfma_f32_16x16x32_bf16 v[224:227], a[40:43], a[224:227], v[224:227]
v_cvt_pk_bf16_f32 v200, v200, v201
v_mfma_f32_16x16x32_bf16 v[240:243], a[4:7], a[144:147], v[240:243]
v_cvt_pk_bf16_f32 v201, v202, v203
v_mfma_f32_16x16x32_bf16 v[240:243], a[12:15], a[160:163], v[240:243]
v_cvt_pk_bf16_f32 v202, v216, v217
v_cvt_pk_bf16_f32 v203, v218, v219
v_mfma_f32_16x16x32_bf16 v[240:243], a[20:23], a[176:179], v[240:243]
v_pk_max_i16 v200, v200, 0
v_mfma_f32_16x16x32_bf16 v[240:243], a[28:31], a[192:195], v[240:243]
v_pk_max_i16 v201, v201, 0
v_pk_max_i16 v202, v202, 0
v_mfma_f32_16x16x32_bf16 v[240:243], a[36:39], a[208:211], v[240:243]
v_pk_max_i16 v203, v203, 0
v_mfma_f32_16x16x32_bf16 v[240:243], a[44:47], a[224:227], v[240:243]
buffer_store_dwordx4 v[200:203], v12, s[12:15], s96 offen offset:2048 sc1
v_mfma_f32_16x16x32_bf16 v[228:231], a[0:3], a[148:151], v[228:231]
v_mul_f32 v204, v204, abs(v204)
v_mul_f32 v205, v205, abs(v205)
v_mfma_f32_16x16x32_bf16 v[228:231], a[8:11], a[164:167], v[228:231]
v_mul_f32 v206, v206, abs(v206)
v_mfma_f32_16x16x32_bf16 v[228:231], a[16:19], a[180:183], v[228:231]
v_mul_f32 v207, v207, abs(v207)
v_mul_f32 v220, v220, abs(v220)
v_mfma_f32_16x16x32_bf16 v[228:231], a[24:27], a[196:199], v[228:231]
v_mul_f32 v221, v221, abs(v221)
v_mfma_f32_16x16x32_bf16 v[228:231], a[32:35], a[212:215], v[228:231]
v_mul_f32 v222, v222, abs(v222)
v_mul_f32 v223, v223, abs(v223)
v_mfma_f32_16x16x32_bf16 v[228:231], a[40:43], a[228:231], v[228:231]
v_cvt_pk_bf16_f32 v204, v204, v205
v_mfma_f32_16x16x32_bf16 v[244:247], a[4:7], a[148:151], v[244:247]
v_cvt_pk_bf16_f32 v205, v206, v207
v_mfma_f32_16x16x32_bf16 v[244:247], a[12:15], a[164:167], v[244:247]
v_cvt_pk_bf16_f32 v206, v220, v221
v_cvt_pk_bf16_f32 v207, v222, v223
v_mfma_f32_16x16x32_bf16 v[244:247], a[20:23], a[180:183], v[244:247]
v_pk_max_i16 v204, v204, 0
v_mfma_f32_16x16x32_bf16 v[244:247], a[28:31], a[196:199], v[244:247]
v_pk_max_i16 v205, v205, 0
v_pk_max_i16 v206, v206, 0
v_mfma_f32_16x16x32_bf16 v[244:247], a[36:39], a[212:215], v[244:247]
v_pk_max_i16 v207, v207, 0
v_mfma_f32_16x16x32_bf16 v[244:247], a[44:47], a[228:231], v[244:247]
buffer_store_dwordx4 v[204:207], v12, s[12:15], s96 offen offset:3072 sc1
v_mfma_f32_16x16x32_bf16 v[232:235], a[0:3], a[152:155], v[232:235]
v_mul_f32 v224, v224, abs(v224)
v_mul_f32 v225, v225, abs(v225)
v_mfma_f32_16x16x32_bf16 v[232:235], a[8:11], a[168:171], v[232:235]
v_mul_f32 v226, v226, abs(v226)
v_mfma_f32_16x16x32_bf16 v[232:235], a[16:19], a[184:187], v[232:235]
v_mul_f32 v227, v227, abs(v227)
v_mul_f32 v240, v240, abs(v240)
v_mfma_f32_16x16x32_bf16 v[232:235], a[24:27], a[200:203], v[232:235]
v_mul_f32 v241, v241, abs(v241)
v_mfma_f32_16x16x32_bf16 v[232:235], a[32:35], a[216:219], v[232:235]
v_mul_f32 v242, v242, abs(v242)
v_mul_f32 v243, v243, abs(v243)
v_mfma_f32_16x16x32_bf16 v[232:235], a[40:43], a[232:235], v[232:235]
v_cvt_pk_bf16_f32 v224, v224, v225
v_mfma_f32_16x16x32_bf16 v[248:251], a[4:7], a[152:155], v[248:251]
v_cvt_pk_bf16_f32 v225, v226, v227
v_mfma_f32_16x16x32_bf16 v[248:251], a[12:15], a[168:171], v[248:251]
v_cvt_pk_bf16_f32 v226, v240, v241
v_cvt_pk_bf16_f32 v227, v242, v243
v_mfma_f32_16x16x32_bf16 v[248:251], a[20:23], a[184:187], v[248:251]
v_pk_max_i16 v224, v224, 0
v_mfma_f32_16x16x32_bf16 v[248:251], a[28:31], a[200:203], v[248:251]
v_pk_max_i16 v225, v225, 0
v_pk_max_i16 v226, v226, 0
v_mfma_f32_16x16x32_bf16 v[248:251], a[36:39], a[216:219], v[248:251]
v_pk_max_i16 v227, v227, 0
v_mfma_f32_16x16x32_bf16 v[248:251], a[44:47], a[232:235], v[248:251]
buffer_store_dwordx4 v[224:227], v12, s[12:15], s97 offen offset:0 sc1
v_mfma_f32_16x16x32_bf16 v[236:239], a[0:3], a[156:159], v[236:239]
v_mul_f32 v228, v228, abs(v228)
v_mul_f32 v229, v229, abs(v229)
v_mfma_f32_16x16x32_bf16 v[236:239], a[8:11], a[172:175], v[236:239]
v_mul_f32 v230, v230, abs(v230)
v_mfma_f32_16x16x32_bf16 v[236:239], a[16:19], a[188:191], v[236:239]
v_mul_f32 v231, v231, abs(v231)
v_mul_f32 v244, v244, abs(v244)
v_mfma_f32_16x16x32_bf16 v[236:239], a[24:27], a[204:207], v[236:239]
v_mul_f32 v245, v245, abs(v245)
v_mfma_f32_16x16x32_bf16 v[236:239], a[32:35], a[220:223], v[236:239]
v_mul_f32 v246, v246, abs(v246)
v_mul_f32 v247, v247, abs(v247)
v_mfma_f32_16x16x32_bf16 v[236:239], a[40:43], a[236:239], v[236:239]
v_cvt_pk_bf16_f32 v228, v228, v229
v_mfma_f32_16x16x32_bf16 v[252:255], a[4:7], a[156:159], v[252:255]
v_cvt_pk_bf16_f32 v229, v230, v231
v_mfma_f32_16x16x32_bf16 v[252:255], a[12:15], a[172:175], v[252:255]
v_cvt_pk_bf16_f32 v230, v244, v245
v_cvt_pk_bf16_f32 v231, v246, v247
v_mfma_f32_16x16x32_bf16 v[252:255], a[20:23], a[188:191], v[252:255]
v_pk_max_i16 v228, v228, 0
v_mfma_f32_16x16x32_bf16 v[252:255], a[28:31], a[204:207], v[252:255]
v_pk_max_i16 v229, v229, 0
PG8:
s_cbranch_execz PG20
v_pk_max_i16 v230, v230, 0
v_mfma_f32_16x16x32_bf16 v[252:255], a[36:39], a[220:223], v[252:255]
v_pk_max_i16 v231, v231, 0
v_mfma_f32_16x16x32_bf16 v[252:255], a[44:47], a[236:239], v[252:255]
buffer_store_dwordx4 v[228:231], v12, s[12:15], s97 offen offset:1024 sc1
v_mul_f32 v232, v232, abs(v232)
v_mul_f32 v233, v233, abs(v233)
v_mul_f32 v234, v234, abs(v234)
v_mul_f32 v235, v235, abs(v235)
v_mul_f32 v248, v248, abs(v248)
v_mul_f32 v249, v249, abs(v249)
v_mul_f32 v250, v250, abs(v250)
v_mul_f32 v251, v251, abs(v251)
v_cvt_pk_bf16_f32 v232, v232, v233
v_cvt_pk_bf16_f32 v233, v234, v235
v_cvt_pk_bf16_f32 v234, v248, v249
v_cvt_pk_bf16_f32 v235, v250, v251
v_pk_max_i16 v232, v232, 0
v_pk_max_i16 v233, v233, 0
v_pk_max_i16 v234, v234, 0
v_pk_max_i16 v235, v235, 0
buffer_store_dwordx4 v[232:235], v12, s[12:15], s97 offen offset:2048 sc1
v_mul_f32 v236, v236, abs(v236)
v_mul_f32 v237, v237, abs(v237)
v_mul_f32 v238, v238, abs(v238)
v_mul_f32 v239, v239, abs(v239)
v_mul_f32 v252, v252, abs(v252)
v_mul_f32 v253, v253, abs(v253)
v_mul_f32 v254, v254, abs(v254)
v_mul_f32 v255, v255, abs(v255)
v_cvt_pk_bf16_f32 v236, v236, v237
v_cvt_pk_bf16_f32 v237, v238, v239
v_cvt_pk_bf16_f32 v238, v252, v253
v_cvt_pk_bf16_f32 v239, v254, v255
v_pk_max_i16 v236, v236, 0
v_pk_max_i16 v237, v237, 0
v_pk_max_i16 v238, v238, 0
v_pk_max_i16 v239, v239, 0
buffer_store_dwordx4 v[236:239], v12, s[12:15], s97 offen offset:3072 sc1
v_add_u32 v10, 16384, v1
buffer_load_dword v0, v24, s[12:15], s100 offen sc1
s_waitcnt lgkmcnt(0)
s_barrier
s_add_u32 m0, s42, 81920
s_nop 0
buffer_load_dwordx4 v14, s[20:23], s71 offen offset:0 lds
buffer_load_dwordx4 v15, s[20:23], s71 offen offset:1024 lds
buffer_load_dwordx4 v16, s[20:23], s71 offen offset:2048 lds
buffer_load_dwordx4 v17, s[20:23], s71 offen offset:3072 lds
s_add_u32 m0, s42, 98304
s_add_u32 s71, s71, 0xe0000
buffer_load_dwordx4 v14, s[20:23], s71 offen offset:0 lds
buffer_load_dwordx4 v15, s[20:23], s71 offen offset:1024 lds
buffer_load_dwordx4 v16, s[20:23], s71 offen offset:2048 lds
buffer_load_dwordx4 v17, s[20:23], s71 offen offset:3072 lds
s_add_u32 s71, s71, 0xe0000
v_add_u32 v56, 65536, v6
v_add_u32 v60, 131072, v6
v_add_u32 v57, 65536, v7
v_add_u32 v61, 131072, v7
v_add_u32 v58, 65536, v8
v_add_u32 v62, 131072, v8
v_add_u32 v59, 65536, v9
v_add_u32 v63, 131072, v9
v_bfe_u32 v27, v1, 4, 4
v_bfe_u32 v28, v1, 8, 1
v_lshrrev_b32 v29, 9, v1
v_lshlrev_b32 v209, 5, v28
v_lshl_add_u32 v209, v29, 4, v209
v_lshl_add_u32 v210, v27, 11, v209
buffer_load_dwordx4 v[32:35], v210, s[28:31], s74 offen offset:0
buffer_load_dwordx4 v[36:39], v210, s[28:31], s74 offen offset:64
buffer_load_dwordx4 v[40:43], v210, s[28:31], s75 offen offset:0
buffer_load_dwordx4 v[44:47], v210, s[28:31], s75 offen offset:64
buffer_load_dwordx4 v[48:51], v209, s[32:35], s73 offen offset:0
buffer_load_dwordx4 v[52:55], v209, s[32:35], s73 offen offset:64
v_lshrrev_b32 v211, 5, v1
v_min_u32 v211, 6, v211
v_lshlrev_b32 v211, 10, v211
v_bfe_u32 v212, v1, 4, 1
v_lshl_add_u32 v211, v212, 7, v211
s_mul_i32 s44, s56, 7
s_add_u32 s44, s44, 4352
v_add_u32 v211, s44, v211
v_mov_b32 v64, 0
v_mov_b32 v65, 0
v_mov_b32 v66, 0
v_mov_b32 v67, 0
v_mov_b32 v68, 0
v_mov_b32 v69, 0
v_mov_b32 v70, 0
v_mov_b32 v71, 0
v_mov_b32 v72, 0
v_mov_b32 v73, 0
v_mov_b32 v74, 0
v_mov_b32 v75, 0
v_mov_b32 v76, 0
v_mov_b32 v77, 0
v_mov_b32 v78, 0
v_mov_b32 v79, 0
v_mov_b32 v80, 0
v_mov_b32 v81, 0
v_mov_b32 v82, 0
v_mov_b32 v83, 0
v_mov_b32 v84, 0
v_mov_b32 v85, 0
v_mov_b32 v86, 0
v_mov_b32 v87, 0
v_mov_b32 v88, 0
v_mov_b32 v89, 0
v_mov_b32 v90, 0
v_mov_b32 v91, 0
v_mov_b32 v92, 0
v_mov_b32 v93, 0
v_mov_b32 v94, 0
v_mov_b32 v95, 0
v_mov_b32 v96, 0
v_mov_b32 v97, 0
v_mov_b32 v98, 0
v_mov_b32 v99, 0
v_mov_b32 v100, 0
v_mov_b32 v101, 0
v_mov_b32 v102, 0
v_mov_b32 v103, 0
v_mov_b32 v104, 0
v_mov_b32 v105, 0
v_mov_b32 v106, 0
v_mov_b32 v107, 0
v_mov_b32 v108, 0
v_mov_b32 v109, 0
v_mov_b32 v110, 0
v_mov_b32 v111, 0
v_mov_b32 v112, 0
v_mov_b32 v113, 0
v_mov_b32 v114, 0
v_mov_b32 v115, 0
v_mov_b32 v116, 0
v_mov_b32 v117, 0
v_mov_b32 v118, 0
v_mov_b32 v119, 0
v_mov_b32 v120, 0
v_mov_b32 v121, 0
v_mov_b32 v122, 0
v_mov_b32 v123, 0
v_mov_b32 v124, 0
v_mov_b32 v125, 0
v_mov_b32 v126, 0
v_mov_b32 v127, 0
s_waitcnt vmcnt(14)
buffer_store_dword v26, v25, s[12:15], s98 offen sc1
s_mov_b32 s84, -1
s_mov_b32 s86, 0
fk_a1_chk:
v_cmp_eq_u32 vcc, v26, v0
s_nop 1
s_andn2_b64 s[88:89], s[84:85], vcc
s_cbranch_scc0 fk_a1_ok
s_add_u32 s86, s86, 1
s_cmp_gt_u32 s86, 0x8000
s_cbranch_scc1 fk_a1_ok
s_sleep 4
fk_a1_ld:
buffer_load_dword v0, v24, s[12:15], s100 offen sc1
s_waitcnt vmcnt(0)
s_branch fk_a1_chk
fk_a1_ok:
buffer_load_dwordx4 a[176:179], v1, s[12:15], s69 offen offset:0 sc1
buffer_load_dwordx4 a[180:183], v1, s[12:15], s69 offen offset:1024 sc1
buffer_load_dwordx4 a[184:187], v10, s[12:15], s69 offen offset:0 sc1
buffer_load_dwordx4 a[188:191], v10, s[12:15], s69 offen offset:1024 sc1
s_add_u32 s69, s69, 0x38000
s_nop 0
buffer_load_dwordx4 a[192:195], v1, s[12:15], s69 offen offset:0 sc1
buffer_load_dwordx4 a[196:199], v1, s[12:15], s69 offen offset:1024 sc1
buffer_load_dwordx4 a[200:203], v10, s[12:15], s69 offen offset:0 sc1
buffer_load_dwordx4 a[204:207], v10, s[12:15], s69 offen offset:1024 sc1
s_add_u32 s69, s69, 0x38000
s_add_u32 m0, s42, 114688
s_nop 0
buffer_load_dwordx4 v14, s[20:23], s71 offen offset:0 lds
buffer_load_dwordx4 v15, s[20:23], s71 offen offset:1024 lds
buffer_load_dwordx4 v16, s[20:23], s71 offen offset:2048 lds
buffer_load_dwordx4 v17, s[20:23], s71 offen offset:3072 lds
s_add_u32 s71, s71, 0xe0000
buffer_load_dwordx4 a[208:211], v1, s[12:15], s69 offen offset:0 sc1
buffer_load_dwordx4 a[212:215], v1, s[12:15], s69 offen offset:1024 sc1
buffer_load_dwordx4 a[216:219], v10, s[12:15], s69 offen offset:0 sc1
buffer_load_dwordx4 a[220:223], v10, s[12:15], s69 offen offset:1024 sc1
s_add_u32 s69, s69, 0x38000
s_add_u32 m0, s42, 49152
s_nop 0
buffer_load_dwordx4 v14, s[20:23], s71 offen offset:0 lds
buffer_load_dwordx4 v15, s[20:23], s71 offen offset:1024 lds
buffer_load_dwordx4 v16, s[20:23], s71 offen offset:2048 lds
buffer_load_dwordx4 v17, s[20:23], s71 offen offset:3072 lds
s_add_u32 s71, s71, 0xe0000
buffer_load_dwordx4 a[224:227], v1, s[12:15], s69 offen offset:0 sc1
buffer_load_dwordx4 a[228:231], v1, s[12:15], s69 offen offset:1024 sc1
buffer_load_dwordx4 a[232:235], v10, s[12:15], s69 offen offset:0 sc1
buffer_load_dwordx4 a[236:239], v10, s[12:15], s69 offen offset:1024 sc1
s_add_u32 s69, s69, 0x38000
s_nop 0
s_mov_b32 s65, 0x40000000
s_mov_b64 s[84:85], -1
s_waitcnt vmcnt(35)
s_barrier
ds_read_b64_tr_b16 a[0:1], v56 offset:16384
ds_read_b64_tr_b16 a[2:3], v56 offset:24576
ds_read_b64_tr_b16 a[16:17], v56 offset:18432
ds_read_b64_tr_b16 a[18:19], v56 offset:26624
ds_read_b64_tr_b16 a[4:5], v57 offset:16384
ds_read_b64_tr_b16 a[6:7], v57 offset:24576
ds_read_b64_tr_b16 a[20:21], v57 offset:18432
ds_read_b64_tr_b16 a[22:23], v57 offset:26624
ds_read_b64_tr_b16 a[8:9], v58 offset:16384
ds_read_b64_tr_b16 a[10:11], v58 offset:24576
ds_read_b64_tr_b16 a[24:25], v58 offset:18432
ds_read_b64_tr_b16 a[26:27], v58 offset:26624
ds_read_b64_tr_b16 a[12:13], v59 offset:16384
ds_read_b64_tr_b16 a[14:15], v59 offset:24576
ds_read_b64_tr_b16 a[28:29], v59 offset:18432
ds_read_b64_tr_b16 a[30:31], v59 offset:26624
s_waitcnt vmcnt(20) lgkmcnt(0)
v_mfma_f32_16x16x32_bf16 v[64:67], a[0:3], a[176:179], v[64:67]
ds_read_b64_tr_b16 a[32:33], v56 offset:17408
buffer_load_dwordx4 a[240:243], v1, s[12:15], s69 offen offset:0 sc1
v_mfma_f32_16x16x32_bf16 v[64:67], a[16:19], a[184:187], v[64:67]
ds_read_b64_tr_b16 a[34:35], v56 offset:25600
ds_read_b64_tr_b16 a[48:49], v56 offset:19456
v_mfma_f32_16x16x32_bf16 v[80:83], a[16:19], a[188:191], v[80:83]
ds_read_b64_tr_b16 a[50:51], v56 offset:27648
v_mfma_f32_16x16x32_bf16 v[80:83], a[0:3], a[180:183], v[80:83]
ds_read_b64_tr_b16 a[36:37], v57 offset:17408
buffer_load_dwordx4 a[244:247], v1, s[12:15], s69 offen offset:1024 sc1
v_mfma_f32_16x16x32_bf16 v[68:71], a[4:7], a[176:179], v[68:71]
ds_read_b64_tr_b16 a[38:39], v57 offset:25600
ds_read_b64_tr_b16 a[52:53], v57 offset:19456
v_mfma_f32_16x16x32_bf16 v[68:71], a[20:23], a[184:187], v[68:71]
ds_read_b64_tr_b16 a[54:55], v57 offset:27648
v_mfma_f32_16x16x32_bf16 v[84:87], a[20:23], a[188:191], v[84:87]
ds_read_b64_tr_b16 a[40:41], v58 offset:17408
buffer_load_dwordx4 a[248:251], v10, s[12:15], s69 offen offset:0 sc1
v_mfma_f32_16x16x32_bf16 v[84:87], a[4:7], a[180:183], v[84:87]
ds_read_b64_tr_b16 a[42:43], v58 offset:25600
ds_read_b64_tr_b16 a[56:57], v58 offset:19456
v_mfma_f32_16x16x32_bf16 v[72:75], a[8:11], a[176:179], v[72:75]
ds_read_b64_tr_b16 a[58:59], v58 offset:27648
v_mfma_f32_16x16x32_bf16 v[72:75], a[24:27], a[184:187], v[72:75]
ds_read_b64_tr_b16 a[44:45], v59 offset:17408
buffer_load_dwordx4 a[252:255], v10, s[12:15], s69 offen offset:1024 sc1
s_add_u32 s69, s69, 0x38000
v_mfma_f32_16x16x32_bf16 v[88:91], a[24:27], a[188:191], v[88:91]
ds_read_b64_tr_b16 a[46:47], v59 offset:25600
ds_read_b64_tr_b16 a[60:61], v59 offset:19456
v_mfma_f32_16x16x32_bf16 v[88:91], a[8:11], a[180:183], v[88:91]
ds_read_b64_tr_b16 a[62:63], v59 offset:27648
v_mfma_f32_16x16x32_bf16 v[76:79], a[12:15], a[176:179], v[76:79]
v_mfma_f32_16x16x32_bf16 v[76:79], a[28:31], a[184:187], v[76:79]
v_mfma_f32_16x16x32_bf16 v[92:95], a[28:31], a[188:191], v[92:95]
v_mfma_f32_16x16x32_bf16 v[92:95], a[12:15], a[180:183], v[92:95]
s_waitcnt lgkmcnt(0)
v_mfma_f32_16x16x32_bf16 v[96:99], a[32:35], a[176:179], v[96:99]
s_barrier
v_mfma_f32_16x16x32_bf16 v[96:99], a[48:51], a[184:187], v[96:99]
s_add_u32 m0, s42, 65536
ds_read_b64_tr_b16 a[0:1], v56 offset:32768
buffer_load_dwordx4 v14, s[20:23], s71 offen offset:0 lds
v_mfma_f32_16x16x32_bf16 v[112:115], a[48:51], a[188:191], v[112:115]
ds_read_b64_tr_b16 a[2:3], v56 offset:40960
ds_read_b64_tr_b16 a[16:17], v56 offset:34816
v_mfma_f32_16x16x32_bf16 v[112:115], a[32:35], a[180:183], v[112:115]
ds_read_b64_tr_b16 a[18:19], v56 offset:43008
v_mfma_f32_16x16x32_bf16 v[100:103], a[36:39], a[176:179], v[100:103]
ds_read_b64_tr_b16 a[4:5], v57 offset:32768
buffer_load_dwordx4 v15, s[20:23], s71 offen offset:1024 lds
v_mfma_f32_16x16x32_bf16 v[100:103], a[52:55], a[184:187], v[100:103]
ds_read_b64_tr_b16 a[6:7], v57 offset:40960
ds_read_b64_tr_b16 a[20:21], v57 offset:34816
v_mfma_f32_16x16x32_bf16 v[116:119], a[52:55], a[188:191], v[116:119]
ds_read_b64_tr_b16 a[22:23], v57 offset:43008
v_mfma_f32_16x16x32_bf16 v[116:119], a[36:39], a[180:183], v[116:119]
ds_read_b64_tr_b16 a[8:9], v58 offset:32768
buffer_load_dwordx4 v16, s[20:23], s71 offen offset:2048 lds
v_mfma_f32_16x16x32_bf16 v[104:107], a[40:43], a[176:179], v[104:107]
ds_read_b64_tr_b16 a[10:11], v58 offset:40960
ds_read_b64_tr_b16 a[24:25], v58 offset:34816
v_mfma_f32_16x16x32_bf16 v[104:107], a[56:59], a[184:187], v[104:107]
ds_read_b64_tr_b16 a[26:27], v58 offset:43008
v_mfma_f32_16x16x32_bf16 v[120:123], a[56:59], a[188:191], v[120:123]
ds_read_b64_tr_b16 a[12:13], v59 offset:32768
buffer_load_dwordx4 v17, s[20:23], s71 offen offset:3072 lds
s_add_u32 s71, s71, 0xe0000
v_mfma_f32_16x16x32_bf16 v[120:123], a[40:43], a[180:183], v[120:123]
ds_read_b64_tr_b16 a[14:15], v59 offset:40960
ds_read_b64_tr_b16 a[28:29], v59 offset:34816
v_mfma_f32_16x16x32_bf16 v[108:111], a[44:47], a[176:179], v[108:111]
ds_read_b64_tr_b16 a[30:31], v59 offset:43008
v_mfma_f32_16x16x32_bf16 v[108:111], a[60:63], a[184:187], v[108:111]
v_mfma_f32_16x16x32_bf16 v[124:127], a[60:63], a[188:191], v[124:127]
v_mfma_f32_16x16x32_bf16 v[124:127], a[44:47], a[180:183], v[124:127]
s_waitcnt vmcnt(24) lgkmcnt(0)
v_mfma_f32_16x16x32_bf16 v[64:67], a[0:3], a[192:195], v[64:67]
ds_read_b64_tr_b16 a[32:33], v56 offset:33792
buffer_load_dwordx4 a[128:131], v1, s[12:15], s69 offen offset:0 sc1
v_mfma_f32_16x16x32_bf16 v[64:67], a[16:19], a[200:203], v[64:67]
ds_read_b64_tr_b16 a[34:35], v56 offset:41984
ds_read_b64_tr_b16 a[48:49], v56 offset:35840
v_mfma_f32_16x16x32_bf16 v[80:83], a[16:19], a[204:207], v[80:83]
buffer_load_dwordx4 a[132:135], v1, s[12:15], s69 offen offset:1024 sc1
ds_read_b64_tr_b16 a[50:51], v56 offset:44032
v_mfma_f32_16x16x32_bf16 v[80:83], a[0:3], a[196:199], v[80:83]
ds_read_b64_tr_b16 a[36:37], v57 offset:33792
buffer_load_dwordx4 a[136:139], v10, s[12:15], s69 offen offset:0 sc1
v_mfma_f32_16x16x32_bf16 v[68:71], a[4:7], a[192:195], v[68:71]
ds_read_b64_tr_b16 a[38:39], v57 offset:41984
ds_read_b64_tr_b16 a[52:53], v57 offset:35840
v_mfma_f32_16x16x32_bf16 v[68:71], a[20:23], a[200:203], v[68:71]
buffer_load_dwordx4 a[140:143], v10, s[12:15], s69 offen offset:1024 sc1
s_add_u32 s69, s69, 0x38000
ds_read_b64_tr_b16 a[54:55], v57 offset:44032
v_mfma_f32_16x16x32_bf16 v[84:87], a[20:23], a[204:207], v[84:87]
s_add_u32 m0, s42, 32768
ds_read_b64_tr_b16 a[40:41], v58 offset:33792
buffer_load_dwordx4 v2, s[24:27], s72 offen offset:0 lds
v_mfma_f32_16x16x32_bf16 v[84:87], a[4:7], a[196:199], v[84:87]
ds_read_b64_tr_b16 a[42:43], v58 offset:41984
ds_read_b64_tr_b16 a[56:57], v58 offset:35840
v_mfma_f32_16x16x32_bf16 v[72:75], a[8:11], a[192:195], v[72:75]
buffer_load_dwordx4 v3, s[24:27], s72 offen offset:1024 lds
ds_read_b64_tr_b16 a[58:59], v58 offset:44032
v_mfma_f32_16x16x32_bf16 v[72:75], a[24:27], a[200:203], v[72:75]
ds_read_b64_tr_b16 a[44:45], v59 offset:33792
buffer_load_dwordx4 v4, s[24:27], s72 offen offset:2048 lds
v_mfma_f32_16x16x32_bf16 v[88:91], a[24:27], a[204:207], v[88:91]
ds_read_b64_tr_b16 a[46:47], v59 offset:41984
ds_read_b64_tr_b16 a[60:61], v59 offset:35840
v_mfma_f32_16x16x32_bf16 v[88:91], a[8:11], a[196:199], v[88:91]
buffer_load_dwordx4 v5, s[24:27], s72 offen offset:3072 lds
s_add_u32 s72, s72, 262144
ds_read_b64_tr_b16 a[62:63], v59 offset:44032
v_mfma_f32_16x16x32_bf16 v[76:79], a[12:15], a[192:195], v[76:79]
v_mfma_f32_16x16x32_bf16 v[76:79], a[28:31], a[200:203], v[76:79]
v_mfma_f32_16x16x32_bf16 v[92:95], a[28:31], a[204:207], v[92:95]
v_mfma_f32_16x16x32_bf16 v[92:95], a[12:15], a[196:199], v[92:95]
s_waitcnt vmcnt(28) lgkmcnt(0)
v_mfma_f32_16x16x32_bf16 v[96:99], a[32:35], a[192:195], v[96:99]
s_barrier
v_mfma_f32_16x16x32_bf16 v[96:99], a[48:51], a[200:203], v[96:99]
s_add_u32 m0, s42, 81920
ds_read_b64_tr_b16 a[0:1], v56 offset:49152
buffer_load_dwordx4 v14, s[20:23], s71 offen offset:0 lds
v_mfma_f32_16x16x32_bf16 v[112:115], a[48:51], a[204:207], v[112:115]
ds_read_b64_tr_b16 a[2:3], v56 offset:57344
ds_read_b64_tr_b16 a[16:17], v56 offset:51200
v_mfma_f32_16x16x32_bf16 v[112:115], a[32:35], a[196:199], v[112:115]
ds_read_b64_tr_b16 a[18:19], v56 offset:59392
v_mfma_f32_16x16x32_bf16 v[100:103], a[36:39], a[192:195], v[100:103]
ds_read_b64_tr_b16 a[4:5], v57 offset:49152
buffer_load_dwordx4 v15, s[20:23], s71 offen offset:1024 lds
v_mfma_f32_16x16x32_bf16 v[100:103], a[52:55], a[200:203], v[100:103]
ds_read_b64_tr_b16 a[6:7], v57 offset:57344
ds_read_b64_tr_b16 a[20:21], v57 offset:51200
v_mfma_f32_16x16x32_bf16 v[116:119], a[52:55], a[204:207], v[116:119]
ds_read_b64_tr_b16 a[22:23], v57 offset:59392
v_mfma_f32_16x16x32_bf16 v[116:119], a[36:39], a[196:199], v[116:119]
ds_read_b64_tr_b16 a[8:9], v58 offset:49152
buffer_load_dwordx4 v16, s[20:23], s71 offen offset:2048 lds
v_mfma_f32_16x16x32_bf16 v[104:107], a[40:43], a[192:195], v[104:107]
ds_read_b64_tr_b16 a[10:11], v58 offset:57344
ds_read_b64_tr_b16 a[24:25], v58 offset:51200
v_mfma_f32_16x16x32_bf16 v[104:107], a[56:59], a[200:203], v[104:107]
ds_read_b64_tr_b16 a[26:27], v58 offset:59392
v_mfma_f32_16x16x32_bf16 v[120:123], a[56:59], a[204:207], v[120:123]
ds_read_b64_tr_b16 a[12:13], v59 offset:49152
buffer_load_dwordx4 v17, s[20:23], s71 offen offset:3072 lds
s_add_u32 s71, s71, 0xe0000
v_mfma_f32_16x16x32_bf16 v[120:123], a[40:43], a[196:199], v[120:123]
ds_read_b64_tr_b16 a[14:15], v59 offset:57344
ds_read_b64_tr_b16 a[28:29], v59 offset:51200
v_mfma_f32_16x16x32_bf16 v[108:111], a[44:47], a[192:195], v[108:111]
ds_read_b64_tr_b16 a[30:31], v59 offset:59392
v_mfma_f32_16x16x32_bf16 v[108:111], a[60:63], a[200:203], v[108:111]
v_mfma_f32_16x16x32_bf16 v[124:127], a[60:63], a[204:207], v[124:127]
v_mfma_f32_16x16x32_bf16 v[124:127], a[44:47], a[196:199], v[124:127]
s_waitcnt vmcnt(28) lgkmcnt(0)
v_mfma_f32_16x16x32_bf16 v[64:67], a[0:3], a[208:211], v[64:67]
ds_read_b64_tr_b16 a[32:33], v56 offset:50176
buffer_load_dwordx4 a[144:147], v1, s[12:15], s69 offen offset:0 sc1
v_mfma_f32_16x16x32_bf16 v[64:67], a[16:19], a[216:219], v[64:67]
ds_read_b64_tr_b16 a[34:35], v56 offset:58368
ds_read_b64_tr_b16 a[48:49], v56 offset:52224
v_mfma_f32_16x16x32_bf16 v[80:83], a[16:19], a[220:223], v[80:83]
ds_read_b64_tr_b16 a[50:51], v56 offset:60416
v_mfma_f32_16x16x32_bf16 v[80:83], a[0:3], a[212:215], v[80:83]
ds_read_b64_tr_b16 a[36:37], v57 offset:50176
buffer_load_dwordx4 a[148:151], v1, s[12:15], s69 offen offset:1024 sc1
v_mfma_f32_16x16x32_bf16 v[68:71], a[4:7], a[208:211], v[68:71]
ds_read_b64_tr_b16 a[38:39], v57 offset:58368
ds_read_b64_tr_b16 a[52:53], v57 offset:52224
v_mfma_f32_16x16x32_bf16 v[68:71], a[20:23], a[216:219], v[68:71]
ds_read_b64_tr_b16 a[54:55], v57 offset:60416
v_mfma_f32_16x16x32_bf16 v[84:87], a[20:23], a[220:223], v[84:87]
ds_read_b64_tr_b16 a[40:41], v58 offset:50176
buffer_load_dwordx4 a[152:155], v10, s[12:15], s69 offen offset:0 sc1
v_mfma_f32_16x16x32_bf16 v[84:87], a[4:7], a[212:215], v[84:87]
ds_read_b64_tr_b16 a[42:43], v58 offset:58368
ds_read_b64_tr_b16 a[56:57], v58 offset:52224
v_mfma_f32_16x16x32_bf16 v[72:75], a[8:11], a[208:211], v[72:75]
ds_read_b64_tr_b16 a[58:59], v58 offset:60416
v_mfma_f32_16x16x32_bf16 v[72:75], a[24:27], a[216:219], v[72:75]
ds_read_b64_tr_b16 a[44:45], v59 offset:50176
buffer_load_dwordx4 a[156:159], v10, s[12:15], s69 offen offset:1024 sc1
s_add_u32 s69, s69, 0x38000
v_mfma_f32_16x16x32_bf16 v[88:91], a[24:27], a[220:223], v[88:91]
ds_read_b64_tr_b16 a[46:47], v59 offset:58368
ds_read_b64_tr_b16 a[60:61], v59 offset:52224
v_mfma_f32_16x16x32_bf16 v[88:91], a[8:11], a[212:215], v[88:91]
ds_read_b64_tr_b16 a[62:63], v59 offset:60416
v_mfma_f32_16x16x32_bf16 v[76:79], a[12:15], a[208:211], v[76:79]
v_mfma_f32_16x16x32_bf16 v[76:79], a[28:31], a[216:219], v[76:79]
v_mfma_f32_16x16x32_bf16 v[92:95], a[28:31], a[220:223], v[92:95]
v_mfma_f32_16x16x32_bf16 v[92:95], a[12:15], a[212:215], v[92:95]
s_waitcnt vmcnt(28) lgkmcnt(0)
v_mfma_f32_16x16x32_bf16 v[96:99], a[32:35], a[208:211], v[96:99]
s_barrier
v_mfma_f32_16x16x32_bf16 v[96:99], a[48:51], a[216:219], v[96:99]
s_add_u32 m0, s42, 98304
ds_read_b64_tr_b16 a[0:1], v6 offset:49152
buffer_load_dwordx4 v14, s[20:23], s71 offen offset:0 lds
v_mfma_f32_16x16x32_bf16 v[112:115], a[48:51], a[220:223], v[112:115]
ds_read_b64_tr_b16 a[2:3], v6 offset:57344
ds_read_b64_tr_b16 a[16:17], v6 offset:51200
v_mfma_f32_16x16x32_bf16 v[112:115], a[32:35], a[212:215], v[112:115]
ds_read_b64_tr_b16 a[18:19], v6 offset:59392
v_mfma_f32_16x16x32_bf16 v[100:103], a[36:39], a[208:211], v[100:103]
ds_read_b64_tr_b16 a[4:5], v7 offset:49152
buffer_load_dwordx4 v15, s[20:23], s71 offen offset:1024 lds
v_mfma_f32_16x16x32_bf16 v[100:103], a[52:55], a[216:219], v[100:103]
ds_read_b64_tr_b16 a[6:7], v7 offset:57344
ds_read_b64_tr_b16 a[20:21], v7 offset:51200
v_mfma_f32_16x16x32_bf16 v[116:119], a[52:55], a[220:223], v[116:119]
ds_read_b64_tr_b16 a[22:23], v7 offset:59392
v_mfma_f32_16x16x32_bf16 v[116:119], a[36:39], a[212:215], v[116:119]
ds_read_b64_tr_b16 a[8:9], v8 offset:49152
buffer_load_dwordx4 v16, s[20:23], s71 offen offset:2048 lds
v_mfma_f32_16x16x32_bf16 v[104:107], a[40:43], a[208:211], v[104:107]
ds_read_b64_tr_b16 a[10:11], v8 offset:57344
ds_read_b64_tr_b16 a[24:25], v8 offset:51200
v_mfma_f32_16x16x32_bf16 v[104:107], a[56:59], a[216:219], v[104:107]
ds_read_b64_tr_b16 a[26:27], v8 offset:59392
v_mfma_f32_16x16x32_bf16 v[120:123], a[56:59], a[220:223], v[120:123]
ds_read_b64_tr_b16 a[12:13], v9 offset:49152
buffer_load_dwordx4 v17, s[20:23], s71 offen offset:3072 lds
s_add_u32 s71, s71, 0xe0000
v_mfma_f32_16x16x32_bf16 v[120:123], a[40:43], a[212:215], v[120:123]
ds_read_b64_tr_b16 a[14:15], v9 offset:57344
ds_read_b64_tr_b16 a[28:29], v9 offset:51200
v_mfma_f32_16x16x32_bf16 v[108:111], a[44:47], a[208:211], v[108:111]
ds_read_b64_tr_b16 a[30:31], v9 offset:59392
v_mfma_f32_16x16x32_bf16 v[108:111], a[60:63], a[216:219], v[108:111]
v_mfma_f32_16x16x32_bf16 v[124:127], a[60:63], a[220:223], v[124:127]
v_mfma_f32_16x16x32_bf16 v[124:127], a[44:47], a[212:215], v[124:127]
s_waitcnt vmcnt(28) lgkmcnt(0)
v_mfma_f32_16x16x32_bf16 v[64:67], a[0:3], a[224:227], v[64:67]
ds_read_b64_tr_b16 a[32:33], v6 offset:50176
buffer_load_dwordx4 a[160:163], v1, s[12:15], s69 offen offset:0 sc1
v_mfma_f32_16x16x32_bf16 v[64:67], a[16:19], a[232:235], v[64:67]
ds_read_b64_tr_b16 a[34:35], v6 offset:58368
ds_read_b64_tr_b16 a[48:49], v6 offset:52224
v_mfma_f32_16x16x32_bf16 v[80:83], a[16:19], a[236:239], v[80:83]
ds_read_b64_tr_b16 a[50:51], v6 offset:60416
v_mfma_f32_16x16x32_bf16 v[80:83], a[0:3], a[228:231], v[80:83]
ds_read_b64_tr_b16 a[36:37], v7 offset:50176
buffer_load_dwordx4 a[164:167], v1, s[12:15], s69 offen offset:1024 sc1
v_mfma_f32_16x16x32_bf16 v[68:71], a[4:7], a[224:227], v[68:71]
ds_read_b64_tr_b16 a[38:39], v7 offset:58368
ds_read_b64_tr_b16 a[52:53], v7 offset:52224
v_mfma_f32_16x16x32_bf16 v[68:71], a[20:23], a[232:235], v[68:71]
ds_read_b64_tr_b16 a[54:55], v7 offset:60416
v_mfma_f32_16x16x32_bf16 v[84:87], a[20:23], a[236:239], v[84:87]
ds_read_b64_tr_b16 a[40:41], v8 offset:50176
buffer_load_dwordx4 a[168:171], v10, s[12:15], s69 offen offset:0 sc1
v_mfma_f32_16x16x32_bf16 v[84:87], a[4:7], a[228:231], v[84:87]
ds_read_b64_tr_b16 a[42:43], v8 offset:58368
ds_read_b64_tr_b16 a[56:57], v8 offset:52224
v_mfma_f32_16x16x32_bf16 v[72:75], a[8:11], a[224:227], v[72:75]
ds_read_b64_tr_b16 a[58:59], v8 offset:60416
v_mfma_f32_16x16x32_bf16 v[72:75], a[24:27], a[232:235], v[72:75]
ds_read_b64_tr_b16 a[44:45], v9 offset:50176
buffer_load_dwordx4 a[172:175], v10, s[12:15], s69 offen offset:1024 sc1
s_add_u32 s69, s69, 0xffe98000
v_mfma_f32_16x16x32_bf16 v[88:91], a[24:27], a[236:239], v[88:91]
ds_read_b64_tr_b16 a[46:47], v9 offset:58368
ds_read_b64_tr_b16 a[60:61], v9 offset:52224
v_mfma_f32_16x16x32_bf16 v[88:91], a[8:11], a[228:231], v[88:91]
ds_read_b64_tr_b16 a[62:63], v9 offset:60416
v_mfma_f32_16x16x32_bf16 v[76:79], a[12:15], a[224:227], v[76:79]
v_mfma_f32_16x16x32_bf16 v[76:79], a[28:31], a[232:235], v[76:79]
v_mfma_f32_16x16x32_bf16 v[92:95], a[28:31], a[236:239], v[92:95]
v_mfma_f32_16x16x32_bf16 v[92:95], a[12:15], a[228:231], v[92:95]
s_waitcnt vmcnt(24) lgkmcnt(0)
v_mfma_f32_16x16x32_bf16 v[96:99], a[32:35], a[224:227], v[96:99]
s_barrier
v_mfma_f32_16x16x32_bf16 v[96:99], a[48:51], a[232:235], v[96:99]
s_add_u32 m0, s42, 114688
ds_read_b64_tr_b16 a[0:1], v56 offset:0
buffer_load_dwordx4 v14, s[20:23], s71 offen offset:0 lds
v_mfma_f32_16x16x32_bf16 v[112:115], a[48:51], a[236:239], v[112:115]
ds_read_b64_tr_b16 a[2:3], v56 offset:8192
ds_read_b64_tr_b16 a[16:17], v56 offset:2048
v_mfma_f32_16x16x32_bf16 v[112:115], a[32:35], a[228:231], v[112:115]
ds_read_b64_tr_b16 a[18:19], v56 offset:10240
v_mfma_f32_16x16x32_bf16 v[100:103], a[36:39], a[224:227], v[100:103]
ds_read_b64_tr_b16 a[4:5], v57 offset:0
buffer_load_dwordx4 v15, s[20:23], s71 offen offset:1024 lds
v_mfma_f32_16x16x32_bf16 v[100:103], a[52:55], a[232:235], v[100:103]
ds_read_b64_tr_b16 a[6:7], v57 offset:8192
ds_read_b64_tr_b16 a[20:21], v57 offset:2048
v_mfma_f32_16x16x32_bf16 v[116:119], a[52:55], a[236:239], v[116:119]
ds_read_b64_tr_b16 a[22:23], v57 offset:10240
v_mfma_f32_16x16x32_bf16 v[116:119], a[36:39], a[228:231], v[116:119]
ds_read_b64_tr_b16 a[8:9], v58 offset:0
buffer_load_dwordx4 v16, s[20:23], s71 offen offset:2048 lds
v_mfma_f32_16x16x32_bf16 v[104:107], a[40:43], a[224:227], v[104:107]
ds_read_b64_tr_b16 a[10:11], v58 offset:8192
ds_read_b64_tr_b16 a[24:25], v58 offset:2048
v_mfma_f32_16x16x32_bf16 v[104:107], a[56:59], a[232:235], v[104:107]
ds_read_b64_tr_b16 a[26:27], v58 offset:10240
v_mfma_f32_16x16x32_bf16 v[120:123], a[56:59], a[236:239], v[120:123]
ds_read_b64_tr_b16 a[12:13], v59 offset:0
buffer_load_dwordx4 v17, s[20:23], s71 offen offset:3072 lds
s_add_u32 s71, s71, 0xffa60000
v_mfma_f32_16x16x32_bf16 v[120:123], a[40:43], a[228:231], v[120:123]
ds_read_b64_tr_b16 a[14:15], v59 offset:8192
ds_read_b64_tr_b16 a[28:29], v59 offset:2048
v_mfma_f32_16x16x32_bf16 v[108:111], a[44:47], a[224:227], v[108:111]
ds_read_b64_tr_b16 a[30:31], v59 offset:10240
v_mfma_f32_16x16x32_bf16 v[108:111], a[60:63], a[232:235], v[108:111]
v_mfma_f32_16x16x32_bf16 v[124:127], a[60:63], a[236:239], v[124:127]
v_mfma_f32_16x16x32_bf16 v[124:127], a[44:47], a[228:231], v[124:127]
s_waitcnt lgkmcnt(0)
v_mfma_f32_16x16x32_bf16 v[64:67], a[0:3], a[240:243], v[64:67]
ds_read_b64_tr_b16 a[32:33], v56 offset:1024
buffer_load_dwordx4 a[176:179], v1, s[12:15], s69 offen offset:0 sc1
v_mfma_f32_16x16x32_bf16 v[64:67], a[16:19], a[248:251], v[64:67]
ds_read_b64_tr_b16 a[34:35], v56 offset:9216
ds_read_b64_tr_b16 a[48:49], v56 offset:3072
v_mfma_f32_16x16x32_bf16 v[80:83], a[16:19], a[252:255], v[80:83]
ds_read_b64_tr_b16 a[50:51], v56 offset:11264
v_mfma_f32_16x16x32_bf16 v[80:83], a[0:3], a[244:247], v[80:83]
ds_read_b64_tr_b16 a[36:37], v57 offset:1024
buffer_load_dwordx4 a[180:183], v1, s[12:15], s69 offen offset:1024 sc1
v_mfma_f32_16x16x32_bf16 v[68:71], a[4:7], a[240:243], v[68:71]
ds_read_b64_tr_b16 a[38:39], v57 offset:9216
ds_read_b64_tr_b16 a[52:53], v57 offset:3072
v_mfma_f32_16x16x32_bf16 v[68:71], a[20:23], a[248:251], v[68:71]
ds_read_b64_tr_b16 a[54:55], v57 offset:11264
v_mfma_f32_16x16x32_bf16 v[84:87], a[20:23], a[252:255], v[84:87]
ds_read_b64_tr_b16 a[40:41], v58 offset:1024
buffer_load_dwordx4 a[184:187], v10, s[12:15], s69 offen offset:0 sc1
v_mfma_f32_16x16x32_bf16 v[84:87], a[4:7], a[244:247], v[84:87]
ds_read_b64_tr_b16 a[42:43], v58 offset:9216
ds_read_b64_tr_b16 a[56:57], v58 offset:3072
v_mfma_f32_16x16x32_bf16 v[72:75], a[8:11], a[240:243], v[72:75]
ds_read_b64_tr_b16 a[58:59], v58 offset:11264
v_mfma_f32_16x16x32_bf16 v[72:75], a[24:27], a[248:251], v[72:75]
ds_read_b64_tr_b16 a[44:45], v59 offset:1024
buffer_load_dwordx4 a[188:191], v10, s[12:15], s69 offen offset:1024 sc1
PG9:
s_cbranch_execz PG21
s_add_u32 s69, s69, 0x38000
v_mfma_f32_16x16x32_bf16 v[88:91], a[24:27], a[252:255], v[88:91]
ds_read_b64_tr_b16 a[46:47], v59 offset:9216
ds_read_b64_tr_b16 a[60:61], v59 offset:3072
v_mfma_f32_16x16x32_bf16 v[88:91], a[8:11], a[244:247], v[88:91]
ds_read_b64_tr_b16 a[62:63], v59 offset:11264
v_mfma_f32_16x16x32_bf16 v[76:79], a[12:15], a[240:243], v[76:79]
v_mfma_f32_16x16x32_bf16 v[76:79], a[28:31], a[248:251], v[76:79]
v_mfma_f32_16x16x32_bf16 v[92:95], a[28:31], a[252:255], v[92:95]
v_mfma_f32_16x16x32_bf16 v[92:95], a[12:15], a[244:247], v[92:95]
s_waitcnt vmcnt(20) lgkmcnt(0)
v_mfma_f32_16x16x32_bf16 v[96:99], a[32:35], a[240:243], v[96:99]
s_barrier
v_mfma_f32_16x16x32_bf16 v[96:99], a[48:51], a[248:251], v[96:99]
s_add_u32 m0, s42, 49152
ds_read_b64_tr_b16 a[0:1], v56 offset:16384
buffer_load_dwordx4 v14, s[20:23], s71 offen offset:0 lds
v_mfma_f32_16x16x32_bf16 v[112:115], a[48:51], a[252:255], v[112:115]
ds_read_b64_tr_b16 a[2:3], v56 offset:24576
ds_read_b64_tr_b16 a[16:17], v56 offset:18432
v_mfma_f32_16x16x32_bf16 v[112:115], a[32:35], a[244:247], v[112:115]
ds_read_b64_tr_b16 a[18:19], v56 offset:26624
v_mfma_f32_16x16x32_bf16 v[100:103], a[36:39], a[240:243], v[100:103]
ds_read_b64_tr_b16 a[4:5], v57 offset:16384
buffer_load_dwordx4 v15, s[20:23], s71 offen offset:1024 lds
v_mfma_f32_16x16x32_bf16 v[100:103], a[52:55], a[248:251], v[100:103]
ds_read_b64_tr_b16 a[6:7], v57 offset:24576
ds_read_b64_tr_b16 a[20:21], v57 offset:18432
v_mfma_f32_16x16x32_bf16 v[116:119], a[52:55], a[252:255], v[116:119]
ds_read_b64_tr_b16 a[22:23], v57 offset:26624
v_mfma_f32_16x16x32_bf16 v[116:119], a[36:39], a[244:247], v[116:119]
ds_read_b64_tr_b16 a[8:9], v58 offset:16384
buffer_load_dwordx4 v16, s[20:23], s71 offen offset:2048 lds
v_mfma_f32_16x16x32_bf16 v[104:107], a[40:43], a[240:243], v[104:107]
ds_read_b64_tr_b16 a[10:11], v58 offset:24576
ds_read_b64_tr_b16 a[24:25], v58 offset:18432
v_mfma_f32_16x16x32_bf16 v[104:107], a[56:59], a[248:251], v[104:107]
ds_read_b64_tr_b16 a[26:27], v58 offset:26624
v_mfma_f32_16x16x32_bf16 v[120:123], a[56:59], a[252:255], v[120:123]
ds_read_b64_tr_b16 a[12:13], v59 offset:16384
buffer_load_dwordx4 v17, s[20:23], s71 offen offset:3072 lds
s_add_u32 s71, s71, 0xe0000
v_mfma_f32_16x16x32_bf16 v[120:123], a[40:43], a[244:247], v[120:123]
ds_read_b64_tr_b16 a[14:15], v59 offset:24576
ds_read_b64_tr_b16 a[28:29], v59 offset:18432
v_mfma_f32_16x16x32_bf16 v[108:111], a[44:47], a[240:243], v[108:111]
ds_read_b64_tr_b16 a[30:31], v59 offset:26624
v_mfma_f32_16x16x32_bf16 v[108:111], a[60:63], a[248:251], v[108:111]
v_mfma_f32_16x16x32_bf16 v[124:127], a[60:63], a[252:255], v[124:127]
v_mfma_f32_16x16x32_bf16 v[124:127], a[44:47], a[244:247], v[124:127]
s_waitcnt lgkmcnt(0)
v_mfma_f32_16x16x32_bf16 v[64:67], a[0:3], a[128:131], v[64:67]
ds_read_b64_tr_b16 a[32:33], v56 offset:17408
buffer_load_dwordx4 a[192:195], v1, s[12:15], s69 offen offset:0 sc1
v_mfma_f32_16x16x32_bf16 v[64:67], a[16:19], a[136:139], v[64:67]
ds_read_b64_tr_b16 a[34:35], v56 offset:25600
ds_read_b64_tr_b16 a[48:49], v56 offset:19456
v_mfma_f32_16x16x32_bf16 v[80:83], a[16:19], a[140:143], v[80:83]
buffer_load_dwordx4 a[196:199], v1, s[12:15], s69 offen offset:1024 sc1
ds_read_b64_tr_b16 a[50:51], v56 offset:27648
v_mfma_f32_16x16x32_bf16 v[80:83], a[0:3], a[132:135], v[80:83]
ds_read_b64_tr_b16 a[36:37], v57 offset:17408
ds_read_b64_tr_b16 a[38:39], v57 offset:25600
v_mfma_f32_16x16x32_bf16 v[68:71], a[4:7], a[128:131], v[68:71]
buffer_load_dwordx4 a[200:203], v10, s[12:15], s69 offen offset:0 sc1
ds_read_b64_tr_b16 a[52:53], v57 offset:19456
v_mfma_f32_16x16x32_bf16 v[68:71], a[20:23], a[136:139], v[68:71]
ds_read_b64_tr_b16 a[54:55], v57 offset:27648
v_mfma_f32_16x16x32_bf16 v[84:87], a[20:23], a[140:143], v[84:87]
ds_read_b64_tr_b16 a[40:41], v58 offset:17408
buffer_load_dwordx4 a[204:207], v10, s[12:15], s69 offen offset:1024 sc1
s_add_u32 s69, s69, 0x38000
v_mfma_f32_16x16x32_bf16 v[84:87], a[4:7], a[132:135], v[84:87]
ds_read_b64_tr_b16 a[42:43], v58 offset:25600
ds_read_b64_tr_b16 a[56:57], v58 offset:19456
v_mfma_f32_16x16x32_bf16 v[72:75], a[8:11], a[128:131], v[72:75]
s_add_u32 s47, s71, 0xffea0000
buffer_load_dword v212, v211, s[20:23], s47 offen
ds_read_b64_tr_b16 a[58:59], v58 offset:27648
v_mfma_f32_16x16x32_bf16 v[72:75], a[24:27], a[136:139], v[72:75]
ds_read_b64_tr_b16 a[44:45], v59 offset:17408
ds_read_b64_tr_b16 a[46:47], v59 offset:25600
v_mfma_f32_16x16x32_bf16 v[88:91], a[24:27], a[140:143], v[88:91]
buffer_load_dword v0, v24, s[12:15], s82 offen sc1
ds_read_b64_tr_b16 a[60:61], v59 offset:19456
v_mfma_f32_16x16x32_bf16 v[88:91], a[8:11], a[132:135], v[88:91]
ds_read_b64_tr_b16 a[62:63], v59 offset:27648
v_mfma_f32_16x16x32_bf16 v[76:79], a[12:15], a[128:131], v[76:79]
v_mfma_f32_16x16x32_bf16 v[76:79], a[28:31], a[136:139], v[76:79]
v_mfma_f32_16x16x32_bf16 v[92:95], a[28:31], a[140:143], v[92:95]
v_mfma_f32_16x16x32_bf16 v[92:95], a[12:15], a[132:135], v[92:95]
s_waitcnt vmcnt(22) lgkmcnt(0)
v_mfma_f32_16x16x32_bf16 v[96:99], a[32:35], a[128:131], v[96:99]
s_barrier
v_mfma_f32_16x16x32_bf16 v[96:99], a[48:51], a[136:139], v[96:99]
s_add_u32 m0, s42, 65536
ds_read_b64_tr_b16 a[0:1], v56 offset:32768
buffer_load_dwordx4 v14, s[20:23], s71 offen offset:0 lds
v_mfma_f32_16x16x32_bf16 v[112:115], a[48:51], a[140:143], v[112:115]
ds_read_b64_tr_b16 a[2:3], v56 offset:40960
ds_read_b64_tr_b16 a[16:17], v56 offset:34816
v_mfma_f32_16x16x32_bf16 v[112:115], a[32:35], a[132:135], v[112:115]
ds_read_b64_tr_b16 a[18:19], v56 offset:43008
v_mfma_f32_16x16x32_bf16 v[100:103], a[36:39], a[128:131], v[100:103]
ds_read_b64_tr_b16 a[4:5], v57 offset:32768
buffer_load_dwordx4 v15, s[20:23], s71 offen offset:1024 lds
v_mfma_f32_16x16x32_bf16 v[100:103], a[52:55], a[136:139], v[100:103]
ds_read_b64_tr_b16 a[6:7], v57 offset:40960
ds_read_b64_tr_b16 a[20:21], v57 offset:34816
v_mfma_f32_16x16x32_bf16 v[116:119], a[52:55], a[140:143], v[116:119]
ds_read_b64_tr_b16 a[22:23], v57 offset:43008
v_mfma_f32_16x16x32_bf16 v[116:119], a[36:39], a[132:135], v[116:119]
ds_read_b64_tr_b16 a[8:9], v58 offset:32768
buffer_load_dwordx4 v16, s[20:23], s71 offen offset:2048 lds
v_mfma_f32_16x16x32_bf16 v[104:107], a[40:43], a[128:131], v[104:107]
ds_read_b64_tr_b16 a[10:11], v58 offset:40960
ds_read_b64_tr_b16 a[24:25], v58 offset:34816
v_mfma_f32_16x16x32_bf16 v[104:107], a[56:59], a[136:139], v[104:107]
ds_read_b64_tr_b16 a[26:27], v58 offset:43008
v_mfma_f32_16x16x32_bf16 v[120:123], a[56:59], a[140:143], v[120:123]
ds_read_b64_tr_b16 a[12:13], v59 offset:32768
buffer_load_dwordx4 v17, s[20:23], s71 offen offset:3072 lds
s_add_u32 s71, s71, 0xe0000
v_mfma_f32_16x16x32_bf16 v[120:123], a[40:43], a[132:135], v[120:123]
ds_read_b64_tr_b16 a[14:15], v59 offset:40960
ds_read_b64_tr_b16 a[28:29], v59 offset:34816
v_mfma_f32_16x16x32_bf16 v[108:111], a[44:47], a[128:131], v[108:111]
ds_read_b64_tr_b16 a[30:31], v59 offset:43008
v_mfma_f32_16x16x32_bf16 v[108:111], a[60:63], a[136:139], v[108:111]
v_mfma_f32_16x16x32_bf16 v[124:127], a[60:63], a[140:143], v[124:127]
v_mfma_f32_16x16x32_bf16 v[124:127], a[44:47], a[132:135], v[124:127]
s_waitcnt lgkmcnt(0)
v_mfma_f32_16x16x32_bf16 v[64:67], a[0:3], a[144:147], v[64:67]
ds_read_b64_tr_b16 a[32:33], v56 offset:33792
buffer_load_dwordx4 a[208:211], v1, s[12:15], s69 offen offset:0 sc1
v_mfma_f32_16x16x32_bf16 v[64:67], a[16:19], a[152:155], v[64:67]
ds_read_b64_tr_b16 a[34:35], v56 offset:41984
ds_read_b64_tr_b16 a[48:49], v56 offset:35840
v_mfma_f32_16x16x32_bf16 v[80:83], a[16:19], a[156:159], v[80:83]
ds_read_b64_tr_b16 a[50:51], v56 offset:44032
v_mfma_f32_16x16x32_bf16 v[80:83], a[0:3], a[148:151], v[80:83]
ds_read_b64_tr_b16 a[36:37], v57 offset:33792
buffer_load_dwordx4 a[212:215], v1, s[12:15], s69 offen offset:1024 sc1
v_mfma_f32_16x16x32_bf16 v[68:71], a[4:7], a[144:147], v[68:71]
ds_read_b64_tr_b16 a[38:39], v57 offset:41984
ds_read_b64_tr_b16 a[52:53], v57 offset:35840
v_mfma_f32_16x16x32_bf16 v[68:71], a[20:23], a[152:155], v[68:71]
ds_read_b64_tr_b16 a[54:55], v57 offset:44032
v_mfma_f32_16x16x32_bf16 v[84:87], a[20:23], a[156:159], v[84:87]
ds_read_b64_tr_b16 a[40:41], v58 offset:33792
buffer_load_dwordx4 a[216:219], v10, s[12:15], s69 offen offset:0 sc1
v_mfma_f32_16x16x32_bf16 v[84:87], a[4:7], a[148:151], v[84:87]
ds_read_b64_tr_b16 a[42:43], v58 offset:41984
ds_read_b64_tr_b16 a[56:57], v58 offset:35840
v_mfma_f32_16x16x32_bf16 v[72:75], a[8:11], a[144:147], v[72:75]
ds_read_b64_tr_b16 a[58:59], v58 offset:44032
v_mfma_f32_16x16x32_bf16 v[72:75], a[24:27], a[152:155], v[72:75]
ds_read_b64_tr_b16 a[44:45], v59 offset:33792
buffer_load_dwordx4 a[220:223], v10, s[12:15], s69 offen offset:1024 sc1
s_add_u32 s69, s69, 0x38000
v_mfma_f32_16x16x32_bf16 v[88:91], a[24:27], a[156:159], v[88:91]
ds_read_b64_tr_b16 a[46:47], v59 offset:41984
ds_read_b64_tr_b16 a[60:61], v59 offset:35840
v_mfma_f32_16x16x32_bf16 v[88:91], a[8:11], a[148:151], v[88:91]
ds_read_b64_tr_b16 a[62:63], v59 offset:44032
v_mfma_f32_16x16x32_bf16 v[76:79], a[12:15], a[144:147], v[76:79]
v_mfma_f32_16x16x32_bf16 v[76:79], a[28:31], a[152:155], v[76:79]
v_mfma_f32_16x16x32_bf16 v[92:95], a[28:31], a[156:159], v[92:95]
v_mfma_f32_16x16x32_bf16 v[92:95], a[12:15], a[148:151], v[92:95]
s_waitcnt vmcnt(22) lgkmcnt(0)
v_mfma_f32_16x16x32_bf16 v[96:99], a[32:35], a[144:147], v[96:99]
s_barrier
v_mfma_f32_16x16x32_bf16 v[96:99], a[48:51], a[152:155], v[96:99]
s_add_u32 m0, s42, 81920
ds_read_b64_tr_b16 a[0:1], v56 offset:49152
buffer_load_dwordx4 v14, s[20:23], s71 offen offset:0 lds
v_mfma_f32_16x16x32_bf16 v[112:115], a[48:51], a[156:159], v[112:115]
ds_read_b64_tr_b16 a[2:3], v56 offset:57344
ds_read_b64_tr_b16 a[16:17], v56 offset:51200
v_mfma_f32_16x16x32_bf16 v[112:115], a[32:35], a[148:151], v[112:115]
ds_read_b64_tr_b16 a[18:19], v56 offset:59392
v_mfma_f32_16x16x32_bf16 v[100:103], a[36:39], a[144:147], v[100:103]
ds_read_b64_tr_b16 a[4:5], v57 offset:49152
buffer_load_dwordx4 v15, s[20:23], s71 offen offset:1024 lds
v_mfma_f32_16x16x32_bf16 v[100:103], a[52:55], a[152:155], v[100:103]
ds_read_b64_tr_b16 a[6:7], v57 offset:57344
ds_read_b64_tr_b16 a[20:21], v57 offset:51200
v_mfma_f32_16x16x32_bf16 v[116:119], a[52:55], a[156:159], v[116:119]
ds_read_b64_tr_b16 a[22:23], v57 offset:59392
v_mfma_f32_16x16x32_bf16 v[116:119], a[36:39], a[148:151], v[116:119]
ds_read_b64_tr_b16 a[8:9], v58 offset:49152
buffer_load_dwordx4 v16, s[20:23], s71 offen offset:2048 lds
v_mfma_f32_16x16x32_bf16 v[104:107], a[40:43], a[144:147], v[104:107]
ds_read_b64_tr_b16 a[10:11], v58 offset:57344
ds_read_b64_tr_b16 a[24:25], v58 offset:51200
v_mfma_f32_16x16x32_bf16 v[104:107], a[56:59], a[152:155], v[104:107]
ds_read_b64_tr_b16 a[26:27], v58 offset:59392
v_mfma_f32_16x16x32_bf16 v[120:123], a[56:59], a[156:159], v[120:123]
ds_read_b64_tr_b16 a[12:13], v59 offset:49152
buffer_load_dwordx4 v17, s[20:23], s71 offen offset:3072 lds
s_add_u32 s71, s71, 0xe0000
v_mfma_f32_16x16x32_bf16 v[120:123], a[40:43], a[148:151], v[120:123]
ds_read_b64_tr_b16 a[14:15], v59 offset:57344
ds_read_b64_tr_b16 a[28:29], v59 offset:51200
v_mfma_f32_16x16x32_bf16 v[108:111], a[44:47], a[144:147], v[108:111]
ds_read_b64_tr_b16 a[30:31], v59 offset:59392
v_mfma_f32_16x16x32_bf16 v[108:111], a[60:63], a[152:155], v[108:111]
v_mfma_f32_16x16x32_bf16 v[124:127], a[60:63], a[156:159], v[124:127]
v_mfma_f32_16x16x32_bf16 v[124:127], a[44:47], a[148:151], v[124:127]
s_waitcnt lgkmcnt(0)
v_mfma_f32_16x16x32_bf16 v[64:67], a[0:3], a[160:163], v[64:67]
ds_read_b64_tr_b16 a[32:33], v56 offset:50176
buffer_load_dwordx4 a[224:227], v1, s[12:15], s69 offen offset:0 sc1
v_mfma_f32_16x16x32_bf16 v[64:67], a[16:19], a[168:171], v[64:67]
ds_read_b64_tr_b16 a[34:35], v56 offset:58368
ds_read_b64_tr_b16 a[48:49], v56 offset:52224
v_mfma_f32_16x16x32_bf16 v[80:83], a[16:19], a[172:175], v[80:83]
ds_read_b64_tr_b16 a[50:51], v56 offset:60416
v_mfma_f32_16x16x32_bf16 v[80:83], a[0:3], a[164:167], v[80:83]
ds_read_b64_tr_b16 a[36:37], v57 offset:50176
buffer_load_dwordx4 a[228:231], v1, s[12:15], s69 offen offset:1024 sc1
v_mfma_f32_16x16x32_bf16 v[68:71], a[4:7], a[160:163], v[68:71]
ds_read_b64_tr_b16 a[38:39], v57 offset:58368
ds_read_b64_tr_b16 a[52:53], v57 offset:52224
v_mfma_f32_16x16x32_bf16 v[68:71], a[20:23], a[168:171], v[68:71]
ds_read_b64_tr_b16 a[54:55], v57 offset:60416
v_mfma_f32_16x16x32_bf16 v[84:87], a[20:23], a[172:175], v[84:87]
ds_read_b64_tr_b16 a[40:41], v58 offset:50176
buffer_load_dwordx4 a[232:235], v10, s[12:15], s69 offen offset:0 sc1
v_mfma_f32_16x16x32_bf16 v[84:87], a[4:7], a[164:167], v[84:87]
ds_read_b64_tr_b16 a[42:43], v58 offset:58368
ds_read_b64_tr_b16 a[56:57], v58 offset:52224
v_mfma_f32_16x16x32_bf16 v[72:75], a[8:11], a[160:163], v[72:75]
ds_read_b64_tr_b16 a[58:59], v58 offset:60416
v_mfma_f32_16x16x32_bf16 v[72:75], a[24:27], a[168:171], v[72:75]
ds_read_b64_tr_b16 a[44:45], v59 offset:50176
buffer_load_dwordx4 a[236:239], v10, s[12:15], s69 offen offset:1024 sc1
s_add_u32 s69, s69, 0xfff40000
v_mfma_f32_16x16x32_bf16 v[88:91], a[24:27], a[172:175], v[88:91]
ds_read_b64_tr_b16 a[46:47], v59 offset:58368
ds_read_b64_tr_b16 a[60:61], v59 offset:52224
v_mfma_f32_16x16x32_bf16 v[88:91], a[8:11], a[164:167], v[88:91]
ds_read_b64_tr_b16 a[62:63], v59 offset:60416
v_mfma_f32_16x16x32_bf16 v[76:79], a[12:15], a[160:163], v[76:79]
v_mfma_f32_16x16x32_bf16 v[76:79], a[28:31], a[168:171], v[76:79]
v_mfma_f32_16x16x32_bf16 v[92:95], a[28:31], a[172:175], v[92:95]
v_mfma_f32_16x16x32_bf16 v[92:95], a[12:15], a[164:167], v[92:95]
s_waitcnt vmcnt(22) lgkmcnt(0)
v_mfma_f32_16x16x32_bf16 v[96:99], a[32:35], a[160:163], v[96:99]
s_barrier
v_mfma_f32_16x16x32_bf16 v[96:99], a[48:51], a[168:171], v[96:99]
s_add_u32 m0, s42, 98304
ds_read_b64_tr_b16 a[0:1], v6 offset:49152
buffer_load_dwordx4 v14, s[20:23], s71 offen offset:0 lds
v_mfma_f32_16x16x32_bf16 v[112:115], a[48:51], a[172:175], v[112:115]
ds_read_b64_tr_b16 a[2:3], v6 offset:57344
ds_read_b64_tr_b16 a[16:17], v6 offset:51200
v_mfma_f32_16x16x32_bf16 v[112:115], a[32:35], a[164:167], v[112:115]
ds_read_b64_tr_b16 a[18:19], v6 offset:59392
v_mfma_f32_16x16x32_bf16 v[100:103], a[36:39], a[160:163], v[100:103]
ds_read_b64_tr_b16 a[4:5], v7 offset:49152
buffer_load_dwordx4 v15, s[20:23], s71 offen offset:1024 lds
v_mfma_f32_16x16x32_bf16 v[100:103], a[52:55], a[168:171], v[100:103]
ds_read_b64_tr_b16 a[6:7], v7 offset:57344
ds_read_b64_tr_b16 a[20:21], v7 offset:51200
v_mfma_f32_16x16x32_bf16 v[116:119], a[52:55], a[172:175], v[116:119]
ds_read_b64_tr_b16 a[22:23], v7 offset:59392
v_mfma_f32_16x16x32_bf16 v[116:119], a[36:39], a[164:167], v[116:119]
ds_read_b64_tr_b16 a[8:9], v8 offset:49152
buffer_load_dwordx4 v16, s[20:23], s71 offen offset:2048 lds
v_mfma_f32_16x16x32_bf16 v[104:107], a[40:43], a[160:163], v[104:107]
ds_read_b64_tr_b16 a[10:11], v8 offset:57344
ds_read_b64_tr_b16 a[24:25], v8 offset:51200
v_mfma_f32_16x16x32_bf16 v[104:107], a[56:59], a[168:171], v[104:107]
ds_read_b64_tr_b16 a[26:27], v8 offset:59392
v_mfma_f32_16x16x32_bf16 v[120:123], a[56:59], a[172:175], v[120:123]
ds_read_b64_tr_b16 a[12:13], v9 offset:49152
buffer_load_dwordx4 v17, s[20:23], s71 offen offset:3072 lds
s_add_u32 s71, s71, 0xffd00000
v_mfma_f32_16x16x32_bf16 v[120:123], a[40:43], a[164:167], v[120:123]
ds_read_b64_tr_b16 a[14:15], v9 offset:57344
ds_read_b64_tr_b16 a[28:29], v9 offset:51200
v_mfma_f32_16x16x32_bf16 v[108:111], a[44:47], a[160:163], v[108:111]
ds_read_b64_tr_b16 a[30:31], v9 offset:59392
v_mfma_f32_16x16x32_bf16 v[108:111], a[60:63], a[168:171], v[108:111]
v_mfma_f32_16x16x32_bf16 v[124:127], a[60:63], a[172:175], v[124:127]
v_mfma_f32_16x16x32_bf16 v[124:127], a[44:47], a[164:167], v[124:127]
s_branch fk_g2
fk_b:
PG1019:
s_cbranch_execz PG13
s_bfe_u32 s62, s2, 0x10001
s_lshl_b32 s62, s62, 2
s_bfe_u32 s44, s2, 0x20003
s_add_u32 s62, s62, s44
s_bfe_u32 s63, s2, 0x10002
s_lshl_b32 s63, s63, 3
s_lshr_b32 s44, s2, 5
s_add_u32 s63, s63, s44
s_lshl_b32 s65, s63, 7
v_lshrrev_b32 v27, 7, v1
v_bfe_u32 v28, v1, 4, 3
v_and_b32 v29, 6, v27
v_xor_b32 v28, v28, v29
s_lshl_b32 s44, s3, 3
v_add_u32 v27, s44, v27
v_mul_u32_u24 v27, 6144, v27
v_lshl_add_u32 v30, v28, 4, v27
s_add_u32 s44, s65, 4096
v_add_u32 v2, s44, v30
s_add_u32 s44, s65, 5120
v_add_u32 v3, s44, v30
s_add_u32 s44, s65, 6144
v_add_u32 v4, s44, v30
s_mul_i32 s42, s3, 3072
s_add_u32 m0, s42, 98304
s_nop 0
buffer_load_dwordx4 v2, s[8:11], s41 offen offset:0 lds
buffer_load_dwordx4 v3, s[8:11], s41 offen offset:1024 lds
buffer_load_dwordx4 v4, s[8:11], s41 offen offset:2048 lds
s_add_u32 m0, s42, 110592
s_add_u32 s41, s41, 196608
buffer_load_dwordx4 v2, s[8:11], s41 offen offset:0 lds
buffer_load_dwordx4 v3, s[8:11], s41 offen offset:1024 lds
buffer_load_dwordx4 v4, s[8:11], s41 offen offset:2048 lds
s_add_u32 m0, s42, 86016
s_add_u32 s41, s41, 196608
buffer_load_dwordx4 v2, s[8:11], s41 offen offset:0 lds
buffer_load_dwordx4 v3, s[8:11], s41 offen offset:1024 lds
buffer_load_dwordx4 v4, s[8:11], s41 offen offset:2048 lds
s_add_u32 m0, s42, 122880
s_add_u32 s41, s41, 196608
buffer_load_dwordx4 v2, s[8:11], s41 offen offset:0 lds
buffer_load_dwordx4 v3, s[8:11], s41 offen offset:1024 lds
buffer_load_dwordx4 v4, s[8:11], s41 offen offset:2048 lds
s_add_u32 s41, s41, 196608
s_lshl_b32 s44, s3, 12
v_add_u32 v12, s44, v1
s_lshl_b32 s45, s62, 19
s_add_u32 s46, s48, s45
s_addc_u32 s47, s49, 0
s_mov_b32 s4, s46
s_and_b32 s5, s47, 0xffff
s_mov_b32 s6, 524288
s_mov_b32 s7, 0x00020000
v_lshrrev_b32 v27, 6, v1
v_and_b32 v27, 7, v27
v_lshrrev_b32 v28, 9, v1
v_mul_u32_u24 v28, 3072, v28
v_bfe_u32 v29, v1, 4, 2
v_lshl_add_u32 v28, v29, 3, v28
v_add_u32 v28, 86016, v28
v_lshl_add_u32 v29, v27, 7, v28
v_lshrrev_b32 v30, 1, v27
v_xor_b32 v6, 0, v30
v_lshl_add_u32 v6, v6, 5, v29
v_xor_b32 v7, 1, v30
v_lshl_add_u32 v7, v7, 5, v29
v_xor_b32 v8, 2, v30
v_lshl_add_u32 v8, v8, 5, v29
v_xor_b32 v9, 3, v30
v_lshl_add_u32 v9, v9, 5, v29
v_add_u32 v18, 36864, v6
v_add_u32 v19, 36864, v7
v_add_u32 v20, 36864, v8
v_add_u32 v21, 36864, v9
s_lshl_b32 s44, s63, 4
s_add_u32 s44, s44, s62
s_lshl_b32 s66, s44, 15
s_add_u32 s66, s66, 4194304
s_and_b32 s45, s3, 1
s_lshl_b32 s46, s45, 18
s_add_u32 s100, s66, s46
s_sub_u32 s100, s100, 32768
s_cmp_eq_u32 s62, 0
s_cselect_b32 s100, 0x40000000, s100
s_add_u32 s67, s66, 262144
s_mul_i32 s99, s63, 4352
s_lshl_b32 s46, s62, 4
s_add_u32 s99, s99, s46
s_add_u32 s99, s99, 36280320
s_lshl_b32 s46, s3, 2
s_add_u32 s98, s99, s46
s_sub_u32 s99, s99, 16
s_lshl_b32 s44, s63, 1
s_add_u32 s44, s44, s45
s_lshr_b32 s47, s3, 1
s_lshl_b32 s96, s62, 19
s_lshl_b32 s46, s44, 14
s_add_u32 s96, s96, s46
s_lshl_b32 s46, s47, 10
s_add_u32 s96, s96, s46
s_add_u32 s96, s96, 16789504
s_lshl_b32 s44, s44, 1
s_add_u32 s44, s44, s47
s_lshl_b32 s44, s44, 2
s_mul_i32 s65, s62, 4352
s_add_u32 s65, s65, s44
s_add_u32 s65, s65, 36245504
s_and_b32 s44, s3, 1
s_lshl_b32 s44, s44, 14
v_add_u32 v244, s44, v1
s_lshr_b32 s45, s3, 1
s_lshl_b32 s46, s45, 10
s_add_u32 s46, s46, 65536
v_add_u32 v245, s46, v244
s_mov_b32 s101, 0xf149f2ca
v_bfe_u32 v27, v1, 4, 4
s_lshl_b32 s46, s45, 4
v_add_u32 v27, s46, v27
v_lshrrev_b32 v28, 8, v1
v_lshlrev_b32 v28, 2, v28
v_mov_b32 v29, s101
s_cmp_eq_u32 s62, 0
s_cselect_b32 s46, s101, 0
v_mov_b32 v240, s46
v_add_u32 v30, 0, v28
v_cmp_gt_u32 vcc, v30, v27
s_nop 1
v_cndmask_b32 v224, 0, v29, vcc
v_cndmask_b32 v232, v29, v240, vcc
v_add_u32 v30, 1, v28
v_cmp_gt_u32 vcc, v30, v27
s_nop 1
v_cndmask_b32 v225, 0, v29, vcc
v_cndmask_b32 v233, v29, v240, vcc
v_add_u32 v30, 2, v28
v_cmp_gt_u32 vcc, v30, v27
s_nop 1
v_cndmask_b32 v226, 0, v29, vcc
v_cndmask_b32 v234, v29, v240, vcc
v_add_u32 v30, 3, v28
v_cmp_gt_u32 vcc, v30, v27
s_nop 1
v_cndmask_b32 v227, 0, v29, vcc
v_cndmask_b32 v235, v29, v240, vcc
v_add_u32 v30, 16, v28
v_cmp_gt_u32 vcc, v30, v27
s_nop 1
v_cndmask_b32 v228, 0, v29, vcc
v_cndmask_b32 v236, v29, v240, vcc
v_add_u32 v30, 17, v28
v_cmp_gt_u32 vcc, v30, v27
s_nop 1
v_cndmask_b32 v229, 0, v29, vcc
v_cndmask_b32 v237, v29, v240, vcc
v_add_u32 v30, 18, v28
v_cmp_gt_u32 vcc, v30, v27
s_nop 1
v_cndmask_b32 v230, 0, v29, vcc
v_cndmask_b32 v238, v29, v240, vcc
v_add_u32 v30, 19, v28
v_cmp_gt_u32 vcc, v30, v27
s_nop 1
v_cndmask_b32 v231, 0, v29, vcc
v_cndmask_b32 v239, v29, v240, vcc
v_mov_b32 v240, 0x3f803f80
v_mov_b32 v241, 0x3f803f80
v_mov_b32 v242, 0x3f803f80
v_mov_b32 v243, 0x3f803f80
v_add_u32 v27, 65536, v12
v_add_u32 v28, 16384, v12
s_mov_b32 s90, 0x3e8293ee
s_and_b32 s44, s63, 7
s_cmp_gt_u32 s44, 3
s_cselect_b32 s45, 1, 0
s_sub_u32 s45, s63, s45
s_lshr_b32 s46, s63, 3
s_sub_u32 s45, s45, s46
s_lshl_b32 s45, s45, 3
s_add_u32 s45, s45, s62
s_lshl_b32 s45, s45, 2
s_add_u32 s45, s45, s3
s_cmp_eq_u32 s44, 3
s_cselect_b32 s91, 0x4000, s45
s_sub_u32 s45, s91, 298
s_cmp_lt_u32 s91, 298
s_cselect_b32 s44, s91, s45
s_cselect_b32 s16, s24, s20
s_cselect_b32 s17, s25, s21
s_cselect_b32 s18, s26, s22
s_mov_b32 s19, 0x00020000
s_mul_i32 s68, s44, 7040
s_add_u32 s68, s68, 4096
s_mul_i32 s79, s91, 7040
s_add_u32 s79, s79, 1060096
v_lshlrev_b32 v30, 3, v1
v_min_u32 v30, 6912, v30
s_waitcnt vmcnt(6)
s_barrier
ds_read_b64_tr_b16 a[0:1], v6 offset:12288
ds_read_b64_tr_b16 a[2:3], v6 offset:18432
ds_read_b64_tr_b16 a[4:5], v6 offset:24576
ds_read_b64_tr_b16 a[6:7], v6 offset:30720
ds_read_b64_tr_b16 a[8:9], v7 offset:12288
ds_read_b64_tr_b16 a[10:11], v7 offset:18432
ds_read_b64_tr_b16 a[12:13], v7 offset:24576
ds_read_b64_tr_b16 a[14:15], v7 offset:30720
ds_read_b64_tr_b16 a[16:17], v8 offset:12288
ds_read_b64_tr_b16 a[18:19], v8 offset:18432
ds_read_b64_tr_b16 a[20:21], v8 offset:24576
ds_read_b64_tr_b16 a[22:23], v8 offset:30720
ds_read_b64_tr_b16 a[24:25], v9 offset:12288
ds_read_b64_tr_b16 a[26:27], v9 offset:18432
ds_read_b64_tr_b16 a[28:29], v9 offset:24576
ds_read_b64_tr_b16 a[30:31], v9 offset:30720
ds_read_b64_tr_b16 a[32:33], v6 offset:13312
ds_read_b64_tr_b16 a[34:35], v6 offset:19456
ds_read_b64_tr_b16 a[36:37], v6 offset:25600
ds_read_b64_tr_b16 a[38:39], v6 offset:31744
ds_read_b64_tr_b16 a[40:41], v7 offset:13312
ds_read_b64_tr_b16 a[42:43], v7 offset:19456
ds_read_b64_tr_b16 a[44:45], v7 offset:25600
ds_read_b64_tr_b16 a[46:47], v7 offset:31744
s_lshr_b32 s46, s62, 1
s_and_b32 s47, s62, 1
s_sub_u32 s45, s47, 1
s_sub_u32 s47, 0, s47
s_cmp_lg_u32 s3, 0
s_cbranch_scc1 fk_lnb_lf_ok
s_lshr_b32 s44, s2, 5
s_lshl_b32 s44, s44, 2
s_add_u32 s44, s44, s46
s_mul_i32 s44, s44, 4352
s_add_u32 s44, s44, 36558848
s_mov_b32 s84, s45
s_mov_b32 s85, s47
s_mov_b32 s86, 0
s_branch fk_lnb_lf_ld
fk_lnb_lf_chk:
v_cmp_eq_u32 vcc, v26, v0
s_nop 1
s_andn2_b64 s[88:89], s[84:85], vcc
s_cbranch_scc0 fk_lnb_lf_ok
s_add_u32 s86, s86, 1
s_cmp_gt_u32 s86, 0x8000
s_cbranch_scc1 fk_lnb_lf_ok
s_sleep 0
fk_lnb_lf_ld:
buffer_load_dword v0, v24, s[12:15], s44 offen sc1
s_waitcnt vmcnt(0)
s_branch fk_lnb_lf_chk
fk_lnb_lf_ok:
s_barrier
s_mov_b32 s85, 0
s_nop 0
buffer_load_dwordx4 a[96:99], v12, s[4:7], s40 offen offset:0 sc1
buffer_load_dwordx4 a[100:103], v12, s[4:7], s40 offen offset:1024 sc1
buffer_load_dwordx4 a[104:107], v12, s[4:7], s40 offen offset:2048 sc1
buffer_load_dwordx4 a[108:111], v12, s[4:7], s40 offen offset:3072 sc1
s_add_u32 s40, s40, 16384
buffer_load_dwordx4 a[112:115], v12, s[4:7], s40 offen offset:0 sc1
buffer_load_dwordx4 a[116:119], v12, s[4:7], s40 offen offset:1024 sc1
buffer_load_dwordx4 a[120:123], v12, s[4:7], s40 offen offset:2048 sc1
buffer_load_dwordx4 a[124:127], v12, s[4:7], s40 offen offset:3072 sc1
s_add_u32 s40, s40, 16384
s_nop 0
buffer_load_dwordx4 a[128:131], v12, s[4:7], s40 offen offset:0 sc1
buffer_load_dwordx4 a[132:135], v12, s[4:7], s40 offen offset:1024 sc1
buffer_load_dwordx4 a[136:139], v12, s[4:7], s40 offen offset:2048 sc1
buffer_load_dwordx4 a[140:143], v12, s[4:7], s40 offen offset:3072 sc1
s_add_u32 s40, s40, 16384
buffer_load_dwordx4 a[144:147], v12, s[4:7], s40 offen offset:0 sc1
buffer_load_dwordx4 a[148:151], v12, s[4:7], s40 offen offset:1024 sc1
buffer_load_dwordx4 a[152:155], v12, s[4:7], s40 offen offset:2048 sc1
buffer_load_dwordx4 a[156:159], v12, s[4:7], s40 offen offset:3072 sc1
s_add_u32 s40, s40, 16384
s_add_u32 m0, s42, 135168
s_nop 0
buffer_load_dwordx4 v2, s[8:11], s41 offen offset:0 lds
buffer_load_dwordx4 v3, s[8:11], s41 offen offset:1024 lds
buffer_load_dwordx4 v4, s[8:11], s41 offen offset:2048 lds
s_add_u32 m0, s42, 147456
s_add_u32 s41, s41, 196608
buffer_load_dwordx4 v2, s[8:11], s41 offen offset:0 lds
buffer_load_dwordx4 v3, s[8:11], s41 offen offset:1024 lds
buffer_load_dwordx4 v4, s[8:11], s41 offen offset:2048 lds
s_add_u32 s41, s41, 196608
s_waitcnt vmcnt(14) lgkmcnt(0)
v_mfma_f32_16x16x32_bf16 v[32:35], a[0:3], a[96:99], 0
ds_read_b64_tr_b16 a[48:49], v8 offset:13312
v_mfma_f32_16x16x32_bf16 v[32:35], a[4:7], a[112:115], v[32:35]
buffer_load_dwordx4 a[160:163], v12, s[4:7], s40 offen offset:0 sc1
v_mfma_f32_16x16x32_bf16 v[36:39], a[0:3], a[100:103], 0
ds_read_b64_tr_b16 a[50:51], v8 offset:19456
v_mfma_f32_16x16x32_bf16 v[36:39], a[4:7], a[116:119], v[36:39]
ds_read_b64_tr_b16 a[52:53], v8 offset:25600
v_mfma_f32_16x16x32_bf16 v[40:43], a[0:3], a[104:107], 0
buffer_load_dwordx4 a[164:167], v12, s[4:7], s40 offen offset:1024 sc1
v_mfma_f32_16x16x32_bf16 v[40:43], a[4:7], a[120:123], v[40:43]
ds_read_b64_tr_b16 a[54:55], v8 offset:31744
v_mfma_f32_16x16x32_bf16 v[44:47], a[0:3], a[108:111], 0
v_mfma_f32_16x16x32_bf16 v[44:47], a[4:7], a[124:127], v[44:47]
ds_read_b64_tr_b16 a[56:57], v9 offset:13312
v_mfma_f32_16x16x32_bf16 v[48:51], a[8:11], a[96:99], 0
buffer_load_dwordx4 a[168:171], v12, s[4:7], s40 offen offset:2048 sc1
v_mfma_f32_16x16x32_bf16 v[48:51], a[12:15], a[112:115], v[48:51]
ds_read_b64_tr_b16 a[58:59], v9 offset:19456
v_mfma_f32_16x16x32_bf16 v[52:55], a[8:11], a[100:103], 0
ds_read_b64_tr_b16 a[60:61], v9 offset:25600
PG10:
s_cbranch_execz PG14
v_mfma_f32_16x16x32_bf16 v[52:55], a[12:15], a[116:119], v[52:55]
buffer_load_dwordx4 a[172:175], v12, s[4:7], s40 offen offset:3072 sc1
s_add_u32 s40, s40, 16384
v_mfma_f32_16x16x32_bf16 v[56:59], a[8:11], a[104:107], 0
ds_read_b64_tr_b16 a[62:63], v9 offset:31744
v_mfma_f32_16x16x32_bf16 v[56:59], a[12:15], a[120:123], v[56:59]
v_mfma_f32_16x16x32_bf16 v[60:63], a[8:11], a[108:111], 0
ds_read_b64_tr_b16 a[64:65], v6 offset:14336
v_mfma_f32_16x16x32_bf16 v[60:63], a[12:15], a[124:127], v[60:63]
buffer_load_dwordx4 a[176:179], v12, s[4:7], s40 offen offset:0 sc1
v_mfma_f32_16x16x32_bf16 v[64:67], a[16:19], a[96:99], 0
ds_read_b64_tr_b16 a[66:67], v6 offset:20480
v_mfma_f32_16x16x32_bf16 v[64:67], a[20:23], a[112:115], v[64:67]
ds_read_b64_tr_b16 a[68:69], v6 offset:26624
v_mfma_f32_16x16x32_bf16 v[68:71], a[16:19], a[100:103], 0
buffer_load_dwordx4 a[180:183], v12, s[4:7], s40 offen offset:1024 sc1
v_mfma_f32_16x16x32_bf16 v[68:71], a[20:23], a[116:119], v[68:71]
ds_read_b64_tr_b16 a[70:71], v6 offset:32768
v_mfma_f32_16x16x32_bf16 v[72:75], a[16:19], a[104:107], 0
v_mfma_f32_16x16x32_bf16 v[72:75], a[20:23], a[120:123], v[72:75]
ds_read_b64_tr_b16 a[72:73], v7 offset:14336
v_mfma_f32_16x16x32_bf16 v[76:79], a[16:19], a[108:111], 0
buffer_load_dwordx4 a[184:187], v12, s[4:7], s40 offen offset:2048 sc1
v_mfma_f32_16x16x32_bf16 v[76:79], a[20:23], a[124:127], v[76:79]
ds_read_b64_tr_b16 a[74:75], v7 offset:20480
v_mfma_f32_16x16x32_bf16 v[80:83], a[24:27], a[96:99], 0
ds_read_b64_tr_b16 a[76:77], v7 offset:26624
v_mfma_f32_16x16x32_bf16 v[80:83], a[28:31], a[112:115], v[80:83]
buffer_load_dwordx4 a[188:191], v12, s[4:7], s40 offen offset:3072 sc1
s_add_u32 s40, s40, 16384
v_mfma_f32_16x16x32_bf16 v[84:87], a[24:27], a[100:103], 0
ds_read_b64_tr_b16 a[78:79], v7 offset:32768
v_mfma_f32_16x16x32_bf16 v[84:87], a[28:31], a[116:119], v[84:87]
v_mfma_f32_16x16x32_bf16 v[88:91], a[24:27], a[104:107], 0
ds_read_b64_tr_b16 a[80:81], v8 offset:14336
v_mfma_f32_16x16x32_bf16 v[88:91], a[28:31], a[120:123], v[88:91]
buffer_load_dwordx4 a[192:195], v12, s[4:7], s40 offen offset:0 sc1
v_mfma_f32_16x16x32_bf16 v[92:95], a[24:27], a[108:111], 0
ds_read_b64_tr_b16 a[82:83], v8 offset:20480
v_mfma_f32_16x16x32_bf16 v[92:95], a[28:31], a[124:127], v[92:95]
ds_read_b64_tr_b16 a[84:85], v8 offset:26624
v_mfma_f32_16x16x32_bf16 v[96:99], a[32:35], a[96:99], 0
buffer_load_dwordx4 a[196:199], v12, s[4:7], s40 offen offset:1024 sc1
v_mfma_f32_16x16x32_bf16 v[96:99], a[36:39], a[112:115], v[96:99]
ds_read_b64_tr_b16 a[86:87], v8 offset:32768
v_mfma_f32_16x16x32_bf16 v[100:103], a[32:35], a[100:103], 0
v_mfma_f32_16x16x32_bf16 v[100:103], a[36:39], a[116:119], v[100:103]
ds_read_b64_tr_b16 a[88:89], v9 offset:14336
v_mfma_f32_16x16x32_bf16 v[104:107], a[32:35], a[104:107], 0
buffer_load_dwordx4 a[200:203], v12, s[4:7], s40 offen offset:2048 sc1
v_mfma_f32_16x16x32_bf16 v[104:107], a[36:39], a[120:123], v[104:107]
ds_read_b64_tr_b16 a[90:91], v9 offset:20480
v_mfma_f32_16x16x32_bf16 v[108:111], a[32:35], a[108:111], 0
ds_read_b64_tr_b16 a[92:93], v9 offset:26624
v_mfma_f32_16x16x32_bf16 v[108:111], a[36:39], a[124:127], v[108:111]
buffer_load_dwordx4 a[204:207], v12, s[4:7], s40 offen offset:3072 sc1
s_add_u32 s40, s40, 16384
v_mfma_f32_16x16x32_bf16 v[112:115], a[40:43], a[96:99], 0
ds_read_b64_tr_b16 a[94:95], v9 offset:32768
v_mfma_f32_16x16x32_bf16 v[112:115], a[44:47], a[112:115], v[112:115]
v_mfma_f32_16x16x32_bf16 v[116:119], a[40:43], a[100:103], 0
v_mfma_f32_16x16x32_bf16 v[116:119], a[44:47], a[116:119], v[116:119]
v_mfma_f32_16x16x32_bf16 v[120:123], a[40:43], a[104:107], 0
v_mfma_f32_16x16x32_bf16 v[120:123], a[44:47], a[120:123], v[120:123]
v_mfma_f32_16x16x32_bf16 v[124:127], a[40:43], a[108:111], 0
v_mfma_f32_16x16x32_bf16 v[124:127], a[44:47], a[124:127], v[124:127]
s_waitcnt lgkmcnt(0)
v_mfma_f32_16x16x32_bf16 v[128:131], a[48:51], a[96:99], 0
v_mfma_f32_16x16x32_bf16 v[128:131], a[52:55], a[112:115], v[128:131]
s_barrier
v_mfma_f32_16x16x32_bf16 v[132:135], a[48:51], a[100:103], 0
ds_read_b64_tr_b16 a[0:1], v6 offset:0
s_add_u32 m0, s42, 98304
v_mfma_f32_16x16x32_bf16 v[132:135], a[52:55], a[116:119], v[132:135]
buffer_load_dwordx4 v2, s[8:11], s41 offen offset:0 lds
v_mfma_f32_16x16x32_bf16 v[136:139], a[48:51], a[104:107], 0
ds_read_b64_tr_b16 a[2:3], v6 offset:6144
v_mfma_f32_16x16x32_bf16 v[136:139], a[52:55], a[120:123], v[136:139]
v_mfma_f32_16x16x32_bf16 v[140:143], a[48:51], a[108:111], 0
ds_read_b64_tr_b16 a[4:5], v18 offset:0
v_mfma_f32_16x16x32_bf16 v[140:143], a[52:55], a[124:127], v[140:143]
ds_read_b64_tr_b16 a[6:7], v18 offset:6144
v_mfma_f32_16x16x32_bf16 v[144:147], a[56:59], a[96:99], 0
ds_read_b64_tr_b16 a[8:9], v7 offset:0
v_mfma_f32_16x16x32_bf16 v[144:147], a[60:63], a[112:115], v[144:147]
v_mfma_f32_16x16x32_bf16 v[148:151], a[56:59], a[100:103], 0
buffer_load_dwordx4 v3, s[8:11], s41 offen offset:1024 lds
v_mfma_f32_16x16x32_bf16 v[148:151], a[60:63], a[116:119], v[148:151]
ds_read_b64_tr_b16 a[10:11], v7 offset:6144
v_mfma_f32_16x16x32_bf16 v[152:155], a[56:59], a[104:107], 0
ds_read_b64_tr_b16 a[12:13], v19 offset:0
v_mfma_f32_16x16x32_bf16 v[152:155], a[60:63], a[120:123], v[152:155]
v_mfma_f32_16x16x32_bf16 v[156:159], a[56:59], a[108:111], 0
ds_read_b64_tr_b16 a[14:15], v19 offset:6144
v_mfma_f32_16x16x32_bf16 v[156:159], a[60:63], a[124:127], v[156:159]
ds_read_b64_tr_b16 a[16:17], v8 offset:0
v_mfma_f32_16x16x32_bf16 v[160:163], a[96:99], a[64:67], 0
buffer_load_dwordx4 v4, s[8:11], s41 offen offset:2048 lds
s_add_u32 s41, s41, 196608
v_mfma_f32_16x16x32_bf16 v[160:163], a[112:115], a[68:71], v[160:163]
v_mfma_f32_16x16x32_bf16 v[164:167], a[100:103], a[64:67], 0
ds_read_b64_tr_b16 a[18:19], v8 offset:6144
v_mfma_f32_16x16x32_bf16 v[164:167], a[116:119], a[68:71], v[164:167]
ds_read_b64_tr_b16 a[20:21], v20 offset:0
v_mfma_f32_16x16x32_bf16 v[168:171], a[104:107], a[64:67], 0
ds_read_b64_tr_b16 a[22:23], v20 offset:6144
v_mfma_f32_16x16x32_bf16 v[168:171], a[120:123], a[68:71], v[168:171]
v_mfma_f32_16x16x32_bf16 v[172:175], a[108:111], a[64:67], 0
ds_read_b64_tr_b16 a[24:25], v9 offset:0
s_add_u32 m0, s42, 110592
v_mfma_f32_16x16x32_bf16 v[172:175], a[124:127], a[68:71], v[172:175]
buffer_load_dwordx4 v2, s[8:11], s41 offen offset:0 lds
v_mfma_f32_16x16x32_bf16 v[176:179], a[96:99], a[72:75], 0
ds_read_b64_tr_b16 a[26:27], v9 offset:6144
v_mfma_f32_16x16x32_bf16 v[176:179], a[112:115], a[76:79], v[176:179]
v_mfma_f32_16x16x32_bf16 v[180:183], a[100:103], a[72:75], 0
ds_read_b64_tr_b16 a[28:29], v21 offset:0
v_mfma_f32_16x16x32_bf16 v[180:183], a[116:119], a[76:79], v[180:183]
ds_read_b64_tr_b16 a[30:31], v21 offset:6144
v_mfma_f32_16x16x32_bf16 v[184:187], a[104:107], a[72:75], 0
ds_read_b64_tr_b16 a[32:33], v6 offset:1024
v_mfma_f32_16x16x32_bf16 v[184:187], a[120:123], a[76:79], v[184:187]
v_mfma_f32_16x16x32_bf16 v[188:191], a[108:111], a[72:75], 0
buffer_load_dwordx4 v3, s[8:11], s41 offen offset:1024 lds
v_mfma_f32_16x16x32_bf16 v[188:191], a[124:127], a[76:79], v[188:191]
ds_read_b64_tr_b16 a[34:35], v6 offset:7168
v_mfma_f32_16x16x32_bf16 v[192:195], a[96:99], a[80:83], 0
ds_read_b64_tr_b16 a[36:37], v18 offset:1024
v_mfma_f32_16x16x32_bf16 v[192:195], a[112:115], a[84:87], v[192:195]
v_mfma_f32_16x16x32_bf16 v[196:199], a[100:103], a[80:83], 0
ds_read_b64_tr_b16 a[38:39], v18 offset:7168
v_mfma_f32_16x16x32_bf16 v[196:199], a[116:119], a[84:87], v[196:199]
ds_read_b64_tr_b16 a[40:41], v7 offset:1024
v_mfma_f32_16x16x32_bf16 v[200:203], a[104:107], a[80:83], 0
buffer_load_dwordx4 v4, s[8:11], s41 offen offset:2048 lds
s_add_u32 s41, s41, 196608
v_mfma_f32_16x16x32_bf16 v[200:203], a[120:123], a[84:87], v[200:203]
v_mfma_f32_16x16x32_bf16 v[204:207], a[108:111], a[80:83], 0
ds_read_b64_tr_b16 a[42:43], v7 offset:7168
v_mfma_f32_16x16x32_bf16 v[204:207], a[124:127], a[84:87], v[204:207]
ds_read_b64_tr_b16 a[44:45], v19 offset:1024
v_mfma_f32_16x16x32_bf16 v[208:211], a[96:99], a[88:91], 0
ds_read_b64_tr_b16 a[46:47], v19 offset:7168
v_mfma_f32_16x16x32_bf16 v[208:211], a[112:115], a[92:95], v[208:211]
v_mfma_f32_16x16x32_bf16 v[212:215], a[100:103], a[88:91], 0
v_mfma_f32_16x16x32_bf16 v[212:215], a[116:119], a[92:95], v[212:215]
v_mfma_f32_16x16x32_bf16 v[216:219], a[104:107], a[88:91], 0
v_mfma_f32_16x16x32_bf16 v[216:219], a[120:123], a[92:95], v[216:219]
v_mfma_f32_16x16x32_bf16 v[220:223], a[108:111], a[88:91], 0
v_mfma_f32_16x16x32_bf16 v[220:223], a[124:127], a[92:95], v[220:223]
s_waitcnt vmcnt(24) lgkmcnt(0)
v_mfma_f32_16x16x32_bf16 v[32:35], a[0:3], a[128:131], v[32:35]
ds_read_b64_tr_b16 a[48:49], v8 offset:1024
v_mfma_f32_16x16x32_bf16 v[32:35], a[4:7], a[144:147], v[32:35]
buffer_load_dwordx4 a[208:211], v12, s[4:7], s40 offen offset:0 sc1
v_mfma_f32_16x16x32_bf16 v[36:39], a[4:7], a[148:151], v[36:39]
ds_read_b64_tr_b16 a[50:51], v8 offset:7168
v_mfma_f32_16x16x32_bf16 v[36:39], a[0:3], a[132:135], v[36:39]
ds_read_b64_tr_b16 a[52:53], v20 offset:1024
v_mfma_f32_16x16x32_bf16 v[40:43], a[0:3], a[136:139], v[40:43]
buffer_load_dwordx4 a[212:215], v12, s[4:7], s40 offen offset:1024 sc1
v_mfma_f32_16x16x32_bf16 v[40:43], a[4:7], a[152:155], v[40:43]
ds_read_b64_tr_b16 a[54:55], v20 offset:7168
v_mfma_f32_16x16x32_bf16 v[44:47], a[4:7], a[156:159], v[44:47]
v_mfma_f32_16x16x32_bf16 v[44:47], a[0:3], a[140:143], v[44:47]
ds_read_b64_tr_b16 a[56:57], v9 offset:1024
v_mfma_f32_16x16x32_bf16 v[48:51], a[8:11], a[128:131], v[48:51]
buffer_load_dwordx4 a[216:219], v12, s[4:7], s40 offen offset:2048 sc1
v_mfma_f32_16x16x32_bf16 v[48:51], a[12:15], a[144:147], v[48:51]
ds_read_b64_tr_b16 a[58:59], v9 offset:7168
v_mfma_f32_16x16x32_bf16 v[52:55], a[12:15], a[148:151], v[52:55]
ds_read_b64_tr_b16 a[60:61], v21 offset:1024
v_mfma_f32_16x16x32_bf16 v[52:55], a[8:11], a[132:135], v[52:55]
buffer_load_dwordx4 a[220:223], v12, s[4:7], s40 offen offset:3072 sc1
s_add_u32 s40, s40, 16384
v_mfma_f32_16x16x32_bf16 v[56:59], a[8:11], a[136:139], v[56:59]
ds_read_b64_tr_b16 a[62:63], v21 offset:7168
v_mfma_f32_16x16x32_bf16 v[56:59], a[12:15], a[152:155], v[56:59]
v_mfma_f32_16x16x32_bf16 v[60:63], a[12:15], a[156:159], v[60:63]
ds_read_b64_tr_b16 a[64:65], v6 offset:2048
v_mfma_f32_16x16x32_bf16 v[60:63], a[8:11], a[140:143], v[60:63]
buffer_load_dwordx4 a[96:99], v12, s[4:7], s40 offen offset:0 sc1
v_mfma_f32_16x16x32_bf16 v[64:67], a[16:19], a[128:131], v[64:67]
ds_read_b64_tr_b16 a[66:67], v6 offset:8192
v_mfma_f32_16x16x32_bf16 v[64:67], a[20:23], a[144:147], v[64:67]
ds_read_b64_tr_b16 a[68:69], v18 offset:2048
v_mfma_f32_16x16x32_bf16 v[68:71], a[20:23], a[148:151], v[68:71]
buffer_load_dwordx4 a[100:103], v12, s[4:7], s40 offen offset:1024 sc1
v_mfma_f32_16x16x32_bf16 v[68:71], a[16:19], a[132:135], v[68:71]
ds_read_b64_tr_b16 a[70:71], v18 offset:8192
v_mfma_f32_16x16x32_bf16 v[72:75], a[16:19], a[136:139], v[72:75]
v_mfma_f32_16x16x32_bf16 v[72:75], a[20:23], a[152:155], v[72:75]
ds_read_b64_tr_b16 a[72:73], v7 offset:2048
v_mfma_f32_16x16x32_bf16 v[76:79], a[20:23], a[156:159], v[76:79]
buffer_load_dwordx4 a[104:107], v12, s[4:7], s40 offen offset:2048 sc1
v_mfma_f32_16x16x32_bf16 v[76:79], a[16:19], a[140:143], v[76:79]
ds_read_b64_tr_b16 a[74:75], v7 offset:8192
v_mfma_f32_16x16x32_bf16 v[80:83], a[24:27], a[128:131], v[80:83]
ds_read_b64_tr_b16 a[76:77], v19 offset:2048
v_mfma_f32_16x16x32_bf16 v[80:83], a[28:31], a[144:147], v[80:83]
buffer_load_dwordx4 a[108:111], v12, s[4:7], s40 offen offset:3072 sc1
s_add_u32 s40, s40, 16384
v_mfma_f32_16x16x32_bf16 v[84:87], a[28:31], a[148:151], v[84:87]
ds_read_b64_tr_b16 a[78:79], v19 offset:8192
v_mfma_f32_16x16x32_bf16 v[84:87], a[24:27], a[132:135], v[84:87]
v_mfma_f32_16x16x32_bf16 v[88:91], a[24:27], a[136:139], v[88:91]
ds_read_b64_tr_b16 a[80:81], v8 offset:2048
v_mfma_f32_16x16x32_bf16 v[88:91], a[28:31], a[152:155], v[88:91]
buffer_load_dwordx4 a[112:115], v12, s[4:7], s40 offen offset:0 sc1
v_mfma_f32_16x16x32_bf16 v[92:95], a[28:31], a[156:159], v[92:95]
ds_read_b64_tr_b16 a[82:83], v8 offset:8192
v_mfma_f32_16x16x32_bf16 v[92:95], a[24:27], a[140:143], v[92:95]
ds_read_b64_tr_b16 a[84:85], v20 offset:2048
v_mfma_f32_16x16x32_bf16 v[96:99], a[32:35], a[128:131], v[96:99]
buffer_load_dwordx4 a[116:119], v12, s[4:7], s40 offen offset:1024 sc1
v_mfma_f32_16x16x32_bf16 v[96:99], a[36:39], a[144:147], v[96:99]
ds_read_b64_tr_b16 a[86:87], v20 offset:8192
v_mfma_f32_16x16x32_bf16 v[100:103], a[36:39], a[148:151], v[100:103]
v_mfma_f32_16x16x32_bf16 v[100:103], a[32:35], a[132:135], v[100:103]
ds_read_b64_tr_b16 a[88:89], v9 offset:2048
v_mfma_f32_16x16x32_bf16 v[104:107], a[32:35], a[136:139], v[104:107]
buffer_load_dwordx4 a[120:123], v12, s[4:7], s40 offen offset:2048 sc1
v_mfma_f32_16x16x32_bf16 v[104:107], a[36:39], a[152:155], v[104:107]
ds_read_b64_tr_b16 a[90:91], v9 offset:8192
v_mfma_f32_16x16x32_bf16 v[108:111], a[36:39], a[156:159], v[108:111]
ds_read_b64_tr_b16 a[92:93], v21 offset:2048
v_mfma_f32_16x16x32_bf16 v[108:111], a[32:35], a[140:143], v[108:111]
buffer_load_dwordx4 a[124:127], v12, s[4:7], s40 offen offset:3072 sc1
s_add_u32 s40, s40, 16384
v_mfma_f32_16x16x32_bf16 v[112:115], a[40:43], a[128:131], v[112:115]
ds_read_b64_tr_b16 a[94:95], v21 offset:8192
v_mfma_f32_16x16x32_bf16 v[112:115], a[44:47], a[144:147], v[112:115]
v_mfma_f32_16x16x32_bf16 v[116:119], a[44:47], a[148:151], v[116:119]
v_mfma_f32_16x16x32_bf16 v[116:119], a[40:43], a[132:135], v[116:119]
v_mfma_f32_16x16x32_bf16 v[120:123], a[40:43], a[136:139], v[120:123]
v_mfma_f32_16x16x32_bf16 v[120:123], a[44:47], a[152:155], v[120:123]
v_mfma_f32_16x16x32_bf16 v[124:127], a[44:47], a[156:159], v[124:127]
v_mfma_f32_16x16x32_bf16 v[124:127], a[40:43], a[140:143], v[124:127]
s_waitcnt vmcnt(30) lgkmcnt(0)
v_mfma_f32_16x16x32_bf16 v[128:131], a[48:51], a[128:131], v[128:131]
v_mfma_f32_16x16x32_bf16 v[128:131], a[52:55], a[144:147], v[128:131]
s_barrier
v_mfma_f32_16x16x32_bf16 v[132:135], a[52:55], a[148:151], v[132:135]
ds_read_b64_tr_b16 a[0:1], v18 offset:12288
s_add_u32 m0, s42, 86016
v_mfma_f32_16x16x32_bf16 v[132:135], a[48:51], a[132:135], v[132:135]
buffer_load_dwordx4 v2, s[8:11], s41 offen offset:0 lds
v_mfma_f32_16x16x32_bf16 v[136:139], a[48:51], a[136:139], v[136:139]
ds_read_b64_tr_b16 a[2:3], v18 offset:18432
v_mfma_f32_16x16x32_bf16 v[136:139], a[52:55], a[152:155], v[136:139]
ds_read_b64_tr_b16 a[4:5], v18 offset:24576
v_mfma_f32_16x16x32_bf16 v[140:143], a[52:55], a[156:159], v[140:143]
v_mfma_f32_16x16x32_bf16 v[140:143], a[48:51], a[140:143], v[140:143]
ds_read_b64_tr_b16 a[6:7], v18 offset:30720
v_mfma_f32_16x16x32_bf16 v[144:147], a[56:59], a[128:131], v[144:147]
buffer_load_dwordx4 v3, s[8:11], s41 offen offset:1024 lds
v_mfma_f32_16x16x32_bf16 v[144:147], a[60:63], a[144:147], v[144:147]
ds_read_b64_tr_b16 a[8:9], v19 offset:12288
v_mfma_f32_16x16x32_bf16 v[148:151], a[60:63], a[148:151], v[148:151]
v_mfma_f32_16x16x32_bf16 v[148:151], a[56:59], a[132:135], v[148:151]
ds_read_b64_tr_b16 a[10:11], v19 offset:18432
v_mfma_f32_16x16x32_bf16 v[152:155], a[56:59], a[136:139], v[152:155]
ds_read_b64_tr_b16 a[12:13], v19 offset:24576
v_mfma_f32_16x16x32_bf16 v[152:155], a[60:63], a[152:155], v[152:155]
buffer_load_dwordx4 v4, s[8:11], s41 offen offset:2048 lds
s_add_u32 s41, s41, 196608
v_mfma_f32_16x16x32_bf16 v[156:159], a[60:63], a[156:159], v[156:159]
ds_read_b64_tr_b16 a[14:15], v19 offset:30720
v_mfma_f32_16x16x32_bf16 v[156:159], a[56:59], a[140:143], v[156:159]
v_mfma_f32_16x16x32_bf16 v[160:163], a[128:131], a[64:67], v[160:163]
ds_read_b64_tr_b16 a[16:17], v20 offset:12288
v_mfma_f32_16x16x32_bf16 v[160:163], a[144:147], a[68:71], v[160:163]
ds_read_b64_tr_b16 a[18:19], v20 offset:18432
v_mfma_f32_16x16x32_bf16 v[164:167], a[148:151], a[68:71], v[164:167]
ds_read_b64_tr_b16 a[20:21], v20 offset:24576
v_mfma_f32_16x16x32_bf16 v[164:167], a[132:135], a[64:67], v[164:167]
s_add_u32 m0, s42, 122880
v_mfma_f32_16x16x32_bf16 v[168:171], a[136:139], a[64:67], v[168:171]
buffer_load_dwordx4 v2, s[8:11], s41 offen offset:0 lds
v_mfma_f32_16x16x32_bf16 v[168:171], a[152:155], a[68:71], v[168:171]
ds_read_b64_tr_b16 a[22:23], v20 offset:30720
v_mfma_f32_16x16x32_bf16 v[172:175], a[156:159], a[68:71], v[172:175]
ds_read_b64_tr_b16 a[24:25], v21 offset:12288
v_mfma_f32_16x16x32_bf16 v[172:175], a[140:143], a[64:67], v[172:175]
ds_read_b64_tr_b16 a[26:27], v21 offset:18432
v_mfma_f32_16x16x32_bf16 v[176:179], a[128:131], a[72:75], v[176:179]
v_mfma_f32_16x16x32_bf16 v[176:179], a[144:147], a[76:79], v[176:179]
buffer_load_dwordx4 v3, s[8:11], s41 offen offset:1024 lds
v_mfma_f32_16x16x32_bf16 v[180:183], a[148:151], a[76:79], v[180:183]
ds_read_b64_tr_b16 a[28:29], v21 offset:24576
v_mfma_f32_16x16x32_bf16 v[180:183], a[132:135], a[72:75], v[180:183]
ds_read_b64_tr_b16 a[30:31], v21 offset:30720
v_mfma_f32_16x16x32_bf16 v[184:187], a[136:139], a[72:75], v[184:187]
v_mfma_f32_16x16x32_bf16 v[184:187], a[152:155], a[76:79], v[184:187]
ds_read_b64_tr_b16 a[32:33], v18 offset:13312
v_mfma_f32_16x16x32_bf16 v[188:191], a[156:159], a[76:79], v[188:191]
ds_read_b64_tr_b16 a[34:35], v18 offset:19456
v_mfma_f32_16x16x32_bf16 v[188:191], a[140:143], a[72:75], v[188:191]
buffer_load_dwordx4 v4, s[8:11], s41 offen offset:2048 lds
s_add_u32 s41, s41, 196608
v_mfma_f32_16x16x32_bf16 v[192:195], a[128:131], a[80:83], v[192:195]
ds_read_b64_tr_b16 a[36:37], v18 offset:25600
v_mfma_f32_16x16x32_bf16 v[192:195], a[144:147], a[84:87], v[192:195]
v_mfma_f32_16x16x32_bf16 v[196:199], a[148:151], a[84:87], v[196:199]
ds_read_b64_tr_b16 a[38:39], v18 offset:31744
v_mfma_f32_16x16x32_bf16 v[196:199], a[132:135], a[80:83], v[196:199]
ds_read_b64_tr_b16 a[40:41], v19 offset:13312
v_mfma_f32_16x16x32_bf16 v[200:203], a[136:139], a[80:83], v[200:203]
buffer_load_dword a251, v30, s[16:19], s68 offen
v_mfma_f32_16x16x32_bf16 v[200:203], a[152:155], a[84:87], v[200:203]
v_mfma_f32_16x16x32_bf16 v[204:207], a[156:159], a[84:87], v[204:207]
ds_read_b64_tr_b16 a[42:43], v19 offset:19456
v_mfma_f32_16x16x32_bf16 v[204:207], a[140:143], a[80:83], v[204:207]
ds_read_b64_tr_b16 a[44:45], v19 offset:25600
v_mfma_f32_16x16x32_bf16 v[208:211], a[128:131], a[88:91], v[208:211]
ds_read_b64_tr_b16 a[46:47], v19 offset:31744
v_mfma_f32_16x16x32_bf16 v[208:211], a[144:147], a[92:95], v[208:211]
v_mfma_f32_16x16x32_bf16 v[212:215], a[148:151], a[92:95], v[212:215]
v_mfma_f32_16x16x32_bf16 v[212:215], a[132:135], a[88:91], v[212:215]
v_mfma_f32_16x16x32_bf16 v[216:219], a[136:139], a[88:91], v[216:219]
v_mfma_f32_16x16x32_bf16 v[216:219], a[152:155], a[92:95], v[216:219]
v_mfma_f32_16x16x32_bf16 v[220:223], a[156:159], a[92:95], v[220:223]
v_mfma_f32_16x16x32_bf16 v[220:223], a[140:143], a[88:91], v[220:223]
s_waitcnt vmcnt(29) lgkmcnt(0)
v_mfma_f32_16x16x32_bf16 v[32:35], a[0:3], a[160:163], v[32:35]
ds_read_b64_tr_b16 a[48:49], v20 offset:13312
v_mfma_f32_16x16x32_bf16 v[32:35], a[4:7], a[176:179], v[32:35]
ds_read_b64_tr_b16 a[50:51], v20 offset:19456
v_mfma_f32_16x16x32_bf16 v[36:39], a[4:7], a[180:183], v[36:39]
v_mfma_f32_16x16x32_bf16 v[36:39], a[0:3], a[164:167], v[36:39]
ds_read_b64_tr_b16 a[52:53], v20 offset:25600
v_mfma_f32_16x16x32_bf16 v[40:43], a[0:3], a[168:171], v[40:43]
v_mfma_f32_16x16x32_bf16 v[40:43], a[4:7], a[184:187], v[40:43]
ds_read_b64_tr_b16 a[54:55], v20 offset:31744
v_mfma_f32_16x16x32_bf16 v[44:47], a[4:7], a[188:191], v[44:47]
v_mfma_f32_16x16x32_bf16 v[44:47], a[0:3], a[172:175], v[44:47]
ds_read_b64_tr_b16 a[56:57], v21 offset:13312
v_mfma_f32_16x16x32_bf16 v[48:51], a[8:11], a[160:163], v[48:51]
ds_read_b64_tr_b16 a[58:59], v21 offset:19456
v_mfma_f32_16x16x32_bf16 v[48:51], a[12:15], a[176:179], v[48:51]
v_mfma_f32_16x16x32_bf16 v[52:55], a[12:15], a[180:183], v[52:55]
ds_read_b64_tr_b16 a[60:61], v21 offset:25600
v_mfma_f32_16x16x32_bf16 v[52:55], a[8:11], a[164:167], v[52:55]
v_mfma_f32_16x16x32_bf16 v[56:59], a[8:11], a[168:171], v[56:59]
ds_read_b64_tr_b16 a[62:63], v21 offset:31744
v_mfma_f32_16x16x32_bf16 v[56:59], a[12:15], a[184:187], v[56:59]
v_mfma_f32_16x16x32_bf16 v[60:63], a[12:15], a[188:191], v[60:63]
ds_read_b64_tr_b16 a[64:65], v18 offset:14336
v_mfma_f32_16x16x32_bf16 v[60:63], a[8:11], a[172:175], v[60:63]
ds_read_b64_tr_b16 a[66:67], v18 offset:20480
v_mfma_f32_16x16x32_bf16 v[64:67], a[16:19], a[160:163], v[64:67]
v_mfma_f32_16x16x32_bf16 v[64:67], a[20:23], a[176:179], v[64:67]
ds_read_b64_tr_b16 a[68:69], v18 offset:26624
v_mfma_f32_16x16x32_bf16 v[68:71], a[20:23], a[180:183], v[68:71]
v_mfma_f32_16x16x32_bf16 v[68:71], a[16:19], a[164:167], v[68:71]
ds_read_b64_tr_b16 a[70:71], v18 offset:32768
v_mfma_f32_16x16x32_bf16 v[72:75], a[16:19], a[168:171], v[72:75]
v_mfma_f32_16x16x32_bf16 v[72:75], a[20:23], a[184:187], v[72:75]
ds_read_b64_tr_b16 a[72:73], v19 offset:14336
v_mfma_f32_16x16x32_bf16 v[76:79], a[20:23], a[188:191], v[76:79]
ds_read_b64_tr_b16 a[74:75], v19 offset:20480
v_mfma_f32_16x16x32_bf16 v[76:79], a[16:19], a[172:175], v[76:79]
v_mfma_f32_16x16x32_bf16 v[80:83], a[24:27], a[160:163], v[80:83]
ds_read_b64_tr_b16 a[76:77], v19 offset:26624
v_mfma_f32_16x16x32_bf16 v[80:83], a[28:31], a[176:179], v[80:83]
v_mfma_f32_16x16x32_bf16 v[84:87], a[28:31], a[180:183], v[84:87]
ds_read_b64_tr_b16 a[78:79], v19 offset:32768
v_mfma_f32_16x16x32_bf16 v[84:87], a[24:27], a[164:167], v[84:87]
v_mfma_f32_16x16x32_bf16 v[88:91], a[24:27], a[168:171], v[88:91]
ds_read_b64_tr_b16 a[80:81], v20 offset:14336
v_mfma_f32_16x16x32_bf16 v[88:91], a[28:31], a[184:187], v[88:91]
ds_read_b64_tr_b16 a[82:83], v20 offset:20480
v_mfma_f32_16x16x32_bf16 v[92:95], a[28:31], a[188:191], v[92:95]
v_mfma_f32_16x16x32_bf16 v[92:95], a[24:27], a[172:175], v[92:95]
ds_read_b64_tr_b16 a[84:85], v20 offset:26624
v_mfma_f32_16x16x32_bf16 v[96:99], a[32:35], a[160:163], v[96:99]
v_mfma_f32_16x16x32_bf16 v[96:99], a[36:39], a[176:179], v[96:99]
ds_read_b64_tr_b16 a[86:87], v20 offset:32768
v_mfma_f32_16x16x32_bf16 v[100:103], a[36:39], a[180:183], v[100:103]
v_mfma_f32_16x16x32_bf16 v[100:103], a[32:35], a[164:167], v[100:103]
ds_read_b64_tr_b16 a[88:89], v21 offset:14336
v_mfma_f32_16x16x32_bf16 v[104:107], a[32:35], a[168:171], v[104:107]
ds_read_b64_tr_b16 a[90:91], v21 offset:20480
v_mfma_f32_16x16x32_bf16 v[104:107], a[36:39], a[184:187], v[104:107]
v_mfma_f32_16x16x32_bf16 v[108:111], a[36:39], a[188:191], v[108:111]
ds_read_b64_tr_b16 a[92:93], v21 offset:26624
v_mfma_f32_16x16x32_bf16 v[108:111], a[32:35], a[172:175], v[108:111]
v_mfma_f32_16x16x32_bf16 v[112:115], a[40:43], a[160:163], v[112:115]
ds_read_b64_tr_b16 a[94:95], v21 offset:32768
v_mfma_f32_16x16x32_bf16 v[112:115], a[44:47], a[176:179], v[112:115]
v_mfma_f32_16x16x32_bf16 v[116:119], a[44:47], a[180:183], v[116:119]
v_mfma_f32_16x16x32_bf16 v[116:119], a[40:43], a[164:167], v[116:119]
v_mfma_f32_16x16x32_bf16 v[120:123], a[40:43], a[168:171], v[120:123]
v_mfma_f32_16x16x32_bf16 v[120:123], a[44:47], a[184:187], v[120:123]
v_mfma_f32_16x16x32_bf16 v[124:127], a[44:47], a[188:191], v[124:127]
v_mfma_f32_16x16x32_bf16 v[124:127], a[40:43], a[172:175], v[124:127]
s_waitcnt vmcnt(19) lgkmcnt(0)
v_mfma_f32_16x16x32_bf16 v[128:131], a[48:51], a[160:163], v[128:131]
v_mfma_f32_16x16x32_bf16 v[128:131], a[52:55], a[176:179], v[128:131]
s_barrier
v_mfma_f32_16x16x32_bf16 v[132:135], a[52:55], a[180:183], v[132:135]
ds_read_b64_tr_b16 a[0:1], v6 offset:12288
v_mfma_f32_16x16x32_bf16 v[132:135], a[48:51], a[164:167], v[132:135]
buffer_load_dwordx4 a[252:255], v1, s[52:55], s56 offen
v_mfma_f32_16x16x32_bf16 v[136:139], a[48:51], a[168:171], v[136:139]
v_mfma_f32_16x16x32_bf16 v[136:139], a[52:55], a[184:187], v[136:139]
ds_read_b64_tr_b16 a[2:3], v6 offset:18432
v_mfma_f32_16x16x32_bf16 v[140:143], a[52:55], a[188:191], v[140:143]
ds_read_b64_tr_b16 a[4:5], v6 offset:24576
v_mfma_f32_16x16x32_bf16 v[140:143], a[48:51], a[172:175], v[140:143]
v_mfma_f32_16x16x32_bf16 v[144:147], a[56:59], a[160:163], v[144:147]
ds_read_b64_tr_b16 a[6:7], v6 offset:30720
v_mfma_f32_16x16x32_bf16 v[144:147], a[60:63], a[176:179], v[144:147]
v_mfma_f32_16x16x32_bf16 v[148:151], a[60:63], a[180:183], v[148:151]
ds_read_b64_tr_b16 a[8:9], v7 offset:12288
v_mfma_f32_16x16x32_bf16 v[148:151], a[56:59], a[164:167], v[148:151]
ds_read_b64_tr_b16 a[10:11], v7 offset:18432
v_mfma_f32_16x16x32_bf16 v[152:155], a[56:59], a[168:171], v[152:155]
v_mfma_f32_16x16x32_bf16 v[152:155], a[60:63], a[184:187], v[152:155]
ds_read_b64_tr_b16 a[12:13], v7 offset:24576
v_mfma_f32_16x16x32_bf16 v[156:159], a[60:63], a[188:191], v[156:159]
ds_read_b64_tr_b16 a[14:15], v7 offset:30720
v_mfma_f32_16x16x32_bf16 v[156:159], a[56:59], a[172:175], v[156:159]
v_mfma_f32_16x16x32_bf16 v[160:163], a[160:163], a[64:67], v[160:163]
ds_read_b64_tr_b16 a[16:17], v8 offset:12288
v_mfma_f32_16x16x32_bf16 v[160:163], a[176:179], a[68:71], v[160:163]
v_mfma_f32_16x16x32_bf16 v[164:167], a[180:183], a[68:71], v[164:167]
ds_read_b64_tr_b16 a[18:19], v8 offset:18432
v_mfma_f32_16x16x32_bf16 v[164:167], a[164:167], a[64:67], v[164:167]
ds_read_b64_tr_b16 a[20:21], v8 offset:24576
v_mfma_f32_16x16x32_bf16 v[168:171], a[168:171], a[64:67], v[168:171]
v_mfma_f32_16x16x32_bf16 v[168:171], a[184:187], a[68:71], v[168:171]
ds_read_b64_tr_b16 a[22:23], v8 offset:30720
v_mfma_f32_16x16x32_bf16 v[172:175], a[188:191], a[68:71], v[172:175]
ds_read_b64_tr_b16 a[24:25], v9 offset:12288
v_mfma_f32_16x16x32_bf16 v[172:175], a[172:175], a[64:67], v[172:175]
v_mfma_f32_16x16x32_bf16 v[176:179], a[160:163], a[72:75], v[176:179]
ds_read_b64_tr_b16 a[26:27], v9 offset:18432
v_mfma_f32_16x16x32_bf16 v[176:179], a[176:179], a[76:79], v[176:179]
v_mfma_f32_16x16x32_bf16 v[180:183], a[180:183], a[76:79], v[180:183]
ds_read_b64_tr_b16 a[28:29], v9 offset:24576
v_mfma_f32_16x16x32_bf16 v[180:183], a[164:167], a[72:75], v[180:183]
ds_read_b64_tr_b16 a[30:31], v9 offset:30720
v_mfma_f32_16x16x32_bf16 v[184:187], a[168:171], a[72:75], v[184:187]
v_mfma_f32_16x16x32_bf16 v[184:187], a[184:187], a[76:79], v[184:187]
ds_read_b64_tr_b16 a[32:33], v6 offset:13312
v_mfma_f32_16x16x32_bf16 v[188:191], a[188:191], a[76:79], v[188:191]
ds_read_b64_tr_b16 a[34:35], v6 offset:19456
v_mfma_f32_16x16x32_bf16 v[188:191], a[172:175], a[72:75], v[188:191]
v_mfma_f32_16x16x32_bf16 v[192:195], a[160:163], a[80:83], v[192:195]
ds_read_b64_tr_b16 a[36:37], v6 offset:25600
v_mfma_f32_16x16x32_bf16 v[192:195], a[176:179], a[84:87], v[192:195]
v_mfma_f32_16x16x32_bf16 v[196:199], a[180:183], a[84:87], v[196:199]
ds_read_b64_tr_b16 a[38:39], v6 offset:31744
v_mfma_f32_16x16x32_bf16 v[196:199], a[164:167], a[80:83], v[196:199]
ds_read_b64_tr_b16 a[40:41], v7 offset:13312
v_mfma_f32_16x16x32_bf16 v[200:203], a[168:171], a[80:83], v[200:203]
v_mfma_f32_16x16x32_bf16 v[200:203], a[184:187], a[84:87], v[200:203]
ds_read_b64_tr_b16 a[42:43], v7 offset:19456
v_mfma_f32_16x16x32_bf16 v[204:207], a[188:191], a[84:87], v[204:207]
ds_read_b64_tr_b16 a[44:45], v7 offset:25600
v_mfma_f32_16x16x32_bf16 v[204:207], a[172:175], a[80:83], v[204:207]
v_mfma_f32_16x16x32_bf16 v[208:211], a[160:163], a[88:91], v[208:211]
ds_read_b64_tr_b16 a[46:47], v7 offset:31744
v_mfma_f32_16x16x32_bf16 v[208:211], a[176:179], a[92:95], v[208:211]
v_mfma_f32_16x16x32_bf16 v[212:215], a[180:183], a[92:95], v[212:215]
v_mfma_f32_16x16x32_bf16 v[212:215], a[164:167], a[88:91], v[212:215]
v_mfma_f32_16x16x32_bf16 v[216:219], a[168:171], a[88:91], v[216:219]
v_mfma_f32_16x16x32_bf16 v[216:219], a[184:187], a[92:95], v[216:219]
v_mfma_f32_16x16x32_bf16 v[220:223], a[188:191], a[92:95], v[220:223]
v_mfma_f32_16x16x32_bf16 v[220:223], a[172:175], a[88:91], v[220:223]
s_waitcnt vmcnt(16) lgkmcnt(0)
v_mfma_f32_16x16x32_bf16 v[32:35], a[0:3], a[192:195], v[32:35]
ds_read_b64_tr_b16 a[48:49], v8 offset:13312
v_mfma_f32_16x16x32_bf16 v[32:35], a[4:7], a[208:211], v[32:35]
buffer_load_dwordx4 a[128:131], v12, s[4:7], s40 offen offset:0 sc1
v_mfma_f32_16x16x32_bf16 v[36:39], a[4:7], a[212:215], v[36:39]
ds_read_b64_tr_b16 a[50:51], v8 offset:19456
v_mfma_f32_16x16x32_bf16 v[36:39], a[0:3], a[196:199], v[36:39]
ds_read_b64_tr_b16 a[52:53], v8 offset:25600
v_mfma_f32_16x16x32_bf16 v[40:43], a[0:3], a[200:203], v[40:43]
buffer_load_dwordx4 a[132:135], v12, s[4:7], s40 offen offset:1024 sc1
v_mfma_f32_16x16x32_bf16 v[40:43], a[4:7], a[216:219], v[40:43]
ds_read_b64_tr_b16 a[54:55], v8 offset:31744
v_mfma_f32_16x16x32_bf16 v[44:47], a[4:7], a[220:223], v[44:47]
v_mfma_f32_16x16x32_bf16 v[44:47], a[0:3], a[204:207], v[44:47]
ds_read_b64_tr_b16 a[56:57], v9 offset:13312
v_mfma_f32_16x16x32_bf16 v[48:51], a[8:11], a[192:195], v[48:51]
buffer_load_dwordx4 a[136:139], v12, s[4:7], s40 offen offset:2048 sc1
v_mfma_f32_16x16x32_bf16 v[48:51], a[12:15], a[208:211], v[48:51]
ds_read_b64_tr_b16 a[58:59], v9 offset:19456
v_mfma_f32_16x16x32_bf16 v[52:55], a[12:15], a[212:215], v[52:55]
ds_read_b64_tr_b16 a[60:61], v9 offset:25600
v_mfma_f32_16x16x32_bf16 v[52:55], a[8:11], a[196:199], v[52:55]
buffer_load_dwordx4 a[140:143], v12, s[4:7], s40 offen offset:3072 sc1
s_add_u32 s40, s40, 16384
v_mfma_f32_16x16x32_bf16 v[56:59], a[8:11], a[200:203], v[56:59]
ds_read_b64_tr_b16 a[62:63], v9 offset:31744
v_mfma_f32_16x16x32_bf16 v[56:59], a[12:15], a[216:219], v[56:59]
v_mfma_f32_16x16x32_bf16 v[60:63], a[12:15], a[220:223], v[60:63]
ds_read_b64_tr_b16 a[64:65], v6 offset:14336
v_mfma_f32_16x16x32_bf16 v[60:63], a[8:11], a[204:207], v[60:63]
buffer_load_dwordx4 a[144:147], v12, s[4:7], s40 offen offset:0 sc1
v_mfma_f32_16x16x32_bf16 v[64:67], a[16:19], a[192:195], v[64:67]
ds_read_b64_tr_b16 a[66:67], v6 offset:20480
v_mfma_f32_16x16x32_bf16 v[64:67], a[20:23], a[208:211], v[64:67]
ds_read_b64_tr_b16 a[68:69], v6 offset:26624
v_mfma_f32_16x16x32_bf16 v[68:71], a[20:23], a[212:215], v[68:71]
buffer_load_dwordx4 a[148:151], v12, s[4:7], s40 offen offset:1024 sc1
v_mfma_f32_16x16x32_bf16 v[68:71], a[16:19], a[196:199], v[68:71]
ds_read_b64_tr_b16 a[70:71], v6 offset:32768
v_mfma_f32_16x16x32_bf16 v[72:75], a[16:19], a[200:203], v[72:75]
v_mfma_f32_16x16x32_bf16 v[72:75], a[20:23], a[216:219], v[72:75]
ds_read_b64_tr_b16 a[72:73], v7 offset:14336
v_mfma_f32_16x16x32_bf16 v[76:79], a[20:23], a[220:223], v[76:79]
buffer_load_dwordx4 a[152:155], v12, s[4:7], s40 offen offset:2048 sc1
PG11:
s_cbranch_execz PG15
v_mfma_f32_16x16x32_bf16 v[76:79], a[16:19], a[204:207], v[76:79]
ds_read_b64_tr_b16 a[74:75], v7 offset:20480
v_mfma_f32_16x16x32_bf16 v[80:83], a[24:27], a[192:195], v[80:83]
ds_read_b64_tr_b16 a[76:77], v7 offset:26624
v_mfma_f32_16x16x32_bf16 v[80:83], a[28:31], a[208:211], v[80:83]
buffer_load_dwordx4 a[156:159], v12, s[4:7], s40 offen offset:3072 sc1
s_add_u32 s40, s40, 16384
v_mfma_f32_16x16x32_bf16 v[84:87], a[28:31], a[212:215], v[84:87]
ds_read_b64_tr_b16 a[78:79], v7 offset:32768
v_mfma_f32_16x16x32_bf16 v[84:87], a[24:27], a[196:199], v[84:87]
v_mfma_f32_16x16x32_bf16 v[88:91], a[24:27], a[200:203], v[88:91]
ds_read_b64_tr_b16 a[80:81], v8 offset:14336
v_mfma_f32_16x16x32_bf16 v[88:91], a[28:31], a[216:219], v[88:91]
buffer_load_dwordx4 a[160:163], v12, s[4:7], s40 offen offset:0 sc1
v_mfma_f32_16x16x32_bf16 v[92:95], a[28:31], a[220:223], v[92:95]
ds_read_b64_tr_b16 a[82:83], v8 offset:20480
v_mfma_f32_16x16x32_bf16 v[92:95], a[24:27], a[204:207], v[92:95]
ds_read_b64_tr_b16 a[84:85], v8 offset:26624
v_mfma_f32_16x16x32_bf16 v[96:99], a[32:35], a[192:195], v[96:99]
buffer_load_dwordx4 a[164:167], v12, s[4:7], s40 offen offset:1024 sc1
v_mfma_f32_16x16x32_bf16 v[96:99], a[36:39], a[208:211], v[96:99]
ds_read_b64_tr_b16 a[86:87], v8 offset:32768
v_mfma_f32_16x16x32_bf16 v[100:103], a[36:39], a[212:215], v[100:103]
v_mfma_f32_16x16x32_bf16 v[100:103], a[32:35], a[196:199], v[100:103]
ds_read_b64_tr_b16 a[88:89], v9 offset:14336
v_mfma_f32_16x16x32_bf16 v[104:107], a[32:35], a[200:203], v[104:107]
buffer_load_dwordx4 a[168:171], v12, s[4:7], s40 offen offset:2048 sc1
v_mfma_f32_16x16x32_bf16 v[104:107], a[36:39], a[216:219], v[104:107]
ds_read_b64_tr_b16 a[90:91], v9 offset:20480
v_mfma_f32_16x16x32_bf16 v[108:111], a[36:39], a[220:223], v[108:111]
ds_read_b64_tr_b16 a[92:93], v9 offset:26624
v_mfma_f32_16x16x32_bf16 v[108:111], a[32:35], a[204:207], v[108:111]
buffer_load_dwordx4 a[172:175], v12, s[4:7], s40 offen offset:3072 sc1
s_add_u32 s40, s40, 16384
v_mfma_f32_16x16x32_bf16 v[112:115], a[40:43], a[192:195], v[112:115]
ds_read_b64_tr_b16 a[94:95], v9 offset:32768
v_mfma_f32_16x16x32_bf16 v[112:115], a[44:47], a[208:211], v[112:115]
v_mfma_f32_16x16x32_bf16 v[116:119], a[44:47], a[212:215], v[116:119]
v_mfma_f32_16x16x32_bf16 v[116:119], a[40:43], a[196:199], v[116:119]
v_mfma_f32_16x16x32_bf16 v[120:123], a[40:43], a[200:203], v[120:123]
v_mfma_f32_16x16x32_bf16 v[120:123], a[44:47], a[216:219], v[120:123]
v_mfma_f32_16x16x32_bf16 v[124:127], a[44:47], a[220:223], v[124:127]
v_mfma_f32_16x16x32_bf16 v[124:127], a[40:43], a[204:207], v[124:127]
s_waitcnt vmcnt(14) lgkmcnt(0)
v_mfma_f32_16x16x32_bf16 v[128:131], a[48:51], a[192:195], v[128:131]
v_mfma_f32_16x16x32_bf16 v[128:131], a[52:55], a[208:211], v[128:131]
s_barrier
v_mfma_f32_16x16x32_bf16 v[132:135], a[52:55], a[212:215], v[132:135]
ds_read_b64_tr_b16 a[0:1], v6 offset:0
s_add_u32 m0, s42, 135168
v_mfma_f32_16x16x32_bf16 v[132:135], a[48:51], a[196:199], v[132:135]
buffer_load_dwordx4 v2, s[8:11], s41 offen offset:0 lds
v_mfma_f32_16x16x32_bf16 v[136:139], a[48:51], a[200:203], v[136:139]
ds_read_b64_tr_b16 a[2:3], v6 offset:6144
v_mfma_f32_16x16x32_bf16 v[136:139], a[52:55], a[216:219], v[136:139]
ds_read_b64_tr_b16 a[4:5], v18 offset:0
v_mfma_f32_16x16x32_bf16 v[140:143], a[52:55], a[220:223], v[140:143]
buffer_load_dwordx4 v3, s[8:11], s41 offen offset:1024 lds
v_mfma_f32_16x16x32_bf16 v[140:143], a[48:51], a[204:207], v[140:143]
v_mfma_f32_16x16x32_bf16 v[144:147], a[56:59], a[192:195], v[144:147]
ds_read_b64_tr_b16 a[6:7], v18 offset:6144
v_mfma_f32_16x16x32_bf16 v[144:147], a[60:63], a[208:211], v[144:147]
ds_read_b64_tr_b16 a[8:9], v7 offset:0
v_mfma_f32_16x16x32_bf16 v[148:151], a[60:63], a[212:215], v[148:151]
ds_read_b64_tr_b16 a[10:11], v7 offset:6144
v_mfma_f32_16x16x32_bf16 v[148:151], a[56:59], a[196:199], v[148:151]
buffer_load_dwordx4 v4, s[8:11], s41 offen offset:2048 lds
s_add_u32 s41, s41, 196608
v_mfma_f32_16x16x32_bf16 v[152:155], a[56:59], a[200:203], v[152:155]
ds_read_b64_tr_b16 a[12:13], v19 offset:0
v_mfma_f32_16x16x32_bf16 v[152:155], a[60:63], a[216:219], v[152:155]
v_mfma_f32_16x16x32_bf16 v[156:159], a[60:63], a[220:223], v[156:159]
ds_read_b64_tr_b16 a[14:15], v19 offset:6144
v_mfma_f32_16x16x32_bf16 v[156:159], a[56:59], a[204:207], v[156:159]
ds_read_b64_tr_b16 a[16:17], v8 offset:0
s_add_u32 m0, s42, 147456
v_mfma_f32_16x16x32_bf16 v[160:163], a[192:195], a[64:67], v[160:163]
buffer_load_dwordx4 v2, s[8:11], s41 offen offset:0 lds
v_mfma_f32_16x16x32_bf16 v[160:163], a[208:211], a[68:71], v[160:163]
ds_read_b64_tr_b16 a[18:19], v8 offset:6144
v_mfma_f32_16x16x32_bf16 v[164:167], a[212:215], a[68:71], v[164:167]
ds_read_b64_tr_b16 a[20:21], v20 offset:0
v_mfma_f32_16x16x32_bf16 v[164:167], a[196:199], a[64:67], v[164:167]
v_mfma_f32_16x16x32_bf16 v[168:171], a[200:203], a[64:67], v[168:171]
buffer_load_dwordx4 v3, s[8:11], s41 offen offset:1024 lds
v_mfma_f32_16x16x32_bf16 v[168:171], a[216:219], a[68:71], v[168:171]
ds_read_b64_tr_b16 a[22:23], v20 offset:6144
v_mfma_f32_16x16x32_bf16 v[172:175], a[220:223], a[68:71], v[172:175]
ds_read_b64_tr_b16 a[24:25], v9 offset:0
v_mfma_f32_16x16x32_bf16 v[172:175], a[204:207], a[64:67], v[172:175]
ds_read_b64_tr_b16 a[26:27], v9 offset:6144
v_mfma_f32_16x16x32_bf16 v[176:179], a[192:195], a[72:75], v[176:179]
v_mfma_f32_16x16x32_bf16 v[176:179], a[208:211], a[76:79], v[176:179]
buffer_load_dwordx4 v4, s[8:11], s41 offen offset:2048 lds
s_add_u32 s41, s41, 196608
v_mfma_f32_16x16x32_bf16 v[180:183], a[212:215], a[76:79], v[180:183]
ds_read_b64_tr_b16 a[28:29], v21 offset:0
v_mfma_f32_16x16x32_bf16 v[180:183], a[196:199], a[72:75], v[180:183]
ds_read_b64_tr_b16 a[30:31], v21 offset:6144
v_mfma_f32_16x16x32_bf16 v[184:187], a[200:203], a[72:75], v[184:187]
ds_read_b64_tr_b16 a[32:33], v6 offset:1024
s_add_u32 m0, s42, 98304
v_mfma_f32_16x16x32_bf16 v[184:187], a[216:219], a[76:79], v[184:187]
buffer_load_dwordx4 v2, s[8:11], s41 offen offset:0 lds
v_mfma_f32_16x16x32_bf16 v[188:191], a[220:223], a[76:79], v[188:191]
v_mfma_f32_16x16x32_bf16 v[188:191], a[204:207], a[72:75], v[188:191]
ds_read_b64_tr_b16 a[34:35], v6 offset:7168
v_mfma_f32_16x16x32_bf16 v[192:195], a[192:195], a[80:83], v[192:195]
ds_read_b64_tr_b16 a[36:37], v18 offset:1024
v_mfma_f32_16x16x32_bf16 v[192:195], a[208:211], a[84:87], v[192:195]
buffer_load_dwordx4 v3, s[8:11], s41 offen offset:1024 lds
v_mfma_f32_16x16x32_bf16 v[196:199], a[212:215], a[84:87], v[196:199]
ds_read_b64_tr_b16 a[38:39], v18 offset:7168
v_mfma_f32_16x16x32_bf16 v[196:199], a[196:199], a[80:83], v[196:199]
ds_read_b64_tr_b16 a[40:41], v7 offset:1024
v_mfma_f32_16x16x32_bf16 v[200:203], a[200:203], a[80:83], v[200:203]
v_mfma_f32_16x16x32_bf16 v[200:203], a[216:219], a[84:87], v[200:203]
ds_read_b64_tr_b16 a[42:43], v7 offset:7168
v_mfma_f32_16x16x32_bf16 v[204:207], a[220:223], a[84:87], v[204:207]
buffer_load_dwordx4 v4, s[8:11], s41 offen offset:2048 lds
s_add_u32 s41, s41, 196608
v_mfma_f32_16x16x32_bf16 v[204:207], a[204:207], a[80:83], v[204:207]
ds_read_b64_tr_b16 a[44:45], v19 offset:1024
v_mfma_f32_16x16x32_bf16 v[208:211], a[192:195], a[88:91], v[208:211]
ds_read_b64_tr_b16 a[46:47], v19 offset:7168
v_mfma_f32_16x16x32_bf16 v[208:211], a[208:211], a[92:95], v[208:211]
v_mfma_f32_16x16x32_bf16 v[212:215], a[212:215], a[92:95], v[212:215]
v_mfma_f32_16x16x32_bf16 v[212:215], a[196:199], a[88:91], v[212:215]
v_mfma_f32_16x16x32_bf16 v[216:219], a[200:203], a[88:91], v[216:219]
v_mfma_f32_16x16x32_bf16 v[216:219], a[216:219], a[92:95], v[216:219]
v_mfma_f32_16x16x32_bf16 v[220:223], a[220:223], a[92:95], v[220:223]
v_mfma_f32_16x16x32_bf16 v[220:223], a[204:207], a[88:91], v[220:223]
s_waitcnt lgkmcnt(0)
v_mfma_f32_16x16x32_bf16 v[32:35], a[0:3], a[96:99], v[32:35]
ds_read_b64_tr_b16 a[48:49], v8 offset:1024
v_mfma_f32_16x16x32_bf16 v[32:35], a[4:7], a[112:115], v[32:35]
buffer_load_dwordx4 a[176:179], v12, s[4:7], s40 offen offset:0 sc1
v_mfma_f32_16x16x32_bf16 v[36:39], a[4:7], a[116:119], v[36:39]
ds_read_b64_tr_b16 a[50:51], v8 offset:7168
v_mfma_f32_16x16x32_bf16 v[36:39], a[0:3], a[100:103], v[36:39]
ds_read_b64_tr_b16 a[52:53], v20 offset:1024
v_mfma_f32_16x16x32_bf16 v[40:43], a[0:3], a[104:107], v[40:43]
buffer_load_dwordx4 a[180:183], v12, s[4:7], s40 offen offset:1024 sc1
v_mfma_f32_16x16x32_bf16 v[40:43], a[4:7], a[120:123], v[40:43]
ds_read_b64_tr_b16 a[54:55], v20 offset:7168
v_mfma_f32_16x16x32_bf16 v[44:47], a[4:7], a[124:127], v[44:47]
v_mfma_f32_16x16x32_bf16 v[44:47], a[0:3], a[108:111], v[44:47]
ds_read_b64_tr_b16 a[56:57], v9 offset:1024
v_mfma_f32_16x16x32_bf16 v[48:51], a[8:11], a[96:99], v[48:51]
buffer_load_dwordx4 a[184:187], v12, s[4:7], s40 offen offset:2048 sc1
v_mfma_f32_16x16x32_bf16 v[48:51], a[12:15], a[112:115], v[48:51]
ds_read_b64_tr_b16 a[58:59], v9 offset:7168
v_mfma_f32_16x16x32_bf16 v[52:55], a[12:15], a[116:119], v[52:55]
ds_read_b64_tr_b16 a[60:61], v21 offset:1024
v_mfma_f32_16x16x32_bf16 v[52:55], a[8:11], a[100:103], v[52:55]
buffer_load_dwordx4 a[188:191], v12, s[4:7], s40 offen offset:3072 sc1
s_add_u32 s40, s40, 16384
v_mfma_f32_16x16x32_bf16 v[56:59], a[8:11], a[104:107], v[56:59]
ds_read_b64_tr_b16 a[62:63], v21 offset:7168
v_mfma_f32_16x16x32_bf16 v[56:59], a[12:15], a[120:123], v[56:59]
v_mfma_f32_16x16x32_bf16 v[60:63], a[12:15], a[124:127], v[60:63]
ds_read_b64_tr_b16 a[64:65], v6 offset:2048
v_mfma_f32_16x16x32_bf16 v[60:63], a[8:11], a[108:111], v[60:63]
buffer_load_dwordx4 a[192:195], v12, s[4:7], s40 offen offset:0 sc1
v_mfma_f32_16x16x32_bf16 v[64:67], a[16:19], a[96:99], v[64:67]
ds_read_b64_tr_b16 a[66:67], v6 offset:8192
v_mfma_f32_16x16x32_bf16 v[64:67], a[20:23], a[112:115], v[64:67]
ds_read_b64_tr_b16 a[68:69], v18 offset:2048
v_mfma_f32_16x16x32_bf16 v[68:71], a[20:23], a[116:119], v[68:71]
buffer_load_dwordx4 a[196:199], v12, s[4:7], s40 offen offset:1024 sc1
v_mfma_f32_16x16x32_bf16 v[68:71], a[16:19], a[100:103], v[68:71]
ds_read_b64_tr_b16 a[70:71], v18 offset:8192
v_mfma_f32_16x16x32_bf16 v[72:75], a[16:19], a[104:107], v[72:75]
v_mfma_f32_16x16x32_bf16 v[72:75], a[20:23], a[120:123], v[72:75]
ds_read_b64_tr_b16 a[72:73], v7 offset:2048
v_mfma_f32_16x16x32_bf16 v[76:79], a[20:23], a[124:127], v[76:79]
buffer_load_dwordx4 a[200:203], v12, s[4:7], s40 offen offset:2048 sc1
v_mfma_f32_16x16x32_bf16 v[76:79], a[16:19], a[108:111], v[76:79]
ds_read_b64_tr_b16 a[74:75], v7 offset:8192
v_mfma_f32_16x16x32_bf16 v[80:83], a[24:27], a[96:99], v[80:83]
ds_read_b64_tr_b16 a[76:77], v19 offset:2048
v_mfma_f32_16x16x32_bf16 v[80:83], a[28:31], a[112:115], v[80:83]
buffer_load_dwordx4 a[204:207], v12, s[4:7], s40 offen offset:3072 sc1
s_add_u32 s40, s40, 16384
v_mfma_f32_16x16x32_bf16 v[84:87], a[28:31], a[116:119], v[84:87]
ds_read_b64_tr_b16 a[78:79], v19 offset:8192
v_mfma_f32_16x16x32_bf16 v[84:87], a[24:27], a[100:103], v[84:87]
v_mfma_f32_16x16x32_bf16 v[88:91], a[24:27], a[104:107], v[88:91]
ds_read_b64_tr_b16 a[80:81], v8 offset:2048
v_mfma_f32_16x16x32_bf16 v[88:91], a[28:31], a[120:123], v[88:91]
buffer_load_dwordx4 a[208:211], v12, s[4:7], s40 offen offset:0 sc1
v_mfma_f32_16x16x32_bf16 v[92:95], a[28:31], a[124:127], v[92:95]
ds_read_b64_tr_b16 a[82:83], v8 offset:8192
v_mfma_f32_16x16x32_bf16 v[92:95], a[24:27], a[108:111], v[92:95]
ds_read_b64_tr_b16 a[84:85], v20 offset:2048
v_mfma_f32_16x16x32_bf16 v[96:99], a[32:35], a[96:99], v[96:99]
buffer_load_dwordx4 a[212:215], v12, s[4:7], s40 offen offset:1024 sc1
v_mfma_f32_16x16x32_bf16 v[96:99], a[36:39], a[112:115], v[96:99]
ds_read_b64_tr_b16 a[86:87], v20 offset:8192
v_mfma_f32_16x16x32_bf16 v[100:103], a[36:39], a[116:119], v[100:103]
v_mfma_f32_16x16x32_bf16 v[100:103], a[32:35], a[100:103], v[100:103]
ds_read_b64_tr_b16 a[88:89], v9 offset:2048
v_mfma_f32_16x16x32_bf16 v[104:107], a[32:35], a[104:107], v[104:107]
buffer_load_dwordx4 a[216:219], v12, s[4:7], s40 offen offset:2048 sc1
v_mfma_f32_16x16x32_bf16 v[104:107], a[36:39], a[120:123], v[104:107]
ds_read_b64_tr_b16 a[90:91], v9 offset:8192
v_mfma_f32_16x16x32_bf16 v[108:111], a[36:39], a[124:127], v[108:111]
ds_read_b64_tr_b16 a[92:93], v21 offset:2048
v_mfma_f32_16x16x32_bf16 v[108:111], a[32:35], a[108:111], v[108:111]
buffer_load_dwordx4 a[220:223], v12, s[4:7], s40 offen offset:3072 sc1
s_add_u32 s40, s40, 16384
v_mfma_f32_16x16x32_bf16 v[112:115], a[40:43], a[96:99], v[112:115]
ds_read_b64_tr_b16 a[94:95], v21 offset:8192
v_mfma_f32_16x16x32_bf16 v[112:115], a[44:47], a[112:115], v[112:115]
v_mfma_f32_16x16x32_bf16 v[116:119], a[44:47], a[116:119], v[116:119]
v_mfma_f32_16x16x32_bf16 v[116:119], a[40:43], a[100:103], v[116:119]
v_mfma_f32_16x16x32_bf16 v[120:123], a[40:43], a[104:107], v[120:123]
v_mfma_f32_16x16x32_bf16 v[120:123], a[44:47], a[120:123], v[120:123]
v_mfma_f32_16x16x32_bf16 v[124:127], a[44:47], a[124:127], v[124:127]
v_mfma_f32_16x16x32_bf16 v[124:127], a[40:43], a[108:111], v[124:127]
s_waitcnt vmcnt(15) lgkmcnt(0)
v_mfma_f32_16x16x32_bf16 v[128:131], a[48:51], a[96:99], v[128:131]
v_mfma_f32_16x16x32_bf16 v[128:131], a[52:55], a[112:115], v[128:131]
s_barrier
v_mfma_f32_16x16x32_bf16 v[132:135], a[52:55], a[116:119], v[132:135]
ds_read_b64_tr_b16 a[0:1], v18 offset:12288
s_add_u32 m0, s42, 110592
v_mfma_f32_16x16x32_bf16 v[132:135], a[48:51], a[100:103], v[132:135]
buffer_load_dwordx4 v2, s[8:11], s41 offen offset:0 lds
v_mfma_f32_16x16x32_bf16 v[136:139], a[48:51], a[104:107], v[136:139]
ds_read_b64_tr_b16 a[2:3], v18 offset:18432
v_mfma_f32_16x16x32_bf16 v[136:139], a[52:55], a[120:123], v[136:139]
ds_read_b64_tr_b16 a[4:5], v18 offset:24576
v_mfma_f32_16x16x32_bf16 v[140:143], a[52:55], a[124:127], v[140:143]
buffer_load_dwordx4 v3, s[8:11], s41 offen offset:1024 lds
v_mfma_f32_16x16x32_bf16 v[140:143], a[48:51], a[108:111], v[140:143]
ds_read_b64_tr_b16 a[6:7], v18 offset:30720
v_mfma_f32_16x16x32_bf16 v[144:147], a[56:59], a[96:99], v[144:147]
v_mfma_f32_16x16x32_bf16 v[144:147], a[60:63], a[112:115], v[144:147]
ds_read_b64_tr_b16 a[8:9], v19 offset:12288
v_mfma_f32_16x16x32_bf16 v[148:151], a[60:63], a[116:119], v[148:151]
buffer_load_dwordx4 v4, s[8:11], s41 offen offset:2048 lds
s_add_u32 s41, s41, 196608
v_mfma_f32_16x16x32_bf16 v[148:151], a[56:59], a[100:103], v[148:151]
ds_read_b64_tr_b16 a[10:11], v19 offset:18432
v_mfma_f32_16x16x32_bf16 v[152:155], a[56:59], a[104:107], v[152:155]
ds_read_b64_tr_b16 a[12:13], v19 offset:24576
v_mfma_f32_16x16x32_bf16 v[152:155], a[60:63], a[120:123], v[152:155]
ds_read_b64_tr_b16 a[14:15], v19 offset:30720
s_add_u32 m0, s42, 86016
v_mfma_f32_16x16x32_bf16 v[156:159], a[60:63], a[124:127], v[156:159]
buffer_load_dwordx4 v2, s[8:11], s41 offen offset:0 lds
v_mfma_f32_16x16x32_bf16 v[156:159], a[56:59], a[108:111], v[156:159]
v_mfma_f32_16x16x32_bf16 v[160:163], a[96:99], a[64:67], v[160:163]
ds_read_b64_tr_b16 a[16:17], v20 offset:12288
v_mfma_f32_16x16x32_bf16 v[160:163], a[112:115], a[68:71], v[160:163]
ds_read_b64_tr_b16 a[18:19], v20 offset:18432
v_mfma_f32_16x16x32_bf16 v[164:167], a[116:119], a[68:71], v[164:167]
buffer_load_dwordx4 v3, s[8:11], s41 offen offset:1024 lds
v_mfma_f32_16x16x32_bf16 v[164:167], a[100:103], a[64:67], v[164:167]
ds_read_b64_tr_b16 a[20:21], v20 offset:24576
v_mfma_f32_16x16x32_bf16 v[168:171], a[104:107], a[64:67], v[168:171]
ds_read_b64_tr_b16 a[22:23], v20 offset:30720
v_mfma_f32_16x16x32_bf16 v[168:171], a[120:123], a[68:71], v[168:171]
v_mfma_f32_16x16x32_bf16 v[172:175], a[124:127], a[68:71], v[172:175]
ds_read_b64_tr_b16 a[24:25], v21 offset:12288
v_mfma_f32_16x16x32_bf16 v[172:175], a[108:111], a[64:67], v[172:175]
buffer_load_dwordx4 v4, s[8:11], s41 offen offset:2048 lds
s_add_u32 s41, s41, 196608
v_mfma_f32_16x16x32_bf16 v[176:179], a[96:99], a[72:75], v[176:179]
ds_read_b64_tr_b16 a[26:27], v21 offset:18432
v_mfma_f32_16x16x32_bf16 v[176:179], a[112:115], a[76:79], v[176:179]
ds_read_b64_tr_b16 a[28:29], v21 offset:24576
s_add_u32 m0, s42, 122880
v_mfma_f32_16x16x32_bf16 v[180:183], a[116:119], a[76:79], v[180:183]
buffer_load_dwordx4 v2, s[8:11], s41 offen offset:0 lds
v_mfma_f32_16x16x32_bf16 v[180:183], a[100:103], a[72:75], v[180:183]
ds_read_b64_tr_b16 a[30:31], v21 offset:30720
v_mfma_f32_16x16x32_bf16 v[184:187], a[104:107], a[72:75], v[184:187]
v_mfma_f32_16x16x32_bf16 v[184:187], a[120:123], a[76:79], v[184:187]
ds_read_b64_tr_b16 a[32:33], v18 offset:13312
v_mfma_f32_16x16x32_bf16 v[188:191], a[124:127], a[76:79], v[188:191]
buffer_load_dwordx4 v3, s[8:11], s41 offen offset:1024 lds
v_mfma_f32_16x16x32_bf16 v[188:191], a[108:111], a[72:75], v[188:191]
ds_read_b64_tr_b16 a[34:35], v18 offset:19456
v_mfma_f32_16x16x32_bf16 v[192:195], a[96:99], a[80:83], v[192:195]
ds_read_b64_tr_b16 a[36:37], v18 offset:25600
v_mfma_f32_16x16x32_bf16 v[192:195], a[112:115], a[84:87], v[192:195]
ds_read_b64_tr_b16 a[38:39], v18 offset:31744
v_mfma_f32_16x16x32_bf16 v[196:199], a[116:119], a[84:87], v[196:199]
buffer_load_dwordx4 v4, s[8:11], s41 offen offset:2048 lds
s_add_u32 s41, s41, 196608
v_mfma_f32_16x16x32_bf16 v[196:199], a[100:103], a[80:83], v[196:199]
v_mfma_f32_16x16x32_bf16 v[200:203], a[104:107], a[80:83], v[200:203]
ds_read_b64_tr_b16 a[40:41], v19 offset:13312
v_mfma_f32_16x16x32_bf16 v[200:203], a[120:123], a[84:87], v[200:203]
ds_read_b64_tr_b16 a[42:43], v19 offset:19456
v_mfma_f32_16x16x32_bf16 v[204:207], a[124:127], a[84:87], v[204:207]
buffer_load_dword a251, v30, s[20:23], s79 offen
s_add_u32 s79, s79, 3153920
v_mfma_f32_16x16x32_bf16 v[204:207], a[108:111], a[80:83], v[204:207]
ds_read_b64_tr_b16 a[44:45], v19 offset:25600
v_mfma_f32_16x16x32_bf16 v[208:211], a[96:99], a[88:91], v[208:211]
ds_read_b64_tr_b16 a[46:47], v19 offset:31744
v_mfma_f32_16x16x32_bf16 v[208:211], a[112:115], a[92:95], v[208:211]
v_mfma_f32_16x16x32_bf16 v[212:215], a[116:119], a[92:95], v[212:215]
v_mfma_f32_16x16x32_bf16 v[212:215], a[100:103], a[88:91], v[212:215]
v_mfma_f32_16x16x32_bf16 v[216:219], a[104:107], a[88:91], v[216:219]
v_mfma_f32_16x16x32_bf16 v[216:219], a[120:123], a[92:95], v[216:219]
v_mfma_f32_16x16x32_bf16 v[220:223], a[124:127], a[92:95], v[220:223]
v_mfma_f32_16x16x32_bf16 v[220:223], a[108:111], a[88:91], v[220:223]
s_waitcnt lgkmcnt(0)
v_mfma_f32_16x16x32_bf16 v[32:35], a[0:3], a[128:131], v[32:35]
ds_read_b64_tr_b16 a[48:49], v20 offset:13312
v_mfma_f32_16x16x32_bf16 v[32:35], a[4:7], a[144:147], v[32:35]
ds_read_b64_tr_b16 a[50:51], v20 offset:19456
v_mfma_f32_16x16x32_bf16 v[36:39], a[4:7], a[148:151], v[36:39]
v_mfma_f32_16x16x32_bf16 v[36:39], a[0:3], a[132:135], v[36:39]
ds_read_b64_tr_b16 a[52:53], v20 offset:25600
v_mfma_f32_16x16x32_bf16 v[40:43], a[0:3], a[136:139], v[40:43]
v_mfma_f32_16x16x32_bf16 v[40:43], a[4:7], a[152:155], v[40:43]
ds_read_b64_tr_b16 a[54:55], v20 offset:31744
v_mfma_f32_16x16x32_bf16 v[44:47], a[4:7], a[156:159], v[44:47]
v_mfma_f32_16x16x32_bf16 v[44:47], a[0:3], a[140:143], v[44:47]
ds_read_b64_tr_b16 a[56:57], v21 offset:13312
v_mfma_f32_16x16x32_bf16 v[48:51], a[8:11], a[128:131], v[48:51]
ds_read_b64_tr_b16 a[58:59], v21 offset:19456
v_mfma_f32_16x16x32_bf16 v[48:51], a[12:15], a[144:147], v[48:51]
v_mfma_f32_16x16x32_bf16 v[52:55], a[12:15], a[148:151], v[52:55]
ds_read_b64_tr_b16 a[60:61], v21 offset:25600
v_mfma_f32_16x16x32_bf16 v[52:55], a[8:11], a[132:135], v[52:55]
v_mfma_f32_16x16x32_bf16 v[56:59], a[8:11], a[136:139], v[56:59]
ds_read_b64_tr_b16 a[62:63], v21 offset:31744
v_mfma_f32_16x16x32_bf16 v[56:59], a[12:15], a[152:155], v[56:59]
v_mfma_f32_16x16x32_bf16 v[60:63], a[12:15], a[156:159], v[60:63]
ds_read_b64_tr_b16 a[64:65], v18 offset:14336
v_mfma_f32_16x16x32_bf16 v[60:63], a[8:11], a[140:143], v[60:63]
ds_read_b64_tr_b16 a[66:67], v18 offset:20480
v_mfma_f32_16x16x32_bf16 v[64:67], a[16:19], a[128:131], v[64:67]
v_mfma_f32_16x16x32_bf16 v[64:67], a[20:23], a[144:147], v[64:67]
ds_read_b64_tr_b16 a[68:69], v18 offset:26624
v_mfma_f32_16x16x32_bf16 v[68:71], a[20:23], a[148:151], v[68:71]
v_mfma_f32_16x16x32_bf16 v[68:71], a[16:19], a[132:135], v[68:71]
ds_read_b64_tr_b16 a[70:71], v18 offset:32768
v_mfma_f32_16x16x32_bf16 v[72:75], a[16:19], a[136:139], v[72:75]
v_mfma_f32_16x16x32_bf16 v[72:75], a[20:23], a[152:155], v[72:75]
ds_read_b64_tr_b16 a[72:73], v19 offset:14336
v_mfma_f32_16x16x32_bf16 v[76:79], a[20:23], a[156:159], v[76:79]
ds_read_b64_tr_b16 a[74:75], v19 offset:20480
v_mfma_f32_16x16x32_bf16 v[76:79], a[16:19], a[140:143], v[76:79]
v_mfma_f32_16x16x32_bf16 v[80:83], a[24:27], a[128:131], v[80:83]
ds_read_b64_tr_b16 a[76:77], v19 offset:26624
v_mfma_f32_16x16x32_bf16 v[80:83], a[28:31], a[144:147], v[80:83]
v_mfma_f32_16x16x32_bf16 v[84:87], a[28:31], a[148:151], v[84:87]
ds_read_b64_tr_b16 a[78:79], v19 offset:32768
v_mfma_f32_16x16x32_bf16 v[84:87], a[24:27], a[132:135], v[84:87]
v_mfma_f32_16x16x32_bf16 v[88:91], a[24:27], a[136:139], v[88:91]
ds_read_b64_tr_b16 a[80:81], v20 offset:14336
v_mfma_f32_16x16x32_bf16 v[88:91], a[28:31], a[152:155], v[88:91]
ds_read_b64_tr_b16 a[82:83], v20 offset:20480
v_mfma_f32_16x16x32_bf16 v[92:95], a[28:31], a[156:159], v[92:95]
v_mfma_f32_16x16x32_bf16 v[92:95], a[24:27], a[140:143], v[92:95]
ds_read_b64_tr_b16 a[84:85], v20 offset:26624
v_mfma_f32_16x16x32_bf16 v[96:99], a[32:35], a[128:131], v[96:99]
v_mfma_f32_16x16x32_bf16 v[96:99], a[36:39], a[144:147], v[96:99]
ds_read_b64_tr_b16 a[86:87], v20 offset:32768
v_mfma_f32_16x16x32_bf16 v[100:103], a[36:39], a[148:151], v[100:103]
v_mfma_f32_16x16x32_bf16 v[100:103], a[32:35], a[132:135], v[100:103]
ds_read_b64_tr_b16 a[88:89], v21 offset:14336
v_mfma_f32_16x16x32_bf16 v[104:107], a[32:35], a[136:139], v[104:107]
ds_read_b64_tr_b16 a[90:91], v21 offset:20480
v_mfma_f32_16x16x32_bf16 v[104:107], a[36:39], a[152:155], v[104:107]
v_mfma_f32_16x16x32_bf16 v[108:111], a[36:39], a[156:159], v[108:111]
ds_read_b64_tr_b16 a[92:93], v21 offset:26624
v_mfma_f32_16x16x32_bf16 v[108:111], a[32:35], a[140:143], v[108:111]
v_mfma_f32_16x16x32_bf16 v[112:115], a[40:43], a[128:131], v[112:115]
ds_read_b64_tr_b16 a[94:95], v21 offset:32768
v_mfma_f32_16x16x32_bf16 v[112:115], a[44:47], a[144:147], v[112:115]
v_mfma_f32_16x16x32_bf16 v[116:119], a[44:47], a[148:151], v[116:119]
v_mfma_f32_16x16x32_bf16 v[116:119], a[40:43], a[132:135], v[116:119]
v_mfma_f32_16x16x32_bf16 v[120:123], a[40:43], a[136:139], v[120:123]
v_mfma_f32_16x16x32_bf16 v[120:123], a[44:47], a[152:155], v[120:123]
v_mfma_f32_16x16x32_bf16 v[124:127], a[44:47], a[156:159], v[124:127]
v_mfma_f32_16x16x32_bf16 v[124:127], a[40:43], a[140:143], v[124:127]
s_waitcnt vmcnt(7) lgkmcnt(0)
v_mfma_f32_16x16x32_bf16 v[128:131], a[48:51], a[128:131], v[128:131]
v_mfma_f32_16x16x32_bf16 v[128:131], a[52:55], a[144:147], v[128:131]
s_barrier
v_mfma_f32_16x16x32_bf16 v[132:135], a[52:55], a[148:151], v[132:135]
ds_read_b64_tr_b16 a[0:1], v6 offset:12288
v_mfma_f32_16x16x32_bf16 v[132:135], a[48:51], a[132:135], v[132:135]
buffer_load_dwordx4 a[252:255], v1, s[52:55], s56 offen
v_mfma_f32_16x16x32_bf16 v[136:139], a[48:51], a[136:139], v[136:139]
v_mfma_f32_16x16x32_bf16 v[136:139], a[52:55], a[152:155], v[136:139]
ds_read_b64_tr_b16 a[2:3], v6 offset:18432
v_mfma_f32_16x16x32_bf16 v[140:143], a[52:55], a[156:159], v[140:143]
ds_read_b64_tr_b16 a[4:5], v6 offset:24576
v_mfma_f32_16x16x32_bf16 v[140:143], a[48:51], a[140:143], v[140:143]
v_mfma_f32_16x16x32_bf16 v[144:147], a[56:59], a[128:131], v[144:147]
ds_read_b64_tr_b16 a[6:7], v6 offset:30720
v_mfma_f32_16x16x32_bf16 v[144:147], a[60:63], a[144:147], v[144:147]
v_mfma_f32_16x16x32_bf16 v[148:151], a[60:63], a[148:151], v[148:151]
ds_read_b64_tr_b16 a[8:9], v7 offset:12288
v_mfma_f32_16x16x32_bf16 v[148:151], a[56:59], a[132:135], v[148:151]
ds_read_b64_tr_b16 a[10:11], v7 offset:18432
v_mfma_f32_16x16x32_bf16 v[152:155], a[56:59], a[136:139], v[152:155]
v_mfma_f32_16x16x32_bf16 v[152:155], a[60:63], a[152:155], v[152:155]
ds_read_b64_tr_b16 a[12:13], v7 offset:24576
v_mfma_f32_16x16x32_bf16 v[156:159], a[60:63], a[156:159], v[156:159]
ds_read_b64_tr_b16 a[14:15], v7 offset:30720
v_mfma_f32_16x16x32_bf16 v[156:159], a[56:59], a[140:143], v[156:159]
v_mfma_f32_16x16x32_bf16 v[160:163], a[128:131], a[64:67], v[160:163]
ds_read_b64_tr_b16 a[16:17], v8 offset:12288
v_mfma_f32_16x16x32_bf16 v[160:163], a[144:147], a[68:71], v[160:163]
v_mfma_f32_16x16x32_bf16 v[164:167], a[148:151], a[68:71], v[164:167]
ds_read_b64_tr_b16 a[18:19], v8 offset:18432
v_mfma_f32_16x16x32_bf16 v[164:167], a[132:135], a[64:67], v[164:167]
ds_read_b64_tr_b16 a[20:21], v8 offset:24576
v_mfma_f32_16x16x32_bf16 v[168:171], a[136:139], a[64:67], v[168:171]
v_mfma_f32_16x16x32_bf16 v[168:171], a[152:155], a[68:71], v[168:171]
ds_read_b64_tr_b16 a[22:23], v8 offset:30720
v_mfma_f32_16x16x32_bf16 v[172:175], a[156:159], a[68:71], v[172:175]
ds_read_b64_tr_b16 a[24:25], v9 offset:12288
v_mfma_f32_16x16x32_bf16 v[172:175], a[140:143], a[64:67], v[172:175]
v_mfma_f32_16x16x32_bf16 v[176:179], a[128:131], a[72:75], v[176:179]
ds_read_b64_tr_b16 a[26:27], v9 offset:18432
v_mfma_f32_16x16x32_bf16 v[176:179], a[144:147], a[76:79], v[176:179]
v_mfma_f32_16x16x32_bf16 v[180:183], a[148:151], a[76:79], v[180:183]
ds_read_b64_tr_b16 a[28:29], v9 offset:24576
v_mfma_f32_16x16x32_bf16 v[180:183], a[132:135], a[72:75], v[180:183]
ds_read_b64_tr_b16 a[30:31], v9 offset:30720
v_mfma_f32_16x16x32_bf16 v[184:187], a[136:139], a[72:75], v[184:187]
v_mfma_f32_16x16x32_bf16 v[184:187], a[152:155], a[76:79], v[184:187]
ds_read_b64_tr_b16 a[32:33], v6 offset:13312
v_mfma_f32_16x16x32_bf16 v[188:191], a[156:159], a[76:79], v[188:191]
ds_read_b64_tr_b16 a[34:35], v6 offset:19456
v_mfma_f32_16x16x32_bf16 v[188:191], a[140:143], a[72:75], v[188:191]
v_mfma_f32_16x16x32_bf16 v[192:195], a[128:131], a[80:83], v[192:195]
ds_read_b64_tr_b16 a[36:37], v6 offset:25600
v_mfma_f32_16x16x32_bf16 v[192:195], a[144:147], a[84:87], v[192:195]
v_mfma_f32_16x16x32_bf16 v[196:199], a[148:151], a[84:87], v[196:199]
ds_read_b64_tr_b16 a[38:39], v6 offset:31744
v_mfma_f32_16x16x32_bf16 v[196:199], a[132:135], a[80:83], v[196:199]
ds_read_b64_tr_b16 a[40:41], v7 offset:13312
v_mfma_f32_16x16x32_bf16 v[200:203], a[136:139], a[80:83], v[200:203]
v_mfma_f32_16x16x32_bf16 v[200:203], a[152:155], a[84:87], v[200:203]
ds_read_b64_tr_b16 a[42:43], v7 offset:19456
v_mfma_f32_16x16x32_bf16 v[204:207], a[156:159], a[84:87], v[204:207]
ds_read_b64_tr_b16 a[44:45], v7 offset:25600
v_mfma_f32_16x16x32_bf16 v[204:207], a[140:143], a[80:83], v[204:207]
v_mfma_f32_16x16x32_bf16 v[208:211], a[128:131], a[88:91], v[208:211]
ds_read_b64_tr_b16 a[46:47], v7 offset:31744
v_mfma_f32_16x16x32_bf16 v[208:211], a[144:147], a[92:95], v[208:211]
v_mfma_f32_16x16x32_bf16 v[212:215], a[148:151], a[92:95], v[212:215]
v_mfma_f32_16x16x32_bf16 v[212:215], a[132:135], a[88:91], v[212:215]
v_mfma_f32_16x16x32_bf16 v[216:219], a[136:139], a[88:91], v[216:219]
v_mfma_f32_16x16x32_bf16 v[216:219], a[152:155], a[92:95], v[216:219]
v_mfma_f32_16x16x32_bf16 v[220:223], a[156:159], a[92:95], v[220:223]
v_mfma_f32_16x16x32_bf16 v[220:223], a[140:143], a[88:91], v[220:223]
s_waitcnt lgkmcnt(0)
v_mfma_f32_16x16x32_bf16 v[32:35], a[0:3], a[160:163], v[32:35]
ds_read_b64_tr_b16 a[48:49], v8 offset:13312
v_mfma_f32_16x16x32_bf16 v[32:35], a[4:7], a[176:179], v[32:35]
buffer_load_dwordx4 a[96:99], v12, s[4:7], s40 offen offset:0 sc1
v_mfma_f32_16x16x32_bf16 v[36:39], a[4:7], a[180:183], v[36:39]
ds_read_b64_tr_b16 a[50:51], v8 offset:19456
v_mfma_f32_16x16x32_bf16 v[36:39], a[0:3], a[164:167], v[36:39]
ds_read_b64_tr_b16 a[52:53], v8 offset:25600
v_mfma_f32_16x16x32_bf16 v[40:43], a[0:3], a[168:171], v[40:43]
buffer_load_dwordx4 a[100:103], v12, s[4:7], s40 offen offset:1024 sc1
v_mfma_f32_16x16x32_bf16 v[40:43], a[4:7], a[184:187], v[40:43]
ds_read_b64_tr_b16 a[54:55], v8 offset:31744
v_mfma_f32_16x16x32_bf16 v[44:47], a[4:7], a[188:191], v[44:47]
v_mfma_f32_16x16x32_bf16 v[44:47], a[0:3], a[172:175], v[44:47]
ds_read_b64_tr_b16 a[56:57], v9 offset:13312
v_mfma_f32_16x16x32_bf16 v[48:51], a[8:11], a[160:163], v[48:51]
buffer_load_dwordx4 a[104:107], v12, s[4:7], s40 offen offset:2048 sc1
v_mfma_f32_16x16x32_bf16 v[48:51], a[12:15], a[176:179], v[48:51]
ds_read_b64_tr_b16 a[58:59], v9 offset:19456
v_mfma_f32_16x16x32_bf16 v[52:55], a[12:15], a[180:183], v[52:55]
ds_read_b64_tr_b16 a[60:61], v9 offset:25600
v_mfma_f32_16x16x32_bf16 v[52:55], a[8:11], a[164:167], v[52:55]
buffer_load_dwordx4 a[108:111], v12, s[4:7], s40 offen offset:3072 sc1
s_add_u32 s40, s40, 16384
v_mfma_f32_16x16x32_bf16 v[56:59], a[8:11], a[168:171], v[56:59]
ds_read_b64_tr_b16 a[62:63], v9 offset:31744
v_mfma_f32_16x16x32_bf16 v[56:59], a[12:15], a[184:187], v[56:59]
v_mfma_f32_16x16x32_bf16 v[60:63], a[12:15], a[188:191], v[60:63]
ds_read_b64_tr_b16 a[64:65], v6 offset:14336
v_mfma_f32_16x16x32_bf16 v[60:63], a[8:11], a[172:175], v[60:63]
buffer_load_dwordx4 a[112:115], v12, s[4:7], s40 offen offset:0 sc1
v_mfma_f32_16x16x32_bf16 v[64:67], a[16:19], a[160:163], v[64:67]
ds_read_b64_tr_b16 a[66:67], v6 offset:20480
v_mfma_f32_16x16x32_bf16 v[64:67], a[20:23], a[176:179], v[64:67]
ds_read_b64_tr_b16 a[68:69], v6 offset:26624
v_mfma_f32_16x16x32_bf16 v[68:71], a[20:23], a[180:183], v[68:71]
buffer_load_dwordx4 a[116:119], v12, s[4:7], s40 offen offset:1024 sc1
v_mfma_f32_16x16x32_bf16 v[68:71], a[16:19], a[164:167], v[68:71]
ds_read_b64_tr_b16 a[70:71], v6 offset:32768
v_mfma_f32_16x16x32_bf16 v[72:75], a[16:19], a[168:171], v[72:75]
v_mfma_f32_16x16x32_bf16 v[72:75], a[20:23], a[184:187], v[72:75]
ds_read_b64_tr_b16 a[72:73], v7 offset:14336
v_mfma_f32_16x16x32_bf16 v[76:79], a[20:23], a[188:191], v[76:79]
buffer_load_dwordx4 a[120:123], v12, s[4:7], s40 offen offset:2048 sc1
v_mfma_f32_16x16x32_bf16 v[76:79], a[16:19], a[172:175], v[76:79]
ds_read_b64_tr_b16 a[74:75], v7 offset:20480
v_mfma_f32_16x16x32_bf16 v[80:83], a[24:27], a[160:163], v[80:83]
ds_read_b64_tr_b16 a[76:77], v7 offset:26624
v_mfma_f32_16x16x32_bf16 v[80:83], a[28:31], a[176:179], v[80:83]
buffer_load_dwordx4 a[124:127], v12, s[4:7], s40 offen offset:3072 sc1
s_add_u32 s40, s40, 16384
v_mfma_f32_16x16x32_bf16 v[84:87], a[28:31], a[180:183], v[84:87]
ds_read_b64_tr_b16 a[78:79], v7 offset:32768
v_mfma_f32_16x16x32_bf16 v[84:87], a[24:27], a[164:167], v[84:87]
v_mfma_f32_16x16x32_bf16 v[88:91], a[24:27], a[168:171], v[88:91]
ds_read_b64_tr_b16 a[80:81], v8 offset:14336
PG12:
s_cbranch_execz PG16
v_mfma_f32_16x16x32_bf16 v[88:91], a[28:31], a[184:187], v[88:91]
buffer_load_dwordx4 a[128:131], v12, s[4:7], s40 offen offset:0 sc1
v_mfma_f32_16x16x32_bf16 v[92:95], a[28:31], a[188:191], v[92:95]
ds_read_b64_tr_b16 a[82:83], v8 offset:20480
v_mfma_f32_16x16x32_bf16 v[92:95], a[24:27], a[172:175], v[92:95]
ds_read_b64_tr_b16 a[84:85], v8 offset:26624
v_mfma_f32_16x16x32_bf16 v[96:99], a[32:35], a[160:163], v[96:99]
buffer_load_dwordx4 a[132:135], v12, s[4:7], s40 offen offset:1024 sc1
v_mfma_f32_16x16x32_bf16 v[96:99], a[36:39], a[176:179], v[96:99]
ds_read_b64_tr_b16 a[86:87], v8 offset:32768
v_mfma_f32_16x16x32_bf16 v[100:103], a[36:39], a[180:183], v[100:103]
v_mfma_f32_16x16x32_bf16 v[100:103], a[32:35], a[164:167], v[100:103]
ds_read_b64_tr_b16 a[88:89], v9 offset:14336
v_mfma_f32_16x16x32_bf16 v[104:107], a[32:35], a[168:171], v[104:107]
buffer_load_dwordx4 a[136:139], v12, s[4:7], s40 offen offset:2048 sc1
v_mfma_f32_16x16x32_bf16 v[104:107], a[36:39], a[184:187], v[104:107]
ds_read_b64_tr_b16 a[90:91], v9 offset:20480
v_mfma_f32_16x16x32_bf16 v[108:111], a[36:39], a[188:191], v[108:111]
ds_read_b64_tr_b16 a[92:93], v9 offset:26624
v_mfma_f32_16x16x32_bf16 v[108:111], a[32:35], a[172:175], v[108:111]
buffer_load_dwordx4 a[140:143], v12, s[4:7], s40 offen offset:3072 sc1
s_add_u32 s40, s40, 16384
v_mfma_f32_16x16x32_bf16 v[112:115], a[40:43], a[160:163], v[112:115]
ds_read_b64_tr_b16 a[94:95], v9 offset:32768
v_mfma_f32_16x16x32_bf16 v[112:115], a[44:47], a[176:179], v[112:115]
v_mfma_f32_16x16x32_bf16 v[116:119], a[44:47], a[180:183], v[116:119]
v_mfma_f32_16x16x32_bf16 v[116:119], a[40:43], a[164:167], v[116:119]
v_mfma_f32_16x16x32_bf16 v[120:123], a[40:43], a[168:171], v[120:123]
v_mfma_f32_16x16x32_bf16 v[120:123], a[44:47], a[184:187], v[120:123]
v_mfma_f32_16x16x32_bf16 v[124:127], a[44:47], a[188:191], v[124:127]
v_mfma_f32_16x16x32_bf16 v[124:127], a[40:43], a[172:175], v[124:127]
s_waitcnt vmcnt(14) lgkmcnt(0)
v_mfma_f32_16x16x32_bf16 v[128:131], a[48:51], a[160:163], v[128:131]
v_mfma_f32_16x16x32_bf16 v[128:131], a[52:55], a[176:179], v[128:131]
s_barrier
v_mfma_f32_16x16x32_bf16 v[132:135], a[52:55], a[180:183], v[132:135]
ds_read_b64_tr_b16 a[0:1], v6 offset:0
s_add_u32 m0, s42, 135168
v_mfma_f32_16x16x32_bf16 v[132:135], a[48:51], a[164:167], v[132:135]
buffer_load_dwordx4 v2, s[8:11], s41 offen offset:0 lds
v_mfma_f32_16x16x32_bf16 v[136:139], a[48:51], a[168:171], v[136:139]
ds_read_b64_tr_b16 a[2:3], v6 offset:6144
v_mfma_f32_16x16x32_bf16 v[136:139], a[52:55], a[184:187], v[136:139]
ds_read_b64_tr_b16 a[4:5], v18 offset:0
v_mfma_f32_16x16x32_bf16 v[140:143], a[52:55], a[188:191], v[140:143]
buffer_load_dwordx4 v3, s[8:11], s41 offen offset:1024 lds
v_mfma_f32_16x16x32_bf16 v[140:143], a[48:51], a[172:175], v[140:143]
v_mfma_f32_16x16x32_bf16 v[144:147], a[56:59], a[160:163], v[144:147]
ds_read_b64_tr_b16 a[6:7], v18 offset:6144
v_mfma_f32_16x16x32_bf16 v[144:147], a[60:63], a[176:179], v[144:147]
ds_read_b64_tr_b16 a[8:9], v7 offset:0
v_mfma_f32_16x16x32_bf16 v[148:151], a[60:63], a[180:183], v[148:151]
ds_read_b64_tr_b16 a[10:11], v7 offset:6144
v_mfma_f32_16x16x32_bf16 v[148:151], a[56:59], a[164:167], v[148:151]
buffer_load_dwordx4 v4, s[8:11], s41 offen offset:2048 lds
s_add_u32 s41, s41, 196608
v_mfma_f32_16x16x32_bf16 v[152:155], a[56:59], a[168:171], v[152:155]
ds_read_b64_tr_b16 a[12:13], v19 offset:0
v_mfma_f32_16x16x32_bf16 v[152:155], a[60:63], a[184:187], v[152:155]
v_mfma_f32_16x16x32_bf16 v[156:159], a[60:63], a[188:191], v[156:159]
ds_read_b64_tr_b16 a[14:15], v19 offset:6144
v_mfma_f32_16x16x32_bf16 v[156:159], a[56:59], a[172:175], v[156:159]
ds_read_b64_tr_b16 a[16:17], v8 offset:0
s_add_u32 m0, s42, 147456
v_mfma_f32_16x16x32_bf16 v[160:163], a[160:163], a[64:67], v[160:163]
buffer_load_dwordx4 v2, s[8:11], s41 offen offset:0 lds
v_mfma_f32_16x16x32_bf16 v[160:163], a[176:179], a[68:71], v[160:163]
ds_read_b64_tr_b16 a[18:19], v8 offset:6144
v_mfma_f32_16x16x32_bf16 v[164:167], a[180:183], a[68:71], v[164:167]
ds_read_b64_tr_b16 a[20:21], v20 offset:0
v_mfma_f32_16x16x32_bf16 v[164:167], a[164:167], a[64:67], v[164:167]
v_mfma_f32_16x16x32_bf16 v[168:171], a[168:171], a[64:67], v[168:171]
buffer_load_dwordx4 v3, s[8:11], s41 offen offset:1024 lds
v_mfma_f32_16x16x32_bf16 v[168:171], a[184:187], a[68:71], v[168:171]
ds_read_b64_tr_b16 a[22:23], v20 offset:6144
v_mfma_f32_16x16x32_bf16 v[172:175], a[188:191], a[68:71], v[172:175]
ds_read_b64_tr_b16 a[24:25], v9 offset:0
v_mfma_f32_16x16x32_bf16 v[172:175], a[172:175], a[64:67], v[172:175]
ds_read_b64_tr_b16 a[26:27], v9 offset:6144
v_mfma_f32_16x16x32_bf16 v[176:179], a[160:163], a[72:75], v[176:179]
v_mfma_f32_16x16x32_bf16 v[176:179], a[176:179], a[76:79], v[176:179]
buffer_load_dwordx4 v4, s[8:11], s41 offen offset:2048 lds
s_add_u32 s41, s41, 196608
v_mfma_f32_16x16x32_bf16 v[180:183], a[180:183], a[76:79], v[180:183]
ds_read_b64_tr_b16 a[28:29], v21 offset:0
v_mfma_f32_16x16x32_bf16 v[180:183], a[164:167], a[72:75], v[180:183]
ds_read_b64_tr_b16 a[30:31], v21 offset:6144
v_mfma_f32_16x16x32_bf16 v[184:187], a[168:171], a[72:75], v[184:187]
ds_read_b64_tr_b16 a[32:33], v6 offset:1024
s_add_u32 m0, s42, 98304
v_mfma_f32_16x16x32_bf16 v[184:187], a[184:187], a[76:79], v[184:187]
buffer_load_dwordx4 v2, s[8:11], s41 offen offset:0 lds
v_mfma_f32_16x16x32_bf16 v[188:191], a[188:191], a[76:79], v[188:191]
v_mfma_f32_16x16x32_bf16 v[188:191], a[172:175], a[72:75], v[188:191]
ds_read_b64_tr_b16 a[34:35], v6 offset:7168
v_mfma_f32_16x16x32_bf16 v[192:195], a[160:163], a[80:83], v[192:195]
ds_read_b64_tr_b16 a[36:37], v18 offset:1024
v_mfma_f32_16x16x32_bf16 v[192:195], a[176:179], a[84:87], v[192:195]
buffer_load_dwordx4 v3, s[8:11], s41 offen offset:1024 lds
v_mfma_f32_16x16x32_bf16 v[196:199], a[180:183], a[84:87], v[196:199]
ds_read_b64_tr_b16 a[38:39], v18 offset:7168
v_mfma_f32_16x16x32_bf16 v[196:199], a[164:167], a[80:83], v[196:199]
ds_read_b64_tr_b16 a[40:41], v7 offset:1024
v_mfma_f32_16x16x32_bf16 v[200:203], a[168:171], a[80:83], v[200:203]
v_mfma_f32_16x16x32_bf16 v[200:203], a[184:187], a[84:87], v[200:203]
ds_read_b64_tr_b16 a[42:43], v7 offset:7168
v_mfma_f32_16x16x32_bf16 v[204:207], a[188:191], a[84:87], v[204:207]
buffer_load_dwordx4 v4, s[8:11], s41 offen offset:2048 lds
s_add_u32 s41, s41, 196608
v_mfma_f32_16x16x32_bf16 v[204:207], a[172:175], a[80:83], v[204:207]
ds_read_b64_tr_b16 a[44:45], v19 offset:1024
v_mfma_f32_16x16x32_bf16 v[208:211], a[160:163], a[88:91], v[208:211]
ds_read_b64_tr_b16 a[46:47], v19 offset:7168
v_mfma_f32_16x16x32_bf16 v[208:211], a[176:179], a[92:95], v[208:211]
v_mfma_f32_16x16x32_bf16 v[212:215], a[180:183], a[92:95], v[212:215]
v_mfma_f32_16x16x32_bf16 v[212:215], a[164:167], a[88:91], v[212:215]
v_mfma_f32_16x16x32_bf16 v[216:219], a[168:171], a[88:91], v[216:219]
v_mfma_f32_16x16x32_bf16 v[216:219], a[184:187], a[92:95], v[216:219]
v_mfma_f32_16x16x32_bf16 v[220:223], a[188:191], a[92:95], v[220:223]
v_mfma_f32_16x16x32_bf16 v[220:223], a[172:175], a[88:91], v[220:223]
s_waitcnt lgkmcnt(0)
v_mfma_f32_16x16x32_bf16 v[32:35], a[0:3], a[192:195], v[32:35]
ds_read_b64_tr_b16 a[48:49], v8 offset:1024
v_mfma_f32_16x16x32_bf16 v[32:35], a[4:7], a[208:211], v[32:35]
buffer_load_dwordx4 a[144:147], v12, s[4:7], s40 offen offset:0 sc1
v_mfma_f32_16x16x32_bf16 v[36:39], a[4:7], a[212:215], v[36:39]
ds_read_b64_tr_b16 a[50:51], v8 offset:7168
v_mfma_f32_16x16x32_bf16 v[36:39], a[0:3], a[196:199], v[36:39]
ds_read_b64_tr_b16 a[52:53], v20 offset:1024
v_mfma_f32_16x16x32_bf16 v[40:43], a[0:3], a[200:203], v[40:43]
buffer_load_dwordx4 a[148:151], v12, s[4:7], s40 offen offset:1024 sc1
v_mfma_f32_16x16x32_bf16 v[40:43], a[4:7], a[216:219], v[40:43]
ds_read_b64_tr_b16 a[54:55], v20 offset:7168
v_mfma_f32_16x16x32_bf16 v[44:47], a[4:7], a[220:223], v[44:47]
v_mfma_f32_16x16x32_bf16 v[44:47], a[0:3], a[204:207], v[44:47]
ds_read_b64_tr_b16 a[56:57], v9 offset:1024
v_mfma_f32_16x16x32_bf16 v[48:51], a[8:11], a[192:195], v[48:51]
buffer_load_dwordx4 a[152:155], v12, s[4:7], s40 offen offset:2048 sc1
v_mfma_f32_16x16x32_bf16 v[48:51], a[12:15], a[208:211], v[48:51]
ds_read_b64_tr_b16 a[58:59], v9 offset:7168
v_mfma_f32_16x16x32_bf16 v[52:55], a[12:15], a[212:215], v[52:55]
ds_read_b64_tr_b16 a[60:61], v21 offset:1024
v_mfma_f32_16x16x32_bf16 v[52:55], a[8:11], a[196:199], v[52:55]
buffer_load_dwordx4 a[156:159], v12, s[4:7], s40 offen offset:3072 sc1
s_add_u32 s40, s40, 16384
v_mfma_f32_16x16x32_bf16 v[56:59], a[8:11], a[200:203], v[56:59]
ds_read_b64_tr_b16 a[62:63], v21 offset:7168
v_mfma_f32_16x16x32_bf16 v[56:59], a[12:15], a[216:219], v[56:59]
v_mfma_f32_16x16x32_bf16 v[60:63], a[12:15], a[220:223], v[60:63]
ds_read_b64_tr_b16 a[64:65], v6 offset:2048
v_mfma_f32_16x16x32_bf16 v[60:63], a[8:11], a[204:207], v[60:63]
buffer_load_dwordx4 a[160:163], v12, s[4:7], s40 offen offset:0 sc1
v_mfma_f32_16x16x32_bf16 v[64:67], a[16:19], a[192:195], v[64:67]
ds_read_b64_tr_b16 a[66:67], v6 offset:8192
v_mfma_f32_16x16x32_bf16 v[64:67], a[20:23], a[208:211], v[64:67]
ds_read_b64_tr_b16 a[68:69], v18 offset:2048
v_mfma_f32_16x16x32_bf16 v[68:71], a[20:23], a[212:215], v[68:71]
buffer_load_dwordx4 a[164:167], v12, s[4:7], s40 offen offset:1024 sc1
v_mfma_f32_16x16x32_bf16 v[68:71], a[16:19], a[196:199], v[68:71]
ds_read_b64_tr_b16 a[70:71], v18 offset:8192
v_mfma_f32_16x16x32_bf16 v[72:75], a[16:19], a[200:203], v[72:75]
v_mfma_f32_16x16x32_bf16 v[72:75], a[20:23], a[216:219], v[72:75]
ds_read_b64_tr_b16 a[72:73], v7 offset:2048
v_mfma_f32_16x16x32_bf16 v[76:79], a[20:23], a[220:223], v[76:79]
buffer_load_dwordx4 a[168:171], v12, s[4:7], s40 offen offset:2048 sc1
v_mfma_f32_16x16x32_bf16 v[76:79], a[16:19], a[204:207], v[76:79]
ds_read_b64_tr_b16 a[74:75], v7 offset:8192
v_mfma_f32_16x16x32_bf16 v[80:83], a[24:27], a[192:195], v[80:83]
ds_read_b64_tr_b16 a[76:77], v19 offset:2048
v_mfma_f32_16x16x32_bf16 v[80:83], a[28:31], a[208:211], v[80:83]
buffer_load_dwordx4 a[172:175], v12, s[4:7], s40 offen offset:3072 sc1
s_add_u32 s40, s40, 16384
v_mfma_f32_16x16x32_bf16 v[84:87], a[28:31], a[212:215], v[84:87]
ds_read_b64_tr_b16 a[78:79], v19 offset:8192
v_mfma_f32_16x16x32_bf16 v[84:87], a[24:27], a[196:199], v[84:87]
v_mfma_f32_16x16x32_bf16 v[88:91], a[24:27], a[200:203], v[88:91]
ds_read_b64_tr_b16 a[80:81], v8 offset:2048
v_mfma_f32_16x16x32_bf16 v[88:91], a[28:31], a[216:219], v[88:91]
buffer_load_dwordx4 a[176:179], v12, s[4:7], s40 offen offset:0 sc1
v_mfma_f32_16x16x32_bf16 v[92:95], a[28:31], a[220:223], v[92:95]
ds_read_b64_tr_b16 a[82:83], v8 offset:8192
v_mfma_f32_16x16x32_bf16 v[92:95], a[24:27], a[204:207], v[92:95]
ds_read_b64_tr_b16 a[84:85], v20 offset:2048
v_mfma_f32_16x16x32_bf16 v[96:99], a[32:35], a[192:195], v[96:99]
buffer_load_dwordx4 a[180:183], v12, s[4:7], s40 offen offset:1024 sc1
v_mfma_f32_16x16x32_bf16 v[96:99], a[36:39], a[208:211], v[96:99]
ds_read_b64_tr_b16 a[86:87], v20 offset:8192
v_mfma_f32_16x16x32_bf16 v[100:103], a[36:39], a[212:215], v[100:103]
v_mfma_f32_16x16x32_bf16 v[100:103], a[32:35], a[196:199], v[100:103]
ds_read_b64_tr_b16 a[88:89], v9 offset:2048
v_mfma_f32_16x16x32_bf16 v[104:107], a[32:35], a[200:203], v[104:107]
buffer_load_dwordx4 a[184:187], v12, s[4:7], s40 offen offset:2048 sc1
v_mfma_f32_16x16x32_bf16 v[104:107], a[36:39], a[216:219], v[104:107]
ds_read_b64_tr_b16 a[90:91], v9 offset:8192
v_mfma_f32_16x16x32_bf16 v[108:111], a[36:39], a[220:223], v[108:111]
ds_read_b64_tr_b16 a[92:93], v21 offset:2048
v_mfma_f32_16x16x32_bf16 v[108:111], a[32:35], a[204:207], v[108:111]
buffer_load_dwordx4 a[188:191], v12, s[4:7], s40 offen offset:3072 sc1
s_add_u32 s40, s40, 16384
v_mfma_f32_16x16x32_bf16 v[112:115], a[40:43], a[192:195], v[112:115]
ds_read_b64_tr_b16 a[94:95], v21 offset:8192
v_mfma_f32_16x16x32_bf16 v[112:115], a[44:47], a[208:211], v[112:115]
v_mfma_f32_16x16x32_bf16 v[116:119], a[44:47], a[212:215], v[116:119]
v_mfma_f32_16x16x32_bf16 v[116:119], a[40:43], a[196:199], v[116:119]
v_mfma_f32_16x16x32_bf16 v[120:123], a[40:43], a[200:203], v[120:123]
v_mfma_f32_16x16x32_bf16 v[120:123], a[44:47], a[216:219], v[120:123]
v_mfma_f32_16x16x32_bf16 v[124:127], a[44:47], a[220:223], v[124:127]
v_mfma_f32_16x16x32_bf16 v[124:127], a[40:43], a[204:207], v[124:127]
s_waitcnt vmcnt(15) lgkmcnt(0)
v_mfma_f32_16x16x32_bf16 v[128:131], a[48:51], a[192:195], v[128:131]
v_mfma_f32_16x16x32_bf16 v[128:131], a[52:55], a[208:211], v[128:131]
s_barrier
v_mfma_f32_16x16x32_bf16 v[132:135], a[52:55], a[212:215], v[132:135]
ds_read_b64_tr_b16 a[0:1], v18 offset:12288
s_add_u32 m0, s42, 110592
v_mfma_f32_16x16x32_bf16 v[132:135], a[48:51], a[196:199], v[132:135]
buffer_load_dwordx4 v2, s[8:11], s41 offen offset:0 lds
v_mfma_f32_16x16x32_bf16 v[136:139], a[48:51], a[200:203], v[136:139]
ds_read_b64_tr_b16 a[2:3], v18 offset:18432
v_mfma_f32_16x16x32_bf16 v[136:139], a[52:55], a[216:219], v[136:139]
ds_read_b64_tr_b16 a[4:5], v18 offset:24576
v_mfma_f32_16x16x32_bf16 v[140:143], a[52:55], a[220:223], v[140:143]
buffer_load_dwordx4 v3, s[8:11], s41 offen offset:1024 lds
v_mfma_f32_16x16x32_bf16 v[140:143], a[48:51], a[204:207], v[140:143]
ds_read_b64_tr_b16 a[6:7], v18 offset:30720
v_mfma_f32_16x16x32_bf16 v[144:147], a[56:59], a[192:195], v[144:147]
v_mfma_f32_16x16x32_bf16 v[144:147], a[60:63], a[208:211], v[144:147]
ds_read_b64_tr_b16 a[8:9], v19 offset:12288
v_mfma_f32_16x16x32_bf16 v[148:151], a[60:63], a[212:215], v[148:151]
buffer_load_dwordx4 v4, s[8:11], s41 offen offset:2048 lds
s_add_u32 s41, s41, 196608
v_mfma_f32_16x16x32_bf16 v[148:151], a[56:59], a[196:199], v[148:151]
ds_read_b64_tr_b16 a[10:11], v19 offset:18432
v_mfma_f32_16x16x32_bf16 v[152:155], a[56:59], a[200:203], v[152:155]
ds_read_b64_tr_b16 a[12:13], v19 offset:24576
v_mfma_f32_16x16x32_bf16 v[152:155], a[60:63], a[216:219], v[152:155]
ds_read_b64_tr_b16 a[14:15], v19 offset:30720
s_add_u32 m0, s42, 86016
v_mfma_f32_16x16x32_bf16 v[156:159], a[60:63], a[220:223], v[156:159]
buffer_load_dwordx4 v2, s[8:11], s41 offen offset:0 lds
v_mfma_f32_16x16x32_bf16 v[156:159], a[56:59], a[204:207], v[156:159]
v_mfma_f32_16x16x32_bf16 v[160:163], a[192:195], a[64:67], v[160:163]
ds_read_b64_tr_b16 a[16:17], v20 offset:12288
v_mfma_f32_16x16x32_bf16 v[160:163], a[208:211], a[68:71], v[160:163]
ds_read_b64_tr_b16 a[18:19], v20 offset:18432
v_mfma_f32_16x16x32_bf16 v[164:167], a[212:215], a[68:71], v[164:167]
buffer_load_dwordx4 v3, s[8:11], s41 offen offset:1024 lds
v_mfma_f32_16x16x32_bf16 v[164:167], a[196:199], a[64:67], v[164:167]
ds_read_b64_tr_b16 a[20:21], v20 offset:24576
v_mfma_f32_16x16x32_bf16 v[168:171], a[200:203], a[64:67], v[168:171]
ds_read_b64_tr_b16 a[22:23], v20 offset:30720
v_mfma_f32_16x16x32_bf16 v[168:171], a[216:219], a[68:71], v[168:171]
v_mfma_f32_16x16x32_bf16 v[172:175], a[220:223], a[68:71], v[172:175]
ds_read_b64_tr_b16 a[24:25], v21 offset:12288
v_mfma_f32_16x16x32_bf16 v[172:175], a[204:207], a[64:67], v[172:175]
buffer_load_dwordx4 v4, s[8:11], s41 offen offset:2048 lds
s_add_u32 s41, s41, 196608
v_mfma_f32_16x16x32_bf16 v[176:179], a[192:195], a[72:75], v[176:179]
ds_read_b64_tr_b16 a[26:27], v21 offset:18432
v_mfma_f32_16x16x32_bf16 v[176:179], a[208:211], a[76:79], v[176:179]
ds_read_b64_tr_b16 a[28:29], v21 offset:24576
s_add_u32 m0, s42, 122880
v_mfma_f32_16x16x32_bf16 v[180:183], a[212:215], a[76:79], v[180:183]
buffer_load_dwordx4 v2, s[8:11], s41 offen offset:0 lds
v_mfma_f32_16x16x32_bf16 v[180:183], a[196:199], a[72:75], v[180:183]
ds_read_b64_tr_b16 a[30:31], v21 offset:30720
v_mfma_f32_16x16x32_bf16 v[184:187], a[200:203], a[72:75], v[184:187]
v_mfma_f32_16x16x32_bf16 v[184:187], a[216:219], a[76:79], v[184:187]
ds_read_b64_tr_b16 a[32:33], v18 offset:13312
v_mfma_f32_16x16x32_bf16 v[188:191], a[220:223], a[76:79], v[188:191]
buffer_load_dwordx4 v3, s[8:11], s41 offen offset:1024 lds
v_mfma_f32_16x16x32_bf16 v[188:191], a[204:207], a[72:75], v[188:191]
ds_read_b64_tr_b16 a[34:35], v18 offset:19456
v_mfma_f32_16x16x32_bf16 v[192:195], a[192:195], a[80:83], v[192:195]
ds_read_b64_tr_b16 a[36:37], v18 offset:25600
v_mfma_f32_16x16x32_bf16 v[192:195], a[208:211], a[84:87], v[192:195]
ds_read_b64_tr_b16 a[38:39], v18 offset:31744
v_mfma_f32_16x16x32_bf16 v[196:199], a[212:215], a[84:87], v[196:199]
buffer_load_dwordx4 v4, s[8:11], s41 offen offset:2048 lds
s_add_u32 s41, s41, 196608
v_mfma_f32_16x16x32_bf16 v[196:199], a[196:199], a[80:83], v[196:199]
v_mfma_f32_16x16x32_bf16 v[200:203], a[200:203], a[80:83], v[200:203]
ds_read_b64_tr_b16 a[40:41], v19 offset:13312
v_mfma_f32_16x16x32_bf16 v[200:203], a[216:219], a[84:87], v[200:203]
ds_read_b64_tr_b16 a[42:43], v19 offset:19456
v_mfma_f32_16x16x32_bf16 v[204:207], a[220:223], a[84:87], v[204:207]
buffer_load_dword a251, v30, s[20:23], s79 offen
s_add_u32 s79, s79, 3153920
v_mfma_f32_16x16x32_bf16 v[204:207], a[204:207], a[80:83], v[204:207]
ds_read_b64_tr_b16 a[44:45], v19 offset:25600
v_mfma_f32_16x16x32_bf16 v[208:211], a[192:195], a[88:91], v[208:211]
ds_read_b64_tr_b16 a[46:47], v19 offset:31744
v_mfma_f32_16x16x32_bf16 v[208:211], a[208:211], a[92:95], v[208:211]
v_mfma_f32_16x16x32_bf16 v[212:215], a[212:215], a[92:95], v[212:215]
v_mfma_f32_16x16x32_bf16 v[212:215], a[196:199], a[88:91], v[212:215]
v_mfma_f32_16x16x32_bf16 v[216:219], a[200:203], a[88:91], v[216:219]
v_mfma_f32_16x16x32_bf16 v[216:219], a[216:219], a[92:95], v[216:219]
v_mfma_f32_16x16x32_bf16 v[220:223], a[220:223], a[92:95], v[220:223]
v_mfma_f32_16x16x32_bf16 v[220:223], a[204:207], a[88:91], v[220:223]
s_waitcnt lgkmcnt(0)
v_mfma_f32_16x16x32_bf16 v[32:35], a[0:3], a[96:99], v[32:35]
ds_read_b64_tr_b16 a[48:49], v20 offset:13312
v_mfma_f32_16x16x32_bf16 v[32:35], a[4:7], a[112:115], v[32:35]
ds_read_b64_tr_b16 a[50:51], v20 offset:19456
v_mfma_f32_16x16x32_bf16 v[36:39], a[4:7], a[116:119], v[36:39]
v_mfma_f32_16x16x32_bf16 v[36:39], a[0:3], a[100:103], v[36:39]
ds_read_b64_tr_b16 a[52:53], v20 offset:25600
v_mfma_f32_16x16x32_bf16 v[40:43], a[0:3], a[104:107], v[40:43]
v_mfma_f32_16x16x32_bf16 v[40:43], a[4:7], a[120:123], v[40:43]
ds_read_b64_tr_b16 a[54:55], v20 offset:31744
v_mfma_f32_16x16x32_bf16 v[44:47], a[4:7], a[124:127], v[44:47]
v_mfma_f32_16x16x32_bf16 v[44:47], a[0:3], a[108:111], v[44:47]
ds_read_b64_tr_b16 a[56:57], v21 offset:13312
v_mfma_f32_16x16x32_bf16 v[48:51], a[8:11], a[96:99], v[48:51]
ds_read_b64_tr_b16 a[58:59], v21 offset:19456
v_mfma_f32_16x16x32_bf16 v[48:51], a[12:15], a[112:115], v[48:51]
v_mfma_f32_16x16x32_bf16 v[52:55], a[12:15], a[116:119], v[52:55]
ds_read_b64_tr_b16 a[60:61], v21 offset:25600
v_mfma_f32_16x16x32_bf16 v[52:55], a[8:11], a[100:103], v[52:55]
v_mfma_f32_16x16x32_bf16 v[56:59], a[8:11], a[104:107], v[56:59]
ds_read_b64_tr_b16 a[62:63], v21 offset:31744
v_mfma_f32_16x16x32_bf16 v[56:59], a[12:15], a[120:123], v[56:59]
v_mfma_f32_16x16x32_bf16 v[60:63], a[12:15], a[124:127], v[60:63]
ds_read_b64_tr_b16 a[64:65], v18 offset:14336
v_mfma_f32_16x16x32_bf16 v[60:63], a[8:11], a[108:111], v[60:63]
ds_read_b64_tr_b16 a[66:67], v18 offset:20480
v_mfma_f32_16x16x32_bf16 v[64:67], a[16:19], a[96:99], v[64:67]
v_mfma_f32_16x16x32_bf16 v[64:67], a[20:23], a[112:115], v[64:67]
ds_read_b64_tr_b16 a[68:69], v18 offset:26624
v_mfma_f32_16x16x32_bf16 v[68:71], a[20:23], a[116:119], v[68:71]
v_mfma_f32_16x16x32_bf16 v[68:71], a[16:19], a[100:103], v[68:71]
ds_read_b64_tr_b16 a[70:71], v18 offset:32768
v_mfma_f32_16x16x32_bf16 v[72:75], a[16:19], a[104:107], v[72:75]
v_mfma_f32_16x16x32_bf16 v[72:75], a[20:23], a[120:123], v[72:75]
ds_read_b64_tr_b16 a[72:73], v19 offset:14336
v_mfma_f32_16x16x32_bf16 v[76:79], a[20:23], a[124:127], v[76:79]
ds_read_b64_tr_b16 a[74:75], v19 offset:20480
v_mfma_f32_16x16x32_bf16 v[76:79], a[16:19], a[108:111], v[76:79]
v_mfma_f32_16x16x32_bf16 v[80:83], a[24:27], a[96:99], v[80:83]
ds_read_b64_tr_b16 a[76:77], v19 offset:26624
v_mfma_f32_16x16x32_bf16 v[80:83], a[28:31], a[112:115], v[80:83]
v_mfma_f32_16x16x32_bf16 v[84:87], a[28:31], a[116:119], v[84:87]
ds_read_b64_tr_b16 a[78:79], v19 offset:32768
v_mfma_f32_16x16x32_bf16 v[84:87], a[24:27], a[100:103], v[84:87]
v_mfma_f32_16x16x32_bf16 v[88:91], a[24:27], a[104:107], v[88:91]
ds_read_b64_tr_b16 a[80:81], v20 offset:14336
v_mfma_f32_16x16x32_bf16 v[88:91], a[28:31], a[120:123], v[88:91]
ds_read_b64_tr_b16 a[82:83], v20 offset:20480
v_mfma_f32_16x16x32_bf16 v[92:95], a[28:31], a[124:127], v[92:95]
v_mfma_f32_16x16x32_bf16 v[92:95], a[24:27], a[108:111], v[92:95]
ds_read_b64_tr_b16 a[84:85], v20 offset:26624
v_mfma_f32_16x16x32_bf16 v[96:99], a[32:35], a[96:99], v[96:99]
v_mfma_f32_16x16x32_bf16 v[96:99], a[36:39], a[112:115], v[96:99]
ds_read_b64_tr_b16 a[86:87], v20 offset:32768
v_mfma_f32_16x16x32_bf16 v[100:103], a[36:39], a[116:119], v[100:103]
v_mfma_f32_16x16x32_bf16 v[100:103], a[32:35], a[100:103], v[100:103]
ds_read_b64_tr_b16 a[88:89], v21 offset:14336
v_mfma_f32_16x16x32_bf16 v[104:107], a[32:35], a[104:107], v[104:107]
ds_read_b64_tr_b16 a[90:91], v21 offset:20480
v_mfma_f32_16x16x32_bf16 v[104:107], a[36:39], a[120:123], v[104:107]
v_mfma_f32_16x16x32_bf16 v[108:111], a[36:39], a[124:127], v[108:111]
ds_read_b64_tr_b16 a[92:93], v21 offset:26624
v_mfma_f32_16x16x32_bf16 v[108:111], a[32:35], a[108:111], v[108:111]
v_mfma_f32_16x16x32_bf16 v[112:115], a[40:43], a[96:99], v[112:115]
ds_read_b64_tr_b16 a[94:95], v21 offset:32768
v_mfma_f32_16x16x32_bf16 v[112:115], a[44:47], a[112:115], v[112:115]
v_mfma_f32_16x16x32_bf16 v[116:119], a[44:47], a[116:119], v[116:119]
v_mfma_f32_16x16x32_bf16 v[116:119], a[40:43], a[100:103], v[116:119]
v_mfma_f32_16x16x32_bf16 v[120:123], a[40:43], a[104:107], v[120:123]
v_mfma_f32_16x16x32_bf16 v[120:123], a[44:47], a[120:123], v[120:123]
v_mfma_f32_16x16x32_bf16 v[124:127], a[44:47], a[124:127], v[124:127]
v_mfma_f32_16x16x32_bf16 v[124:127], a[40:43], a[108:111], v[124:127]
s_waitcnt vmcnt(7) lgkmcnt(0)
v_mfma_f32_16x16x32_bf16 v[128:131], a[48:51], a[96:99], v[128:131]
v_mfma_f32_16x16x32_bf16 v[128:131], a[52:55], a[112:115], v[128:131]
s_barrier
v_mfma_f32_16x16x32_bf16 v[132:135], a[52:55], a[116:119], v[132:135]
ds_read_b64_tr_b16 a[0:1], v6 offset:12288
v_mfma_f32_16x16x32_bf16 v[132:135], a[48:51], a[100:103], v[132:135]
buffer_load_dwordx4 a[252:255], v1, s[52:55], s56 offen
v_mfma_f32_16x16x32_bf16 v[136:139], a[48:51], a[104:107], v[136:139]
v_mfma_f32_16x16x32_bf16 v[136:139], a[52:55], a[120:123], v[136:139]
ds_read_b64_tr_b16 a[2:3], v6 offset:18432
v_mfma_f32_16x16x32_bf16 v[140:143], a[52:55], a[124:127], v[140:143]
ds_read_b64_tr_b16 a[4:5], v6 offset:24576
v_mfma_f32_16x16x32_bf16 v[140:143], a[48:51], a[108:111], v[140:143]
v_mfma_f32_16x16x32_bf16 v[144:147], a[56:59], a[96:99], v[144:147]
ds_read_b64_tr_b16 a[6:7], v6 offset:30720
v_mfma_f32_16x16x32_bf16 v[144:147], a[60:63], a[112:115], v[144:147]
v_mfma_f32_16x16x32_bf16 v[148:151], a[60:63], a[116:119], v[148:151]
ds_read_b64_tr_b16 a[8:9], v7 offset:12288
v_mfma_f32_16x16x32_bf16 v[148:151], a[56:59], a[100:103], v[148:151]
ds_read_b64_tr_b16 a[10:11], v7 offset:18432
v_mfma_f32_16x16x32_bf16 v[152:155], a[56:59], a[104:107], v[152:155]
v_mfma_f32_16x16x32_bf16 v[152:155], a[60:63], a[120:123], v[152:155]
ds_read_b64_tr_b16 a[12:13], v7 offset:24576
v_mfma_f32_16x16x32_bf16 v[156:159], a[60:63], a[124:127], v[156:159]
ds_read_b64_tr_b16 a[14:15], v7 offset:30720
v_mfma_f32_16x16x32_bf16 v[156:159], a[56:59], a[108:111], v[156:159]
v_mfma_f32_16x16x32_bf16 v[160:163], a[96:99], a[64:67], v[160:163]
ds_read_b64_tr_b16 a[16:17], v8 offset:12288
v_mfma_f32_16x16x32_bf16 v[160:163], a[112:115], a[68:71], v[160:163]
v_mfma_f32_16x16x32_bf16 v[164:167], a[116:119], a[68:71], v[164:167]
ds_read_b64_tr_b16 a[18:19], v8 offset:18432
v_mfma_f32_16x16x32_bf16 v[164:167], a[100:103], a[64:67], v[164:167]
ds_read_b64_tr_b16 a[20:21], v8 offset:24576
v_mfma_f32_16x16x32_bf16 v[168:171], a[104:107], a[64:67], v[168:171]
v_mfma_f32_16x16x32_bf16 v[168:171], a[120:123], a[68:71], v[168:171]
ds_read_b64_tr_b16 a[22:23], v8 offset:30720
v_mfma_f32_16x16x32_bf16 v[172:175], a[124:127], a[68:71], v[172:175]
ds_read_b64_tr_b16 a[24:25], v9 offset:12288
v_mfma_f32_16x16x32_bf16 v[172:175], a[108:111], a[64:67], v[172:175]
v_mfma_f32_16x16x32_bf16 v[176:179], a[96:99], a[72:75], v[176:179]
ds_read_b64_tr_b16 a[26:27], v9 offset:18432
v_mfma_f32_16x16x32_bf16 v[176:179], a[112:115], a[76:79], v[176:179]
v_mfma_f32_16x16x32_bf16 v[180:183], a[116:119], a[76:79], v[180:183]
ds_read_b64_tr_b16 a[28:29], v9 offset:24576
v_mfma_f32_16x16x32_bf16 v[180:183], a[100:103], a[72:75], v[180:183]
ds_read_b64_tr_b16 a[30:31], v9 offset:30720
v_mfma_f32_16x16x32_bf16 v[184:187], a[104:107], a[72:75], v[184:187]
v_mfma_f32_16x16x32_bf16 v[184:187], a[120:123], a[76:79], v[184:187]
ds_read_b64_tr_b16 a[32:33], v6 offset:13312
v_mfma_f32_16x16x32_bf16 v[188:191], a[124:127], a[76:79], v[188:191]
ds_read_b64_tr_b16 a[34:35], v6 offset:19456
v_mfma_f32_16x16x32_bf16 v[188:191], a[108:111], a[72:75], v[188:191]
v_mfma_f32_16x16x32_bf16 v[192:195], a[96:99], a[80:83], v[192:195]
ds_read_b64_tr_b16 a[36:37], v6 offset:25600
v_mfma_f32_16x16x32_bf16 v[192:195], a[112:115], a[84:87], v[192:195]
v_mfma_f32_16x16x32_bf16 v[196:199], a[116:119], a[84:87], v[196:199]
ds_read_b64_tr_b16 a[38:39], v6 offset:31744
v_mfma_f32_16x16x32_bf16 v[196:199], a[100:103], a[80:83], v[196:199]
ds_read_b64_tr_b16 a[40:41], v7 offset:13312
v_mfma_f32_16x16x32_bf16 v[200:203], a[104:107], a[80:83], v[200:203]
v_mfma_f32_16x16x32_bf16 v[200:203], a[120:123], a[84:87], v[200:203]
ds_read_b64_tr_b16 a[42:43], v7 offset:19456
v_mfma_f32_16x16x32_bf16 v[204:207], a[124:127], a[84:87], v[204:207]
ds_read_b64_tr_b16 a[44:45], v7 offset:25600
v_mfma_f32_16x16x32_bf16 v[204:207], a[108:111], a[80:83], v[204:207]
v_mfma_f32_16x16x32_bf16 v[208:211], a[96:99], a[88:91], v[208:211]
ds_read_b64_tr_b16 a[46:47], v7 offset:31744
v_mfma_f32_16x16x32_bf16 v[208:211], a[112:115], a[92:95], v[208:211]
v_mfma_f32_16x16x32_bf16 v[212:215], a[116:119], a[92:95], v[212:215]
v_mfma_f32_16x16x32_bf16 v[212:215], a[100:103], a[88:91], v[212:215]
v_mfma_f32_16x16x32_bf16 v[216:219], a[104:107], a[88:91], v[216:219]
v_mfma_f32_16x16x32_bf16 v[216:219], a[120:123], a[92:95], v[216:219]
v_mfma_f32_16x16x32_bf16 v[220:223], a[124:127], a[92:95], v[220:223]
v_mfma_f32_16x16x32_bf16 v[220:223], a[108:111], a[88:91], v[220:223]
s_waitcnt lgkmcnt(0)
v_mfma_f32_16x16x32_bf16 v[32:35], a[0:3], a[128:131], v[32:35]
ds_read_b64_tr_b16 a[48:49], v8 offset:13312
v_mfma_f32_16x16x32_bf16 v[32:35], a[4:7], a[144:147], v[32:35]
buffer_load_dwordx4 a[192:195], v12, s[4:7], s40 offen offset:0 sc1
v_mfma_f32_16x16x32_bf16 v[36:39], a[4:7], a[148:151], v[36:39]
ds_read_b64_tr_b16 a[50:51], v8 offset:19456
v_mfma_f32_16x16x32_bf16 v[36:39], a[0:3], a[132:135], v[36:39]
ds_read_b64_tr_b16 a[52:53], v8 offset:25600
v_mfma_f32_16x16x32_bf16 v[40:43], a[0:3], a[136:139], v[40:43]
buffer_load_dwordx4 a[196:199], v12, s[4:7], s40 offen offset:1024 sc1
v_mfma_f32_16x16x32_bf16 v[40:43], a[4:7], a[152:155], v[40:43]
ds_read_b64_tr_b16 a[54:55], v8 offset:31744
v_mfma_f32_16x16x32_bf16 v[44:47], a[4:7], a[156:159], v[44:47]
v_mfma_f32_16x16x32_bf16 v[44:47], a[0:3], a[140:143], v[44:47]
ds_read_b64_tr_b16 a[56:57], v9 offset:13312
v_mfma_f32_16x16x32_bf16 v[48:51], a[8:11], a[128:131], v[48:51]
buffer_load_dwordx4 a[200:203], v12, s[4:7], s40 offen offset:2048 sc1
v_mfma_f32_16x16x32_bf16 v[48:51], a[12:15], a[144:147], v[48:51]
ds_read_b64_tr_b16 a[58:59], v9 offset:19456
v_mfma_f32_16x16x32_bf16 v[52:55], a[12:15], a[148:151], v[52:55]
ds_read_b64_tr_b16 a[60:61], v9 offset:25600
v_mfma_f32_16x16x32_bf16 v[52:55], a[8:11], a[132:135], v[52:55]
buffer_load_dwordx4 a[204:207], v12, s[4:7], s40 offen offset:3072 sc1
s_add_u32 s40, s40, 16384
v_mfma_f32_16x16x32_bf16 v[56:59], a[8:11], a[136:139], v[56:59]
ds_read_b64_tr_b16 a[62:63], v9 offset:31744
v_mfma_f32_16x16x32_bf16 v[56:59], a[12:15], a[152:155], v[56:59]
v_mfma_f32_16x16x32_bf16 v[60:63], a[12:15], a[156:159], v[60:63]
ds_read_b64_tr_b16 a[64:65], v6 offset:14336
v_mfma_f32_16x16x32_bf16 v[60:63], a[8:11], a[140:143], v[60:63]
buffer_load_dwordx4 a[208:211], v12, s[4:7], s40 offen offset:0 sc1
v_mfma_f32_16x16x32_bf16 v[64:67], a[16:19], a[128:131], v[64:67]
ds_read_b64_tr_b16 a[66:67], v6 offset:20480
v_mfma_f32_16x16x32_bf16 v[64:67], a[20:23], a[144:147], v[64:67]
ds_read_b64_tr_b16 a[68:69], v6 offset:26624
v_mfma_f32_16x16x32_bf16 v[68:71], a[20:23], a[148:151], v[68:71]
buffer_load_dwordx4 a[212:215], v12, s[4:7], s40 offen offset:1024 sc1
v_mfma_f32_16x16x32_bf16 v[68:71], a[16:19], a[132:135], v[68:71]
ds_read_b64_tr_b16 a[70:71], v6 offset:32768
v_mfma_f32_16x16x32_bf16 v[72:75], a[16:19], a[136:139], v[72:75]
v_mfma_f32_16x16x32_bf16 v[72:75], a[20:23], a[152:155], v[72:75]
ds_read_b64_tr_b16 a[72:73], v7 offset:14336
v_mfma_f32_16x16x32_bf16 v[76:79], a[20:23], a[156:159], v[76:79]
buffer_load_dwordx4 a[216:219], v12, s[4:7], s40 offen offset:2048 sc1
v_mfma_f32_16x16x32_bf16 v[76:79], a[16:19], a[140:143], v[76:79]
ds_read_b64_tr_b16 a[74:75], v7 offset:20480
v_mfma_f32_16x16x32_bf16 v[80:83], a[24:27], a[128:131], v[80:83]
ds_read_b64_tr_b16 a[76:77], v7 offset:26624
v_mfma_f32_16x16x32_bf16 v[80:83], a[28:31], a[144:147], v[80:83]
buffer_load_dwordx4 a[220:223], v12, s[4:7], s40 offen offset:3072 sc1
s_add_u32 s40, s40, 16384
v_mfma_f32_16x16x32_bf16 v[84:87], a[28:31], a[148:151], v[84:87]
ds_read_b64_tr_b16 a[78:79], v7 offset:32768
v_mfma_f32_16x16x32_bf16 v[84:87], a[24:27], a[132:135], v[84:87]
v_mfma_f32_16x16x32_bf16 v[88:91], a[24:27], a[136:139], v[88:91]
ds_read_b64_tr_b16 a[80:81], v8 offset:14336
v_mfma_f32_16x16x32_bf16 v[88:91], a[28:31], a[152:155], v[88:91]
buffer_load_dwordx4 a[96:99], v12, s[4:7], s40 offen offset:0 sc1
v_mfma_f32_16x16x32_bf16 v[92:95], a[28:31], a[156:159], v[92:95]
ds_read_b64_tr_b16 a[82:83], v8 offset:20480
v_mfma_f32_16x16x32_bf16 v[92:95], a[24:27], a[140:143], v[92:95]
ds_read_b64_tr_b16 a[84:85], v8 offset:26624
v_mfma_f32_16x16x32_bf16 v[96:99], a[32:35], a[128:131], v[96:99]
buffer_load_dwordx4 a[100:103], v12, s[4:7], s40 offen offset:1024 sc1
v_mfma_f32_16x16x32_bf16 v[96:99], a[36:39], a[144:147], v[96:99]
ds_read_b64_tr_b16 a[86:87], v8 offset:32768
v_mfma_f32_16x16x32_bf16 v[100:103], a[36:39], a[148:151], v[100:103]
v_mfma_f32_16x16x32_bf16 v[100:103], a[32:35], a[132:135], v[100:103]
PG13:
s_cbranch_execz PG17
ds_read_b64_tr_b16 a[88:89], v9 offset:14336
v_mfma_f32_16x16x32_bf16 v[104:107], a[32:35], a[136:139], v[104:107]
buffer_load_dwordx4 a[104:107], v12, s[4:7], s40 offen offset:2048 sc1
v_mfma_f32_16x16x32_bf16 v[104:107], a[36:39], a[152:155], v[104:107]
ds_read_b64_tr_b16 a[90:91], v9 offset:20480
v_mfma_f32_16x16x32_bf16 v[108:111], a[36:39], a[156:159], v[108:111]
ds_read_b64_tr_b16 a[92:93], v9 offset:26624
v_mfma_f32_16x16x32_bf16 v[108:111], a[32:35], a[140:143], v[108:111]
buffer_load_dwordx4 a[108:111], v12, s[4:7], s40 offen offset:3072 sc1
s_add_u32 s40, s40, 16384
v_mfma_f32_16x16x32_bf16 v[112:115], a[40:43], a[128:131], v[112:115]
ds_read_b64_tr_b16 a[94:95], v9 offset:32768
v_mfma_f32_16x16x32_bf16 v[112:115], a[44:47], a[144:147], v[112:115]
v_mfma_f32_16x16x32_bf16 v[116:119], a[44:47], a[148:151], v[116:119]
v_mfma_f32_16x16x32_bf16 v[116:119], a[40:43], a[132:135], v[116:119]
v_mfma_f32_16x16x32_bf16 v[120:123], a[40:43], a[136:139], v[120:123]
v_mfma_f32_16x16x32_bf16 v[120:123], a[44:47], a[152:155], v[120:123]
v_mfma_f32_16x16x32_bf16 v[124:127], a[44:47], a[156:159], v[124:127]
v_mfma_f32_16x16x32_bf16 v[124:127], a[40:43], a[140:143], v[124:127]
s_waitcnt vmcnt(14) lgkmcnt(0)
v_mfma_f32_16x16x32_bf16 v[128:131], a[48:51], a[128:131], v[128:131]
v_mfma_f32_16x16x32_bf16 v[128:131], a[52:55], a[144:147], v[128:131]
s_barrier
v_mfma_f32_16x16x32_bf16 v[132:135], a[52:55], a[148:151], v[132:135]
ds_read_b64_tr_b16 a[0:1], v6 offset:0
s_add_u32 m0, s42, 135168
v_mfma_f32_16x16x32_bf16 v[132:135], a[48:51], a[132:135], v[132:135]
buffer_load_dwordx4 v2, s[8:11], s41 offen offset:0 lds
v_mfma_f32_16x16x32_bf16 v[136:139], a[48:51], a[136:139], v[136:139]
ds_read_b64_tr_b16 a[2:3], v6 offset:6144
v_mfma_f32_16x16x32_bf16 v[136:139], a[52:55], a[152:155], v[136:139]
ds_read_b64_tr_b16 a[4:5], v18 offset:0
v_mfma_f32_16x16x32_bf16 v[140:143], a[52:55], a[156:159], v[140:143]
buffer_load_dwordx4 v3, s[8:11], s41 offen offset:1024 lds
v_mfma_f32_16x16x32_bf16 v[140:143], a[48:51], a[140:143], v[140:143]
v_mfma_f32_16x16x32_bf16 v[144:147], a[56:59], a[128:131], v[144:147]
ds_read_b64_tr_b16 a[6:7], v18 offset:6144
v_mfma_f32_16x16x32_bf16 v[144:147], a[60:63], a[144:147], v[144:147]
ds_read_b64_tr_b16 a[8:9], v7 offset:0
v_mfma_f32_16x16x32_bf16 v[148:151], a[60:63], a[148:151], v[148:151]
ds_read_b64_tr_b16 a[10:11], v7 offset:6144
v_mfma_f32_16x16x32_bf16 v[148:151], a[56:59], a[132:135], v[148:151]
buffer_load_dwordx4 v4, s[8:11], s41 offen offset:2048 lds
s_add_u32 s41, s41, 196608
v_mfma_f32_16x16x32_bf16 v[152:155], a[56:59], a[136:139], v[152:155]
ds_read_b64_tr_b16 a[12:13], v19 offset:0
v_mfma_f32_16x16x32_bf16 v[152:155], a[60:63], a[152:155], v[152:155]
v_mfma_f32_16x16x32_bf16 v[156:159], a[60:63], a[156:159], v[156:159]
ds_read_b64_tr_b16 a[14:15], v19 offset:6144
v_mfma_f32_16x16x32_bf16 v[156:159], a[56:59], a[140:143], v[156:159]
ds_read_b64_tr_b16 a[16:17], v8 offset:0
s_add_u32 m0, s42, 147456
v_mfma_f32_16x16x32_bf16 v[160:163], a[128:131], a[64:67], v[160:163]
buffer_load_dwordx4 v2, s[8:11], s41 offen offset:0 lds
v_mfma_f32_16x16x32_bf16 v[160:163], a[144:147], a[68:71], v[160:163]
ds_read_b64_tr_b16 a[18:19], v8 offset:6144
v_mfma_f32_16x16x32_bf16 v[164:167], a[148:151], a[68:71], v[164:167]
ds_read_b64_tr_b16 a[20:21], v20 offset:0
v_mfma_f32_16x16x32_bf16 v[164:167], a[132:135], a[64:67], v[164:167]
v_mfma_f32_16x16x32_bf16 v[168:171], a[136:139], a[64:67], v[168:171]
buffer_load_dwordx4 v3, s[8:11], s41 offen offset:1024 lds
v_mfma_f32_16x16x32_bf16 v[168:171], a[152:155], a[68:71], v[168:171]
ds_read_b64_tr_b16 a[22:23], v20 offset:6144
v_mfma_f32_16x16x32_bf16 v[172:175], a[156:159], a[68:71], v[172:175]
ds_read_b64_tr_b16 a[24:25], v9 offset:0
v_mfma_f32_16x16x32_bf16 v[172:175], a[140:143], a[64:67], v[172:175]
ds_read_b64_tr_b16 a[26:27], v9 offset:6144
v_mfma_f32_16x16x32_bf16 v[176:179], a[128:131], a[72:75], v[176:179]
v_mfma_f32_16x16x32_bf16 v[176:179], a[144:147], a[76:79], v[176:179]
buffer_load_dwordx4 v4, s[8:11], s41 offen offset:2048 lds
s_add_u32 s41, s41, 196608
v_mfma_f32_16x16x32_bf16 v[180:183], a[148:151], a[76:79], v[180:183]
ds_read_b64_tr_b16 a[28:29], v21 offset:0
v_mfma_f32_16x16x32_bf16 v[180:183], a[132:135], a[72:75], v[180:183]
ds_read_b64_tr_b16 a[30:31], v21 offset:6144
v_mfma_f32_16x16x32_bf16 v[184:187], a[136:139], a[72:75], v[184:187]
ds_read_b64_tr_b16 a[32:33], v6 offset:1024
s_add_u32 m0, s42, 98304
v_mfma_f32_16x16x32_bf16 v[184:187], a[152:155], a[76:79], v[184:187]
buffer_load_dwordx4 v2, s[8:11], s41 offen offset:0 lds
v_mfma_f32_16x16x32_bf16 v[188:191], a[156:159], a[76:79], v[188:191]
v_mfma_f32_16x16x32_bf16 v[188:191], a[140:143], a[72:75], v[188:191]
ds_read_b64_tr_b16 a[34:35], v6 offset:7168
v_mfma_f32_16x16x32_bf16 v[192:195], a[128:131], a[80:83], v[192:195]
ds_read_b64_tr_b16 a[36:37], v18 offset:1024
v_mfma_f32_16x16x32_bf16 v[192:195], a[144:147], a[84:87], v[192:195]
buffer_load_dwordx4 v3, s[8:11], s41 offen offset:1024 lds
v_mfma_f32_16x16x32_bf16 v[196:199], a[148:151], a[84:87], v[196:199]
ds_read_b64_tr_b16 a[38:39], v18 offset:7168
v_mfma_f32_16x16x32_bf16 v[196:199], a[132:135], a[80:83], v[196:199]
ds_read_b64_tr_b16 a[40:41], v7 offset:1024
v_mfma_f32_16x16x32_bf16 v[200:203], a[136:139], a[80:83], v[200:203]
v_mfma_f32_16x16x32_bf16 v[200:203], a[152:155], a[84:87], v[200:203]
ds_read_b64_tr_b16 a[42:43], v7 offset:7168
v_mfma_f32_16x16x32_bf16 v[204:207], a[156:159], a[84:87], v[204:207]
buffer_load_dwordx4 v4, s[8:11], s41 offen offset:2048 lds
s_add_u32 s41, s41, 196608
v_mfma_f32_16x16x32_bf16 v[204:207], a[140:143], a[80:83], v[204:207]
ds_read_b64_tr_b16 a[44:45], v19 offset:1024
v_mfma_f32_16x16x32_bf16 v[208:211], a[128:131], a[88:91], v[208:211]
ds_read_b64_tr_b16 a[46:47], v19 offset:7168
v_mfma_f32_16x16x32_bf16 v[208:211], a[144:147], a[92:95], v[208:211]
v_mfma_f32_16x16x32_bf16 v[212:215], a[148:151], a[92:95], v[212:215]
v_mfma_f32_16x16x32_bf16 v[212:215], a[132:135], a[88:91], v[212:215]
v_mfma_f32_16x16x32_bf16 v[216:219], a[136:139], a[88:91], v[216:219]
v_mfma_f32_16x16x32_bf16 v[216:219], a[152:155], a[92:95], v[216:219]
v_mfma_f32_16x16x32_bf16 v[220:223], a[156:159], a[92:95], v[220:223]
v_mfma_f32_16x16x32_bf16 v[220:223], a[140:143], a[88:91], v[220:223]
s_waitcnt lgkmcnt(0)
v_mfma_f32_16x16x32_bf16 v[32:35], a[0:3], a[160:163], v[32:35]
ds_read_b64_tr_b16 a[48:49], v8 offset:1024
v_mfma_f32_16x16x32_bf16 v[32:35], a[4:7], a[176:179], v[32:35]
buffer_load_dwordx4 a[112:115], v12, s[4:7], s40 offen offset:0 sc1
v_mfma_f32_16x16x32_bf16 v[36:39], a[4:7], a[180:183], v[36:39]
ds_read_b64_tr_b16 a[50:51], v8 offset:7168
v_mfma_f32_16x16x32_bf16 v[36:39], a[0:3], a[164:167], v[36:39]
ds_read_b64_tr_b16 a[52:53], v20 offset:1024
v_mfma_f32_16x16x32_bf16 v[40:43], a[0:3], a[168:171], v[40:43]
buffer_load_dwordx4 a[116:119], v12, s[4:7], s40 offen offset:1024 sc1
v_mfma_f32_16x16x32_bf16 v[40:43], a[4:7], a[184:187], v[40:43]
ds_read_b64_tr_b16 a[54:55], v20 offset:7168
v_mfma_f32_16x16x32_bf16 v[44:47], a[4:7], a[188:191], v[44:47]
v_mfma_f32_16x16x32_bf16 v[44:47], a[0:3], a[172:175], v[44:47]
ds_read_b64_tr_b16 a[56:57], v9 offset:1024
v_mfma_f32_16x16x32_bf16 v[48:51], a[8:11], a[160:163], v[48:51]
buffer_load_dwordx4 a[120:123], v12, s[4:7], s40 offen offset:2048 sc1
v_mfma_f32_16x16x32_bf16 v[48:51], a[12:15], a[176:179], v[48:51]
ds_read_b64_tr_b16 a[58:59], v9 offset:7168
v_mfma_f32_16x16x32_bf16 v[52:55], a[12:15], a[180:183], v[52:55]
ds_read_b64_tr_b16 a[60:61], v21 offset:1024
v_mfma_f32_16x16x32_bf16 v[52:55], a[8:11], a[164:167], v[52:55]
buffer_load_dwordx4 a[124:127], v12, s[4:7], s40 offen offset:3072 sc1
s_add_u32 s40, s40, 16384
v_mfma_f32_16x16x32_bf16 v[56:59], a[8:11], a[168:171], v[56:59]
ds_read_b64_tr_b16 a[62:63], v21 offset:7168
v_mfma_f32_16x16x32_bf16 v[56:59], a[12:15], a[184:187], v[56:59]
v_mfma_f32_16x16x32_bf16 v[60:63], a[12:15], a[188:191], v[60:63]
ds_read_b64_tr_b16 a[64:65], v6 offset:2048
v_mfma_f32_16x16x32_bf16 v[60:63], a[8:11], a[172:175], v[60:63]
buffer_load_dwordx4 a[128:131], v12, s[4:7], s40 offen offset:0 sc1
v_mfma_f32_16x16x32_bf16 v[64:67], a[16:19], a[160:163], v[64:67]
ds_read_b64_tr_b16 a[66:67], v6 offset:8192
v_mfma_f32_16x16x32_bf16 v[64:67], a[20:23], a[176:179], v[64:67]
ds_read_b64_tr_b16 a[68:69], v18 offset:2048
v_mfma_f32_16x16x32_bf16 v[68:71], a[20:23], a[180:183], v[68:71]
buffer_load_dwordx4 a[132:135], v12, s[4:7], s40 offen offset:1024 sc1
v_mfma_f32_16x16x32_bf16 v[68:71], a[16:19], a[164:167], v[68:71]
ds_read_b64_tr_b16 a[70:71], v18 offset:8192
v_mfma_f32_16x16x32_bf16 v[72:75], a[16:19], a[168:171], v[72:75]
v_mfma_f32_16x16x32_bf16 v[72:75], a[20:23], a[184:187], v[72:75]
ds_read_b64_tr_b16 a[72:73], v7 offset:2048
v_mfma_f32_16x16x32_bf16 v[76:79], a[20:23], a[188:191], v[76:79]
buffer_load_dwordx4 a[136:139], v12, s[4:7], s40 offen offset:2048 sc1
v_mfma_f32_16x16x32_bf16 v[76:79], a[16:19], a[172:175], v[76:79]
ds_read_b64_tr_b16 a[74:75], v7 offset:8192
v_mfma_f32_16x16x32_bf16 v[80:83], a[24:27], a[160:163], v[80:83]
ds_read_b64_tr_b16 a[76:77], v19 offset:2048
v_mfma_f32_16x16x32_bf16 v[80:83], a[28:31], a[176:179], v[80:83]
buffer_load_dwordx4 a[140:143], v12, s[4:7], s40 offen offset:3072 sc1
s_add_u32 s40, s40, 16384
v_mfma_f32_16x16x32_bf16 v[84:87], a[28:31], a[180:183], v[84:87]
ds_read_b64_tr_b16 a[78:79], v19 offset:8192
v_mfma_f32_16x16x32_bf16 v[84:87], a[24:27], a[164:167], v[84:87]
v_mfma_f32_16x16x32_bf16 v[88:91], a[24:27], a[168:171], v[88:91]
ds_read_b64_tr_b16 a[80:81], v8 offset:2048
v_mfma_f32_16x16x32_bf16 v[88:91], a[28:31], a[184:187], v[88:91]
buffer_load_dwordx4 a[144:147], v12, s[4:7], s40 offen offset:0 sc1
v_mfma_f32_16x16x32_bf16 v[92:95], a[28:31], a[188:191], v[92:95]
ds_read_b64_tr_b16 a[82:83], v8 offset:8192
v_mfma_f32_16x16x32_bf16 v[92:95], a[24:27], a[172:175], v[92:95]
ds_read_b64_tr_b16 a[84:85], v20 offset:2048
v_mfma_f32_16x16x32_bf16 v[96:99], a[32:35], a[160:163], v[96:99]
buffer_load_dwordx4 a[148:151], v12, s[4:7], s40 offen offset:1024 sc1
v_mfma_f32_16x16x32_bf16 v[96:99], a[36:39], a[176:179], v[96:99]
ds_read_b64_tr_b16 a[86:87], v20 offset:8192
v_mfma_f32_16x16x32_bf16 v[100:103], a[36:39], a[180:183], v[100:103]
v_mfma_f32_16x16x32_bf16 v[100:103], a[32:35], a[164:167], v[100:103]
ds_read_b64_tr_b16 a[88:89], v9 offset:2048
v_mfma_f32_16x16x32_bf16 v[104:107], a[32:35], a[168:171], v[104:107]
buffer_load_dwordx4 a[152:155], v12, s[4:7], s40 offen offset:2048 sc1
v_mfma_f32_16x16x32_bf16 v[104:107], a[36:39], a[184:187], v[104:107]
ds_read_b64_tr_b16 a[90:91], v9 offset:8192
v_mfma_f32_16x16x32_bf16 v[108:111], a[36:39], a[188:191], v[108:111]
ds_read_b64_tr_b16 a[92:93], v21 offset:2048
v_mfma_f32_16x16x32_bf16 v[108:111], a[32:35], a[172:175], v[108:111]
buffer_load_dwordx4 a[156:159], v12, s[4:7], s40 offen offset:3072 sc1
s_add_u32 s40, s40, 16384
v_mfma_f32_16x16x32_bf16 v[112:115], a[40:43], a[160:163], v[112:115]
ds_read_b64_tr_b16 a[94:95], v21 offset:8192
v_mfma_f32_16x16x32_bf16 v[112:115], a[44:47], a[176:179], v[112:115]
v_mfma_f32_16x16x32_bf16 v[116:119], a[44:47], a[180:183], v[116:119]
v_mfma_f32_16x16x32_bf16 v[116:119], a[40:43], a[164:167], v[116:119]
v_mfma_f32_16x16x32_bf16 v[120:123], a[40:43], a[168:171], v[120:123]
v_mfma_f32_16x16x32_bf16 v[120:123], a[44:47], a[184:187], v[120:123]
v_mfma_f32_16x16x32_bf16 v[124:127], a[44:47], a[188:191], v[124:127]
v_mfma_f32_16x16x32_bf16 v[124:127], a[40:43], a[172:175], v[124:127]
s_waitcnt vmcnt(15) lgkmcnt(0)
v_mfma_f32_16x16x32_bf16 v[128:131], a[48:51], a[160:163], v[128:131]
v_mfma_f32_16x16x32_bf16 v[128:131], a[52:55], a[176:179], v[128:131]
s_barrier
v_mfma_f32_16x16x32_bf16 v[132:135], a[52:55], a[180:183], v[132:135]
ds_read_b64_tr_b16 a[0:1], v18 offset:12288
s_add_u32 m0, s42, 110592
v_mfma_f32_16x16x32_bf16 v[132:135], a[48:51], a[164:167], v[132:135]
buffer_load_dwordx4 v2, s[8:11], s41 offen offset:0 lds
v_mfma_f32_16x16x32_bf16 v[136:139], a[48:51], a[168:171], v[136:139]
ds_read_b64_tr_b16 a[2:3], v18 offset:18432
v_mfma_f32_16x16x32_bf16 v[136:139], a[52:55], a[184:187], v[136:139]
ds_read_b64_tr_b16 a[4:5], v18 offset:24576
v_mfma_f32_16x16x32_bf16 v[140:143], a[52:55], a[188:191], v[140:143]
buffer_load_dwordx4 v3, s[8:11], s41 offen offset:1024 lds
v_mfma_f32_16x16x32_bf16 v[140:143], a[48:51], a[172:175], v[140:143]
v_mfma_f32_16x16x32_bf16 v[144:147], a[56:59], a[160:163], v[144:147]
ds_read_b64_tr_b16 a[6:7], v18 offset:30720
v_mfma_f32_16x16x32_bf16 v[144:147], a[60:63], a[176:179], v[144:147]
ds_read_b64_tr_b16 a[8:9], v19 offset:12288
v_mfma_f32_16x16x32_bf16 v[148:151], a[60:63], a[180:183], v[148:151]
ds_read_b64_tr_b16 a[10:11], v19 offset:18432
v_mfma_f32_16x16x32_bf16 v[148:151], a[56:59], a[164:167], v[148:151]
buffer_load_dwordx4 v4, s[8:11], s41 offen offset:2048 lds
s_add_u32 s41, s41, 196608
v_mfma_f32_16x16x32_bf16 v[152:155], a[56:59], a[168:171], v[152:155]
ds_read_b64_tr_b16 a[12:13], v19 offset:24576
v_mfma_f32_16x16x32_bf16 v[152:155], a[60:63], a[184:187], v[152:155]
v_mfma_f32_16x16x32_bf16 v[156:159], a[60:63], a[188:191], v[156:159]
ds_read_b64_tr_b16 a[14:15], v19 offset:30720
v_mfma_f32_16x16x32_bf16 v[156:159], a[56:59], a[172:175], v[156:159]
ds_read_b64_tr_b16 a[16:17], v20 offset:12288
s_add_u32 m0, s42, 86016
v_mfma_f32_16x16x32_bf16 v[160:163], a[160:163], a[64:67], v[160:163]
buffer_load_dwordx4 v2, s[8:11], s41 offen offset:0 lds
v_mfma_f32_16x16x32_bf16 v[160:163], a[176:179], a[68:71], v[160:163]
ds_read_b64_tr_b16 a[18:19], v20 offset:18432
v_mfma_f32_16x16x32_bf16 v[164:167], a[180:183], a[68:71], v[164:167]
ds_read_b64_tr_b16 a[20:21], v20 offset:24576
v_mfma_f32_16x16x32_bf16 v[164:167], a[164:167], a[64:67], v[164:167]
v_mfma_f32_16x16x32_bf16 v[168:171], a[168:171], a[64:67], v[168:171]
buffer_load_dwordx4 v3, s[8:11], s41 offen offset:1024 lds
v_mfma_f32_16x16x32_bf16 v[168:171], a[184:187], a[68:71], v[168:171]
ds_read_b64_tr_b16 a[22:23], v20 offset:30720
v_mfma_f32_16x16x32_bf16 v[172:175], a[188:191], a[68:71], v[172:175]
ds_read_b64_tr_b16 a[24:25], v21 offset:12288
v_mfma_f32_16x16x32_bf16 v[172:175], a[172:175], a[64:67], v[172:175]
ds_read_b64_tr_b16 a[26:27], v21 offset:18432
v_mfma_f32_16x16x32_bf16 v[176:179], a[160:163], a[72:75], v[176:179]
v_mfma_f32_16x16x32_bf16 v[176:179], a[176:179], a[76:79], v[176:179]
buffer_load_dwordx4 v4, s[8:11], s41 offen offset:2048 lds
s_add_u32 s41, s41, 196608
v_mfma_f32_16x16x32_bf16 v[180:183], a[180:183], a[76:79], v[180:183]
ds_read_b64_tr_b16 a[28:29], v21 offset:24576
v_mfma_f32_16x16x32_bf16 v[180:183], a[164:167], a[72:75], v[180:183]
ds_read_b64_tr_b16 a[30:31], v21 offset:30720
v_mfma_f32_16x16x32_bf16 v[184:187], a[168:171], a[72:75], v[184:187]
ds_read_b64_tr_b16 a[32:33], v18 offset:13312
s_add_u32 m0, s42, 122880
v_mfma_f32_16x16x32_bf16 v[184:187], a[184:187], a[76:79], v[184:187]
buffer_load_dwordx4 v2, s[8:11], s41 offen offset:0 lds
v_mfma_f32_16x16x32_bf16 v[188:191], a[188:191], a[76:79], v[188:191]
v_mfma_f32_16x16x32_bf16 v[188:191], a[172:175], a[72:75], v[188:191]
ds_read_b64_tr_b16 a[34:35], v18 offset:19456
v_mfma_f32_16x16x32_bf16 v[192:195], a[160:163], a[80:83], v[192:195]
ds_read_b64_tr_b16 a[36:37], v18 offset:25600
v_mfma_f32_16x16x32_bf16 v[192:195], a[176:179], a[84:87], v[192:195]
buffer_load_dwordx4 v3, s[8:11], s41 offen offset:1024 lds
v_mfma_f32_16x16x32_bf16 v[196:199], a[180:183], a[84:87], v[196:199]
ds_read_b64_tr_b16 a[38:39], v18 offset:31744
v_mfma_f32_16x16x32_bf16 v[196:199], a[164:167], a[80:83], v[196:199]
ds_read_b64_tr_b16 a[40:41], v19 offset:13312
v_mfma_f32_16x16x32_bf16 v[200:203], a[168:171], a[80:83], v[200:203]
v_mfma_f32_16x16x32_bf16 v[200:203], a[184:187], a[84:87], v[200:203]
ds_read_b64_tr_b16 a[42:43], v19 offset:19456
v_mfma_f32_16x16x32_bf16 v[204:207], a[188:191], a[84:87], v[204:207]
buffer_load_dwordx4 v4, s[8:11], s41 offen offset:2048 lds
s_add_u32 s41, s41, 196608
v_mfma_f32_16x16x32_bf16 v[204:207], a[172:175], a[80:83], v[204:207]
ds_read_b64_tr_b16 a[44:45], v19 offset:25600
v_mfma_f32_16x16x32_bf16 v[208:211], a[160:163], a[88:91], v[208:211]
ds_read_b64_tr_b16 a[46:47], v19 offset:31744
v_mfma_f32_16x16x32_bf16 v[208:211], a[176:179], a[92:95], v[208:211]
v_mfma_f32_16x16x32_bf16 v[212:215], a[180:183], a[92:95], v[212:215]
v_mfma_f32_16x16x32_bf16 v[212:215], a[164:167], a[88:91], v[212:215]
v_mfma_f32_16x16x32_bf16 v[216:219], a[168:171], a[88:91], v[216:219]
v_mfma_f32_16x16x32_bf16 v[216:219], a[184:187], a[92:95], v[216:219]
v_mfma_f32_16x16x32_bf16 v[220:223], a[188:191], a[92:95], v[220:223]
v_mfma_f32_16x16x32_bf16 v[220:223], a[172:175], a[88:91], v[220:223]
s_waitcnt lgkmcnt(0)
v_mfma_f32_16x16x32_bf16 v[32:35], a[0:3], a[192:195], v[32:35]
ds_read_b64_tr_b16 a[48:49], v20 offset:13312
v_mfma_f32_16x16x32_bf16 v[32:35], a[4:7], a[208:211], v[32:35]
buffer_load_dwordx4 a[160:163], v12, s[4:7], s40 offen offset:0 sc1
v_mfma_f32_16x16x32_bf16 v[36:39], a[4:7], a[212:215], v[36:39]
ds_read_b64_tr_b16 a[50:51], v20 offset:19456
v_mfma_f32_16x16x32_bf16 v[36:39], a[0:3], a[196:199], v[36:39]
ds_read_b64_tr_b16 a[52:53], v20 offset:25600
v_mfma_f32_16x16x32_bf16 v[40:43], a[0:3], a[200:203], v[40:43]
v_mfma_f32_16x16x32_bf16 v[40:43], a[4:7], a[216:219], v[40:43]
ds_read_b64_tr_b16 a[54:55], v20 offset:31744
v_mfma_f32_16x16x32_bf16 v[44:47], a[4:7], a[220:223], v[44:47]
buffer_load_dwordx4 a[164:167], v12, s[4:7], s40 offen offset:1024 sc1
v_mfma_f32_16x16x32_bf16 v[44:47], a[0:3], a[204:207], v[44:47]
ds_read_b64_tr_b16 a[56:57], v21 offset:13312
v_mfma_f32_16x16x32_bf16 v[48:51], a[8:11], a[192:195], v[48:51]
v_mfma_f32_16x16x32_bf16 v[48:51], a[12:15], a[208:211], v[48:51]
ds_read_b64_tr_b16 a[58:59], v21 offset:19456
v_mfma_f32_16x16x32_bf16 v[52:55], a[12:15], a[212:215], v[52:55]
ds_read_b64_tr_b16 a[60:61], v21 offset:25600
v_mfma_f32_16x16x32_bf16 v[52:55], a[8:11], a[196:199], v[52:55]
buffer_load_dwordx4 a[168:171], v12, s[4:7], s40 offen offset:2048 sc1
v_mfma_f32_16x16x32_bf16 v[56:59], a[8:11], a[200:203], v[56:59]
v_mfma_f32_16x16x32_bf16 v[56:59], a[12:15], a[216:219], v[56:59]
ds_read_b64_tr_b16 a[62:63], v21 offset:31744
v_mfma_f32_16x16x32_bf16 v[60:63], a[12:15], a[220:223], v[60:63]
ds_read_b64_tr_b16 a[64:65], v18 offset:14336
v_mfma_f32_16x16x32_bf16 v[60:63], a[8:11], a[204:207], v[60:63]
ds_read_b64_tr_b16 a[66:67], v18 offset:20480
v_mfma_f32_16x16x32_bf16 v[64:67], a[16:19], a[192:195], v[64:67]
v_mfma_f32_16x16x32_bf16 v[64:67], a[20:23], a[208:211], v[64:67]
buffer_load_dwordx4 a[172:175], v12, s[4:7], s40 offen offset:3072 sc1
s_add_u32 s40, s40, 16384
v_mfma_f32_16x16x32_bf16 v[68:71], a[20:23], a[212:215], v[68:71]
ds_read_b64_tr_b16 a[68:69], v18 offset:26624
v_mfma_f32_16x16x32_bf16 v[68:71], a[16:19], a[196:199], v[68:71]
ds_read_b64_tr_b16 a[70:71], v18 offset:32768
v_mfma_f32_16x16x32_bf16 v[72:75], a[16:19], a[200:203], v[72:75]
v_mfma_f32_16x16x32_bf16 v[72:75], a[20:23], a[216:219], v[72:75]
ds_read_b64_tr_b16 a[72:73], v19 offset:14336
v_mfma_f32_16x16x32_bf16 v[76:79], a[20:23], a[220:223], v[76:79]
buffer_load_dwordx4 a[176:179], v12, s[4:7], s40 offen offset:0 sc1
v_mfma_f32_16x16x32_bf16 v[76:79], a[16:19], a[204:207], v[76:79]
ds_read_b64_tr_b16 a[74:75], v19 offset:20480
v_mfma_f32_16x16x32_bf16 v[80:83], a[24:27], a[192:195], v[80:83]
ds_read_b64_tr_b16 a[76:77], v19 offset:26624
v_mfma_f32_16x16x32_bf16 v[80:83], a[28:31], a[208:211], v[80:83]
v_mfma_f32_16x16x32_bf16 v[84:87], a[28:31], a[212:215], v[84:87]
ds_read_b64_tr_b16 a[78:79], v19 offset:32768
v_mfma_f32_16x16x32_bf16 v[84:87], a[24:27], a[196:199], v[84:87]
buffer_load_dwordx4 a[180:183], v12, s[4:7], s40 offen offset:1024 sc1
v_mfma_f32_16x16x32_bf16 v[88:91], a[24:27], a[200:203], v[88:91]
ds_read_b64_tr_b16 a[80:81], v20 offset:14336
v_mfma_f32_16x16x32_bf16 v[88:91], a[28:31], a[216:219], v[88:91]
v_mfma_f32_16x16x32_bf16 v[92:95], a[28:31], a[220:223], v[92:95]
ds_read_b64_tr_b16 a[82:83], v20 offset:20480
v_mfma_f32_16x16x32_bf16 v[92:95], a[24:27], a[204:207], v[92:95]
ds_read_b64_tr_b16 a[84:85], v20 offset:26624
v_mfma_f32_16x16x32_bf16 v[96:99], a[32:35], a[192:195], v[96:99]
buffer_load_dwordx4 a[184:187], v12, s[4:7], s40 offen offset:2048 sc1
v_mfma_f32_16x16x32_bf16 v[96:99], a[36:39], a[208:211], v[96:99]
v_mfma_f32_16x16x32_bf16 v[100:103], a[36:39], a[212:215], v[100:103]
ds_read_b64_tr_b16 a[86:87], v20 offset:32768
v_mfma_f32_16x16x32_bf16 v[100:103], a[32:35], a[196:199], v[100:103]
ds_read_b64_tr_b16 a[88:89], v21 offset:14336
v_mfma_f32_16x16x32_bf16 v[104:107], a[32:35], a[200:203], v[104:107]
ds_read_b64_tr_b16 a[90:91], v21 offset:20480
v_mfma_f32_16x16x32_bf16 v[104:107], a[36:39], a[216:219], v[104:107]
v_mfma_f32_16x16x32_bf16 v[108:111], a[36:39], a[220:223], v[108:111]
buffer_load_dwordx4 a[188:191], v12, s[4:7], s40 offen offset:3072 sc1
s_add_u32 s40, s40, 16384
v_mfma_f32_16x16x32_bf16 v[108:111], a[32:35], a[204:207], v[108:111]
ds_read_b64_tr_b16 a[92:93], v21 offset:26624
v_mfma_f32_16x16x32_bf16 v[112:115], a[40:43], a[192:195], v[112:115]
ds_read_b64_tr_b16 a[94:95], v21 offset:32768
v_mfma_f32_16x16x32_bf16 v[112:115], a[44:47], a[208:211], v[112:115]
v_mfma_f32_16x16x32_bf16 v[116:119], a[44:47], a[212:215], v[116:119]
v_mfma_f32_16x16x32_bf16 v[116:119], a[40:43], a[196:199], v[116:119]
v_mfma_f32_16x16x32_bf16 v[120:123], a[40:43], a[200:203], v[120:123]
v_mfma_f32_16x16x32_bf16 v[120:123], a[44:47], a[216:219], v[120:123]
v_mfma_f32_16x16x32_bf16 v[124:127], a[44:47], a[220:223], v[124:127]
v_mfma_f32_16x16x32_bf16 v[124:127], a[40:43], a[204:207], v[124:127]
s_waitcnt vmcnt(14) lgkmcnt(0)
v_mfma_f32_16x16x32_bf16 v[128:131], a[48:51], a[192:195], v[128:131]
v_mfma_f32_16x16x32_bf16 v[128:131], a[52:55], a[208:211], v[128:131]
s_barrier
v_mfma_f32_16x16x32_bf16 v[132:135], a[52:55], a[212:215], v[132:135]
ds_read_b64_tr_b16 a[0:1], v6 offset:12288
s_add_u32 m0, s42, 135168
v_mfma_f32_16x16x32_bf16 v[132:135], a[48:51], a[196:199], v[132:135]
buffer_load_dwordx4 v2, s[8:11], s41 offen offset:0 lds
v_mfma_f32_16x16x32_bf16 v[136:139], a[48:51], a[200:203], v[136:139]
ds_read_b64_tr_b16 a[2:3], v6 offset:18432
v_mfma_f32_16x16x32_bf16 v[136:139], a[52:55], a[216:219], v[136:139]
ds_read_b64_tr_b16 a[4:5], v6 offset:24576
v_mfma_f32_16x16x32_bf16 v[140:143], a[52:55], a[220:223], v[140:143]
v_mfma_f32_16x16x32_bf16 v[140:143], a[48:51], a[204:207], v[140:143]
ds_read_b64_tr_b16 a[6:7], v6 offset:30720
v_mfma_f32_16x16x32_bf16 v[144:147], a[56:59], a[192:195], v[144:147]
buffer_load_dwordx4 v3, s[8:11], s41 offen offset:1024 lds
v_mfma_f32_16x16x32_bf16 v[144:147], a[60:63], a[208:211], v[144:147]
ds_read_b64_tr_b16 a[8:9], v7 offset:12288
v_mfma_f32_16x16x32_bf16 v[148:151], a[60:63], a[212:215], v[148:151]
v_mfma_f32_16x16x32_bf16 v[148:151], a[56:59], a[196:199], v[148:151]
ds_read_b64_tr_b16 a[10:11], v7 offset:18432
v_mfma_f32_16x16x32_bf16 v[152:155], a[56:59], a[200:203], v[152:155]
ds_read_b64_tr_b16 a[12:13], v7 offset:24576
v_mfma_f32_16x16x32_bf16 v[152:155], a[60:63], a[216:219], v[152:155]
buffer_load_dwordx4 v4, s[8:11], s41 offen offset:2048 lds
s_add_u32 s41, s41, 196608
v_mfma_f32_16x16x32_bf16 v[156:159], a[60:63], a[220:223], v[156:159]
ds_read_b64_tr_b16 a[14:15], v7 offset:30720
v_mfma_f32_16x16x32_bf16 v[156:159], a[56:59], a[204:207], v[156:159]
v_mfma_f32_16x16x32_bf16 v[160:163], a[192:195], a[64:67], v[160:163]
ds_read_b64_tr_b16 a[16:17], v8 offset:12288
v_mfma_f32_16x16x32_bf16 v[160:163], a[208:211], a[68:71], v[160:163]
ds_read_b64_tr_b16 a[18:19], v8 offset:18432
v_mfma_f32_16x16x32_bf16 v[164:167], a[212:215], a[68:71], v[164:167]
ds_read_b64_tr_b16 a[20:21], v8 offset:24576
v_mfma_f32_16x16x32_bf16 v[164:167], a[196:199], a[64:67], v[164:167]
s_add_u32 m0, s42, 147456
v_mfma_f32_16x16x32_bf16 v[168:171], a[200:203], a[64:67], v[168:171]
buffer_load_dwordx4 v2, s[8:11], s41 offen offset:0 lds
v_mfma_f32_16x16x32_bf16 v[168:171], a[216:219], a[68:71], v[168:171]
ds_read_b64_tr_b16 a[22:23], v8 offset:30720
v_mfma_f32_16x16x32_bf16 v[172:175], a[220:223], a[68:71], v[172:175]
ds_read_b64_tr_b16 a[24:25], v9 offset:12288
v_mfma_f32_16x16x32_bf16 v[172:175], a[204:207], a[64:67], v[172:175]
ds_read_b64_tr_b16 a[26:27], v9 offset:18432
v_mfma_f32_16x16x32_bf16 v[176:179], a[192:195], a[72:75], v[176:179]
v_mfma_f32_16x16x32_bf16 v[176:179], a[208:211], a[76:79], v[176:179]
buffer_load_dwordx4 v3, s[8:11], s41 offen offset:1024 lds
v_mfma_f32_16x16x32_bf16 v[180:183], a[212:215], a[76:79], v[180:183]
ds_read_b64_tr_b16 a[28:29], v9 offset:24576
v_mfma_f32_16x16x32_bf16 v[180:183], a[196:199], a[72:75], v[180:183]
ds_read_b64_tr_b16 a[30:31], v9 offset:30720
v_mfma_f32_16x16x32_bf16 v[184:187], a[200:203], a[72:75], v[184:187]
v_mfma_f32_16x16x32_bf16 v[184:187], a[216:219], a[76:79], v[184:187]
ds_read_b64_tr_b16 a[32:33], v6 offset:13312
v_mfma_f32_16x16x32_bf16 v[188:191], a[220:223], a[76:79], v[188:191]
ds_read_b64_tr_b16 a[34:35], v6 offset:19456
v_mfma_f32_16x16x32_bf16 v[188:191], a[204:207], a[72:75], v[188:191]
buffer_load_dwordx4 v4, s[8:11], s41 offen offset:2048 lds
s_add_u32 s41, s41, 196608
v_mfma_f32_16x16x32_bf16 v[192:195], a[192:195], a[80:83], v[192:195]
ds_read_b64_tr_b16 a[36:37], v6 offset:25600
v_mfma_f32_16x16x32_bf16 v[192:195], a[208:211], a[84:87], v[192:195]
v_mfma_f32_16x16x32_bf16 v[196:199], a[212:215], a[84:87], v[196:199]
ds_read_b64_tr_b16 a[38:39], v6 offset:31744
v_mfma_f32_16x16x32_bf16 v[196:199], a[196:199], a[80:83], v[196:199]
ds_read_b64_tr_b16 a[40:41], v7 offset:13312
v_mfma_f32_16x16x32_bf16 v[200:203], a[200:203], a[80:83], v[200:203]
buffer_load_dwordx4 a[252:255], v1, s[52:55], s56 offen
v_mfma_f32_16x16x32_bf16 v[200:203], a[216:219], a[84:87], v[200:203]
v_mfma_f32_16x16x32_bf16 v[204:207], a[220:223], a[84:87], v[204:207]
ds_read_b64_tr_b16 a[42:43], v7 offset:19456
v_mfma_f32_16x16x32_bf16 v[204:207], a[204:207], a[80:83], v[204:207]
ds_read_b64_tr_b16 a[44:45], v7 offset:25600
v_mfma_f32_16x16x32_bf16 v[208:211], a[192:195], a[88:91], v[208:211]
ds_read_b64_tr_b16 a[46:47], v7 offset:31744
v_mfma_f32_16x16x32_bf16 v[208:211], a[208:211], a[92:95], v[208:211]
v_mfma_f32_16x16x32_bf16 v[212:215], a[212:215], a[92:95], v[212:215]
v_mfma_f32_16x16x32_bf16 v[212:215], a[196:199], a[88:91], v[212:215]
v_mfma_f32_16x16x32_bf16 v[216:219], a[200:203], a[88:91], v[216:219]
v_mfma_f32_16x16x32_bf16 v[216:219], a[216:219], a[92:95], v[216:219]
v_mfma_f32_16x16x32_bf16 v[220:223], a[220:223], a[92:95], v[220:223]
v_mfma_f32_16x16x32_bf16 v[220:223], a[204:207], a[88:91], v[220:223]
s_waitcnt lgkmcnt(0)
v_mfma_f32_16x16x32_bf16 v[32:35], a[0:3], a[96:99], v[32:35]
ds_read_b64_tr_b16 a[48:49], v8 offset:13312
v_mfma_f32_16x16x32_bf16 v[32:35], a[4:7], a[112:115], v[32:35]
buffer_load_dwordx4 a[192:195], v12, s[4:7], s40 offen offset:0 sc1
v_mfma_f32_16x16x32_bf16 v[36:39], a[4:7], a[116:119], v[36:39]
ds_read_b64_tr_b16 a[50:51], v8 offset:19456
v_mfma_f32_16x16x32_bf16 v[36:39], a[0:3], a[100:103], v[36:39]
ds_read_b64_tr_b16 a[52:53], v8 offset:25600
v_mfma_f32_16x16x32_bf16 v[40:43], a[0:3], a[104:107], v[40:43]
v_mfma_f32_16x16x32_bf16 v[40:43], a[4:7], a[120:123], v[40:43]
ds_read_b64_tr_b16 a[54:55], v8 offset:31744
v_mfma_f32_16x16x32_bf16 v[44:47], a[4:7], a[124:127], v[44:47]
buffer_load_dwordx4 a[196:199], v12, s[4:7], s40 offen offset:1024 sc1
v_mfma_f32_16x16x32_bf16 v[44:47], a[0:3], a[108:111], v[44:47]
ds_read_b64_tr_b16 a[56:57], v9 offset:13312
v_mfma_f32_16x16x32_bf16 v[48:51], a[8:11], a[96:99], v[48:51]
v_mfma_f32_16x16x32_bf16 v[48:51], a[12:15], a[112:115], v[48:51]
ds_read_b64_tr_b16 a[58:59], v9 offset:19456
v_mfma_f32_16x16x32_bf16 v[52:55], a[12:15], a[116:119], v[52:55]
ds_read_b64_tr_b16 a[60:61], v9 offset:25600
v_mfma_f32_16x16x32_bf16 v[52:55], a[8:11], a[100:103], v[52:55]
buffer_load_dwordx4 a[200:203], v12, s[4:7], s40 offen offset:2048 sc1
v_mfma_f32_16x16x32_bf16 v[56:59], a[8:11], a[104:107], v[56:59]
v_mfma_f32_16x16x32_bf16 v[56:59], a[12:15], a[120:123], v[56:59]
ds_read_b64_tr_b16 a[62:63], v9 offset:31744
v_mfma_f32_16x16x32_bf16 v[60:63], a[12:15], a[124:127], v[60:63]
ds_read_b64_tr_b16 a[64:65], v6 offset:14336
v_mfma_f32_16x16x32_bf16 v[60:63], a[8:11], a[108:111], v[60:63]
ds_read_b64_tr_b16 a[66:67], v6 offset:20480
v_mfma_f32_16x16x32_bf16 v[64:67], a[16:19], a[96:99], v[64:67]
v_mfma_f32_16x16x32_bf16 v[64:67], a[20:23], a[112:115], v[64:67]
buffer_load_dwordx4 a[204:207], v12, s[4:7], s40 offen offset:3072 sc1
s_add_u32 s40, s40, 16384
v_mfma_f32_16x16x32_bf16 v[68:71], a[20:23], a[116:119], v[68:71]
ds_read_b64_tr_b16 a[68:69], v6 offset:26624
v_mfma_f32_16x16x32_bf16 v[68:71], a[16:19], a[100:103], v[68:71]
ds_read_b64_tr_b16 a[70:71], v6 offset:32768
v_mfma_f32_16x16x32_bf16 v[72:75], a[16:19], a[104:107], v[72:75]
v_mfma_f32_16x16x32_bf16 v[72:75], a[20:23], a[120:123], v[72:75]
ds_read_b64_tr_b16 a[72:73], v7 offset:14336
v_mfma_f32_16x16x32_bf16 v[76:79], a[20:23], a[124:127], v[76:79]
buffer_load_dwordx4 a[208:211], v12, s[4:7], s40 offen offset:0 sc1
v_mfma_f32_16x16x32_bf16 v[76:79], a[16:19], a[108:111], v[76:79]
ds_read_b64_tr_b16 a[74:75], v7 offset:20480
v_mfma_f32_16x16x32_bf16 v[80:83], a[24:27], a[96:99], v[80:83]
ds_read_b64_tr_b16 a[76:77], v7 offset:26624
v_mfma_f32_16x16x32_bf16 v[80:83], a[28:31], a[112:115], v[80:83]
v_mfma_f32_16x16x32_bf16 v[84:87], a[28:31], a[116:119], v[84:87]
ds_read_b64_tr_b16 a[78:79], v7 offset:32768
v_mfma_f32_16x16x32_bf16 v[84:87], a[24:27], a[100:103], v[84:87]
buffer_load_dwordx4 a[212:215], v12, s[4:7], s40 offen offset:1024 sc1
v_mfma_f32_16x16x32_bf16 v[88:91], a[24:27], a[104:107], v[88:91]
ds_read_b64_tr_b16 a[80:81], v8 offset:14336
v_mfma_f32_16x16x32_bf16 v[88:91], a[28:31], a[120:123], v[88:91]
v_mfma_f32_16x16x32_bf16 v[92:95], a[28:31], a[124:127], v[92:95]
ds_read_b64_tr_b16 a[82:83], v8 offset:20480
v_mfma_f32_16x16x32_bf16 v[92:95], a[24:27], a[108:111], v[92:95]
ds_read_b64_tr_b16 a[84:85], v8 offset:26624
v_mfma_f32_16x16x32_bf16 v[96:99], a[32:35], a[96:99], v[96:99]
buffer_load_dwordx4 a[216:219], v12, s[4:7], s40 offen offset:2048 sc1
v_mfma_f32_16x16x32_bf16 v[96:99], a[36:39], a[112:115], v[96:99]
v_mfma_f32_16x16x32_bf16 v[100:103], a[36:39], a[116:119], v[100:103]
PG14:
s_cbranch_execz PG18
ds_read_b64_tr_b16 a[86:87], v8 offset:32768
v_mfma_f32_16x16x32_bf16 v[100:103], a[32:35], a[100:103], v[100:103]
ds_read_b64_tr_b16 a[88:89], v9 offset:14336
v_mfma_f32_16x16x32_bf16 v[104:107], a[32:35], a[104:107], v[104:107]
ds_read_b64_tr_b16 a[90:91], v9 offset:20480
v_mfma_f32_16x16x32_bf16 v[104:107], a[36:39], a[120:123], v[104:107]
v_mfma_f32_16x16x32_bf16 v[108:111], a[36:39], a[124:127], v[108:111]
buffer_load_dwordx4 a[220:223], v12, s[4:7], s40 offen offset:3072 sc1
s_add_u32 s40, s40, 16384
v_mfma_f32_16x16x32_bf16 v[108:111], a[32:35], a[108:111], v[108:111]
ds_read_b64_tr_b16 a[92:93], v9 offset:26624
v_mfma_f32_16x16x32_bf16 v[112:115], a[40:43], a[96:99], v[112:115]
ds_read_b64_tr_b16 a[94:95], v9 offset:32768
v_mfma_f32_16x16x32_bf16 v[112:115], a[44:47], a[112:115], v[112:115]
v_mfma_f32_16x16x32_bf16 v[116:119], a[44:47], a[116:119], v[116:119]
v_mfma_f32_16x16x32_bf16 v[116:119], a[40:43], a[100:103], v[116:119]
v_mfma_f32_16x16x32_bf16 v[120:123], a[40:43], a[104:107], v[120:123]
v_mfma_f32_16x16x32_bf16 v[120:123], a[44:47], a[120:123], v[120:123]
v_mfma_f32_16x16x32_bf16 v[124:127], a[44:47], a[124:127], v[124:127]
v_mfma_f32_16x16x32_bf16 v[124:127], a[40:43], a[108:111], v[124:127]
s_waitcnt vmcnt(23) lgkmcnt(0)
v_mfma_f32_16x16x32_bf16 v[128:131], a[48:51], a[96:99], v[128:131]
v_mfma_f32_16x16x32_bf16 v[128:131], a[52:55], a[112:115], v[128:131]
s_barrier
v_mfma_f32_16x16x32_bf16 v[132:135], a[52:55], a[116:119], v[132:135]
ds_read_b64_tr_b16 a[0:1], v6 offset:0
s_add_u32 m0, s42, 98304
v_mfma_f32_16x16x32_bf16 v[132:135], a[48:51], a[100:103], v[132:135]
buffer_load_dwordx4 v2, s[8:11], s41 offen offset:0 lds
v_mfma_f32_16x16x32_bf16 v[136:139], a[48:51], a[104:107], v[136:139]
ds_read_b64_tr_b16 a[2:3], v6 offset:6144
v_mfma_f32_16x16x32_bf16 v[136:139], a[52:55], a[120:123], v[136:139]
v_mfma_f32_16x16x32_bf16 v[140:143], a[52:55], a[124:127], v[140:143]
ds_read_b64_tr_b16 a[4:5], v18 offset:0
v_mfma_f32_16x16x32_bf16 v[140:143], a[48:51], a[108:111], v[140:143]
ds_read_b64_tr_b16 a[6:7], v18 offset:6144
v_mfma_f32_16x16x32_bf16 v[144:147], a[56:59], a[96:99], v[144:147]
ds_read_b64_tr_b16 a[8:9], v7 offset:0
v_mfma_f32_16x16x32_bf16 v[144:147], a[60:63], a[112:115], v[144:147]
v_mfma_f32_16x16x32_bf16 v[148:151], a[60:63], a[116:119], v[148:151]
buffer_load_dwordx4 v3, s[8:11], s41 offen offset:1024 lds
v_mfma_f32_16x16x32_bf16 v[148:151], a[56:59], a[100:103], v[148:151]
ds_read_b64_tr_b16 a[10:11], v7 offset:6144
v_mfma_f32_16x16x32_bf16 v[152:155], a[56:59], a[104:107], v[152:155]
ds_read_b64_tr_b16 a[12:13], v19 offset:0
v_mfma_f32_16x16x32_bf16 v[152:155], a[60:63], a[120:123], v[152:155]
v_mfma_f32_16x16x32_bf16 v[156:159], a[60:63], a[124:127], v[156:159]
ds_read_b64_tr_b16 a[14:15], v19 offset:6144
v_mfma_f32_16x16x32_bf16 v[156:159], a[56:59], a[108:111], v[156:159]
ds_read_b64_tr_b16 a[16:17], v8 offset:0
v_mfma_f32_16x16x32_bf16 v[160:163], a[96:99], a[64:67], v[160:163]
buffer_load_dwordx4 v4, s[8:11], s41 offen offset:2048 lds
s_add_u32 s41, s41, 196608
v_mfma_f32_16x16x32_bf16 v[160:163], a[112:115], a[68:71], v[160:163]
v_mfma_f32_16x16x32_bf16 v[164:167], a[116:119], a[68:71], v[164:167]
ds_read_b64_tr_b16 a[18:19], v8 offset:6144
v_mfma_f32_16x16x32_bf16 v[164:167], a[100:103], a[64:67], v[164:167]
ds_read_b64_tr_b16 a[20:21], v20 offset:0
v_mfma_f32_16x16x32_bf16 v[168:171], a[104:107], a[64:67], v[168:171]
ds_read_b64_tr_b16 a[22:23], v20 offset:6144
v_mfma_f32_16x16x32_bf16 v[168:171], a[120:123], a[68:71], v[168:171]
v_mfma_f32_16x16x32_bf16 v[172:175], a[124:127], a[68:71], v[172:175]
ds_read_b64_tr_b16 a[24:25], v9 offset:0
s_add_u32 m0, s42, 110592
v_mfma_f32_16x16x32_bf16 v[172:175], a[108:111], a[64:67], v[172:175]
buffer_load_dwordx4 v2, s[8:11], s41 offen offset:0 lds
v_mfma_f32_16x16x32_bf16 v[176:179], a[96:99], a[72:75], v[176:179]
ds_read_b64_tr_b16 a[26:27], v9 offset:6144
v_mfma_f32_16x16x32_bf16 v[176:179], a[112:115], a[76:79], v[176:179]
v_mfma_f32_16x16x32_bf16 v[180:183], a[116:119], a[76:79], v[180:183]
ds_read_b64_tr_b16 a[28:29], v21 offset:0
v_mfma_f32_16x16x32_bf16 v[180:183], a[100:103], a[72:75], v[180:183]
ds_read_b64_tr_b16 a[30:31], v21 offset:6144
v_mfma_f32_16x16x32_bf16 v[184:187], a[104:107], a[72:75], v[184:187]
ds_read_b64_tr_b16 a[32:33], v6 offset:1024
v_mfma_f32_16x16x32_bf16 v[184:187], a[120:123], a[76:79], v[184:187]
v_mfma_f32_16x16x32_bf16 v[188:191], a[124:127], a[76:79], v[188:191]
buffer_load_dwordx4 v3, s[8:11], s41 offen offset:1024 lds
v_mfma_f32_16x16x32_bf16 v[188:191], a[108:111], a[72:75], v[188:191]
ds_read_b64_tr_b16 a[34:35], v6 offset:7168
v_mfma_f32_16x16x32_bf16 v[192:195], a[96:99], a[80:83], v[192:195]
ds_read_b64_tr_b16 a[36:37], v18 offset:1024
v_mfma_f32_16x16x32_bf16 v[192:195], a[112:115], a[84:87], v[192:195]
v_mfma_f32_16x16x32_bf16 v[196:199], a[116:119], a[84:87], v[196:199]
ds_read_b64_tr_b16 a[38:39], v18 offset:7168
v_mfma_f32_16x16x32_bf16 v[196:199], a[100:103], a[80:83], v[196:199]
ds_read_b64_tr_b16 a[40:41], v7 offset:1024
v_mfma_f32_16x16x32_bf16 v[200:203], a[104:107], a[80:83], v[200:203]
buffer_load_dwordx4 v4, s[8:11], s41 offen offset:2048 lds
s_add_u32 s41, s41, 196608
v_mfma_f32_16x16x32_bf16 v[200:203], a[120:123], a[84:87], v[200:203]
v_mfma_f32_16x16x32_bf16 v[204:207], a[124:127], a[84:87], v[204:207]
ds_read_b64_tr_b16 a[42:43], v7 offset:7168
v_mfma_f32_16x16x32_bf16 v[204:207], a[108:111], a[80:83], v[204:207]
ds_read_b64_tr_b16 a[44:45], v19 offset:1024
v_mfma_f32_16x16x32_bf16 v[208:211], a[96:99], a[88:91], v[208:211]
ds_read_b64_tr_b16 a[46:47], v19 offset:7168
v_mfma_f32_16x16x32_bf16 v[208:211], a[112:115], a[92:95], v[208:211]
v_mfma_f32_16x16x32_bf16 v[212:215], a[116:119], a[92:95], v[212:215]
v_mfma_f32_16x16x32_bf16 v[212:215], a[100:103], a[88:91], v[212:215]
v_mfma_f32_16x16x32_bf16 v[216:219], a[104:107], a[88:91], v[216:219]
v_mfma_f32_16x16x32_bf16 v[216:219], a[120:123], a[92:95], v[216:219]
v_mfma_f32_16x16x32_bf16 v[220:223], a[124:127], a[92:95], v[220:223]
v_mfma_f32_16x16x32_bf16 v[220:223], a[108:111], a[88:91], v[220:223]
s_waitcnt lgkmcnt(0)
v_mfma_f32_16x16x32_bf16 v[32:35], a[0:3], a[128:131], v[32:35]
ds_read_b64_tr_b16 a[48:49], v8 offset:1024
v_mfma_f32_16x16x32_bf16 v[32:35], a[4:7], a[144:147], v[32:35]
ds_read_b64_tr_b16 a[50:51], v8 offset:7168
v_mfma_f32_16x16x32_bf16 v[36:39], a[4:7], a[148:151], v[36:39]
v_mfma_f32_16x16x32_bf16 v[36:39], a[0:3], a[132:135], v[36:39]
ds_read_b64_tr_b16 a[52:53], v20 offset:1024
v_mfma_f32_16x16x32_bf16 v[40:43], a[0:3], a[136:139], v[40:43]
v_mfma_f32_16x16x32_bf16 v[40:43], a[4:7], a[152:155], v[40:43]
ds_read_b64_tr_b16 a[54:55], v20 offset:7168
v_mfma_f32_16x16x32_bf16 v[44:47], a[4:7], a[156:159], v[44:47]
v_mfma_f32_16x16x32_bf16 v[44:47], a[0:3], a[140:143], v[44:47]
ds_read_b64_tr_b16 a[56:57], v9 offset:1024
v_mfma_f32_16x16x32_bf16 v[48:51], a[8:11], a[128:131], v[48:51]
ds_read_b64_tr_b16 a[58:59], v9 offset:7168
v_mfma_f32_16x16x32_bf16 v[48:51], a[12:15], a[144:147], v[48:51]
v_mfma_f32_16x16x32_bf16 v[52:55], a[12:15], a[148:151], v[52:55]
ds_read_b64_tr_b16 a[60:61], v21 offset:1024
v_mfma_f32_16x16x32_bf16 v[52:55], a[8:11], a[132:135], v[52:55]
v_mfma_f32_16x16x32_bf16 v[56:59], a[8:11], a[136:139], v[56:59]
ds_read_b64_tr_b16 a[62:63], v21 offset:7168
v_mfma_f32_16x16x32_bf16 v[56:59], a[12:15], a[152:155], v[56:59]
v_mfma_f32_16x16x32_bf16 v[60:63], a[12:15], a[156:159], v[60:63]
ds_read_b64_tr_b16 a[64:65], v6 offset:2048
v_mfma_f32_16x16x32_bf16 v[60:63], a[8:11], a[140:143], v[60:63]
ds_read_b64_tr_b16 a[66:67], v6 offset:8192
v_mfma_f32_16x16x32_bf16 v[64:67], a[16:19], a[128:131], v[64:67]
v_mfma_f32_16x16x32_bf16 v[64:67], a[20:23], a[144:147], v[64:67]
ds_read_b64_tr_b16 a[68:69], v18 offset:2048
v_mfma_f32_16x16x32_bf16 v[68:71], a[20:23], a[148:151], v[68:71]
v_mfma_f32_16x16x32_bf16 v[68:71], a[16:19], a[132:135], v[68:71]
ds_read_b64_tr_b16 a[70:71], v18 offset:8192
v_mfma_f32_16x16x32_bf16 v[72:75], a[16:19], a[136:139], v[72:75]
v_mfma_f32_16x16x32_bf16 v[72:75], a[20:23], a[152:155], v[72:75]
ds_read_b64_tr_b16 a[72:73], v7 offset:2048
v_mfma_f32_16x16x32_bf16 v[76:79], a[20:23], a[156:159], v[76:79]
ds_read_b64_tr_b16 a[74:75], v7 offset:8192
v_mfma_f32_16x16x32_bf16 v[76:79], a[16:19], a[140:143], v[76:79]
v_mfma_f32_16x16x32_bf16 v[80:83], a[24:27], a[128:131], v[80:83]
ds_read_b64_tr_b16 a[76:77], v19 offset:2048
v_mfma_f32_16x16x32_bf16 v[80:83], a[28:31], a[144:147], v[80:83]
v_mfma_f32_16x16x32_bf16 v[84:87], a[28:31], a[148:151], v[84:87]
ds_read_b64_tr_b16 a[78:79], v19 offset:8192
v_mfma_f32_16x16x32_bf16 v[84:87], a[24:27], a[132:135], v[84:87]
v_mfma_f32_16x16x32_bf16 v[88:91], a[24:27], a[136:139], v[88:91]
ds_read_b64_tr_b16 a[80:81], v8 offset:2048
v_mfma_f32_16x16x32_bf16 v[88:91], a[28:31], a[152:155], v[88:91]
ds_read_b64_tr_b16 a[82:83], v8 offset:8192
v_mfma_f32_16x16x32_bf16 v[92:95], a[28:31], a[156:159], v[92:95]
v_mfma_f32_16x16x32_bf16 v[92:95], a[24:27], a[140:143], v[92:95]
ds_read_b64_tr_b16 a[84:85], v20 offset:2048
v_mfma_f32_16x16x32_bf16 v[96:99], a[32:35], a[128:131], v[96:99]
v_mfma_f32_16x16x32_bf16 v[96:99], a[36:39], a[144:147], v[96:99]
ds_read_b64_tr_b16 a[86:87], v20 offset:8192
v_mfma_f32_16x16x32_bf16 v[100:103], a[36:39], a[148:151], v[100:103]
v_mfma_f32_16x16x32_bf16 v[100:103], a[32:35], a[132:135], v[100:103]
ds_read_b64_tr_b16 a[88:89], v9 offset:2048
v_mfma_f32_16x16x32_bf16 v[104:107], a[32:35], a[136:139], v[104:107]
ds_read_b64_tr_b16 a[90:91], v9 offset:8192
v_mfma_f32_16x16x32_bf16 v[104:107], a[36:39], a[152:155], v[104:107]
v_mfma_f32_16x16x32_bf16 v[108:111], a[36:39], a[156:159], v[108:111]
ds_read_b64_tr_b16 a[92:93], v21 offset:2048
v_mfma_f32_16x16x32_bf16 v[108:111], a[32:35], a[140:143], v[108:111]
v_mfma_f32_16x16x32_bf16 v[112:115], a[40:43], a[128:131], v[112:115]
ds_read_b64_tr_b16 a[94:95], v21 offset:8192
v_mfma_f32_16x16x32_bf16 v[112:115], a[44:47], a[144:147], v[112:115]
v_mfma_f32_16x16x32_bf16 v[116:119], a[44:47], a[148:151], v[116:119]
v_mfma_f32_16x16x32_bf16 v[116:119], a[40:43], a[132:135], v[116:119]
v_mfma_f32_16x16x32_bf16 v[120:123], a[40:43], a[136:139], v[120:123]
v_mfma_f32_16x16x32_bf16 v[120:123], a[44:47], a[152:155], v[120:123]
v_mfma_f32_16x16x32_bf16 v[124:127], a[44:47], a[156:159], v[124:127]
v_mfma_f32_16x16x32_bf16 v[124:127], a[40:43], a[140:143], v[124:127]
s_waitcnt vmcnt(0) lgkmcnt(0)
v_mfma_f32_16x16x32_bf16 v[128:131], a[48:51], a[128:131], v[128:131]
v_mfma_f32_16x16x32_bf16 v[128:131], a[52:55], a[144:147], v[128:131]
s_barrier
v_mfma_f32_16x16x32_bf16 v[132:135], a[52:55], a[148:151], v[132:135]
ds_read_b64_tr_b16 a[0:1], v18 offset:13312
v_mfma_f32_16x16x32_bf16 v[132:135], a[48:51], a[132:135], v[132:135]
v_mfma_f32_16x16x32_bf16 v[136:139], a[48:51], a[136:139], v[136:139]
ds_read_b64_tr_b16 a[2:3], v18 offset:19456
v_mfma_f32_16x16x32_bf16 v[136:139], a[52:55], a[152:155], v[136:139]
v_mfma_f32_16x16x32_bf16 v[140:143], a[52:55], a[156:159], v[140:143]
v_mfma_f32_16x16x32_bf16 v[140:143], a[48:51], a[140:143], v[140:143]
ds_read_b64_tr_b16 a[4:5], v19 offset:13312
v_mfma_f32_16x16x32_bf16 v[144:147], a[56:59], a[128:131], v[144:147]
v_mfma_f32_16x16x32_bf16 v[144:147], a[60:63], a[144:147], v[144:147]
ds_read_b64_tr_b16 a[6:7], v19 offset:19456
v_mfma_f32_16x16x32_bf16 v[148:151], a[60:63], a[148:151], v[148:151]
v_mfma_f32_16x16x32_bf16 v[148:151], a[56:59], a[132:135], v[148:151]
v_mfma_f32_16x16x32_bf16 v[152:155], a[56:59], a[136:139], v[152:155]
ds_read_b64_tr_b16 a[8:9], v18 offset:25600
v_mfma_f32_16x16x32_bf16 v[152:155], a[60:63], a[152:155], v[152:155]
v_mfma_f32_16x16x32_bf16 v[156:159], a[60:63], a[156:159], v[156:159]
ds_read_b64_tr_b16 a[10:11], v18 offset:31744
v_mfma_f32_16x16x32_bf16 v[156:159], a[56:59], a[140:143], v[156:159]
v_mfma_f32_16x16x32_bf16 v[160:163], a[128:131], a[64:67], v[160:163]
v_mfma_f32_16x16x32_bf16 v[160:163], a[144:147], a[68:71], v[160:163]
ds_read_b64_tr_b16 a[12:13], v19 offset:25600
v_mfma_f32_16x16x32_bf16 v[164:167], a[148:151], a[68:71], v[164:167]
v_mfma_f32_16x16x32_bf16 v[164:167], a[132:135], a[64:67], v[164:167]
ds_read_b64_tr_b16 a[14:15], v19 offset:31744
v_mfma_f32_16x16x32_bf16 v[168:171], a[136:139], a[64:67], v[168:171]
v_mfma_f32_16x16x32_bf16 v[168:171], a[152:155], a[68:71], v[168:171]
v_mfma_f32_16x16x32_bf16 v[172:175], a[156:159], a[68:71], v[172:175]
ds_read_b64_tr_b16 a[16:17], v6 offset:13312
v_mfma_f32_16x16x32_bf16 v[172:175], a[140:143], a[64:67], v[172:175]
v_mfma_f32_16x16x32_bf16 v[176:179], a[128:131], a[72:75], v[176:179]
ds_read_b64_tr_b16 a[18:19], v6 offset:19456
v_mfma_f32_16x16x32_bf16 v[176:179], a[144:147], a[76:79], v[176:179]
v_mfma_f32_16x16x32_bf16 v[180:183], a[148:151], a[76:79], v[180:183]
v_mfma_f32_16x16x32_bf16 v[180:183], a[132:135], a[72:75], v[180:183]
ds_read_b64_tr_b16 a[20:21], v7 offset:13312
v_mfma_f32_16x16x32_bf16 v[184:187], a[136:139], a[72:75], v[184:187]
v_mfma_f32_16x16x32_bf16 v[184:187], a[152:155], a[76:79], v[184:187]
ds_read_b64_tr_b16 a[22:23], v7 offset:19456
v_mfma_f32_16x16x32_bf16 v[188:191], a[156:159], a[76:79], v[188:191]
v_mfma_f32_16x16x32_bf16 v[188:191], a[140:143], a[72:75], v[188:191]
v_mfma_f32_16x16x32_bf16 v[192:195], a[128:131], a[80:83], v[192:195]
ds_read_b64_tr_b16 a[24:25], v6 offset:25600
v_mfma_f32_16x16x32_bf16 v[192:195], a[144:147], a[84:87], v[192:195]
v_mfma_f32_16x16x32_bf16 v[196:199], a[148:151], a[84:87], v[196:199]
ds_read_b64_tr_b16 a[26:27], v6 offset:31744
v_mfma_f32_16x16x32_bf16 v[196:199], a[132:135], a[80:83], v[196:199]
v_mfma_f32_16x16x32_bf16 v[200:203], a[136:139], a[80:83], v[200:203]
v_mfma_f32_16x16x32_bf16 v[200:203], a[152:155], a[84:87], v[200:203]
ds_read_b64_tr_b16 a[28:29], v7 offset:25600
v_mfma_f32_16x16x32_bf16 v[204:207], a[156:159], a[84:87], v[204:207]
v_mfma_f32_16x16x32_bf16 v[204:207], a[140:143], a[80:83], v[204:207]
ds_read_b64_tr_b16 a[30:31], v7 offset:31744
v_mfma_f32_16x16x32_bf16 v[208:211], a[128:131], a[88:91], v[208:211]
v_mfma_f32_16x16x32_bf16 v[208:211], a[144:147], a[92:95], v[208:211]
v_mfma_f32_16x16x32_bf16 v[212:215], a[148:151], a[92:95], v[212:215]
v_mfma_f32_16x16x32_bf16 v[212:215], a[132:135], a[88:91], v[212:215]
v_mfma_f32_16x16x32_bf16 v[216:219], a[136:139], a[88:91], v[216:219]
v_mfma_f32_16x16x32_bf16 v[216:219], a[152:155], a[92:95], v[216:219]
v_mfma_f32_16x16x32_bf16 v[220:223], a[156:159], a[92:95], v[220:223]
v_mfma_f32_16x16x32_bf16 v[220:223], a[140:143], a[88:91], v[220:223]
s_waitcnt lgkmcnt(0)
v_mfma_f32_16x16x32_bf16 v[96:99], a[0:3], a[160:163], v[96:99]
ds_read_b64_tr_b16 a[48:49], v20 offset:13312
v_mfma_f32_16x16x32_bf16 v[96:99], a[8:11], a[176:179], v[96:99]
ds_read_b64_tr_b16 a[50:51], v20 offset:19456
v_mfma_f32_16x16x32_bf16 v[96:99], a[16:19], a[192:195], v[96:99]
ds_read_b64_tr_b16 a[52:53], v21 offset:13312
v_mfma_f32_16x16x32_bf16 v[96:99], a[24:27], a[208:211], v[96:99]
v_mfma_f32_16x16x32_bf16 v[112:115], a[4:7], a[160:163], v[112:115]
ds_read_b64_tr_b16 a[54:55], v21 offset:19456
v_mfma_f32_16x16x32_bf16 v[112:115], a[12:15], a[176:179], v[112:115]
ds_read_b64_tr_b16 a[56:57], v20 offset:25600
v_mfma_f32_16x16x32_bf16 v[112:115], a[20:23], a[192:195], v[112:115]
ds_read_b64_tr_b16 a[58:59], v20 offset:31744
v_mfma_f32_16x16x32_bf16 v[112:115], a[28:31], a[208:211], v[112:115]
v_mfma_f32_16x16x32_bf16 v[100:103], a[0:3], a[164:167], v[100:103]
ds_read_b64_tr_b16 a[60:61], v21 offset:25600
v_mfma_f32_16x16x32_bf16 v[100:103], a[8:11], a[180:183], v[100:103]
ds_read_b64_tr_b16 a[62:63], v21 offset:31744
v_mfma_f32_16x16x32_bf16 v[100:103], a[16:19], a[196:199], v[100:103]
v_mfma_f32_16x16x32_bf16 v[100:103], a[24:27], a[212:215], v[100:103]
ds_read_b64_tr_b16 a[64:65], v8 offset:13312
v_mfma_f32_16x16x32_bf16 v[116:119], a[4:7], a[164:167], v[116:119]
ds_read_b64_tr_b16 a[66:67], v8 offset:19456
v_mfma_f32_16x16x32_bf16 v[116:119], a[12:15], a[180:183], v[116:119]
v_mfma_f32_16x16x32_bf16 v[116:119], a[20:23], a[196:199], v[116:119]
ds_read_b64_tr_b16 a[68:69], v9 offset:13312
v_mfma_f32_16x16x32_bf16 v[116:119], a[28:31], a[212:215], v[116:119]
v_mfma_f32_16x16x32_bf16 v[104:107], a[0:3], a[168:171], v[104:107]
v_cvt_pk_bf16_f32 v96, v96, v97
v_mfma_f32_16x16x32_bf16 v[104:107], a[8:11], a[184:187], v[104:107]
ds_read_b64_tr_b16 a[70:71], v9 offset:19456
v_cvt_pk_bf16_f32 v97, v98, v99
v_mfma_f32_16x16x32_bf16 v[104:107], a[16:19], a[200:203], v[104:107]
ds_read_b64_tr_b16 a[72:73], v8 offset:25600
v_cvt_pk_bf16_f32 v98, v112, v113
v_mfma_f32_16x16x32_bf16 v[104:107], a[24:27], a[216:219], v[104:107]
ds_read_b64_tr_b16 a[74:75], v8 offset:31744
v_mfma_f32_16x16x32_bf16 v[120:123], a[4:7], a[168:171], v[120:123]
v_cvt_pk_bf16_f32 v99, v114, v115
v_mfma_f32_16x16x32_bf16 v[120:123], a[12:15], a[184:187], v[120:123]
ds_read_b64_tr_b16 a[76:77], v9 offset:25600
buffer_store_dwordx4 v[96:99], v12, s[12:15], s66 offen offset:0 sc1
v_mfma_f32_16x16x32_bf16 v[120:123], a[20:23], a[200:203], v[120:123]
ds_read_b64_tr_b16 a[78:79], v9 offset:31744
v_mfma_f32_16x16x32_bf16 v[120:123], a[28:31], a[216:219], v[120:123]
ds_write_b128 v12, v[96:99] offset:0
v_mfma_f32_16x16x32_bf16 v[108:111], a[0:3], a[172:175], v[108:111]
v_cvt_pk_bf16_f32 v100, v100, v101
v_mfma_f32_16x16x32_bf16 v[108:111], a[8:11], a[188:191], v[108:111]
v_cvt_pk_bf16_f32 v101, v102, v103
v_mfma_f32_16x16x32_bf16 v[108:111], a[16:19], a[204:207], v[108:111]
v_cvt_pk_bf16_f32 v102, v116, v117
v_mfma_f32_16x16x32_bf16 v[108:111], a[24:27], a[220:223], v[108:111]
v_mfma_f32_16x16x32_bf16 v[124:127], a[4:7], a[172:175], v[124:127]
v_cvt_pk_bf16_f32 v103, v118, v119
v_mfma_f32_16x16x32_bf16 v[124:127], a[12:15], a[188:191], v[124:127]
buffer_store_dwordx4 v[100:103], v12, s[12:15], s66 offen offset:1024 sc1
v_mfma_f32_16x16x32_bf16 v[124:127], a[20:23], a[204:207], v[124:127]
ds_write_b128 v12, v[100:103] offset:1024
v_mfma_f32_16x16x32_bf16 v[124:127], a[28:31], a[220:223], v[124:127]
s_waitcnt lgkmcnt(0)
v_mfma_f32_16x16x32_bf16 v[128:131], a[48:51], a[160:163], v[128:131]
v_cvt_pk_bf16_f32 v104, v104, v105
v_mfma_f32_16x16x32_bf16 v[128:131], a[56:59], a[176:179], v[128:131]
ds_read_b64_tr_b16 a[0:1], v18 offset:14336
v_cvt_pk_bf16_f32 v105, v106, v107
v_mfma_f32_16x16x32_bf16 v[128:131], a[64:67], a[192:195], v[128:131]
ds_read_b64_tr_b16 a[2:3], v18 offset:20480
v_cvt_pk_bf16_f32 v106, v120, v121
v_mfma_f32_16x16x32_bf16 v[128:131], a[72:75], a[208:211], v[128:131]
ds_read_b64_tr_b16 a[4:5], v19 offset:14336
v_mfma_f32_16x16x32_bf16 v[144:147], a[52:55], a[160:163], v[144:147]
v_cvt_pk_bf16_f32 v107, v122, v123
v_mfma_f32_16x16x32_bf16 v[144:147], a[60:63], a[176:179], v[144:147]
ds_read_b64_tr_b16 a[6:7], v19 offset:20480
buffer_store_dwordx4 v[104:107], v12, s[12:15], s66 offen offset:2048 sc1
v_mfma_f32_16x16x32_bf16 v[144:147], a[68:71], a[192:195], v[144:147]
ds_read_b64_tr_b16 a[8:9], v18 offset:26624
ds_write_b128 v12, v[104:107] offset:2048
v_mfma_f32_16x16x32_bf16 v[144:147], a[76:79], a[208:211], v[144:147]
ds_read_b64_tr_b16 a[10:11], v18 offset:32768
v_mfma_f32_16x16x32_bf16 v[132:135], a[48:51], a[164:167], v[132:135]
v_cvt_pk_bf16_f32 v108, v108, v109
v_mfma_f32_16x16x32_bf16 v[132:135], a[56:59], a[180:183], v[132:135]
ds_read_b64_tr_b16 a[12:13], v19 offset:26624
v_cvt_pk_bf16_f32 v109, v110, v111
v_mfma_f32_16x16x32_bf16 v[132:135], a[64:67], a[196:199], v[132:135]
ds_read_b64_tr_b16 a[14:15], v19 offset:32768
v_cvt_pk_bf16_f32 v110, v124, v125
v_mfma_f32_16x16x32_bf16 v[132:135], a[72:75], a[212:215], v[132:135]
ds_read_b64_tr_b16 a[16:17], v6 offset:14336
v_mfma_f32_16x16x32_bf16 v[148:151], a[52:55], a[164:167], v[148:151]
v_cvt_pk_bf16_f32 v111, v126, v127
v_mfma_f32_16x16x32_bf16 v[148:151], a[60:63], a[180:183], v[148:151]
ds_read_b64_tr_b16 a[18:19], v6 offset:20480
buffer_store_dwordx4 v[108:111], v12, s[12:15], s66 offen offset:3072 sc1
v_mfma_f32_16x16x32_bf16 v[148:151], a[68:71], a[196:199], v[148:151]
ds_read_b64_tr_b16 a[20:21], v7 offset:14336
v_mfma_f32_16x16x32_bf16 v[148:151], a[76:79], a[212:215], v[148:151]
ds_write_b128 v12, v[108:111] offset:3072
v_mfma_f32_16x16x32_bf16 v[136:139], a[48:51], a[168:171], v[136:139]
v_cvt_pk_bf16_f32 v128, v128, v129
v_mfma_f32_16x16x32_bf16 v[136:139], a[56:59], a[184:187], v[136:139]
ds_read_b64_tr_b16 a[22:23], v7 offset:20480
v_cvt_pk_bf16_f32 v129, v130, v131
v_mfma_f32_16x16x32_bf16 v[136:139], a[64:67], a[200:203], v[136:139]
ds_read_b64_tr_b16 a[24:25], v6 offset:26624
v_cvt_pk_bf16_f32 v130, v144, v145
v_mfma_f32_16x16x32_bf16 v[136:139], a[72:75], a[216:219], v[136:139]
ds_read_b64_tr_b16 a[26:27], v6 offset:32768
v_mfma_f32_16x16x32_bf16 v[152:155], a[52:55], a[168:171], v[152:155]
v_cvt_pk_bf16_f32 v131, v146, v147
v_mfma_f32_16x16x32_bf16 v[152:155], a[60:63], a[184:187], v[152:155]
ds_read_b64_tr_b16 a[28:29], v7 offset:26624
buffer_store_dwordx4 v[128:131], v12, s[12:15], s67 offen offset:0 sc1
v_mfma_f32_16x16x32_bf16 v[152:155], a[68:71], a[200:203], v[152:155]
ds_read_b64_tr_b16 a[30:31], v7 offset:32768
v_mfma_f32_16x16x32_bf16 v[152:155], a[76:79], a[216:219], v[152:155]
ds_write_b128 v12, v[128:131] offset:16384
v_mfma_f32_16x16x32_bf16 v[140:143], a[48:51], a[172:175], v[140:143]
v_cvt_pk_bf16_f32 v132, v132, v133
v_mfma_f32_16x16x32_bf16 v[140:143], a[56:59], a[188:191], v[140:143]
v_cvt_pk_bf16_f32 v133, v134, v135
v_mfma_f32_16x16x32_bf16 v[140:143], a[64:67], a[204:207], v[140:143]
v_cvt_pk_bf16_f32 v134, v148, v149
v_mfma_f32_16x16x32_bf16 v[140:143], a[72:75], a[220:223], v[140:143]
v_mfma_f32_16x16x32_bf16 v[156:159], a[52:55], a[172:175], v[156:159]
v_cvt_pk_bf16_f32 v135, v150, v151
v_mfma_f32_16x16x32_bf16 v[156:159], a[60:63], a[188:191], v[156:159]
buffer_store_dwordx4 v[132:135], v12, s[12:15], s67 offen offset:1024 sc1
v_mfma_f32_16x16x32_bf16 v[156:159], a[68:71], a[204:207], v[156:159]
ds_write_b128 v12, v[132:135] offset:17408
v_mfma_f32_16x16x32_bf16 v[156:159], a[76:79], a[220:223], v[156:159]
s_waitcnt lgkmcnt(0)
v_mfma_f32_16x16x32_bf16 v[160:163], a[160:163], a[0:3], v[160:163]
v_cvt_pk_bf16_f32 v136, v136, v137
v_mfma_f32_16x16x32_bf16 v[160:163], a[176:179], a[8:11], v[160:163]
ds_read_b64_tr_b16 a[48:49], v20 offset:14336
v_cvt_pk_bf16_f32 v137, v138, v139
v_mfma_f32_16x16x32_bf16 v[160:163], a[192:195], a[16:19], v[160:163]
ds_read_b64_tr_b16 a[50:51], v20 offset:20480
v_cvt_pk_bf16_f32 v138, v152, v153
v_mfma_f32_16x16x32_bf16 v[160:163], a[208:211], a[24:27], v[160:163]
ds_read_b64_tr_b16 a[52:53], v21 offset:14336
v_mfma_f32_16x16x32_bf16 v[164:167], a[164:167], a[0:3], v[164:167]
v_cvt_pk_bf16_f32 v139, v154, v155
v_mfma_f32_16x16x32_bf16 v[164:167], a[180:183], a[8:11], v[164:167]
ds_read_b64_tr_b16 a[54:55], v21 offset:20480
buffer_store_dwordx4 v[136:139], v12, s[12:15], s67 offen offset:2048 sc1
v_mfma_f32_16x16x32_bf16 v[164:167], a[196:199], a[16:19], v[164:167]
ds_read_b64_tr_b16 a[56:57], v20 offset:26624
ds_write_b128 v12, v[136:139] offset:18432
v_mfma_f32_16x16x32_bf16 v[164:167], a[212:215], a[24:27], v[164:167]
ds_read_b64_tr_b16 a[58:59], v20 offset:32768
v_mfma_f32_16x16x32_bf16 v[176:179], a[160:163], a[4:7], v[176:179]
v_cvt_pk_bf16_f32 v140, v140, v141
v_mfma_f32_16x16x32_bf16 v[176:179], a[176:179], a[12:15], v[176:179]
ds_read_b64_tr_b16 a[60:61], v21 offset:26624
v_cvt_pk_bf16_f32 v141, v142, v143
v_mfma_f32_16x16x32_bf16 v[176:179], a[192:195], a[20:23], v[176:179]
ds_read_b64_tr_b16 a[62:63], v21 offset:32768
v_cvt_pk_bf16_f32 v142, v156, v157
v_mfma_f32_16x16x32_bf16 v[176:179], a[208:211], a[28:31], v[176:179]
ds_read_b64_tr_b16 a[64:65], v8 offset:14336
v_mfma_f32_16x16x32_bf16 v[180:183], a[164:167], a[4:7], v[180:183]
v_cvt_pk_bf16_f32 v143, v158, v159
v_mfma_f32_16x16x32_bf16 v[180:183], a[180:183], a[12:15], v[180:183]
ds_read_b64_tr_b16 a[66:67], v8 offset:20480
buffer_store_dwordx4 v[140:143], v12, s[12:15], s67 offen offset:3072 sc1
v_mfma_f32_16x16x32_bf16 v[180:183], a[196:199], a[20:23], v[180:183]
ds_read_b64_tr_b16 a[68:69], v9 offset:14336
v_mfma_f32_16x16x32_bf16 v[180:183], a[212:215], a[28:31], v[180:183]
ds_write_b128 v12, v[140:143] offset:19456
v_mfma_f32_16x16x32_bf16 v[168:171], a[168:171], a[0:3], v[168:171]
v_cvt_pk_bf16_f32 v160, v160, v161
v_mfma_f32_16x16x32_bf16 v[168:171], a[184:187], a[8:11], v[168:171]
ds_read_b64_tr_b16 a[70:71], v9 offset:20480
v_cvt_pk_bf16_f32 v161, v162, v163
v_mfma_f32_16x16x32_bf16 v[168:171], a[200:203], a[16:19], v[168:171]
ds_read_b64_tr_b16 a[72:73], v8 offset:26624
v_cvt_pk_bf16_f32 v162, v164, v165
v_mfma_f32_16x16x32_bf16 v[168:171], a[216:219], a[24:27], v[168:171]
ds_read_b64_tr_b16 a[74:75], v8 offset:32768
v_mfma_f32_16x16x32_bf16 v[172:175], a[172:175], a[0:3], v[172:175]
v_cvt_pk_bf16_f32 v163, v166, v167
v_mfma_f32_16x16x32_bf16 v[172:175], a[188:191], a[8:11], v[172:175]
ds_read_b64_tr_b16 a[76:77], v9 offset:26624
buffer_store_dwordx4 v[160:163], v28, s[12:15], s66 offen offset:0 sc1
v_mfma_f32_16x16x32_bf16 v[172:175], a[204:207], a[16:19], v[172:175]
ds_read_b64_tr_b16 a[78:79], v9 offset:32768
v_mfma_f32_16x16x32_bf16 v[172:175], a[220:223], a[24:27], v[172:175]
ds_write_b128 v12, v[160:163] offset:32768
v_mfma_f32_16x16x32_bf16 v[184:187], a[168:171], a[4:7], v[184:187]
v_cvt_pk_bf16_f32 v176, v176, v177
v_mfma_f32_16x16x32_bf16 v[184:187], a[184:187], a[12:15], v[184:187]
v_cvt_pk_bf16_f32 v177, v178, v179
v_mfma_f32_16x16x32_bf16 v[184:187], a[200:203], a[20:23], v[184:187]
v_cvt_pk_bf16_f32 v178, v180, v181
v_mfma_f32_16x16x32_bf16 v[184:187], a[216:219], a[28:31], v[184:187]
v_mfma_f32_16x16x32_bf16 v[188:191], a[172:175], a[4:7], v[188:191]
v_cvt_pk_bf16_f32 v179, v182, v183
v_mfma_f32_16x16x32_bf16 v[188:191], a[188:191], a[12:15], v[188:191]
buffer_store_dwordx4 v[176:179], v28, s[12:15], s66 offen offset:1024 sc1
v_mfma_f32_16x16x32_bf16 v[188:191], a[204:207], a[20:23], v[188:191]
ds_write_b128 v12, v[176:179] offset:33792
v_mfma_f32_16x16x32_bf16 v[188:191], a[220:223], a[28:31], v[188:191]
s_waitcnt lgkmcnt(0)
v_mfma_f32_16x16x32_bf16 v[192:195], a[160:163], a[48:51], v[192:195]
v_cvt_pk_bf16_f32 v168, v168, v169
v_mfma_f32_16x16x32_bf16 v[192:195], a[176:179], a[56:59], v[192:195]
ds_read_b64_tr_b16 a[0:1], v18 offset:12288
v_cvt_pk_bf16_f32 v169, v170, v171
v_mfma_f32_16x16x32_bf16 v[192:195], a[192:195], a[64:67], v[192:195]
ds_read_b64_tr_b16 a[2:3], v18 offset:18432
v_cvt_pk_bf16_f32 v170, v172, v173
v_mfma_f32_16x16x32_bf16 v[192:195], a[208:211], a[72:75], v[192:195]
ds_read_b64_tr_b16 a[4:5], v19 offset:12288
v_mfma_f32_16x16x32_bf16 v[196:199], a[164:167], a[48:51], v[196:199]
v_cvt_pk_bf16_f32 v171, v174, v175
v_mfma_f32_16x16x32_bf16 v[196:199], a[180:183], a[56:59], v[196:199]
ds_read_b64_tr_b16 a[6:7], v19 offset:18432
buffer_store_dwordx4 v[168:171], v28, s[12:15], s66 offen offset:2048 sc1
v_mfma_f32_16x16x32_bf16 v[196:199], a[196:199], a[64:67], v[196:199]
ds_read_b64_tr_b16 a[8:9], v18 offset:24576
ds_write_b128 v12, v[168:171] offset:34816
v_mfma_f32_16x16x32_bf16 v[196:199], a[212:215], a[72:75], v[196:199]
ds_read_b64_tr_b16 a[10:11], v18 offset:30720
v_mfma_f32_16x16x32_bf16 v[208:211], a[160:163], a[52:55], v[208:211]
v_cvt_pk_bf16_f32 v184, v184, v185
v_mfma_f32_16x16x32_bf16 v[208:211], a[176:179], a[60:63], v[208:211]
ds_read_b64_tr_b16 a[12:13], v19 offset:24576
v_cvt_pk_bf16_f32 v185, v186, v187
v_mfma_f32_16x16x32_bf16 v[208:211], a[192:195], a[68:71], v[208:211]
ds_read_b64_tr_b16 a[14:15], v19 offset:30720
v_cvt_pk_bf16_f32 v186, v188, v189
v_mfma_f32_16x16x32_bf16 v[208:211], a[208:211], a[76:79], v[208:211]
ds_read_b64_tr_b16 a[16:17], v6 offset:12288
v_mfma_f32_16x16x32_bf16 v[212:215], a[164:167], a[52:55], v[212:215]
v_cvt_pk_bf16_f32 v187, v190, v191
v_mfma_f32_16x16x32_bf16 v[212:215], a[180:183], a[60:63], v[212:215]
ds_read_b64_tr_b16 a[18:19], v6 offset:18432
buffer_store_dwordx4 v[184:187], v28, s[12:15], s66 offen offset:3072 sc1
v_mfma_f32_16x16x32_bf16 v[212:215], a[196:199], a[68:71], v[212:215]
ds_read_b64_tr_b16 a[20:21], v7 offset:12288
v_mfma_f32_16x16x32_bf16 v[212:215], a[212:215], a[76:79], v[212:215]
ds_write_b128 v12, v[184:187] offset:35840
v_mfma_f32_16x16x32_bf16 v[200:203], a[168:171], a[48:51], v[200:203]
v_cvt_pk_bf16_f32 v192, v192, v193
v_mfma_f32_16x16x32_bf16 v[200:203], a[184:187], a[56:59], v[200:203]
ds_read_b64_tr_b16 a[22:23], v7 offset:18432
v_cvt_pk_bf16_f32 v193, v194, v195
v_mfma_f32_16x16x32_bf16 v[200:203], a[200:203], a[64:67], v[200:203]
ds_read_b64_tr_b16 a[24:25], v6 offset:24576
v_cvt_pk_bf16_f32 v194, v196, v197
v_mfma_f32_16x16x32_bf16 v[200:203], a[216:219], a[72:75], v[200:203]
ds_read_b64_tr_b16 a[26:27], v6 offset:30720
v_mfma_f32_16x16x32_bf16 v[204:207], a[172:175], a[48:51], v[204:207]
v_cvt_pk_bf16_f32 v195, v198, v199
v_mfma_f32_16x16x32_bf16 v[204:207], a[188:191], a[56:59], v[204:207]
ds_read_b64_tr_b16 a[28:29], v7 offset:24576
buffer_store_dwordx4 v[192:195], v28, s[12:15], s67 offen offset:0 sc1
v_mfma_f32_16x16x32_bf16 v[204:207], a[204:207], a[64:67], v[204:207]
ds_read_b64_tr_b16 a[30:31], v7 offset:30720
v_mfma_f32_16x16x32_bf16 v[204:207], a[220:223], a[72:75], v[204:207]
ds_write_b128 v12, v[192:195] offset:49152
v_mfma_f32_16x16x32_bf16 v[216:219], a[168:171], a[52:55], v[216:219]
v_cvt_pk_bf16_f32 v208, v208, v209
v_mfma_f32_16x16x32_bf16 v[216:219], a[184:187], a[60:63], v[216:219]
v_cvt_pk_bf16_f32 v209, v210, v211
v_mfma_f32_16x16x32_bf16 v[216:219], a[200:203], a[68:71], v[216:219]
v_cvt_pk_bf16_f32 v210, v212, v213
v_mfma_f32_16x16x32_bf16 v[216:219], a[216:219], a[76:79], v[216:219]
PG15:
s_cbranch_execz PG1037
v_mfma_f32_16x16x32_bf16 v[220:223], a[172:175], a[52:55], v[220:223]
v_cvt_pk_bf16_f32 v211, v214, v215
v_mfma_f32_16x16x32_bf16 v[220:223], a[188:191], a[60:63], v[220:223]
buffer_store_dwordx4 v[208:211], v28, s[12:15], s67 offen offset:1024 sc1
v_mfma_f32_16x16x32_bf16 v[220:223], a[204:207], a[68:71], v[220:223]
ds_write_b128 v12, v[208:211] offset:50176
v_mfma_f32_16x16x32_bf16 v[220:223], a[220:223], a[76:79], v[220:223]
s_waitcnt lgkmcnt(0)
v_mfma_f32_16x16x32_bf16 v[32:35], a[0:3], a[160:163], v[32:35]
v_cvt_pk_bf16_f32 v200, v200, v201
v_mfma_f32_16x16x32_bf16 v[32:35], a[8:11], a[176:179], v[32:35]
ds_read_b64_tr_b16 a[48:49], v20 offset:12288
v_cvt_pk_bf16_f32 v201, v202, v203
v_mfma_f32_16x16x32_bf16 v[32:35], a[16:19], a[192:195], v[32:35]
ds_read_b64_tr_b16 a[50:51], v20 offset:18432
v_cvt_pk_bf16_f32 v202, v204, v205
v_mfma_f32_16x16x32_bf16 v[32:35], a[24:27], a[208:211], v[32:35]
ds_read_b64_tr_b16 a[52:53], v21 offset:12288
v_mfma_f32_16x16x32_bf16 v[48:51], a[4:7], a[160:163], v[48:51]
v_cvt_pk_bf16_f32 v203, v206, v207
v_mfma_f32_16x16x32_bf16 v[48:51], a[12:15], a[176:179], v[48:51]
ds_read_b64_tr_b16 a[54:55], v21 offset:18432
buffer_store_dwordx4 v[200:203], v28, s[12:15], s67 offen offset:2048 sc1
v_mfma_f32_16x16x32_bf16 v[48:51], a[20:23], a[192:195], v[48:51]
ds_read_b64_tr_b16 a[56:57], v20 offset:24576
ds_write_b128 v12, v[200:203] offset:51200
v_mfma_f32_16x16x32_bf16 v[48:51], a[28:31], a[208:211], v[48:51]
ds_read_b64_tr_b16 a[58:59], v20 offset:30720
v_mfma_f32_16x16x32_bf16 v[36:39], a[0:3], a[164:167], v[36:39]
v_cvt_pk_bf16_f32 v216, v216, v217
v_mfma_f32_16x16x32_bf16 v[36:39], a[8:11], a[180:183], v[36:39]
ds_read_b64_tr_b16 a[60:61], v21 offset:24576
v_cvt_pk_bf16_f32 v217, v218, v219
v_mfma_f32_16x16x32_bf16 v[36:39], a[16:19], a[196:199], v[36:39]
ds_read_b64_tr_b16 a[62:63], v21 offset:30720
v_cvt_pk_bf16_f32 v218, v220, v221
v_mfma_f32_16x16x32_bf16 v[36:39], a[24:27], a[212:215], v[36:39]
ds_read_b64_tr_b16 a[64:65], v8 offset:12288
v_mfma_f32_16x16x32_bf16 v[52:55], a[4:7], a[164:167], v[52:55]
v_cvt_pk_bf16_f32 v219, v222, v223
v_mfma_f32_16x16x32_bf16 v[52:55], a[12:15], a[180:183], v[52:55]
ds_read_b64_tr_b16 a[66:67], v8 offset:18432
buffer_store_dwordx4 v[216:219], v28, s[12:15], s67 offen offset:3072 sc1
v_mfma_f32_16x16x32_bf16 v[52:55], a[20:23], a[196:199], v[52:55]
ds_read_b64_tr_b16 a[68:69], v9 offset:12288
v_mfma_f32_16x16x32_bf16 v[52:55], a[28:31], a[212:215], v[52:55]
ds_write_b128 v12, v[216:219] offset:52224
v_mfma_f32_16x16x32_bf16 v[40:43], a[0:3], a[168:171], v[40:43]
v_mul_f32 v32, s90, v32
v_mul_f32 v33, s90, v33
v_mfma_f32_16x16x32_bf16 v[40:43], a[8:11], a[184:187], v[40:43]
ds_read_b64_tr_b16 a[70:71], v9 offset:18432
v_mul_f32 v34, s90, v34
v_mfma_f32_16x16x32_bf16 v[40:43], a[16:19], a[200:203], v[40:43]
ds_read_b64_tr_b16 a[72:73], v8 offset:24576
v_mul_f32 v35, s90, v35
v_mul_f32 v48, s90, v48
v_mfma_f32_16x16x32_bf16 v[40:43], a[24:27], a[216:219], v[40:43]
v_mul_f32 v49, s90, v49
v_mfma_f32_16x16x32_bf16 v[56:59], a[4:7], a[168:171], v[56:59]
ds_read_b64_tr_b16 a[74:75], v8 offset:30720
v_mul_f32 v50, s90, v50
v_mul_f32 v51, s90, v51
v_mfma_f32_16x16x32_bf16 v[56:59], a[12:15], a[184:187], v[56:59]
ds_read_b64_tr_b16 a[76:77], v9 offset:24576
v_cvt_pk_bf16_f32 v32, v32, v33
v_cvt_pk_bf16_f32 v33, v34, v35
v_mfma_f32_16x16x32_bf16 v[56:59], a[20:23], a[200:203], v[56:59]
v_cvt_pk_bf16_f32 v34, v48, v49
v_mfma_f32_16x16x32_bf16 v[56:59], a[28:31], a[216:219], v[56:59]
ds_read_b64_tr_b16 a[78:79], v9 offset:30720
v_cvt_pk_bf16_f32 v35, v50, v51
v_mfma_f32_16x16x32_bf16 v[44:47], a[0:3], a[172:175], v[44:47]
ds_write_b128 v27, v[32:35] offset:0
v_mul_f32 v36, s90, v36
v_mul_f32 v37, s90, v37
v_mfma_f32_16x16x32_bf16 v[44:47], a[8:11], a[188:191], v[44:47]
v_mul_f32 v38, s90, v38
v_mul_f32 v39, s90, v39
v_mfma_f32_16x16x32_bf16 v[44:47], a[16:19], a[204:207], v[44:47]
v_mul_f32 v52, s90, v52
v_mfma_f32_16x16x32_bf16 v[44:47], a[24:27], a[220:223], v[44:47]
v_mul_f32 v53, s90, v53
v_mul_f32 v54, s90, v54
v_mfma_f32_16x16x32_bf16 v[60:63], a[4:7], a[172:175], v[60:63]
v_mul_f32 v55, s90, v55
v_cvt_pk_bf16_f32 v36, v36, v37
v_mfma_f32_16x16x32_bf16 v[60:63], a[12:15], a[188:191], v[60:63]
v_cvt_pk_bf16_f32 v37, v38, v39
v_mfma_f32_16x16x32_bf16 v[60:63], a[20:23], a[204:207], v[60:63]
v_cvt_pk_bf16_f32 v38, v52, v53
v_cvt_pk_bf16_f32 v39, v54, v55
v_mfma_f32_16x16x32_bf16 v[60:63], a[28:31], a[220:223], v[60:63]
ds_write_b128 v27, v[36:39] offset:1024
s_waitcnt lgkmcnt(0)
v_mfma_f32_16x16x32_bf16 v[64:67], a[48:51], a[160:163], v[64:67]
v_mul_f32 v40, s90, v40
v_mul_f32 v41, s90, v41
v_mfma_f32_16x16x32_bf16 v[64:67], a[56:59], a[176:179], v[64:67]
v_mul_f32 v42, s90, v42
v_mul_f32 v43, s90, v43
v_mfma_f32_16x16x32_bf16 v[64:67], a[64:67], a[192:195], v[64:67]
v_mul_f32 v56, s90, v56
v_mfma_f32_16x16x32_bf16 v[64:67], a[72:75], a[208:211], v[64:67]
v_mul_f32 v57, s90, v57
v_mul_f32 v58, s90, v58
v_mfma_f32_16x16x32_bf16 v[80:83], a[52:55], a[160:163], v[80:83]
v_mul_f32 v59, s90, v59
v_cvt_pk_bf16_f32 v40, v40, v41
v_mfma_f32_16x16x32_bf16 v[80:83], a[60:63], a[176:179], v[80:83]
v_cvt_pk_bf16_f32 v41, v42, v43
v_mfma_f32_16x16x32_bf16 v[80:83], a[68:71], a[192:195], v[80:83]
v_cvt_pk_bf16_f32 v42, v56, v57
v_cvt_pk_bf16_f32 v43, v58, v59
v_mfma_f32_16x16x32_bf16 v[80:83], a[76:79], a[208:211], v[80:83]
ds_write_b128 v27, v[40:43] offset:2048
v_mfma_f32_16x16x32_bf16 v[68:71], a[48:51], a[164:167], v[68:71]
v_mul_f32 v44, s90, v44
v_mul_f32 v45, s90, v45
v_mfma_f32_16x16x32_bf16 v[68:71], a[56:59], a[180:183], v[68:71]
v_mul_f32 v46, s90, v46
v_mul_f32 v47, s90, v47
v_mfma_f32_16x16x32_bf16 v[68:71], a[64:67], a[196:199], v[68:71]
v_mul_f32 v60, s90, v60
v_mfma_f32_16x16x32_bf16 v[68:71], a[72:75], a[212:215], v[68:71]
v_mul_f32 v61, s90, v61
v_mul_f32 v62, s90, v62
v_mfma_f32_16x16x32_bf16 v[84:87], a[52:55], a[164:167], v[84:87]
v_mul_f32 v63, s90, v63
v_cvt_pk_bf16_f32 v44, v44, v45
v_mfma_f32_16x16x32_bf16 v[84:87], a[60:63], a[180:183], v[84:87]
v_cvt_pk_bf16_f32 v45, v46, v47
v_mfma_f32_16x16x32_bf16 v[84:87], a[68:71], a[196:199], v[84:87]
v_cvt_pk_bf16_f32 v46, v60, v61
v_cvt_pk_bf16_f32 v47, v62, v63
v_mfma_f32_16x16x32_bf16 v[84:87], a[76:79], a[212:215], v[84:87]
ds_write_b128 v27, v[44:47] offset:3072
v_mfma_f32_16x16x32_bf16 v[72:75], a[48:51], a[168:171], v[72:75]
v_mul_f32 v64, s90, v64
v_mul_f32 v65, s90, v65
v_mfma_f32_16x16x32_bf16 v[72:75], a[56:59], a[184:187], v[72:75]
v_mul_f32 v66, s90, v66
v_mul_f32 v67, s90, v67
v_mfma_f32_16x16x32_bf16 v[72:75], a[64:67], a[200:203], v[72:75]
v_mul_f32 v80, s90, v80
v_mfma_f32_16x16x32_bf16 v[72:75], a[72:75], a[216:219], v[72:75]
v_mul_f32 v81, s90, v81
v_mul_f32 v82, s90, v82
v_mfma_f32_16x16x32_bf16 v[88:91], a[52:55], a[168:171], v[88:91]
v_mul_f32 v83, s90, v83
v_cvt_pk_bf16_f32 v64, v64, v65
v_mfma_f32_16x16x32_bf16 v[88:91], a[60:63], a[184:187], v[88:91]
v_cvt_pk_bf16_f32 v65, v66, v67
v_mfma_f32_16x16x32_bf16 v[88:91], a[68:71], a[200:203], v[88:91]
v_cvt_pk_bf16_f32 v66, v80, v81
v_cvt_pk_bf16_f32 v67, v82, v83
v_mfma_f32_16x16x32_bf16 v[88:91], a[76:79], a[216:219], v[88:91]
ds_write_b128 v27, v[64:67] offset:16384
v_mfma_f32_16x16x32_bf16 v[76:79], a[48:51], a[172:175], v[76:79]
v_mul_f32 v68, s90, v68
v_mul_f32 v69, s90, v69
v_mfma_f32_16x16x32_bf16 v[76:79], a[56:59], a[188:191], v[76:79]
v_mul_f32 v70, s90, v70
v_mul_f32 v71, s90, v71
v_mfma_f32_16x16x32_bf16 v[76:79], a[64:67], a[204:207], v[76:79]
v_mul_f32 v84, s90, v84
v_mfma_f32_16x16x32_bf16 v[76:79], a[72:75], a[220:223], v[76:79]
v_mul_f32 v85, s90, v85
v_mul_f32 v86, s90, v86
v_mfma_f32_16x16x32_bf16 v[92:95], a[52:55], a[172:175], v[92:95]
v_mul_f32 v87, s90, v87
v_cvt_pk_bf16_f32 v68, v68, v69
v_mfma_f32_16x16x32_bf16 v[92:95], a[60:63], a[188:191], v[92:95]
v_cvt_pk_bf16_f32 v69, v70, v71
v_mfma_f32_16x16x32_bf16 v[92:95], a[68:71], a[204:207], v[92:95]
v_cvt_pk_bf16_f32 v70, v84, v85
v_cvt_pk_bf16_f32 v71, v86, v87
v_mfma_f32_16x16x32_bf16 v[92:95], a[76:79], a[220:223], v[92:95]
ds_write_b128 v27, v[68:71] offset:17408
v_mul_f32 v72, s90, v72
v_mul_f32 v73, s90, v73
v_mul_f32 v74, s90, v74
v_mul_f32 v75, s90, v75
v_mul_f32 v88, s90, v88
v_mul_f32 v89, s90, v89
v_mul_f32 v90, s90, v90
v_mul_f32 v91, s90, v91
v_cvt_pk_bf16_f32 v72, v72, v73
v_cvt_pk_bf16_f32 v73, v74, v75
v_cvt_pk_bf16_f32 v74, v88, v89
v_cvt_pk_bf16_f32 v75, v90, v91
ds_write_b128 v27, v[72:75] offset:18432
v_mul_f32 v76, s90, v76
v_mul_f32 v77, s90, v77
v_mul_f32 v78, s90, v78
v_mul_f32 v79, s90, v79
v_mul_f32 v92, s90, v92
v_mul_f32 v93, s90, v93
v_mul_f32 v94, s90, v94
v_mul_f32 v95, s90, v95
v_cvt_pk_bf16_f32 v76, v76, v77
v_cvt_pk_bf16_f32 v77, v78, v79
v_cvt_pk_bf16_f32 v78, v92, v93
v_cvt_pk_bf16_f32 v79, v94, v95
ds_write_b128 v27, v[76:79] offset:19456
s_mov_b32 s28, s50
s_and_b32 s29, s51, 0xffff
s_mov_b32 s30, 4194304
s_mov_b32 s31, 0x00020000
s_waitcnt lgkmcnt(0)
s_barrier
ds_read_b128 v[32:35], v245 offset:0
ds_read_b128 a[128:131], v244 offset:0
ds_read_b128 a[132:135], v244 offset:1024
ds_read_b128 v[36:39], v245 offset:2048
ds_read_b128 a[136:139], v244 offset:2048
ds_read_b128 a[140:143], v244 offset:3072
ds_read_b128 v[40:43], v245 offset:4096
ds_read_b128 a[144:147], v244 offset:4096
ds_read_b128 a[148:151], v244 offset:5120
ds_read_b128 v[44:47], v245 offset:6144
ds_read_b128 a[152:155], v244 offset:6144
ds_read_b128 a[156:159], v244 offset:7168
ds_read_b128 v[48:51], v245 offset:8192
ds_read_b128 a[160:163], v244 offset:8192
ds_read_b128 a[164:167], v244 offset:9216
ds_read_b128 v[52:55], v245 offset:10240
ds_read_b128 a[168:171], v244 offset:10240
ds_read_b128 a[172:175], v244 offset:11264
ds_read_b128 v[56:59], v245 offset:12288
ds_read_b128 a[176:179], v244 offset:12288
ds_read_b128 a[180:183], v244 offset:13312
ds_read_b128 v[60:63], v245 offset:14336
ds_read_b128 a[184:187], v244 offset:14336
ds_read_b128 a[188:191], v244 offset:15360
v_lshrrev_b32 v27, 6, v1
v_and_b32 v27, 7, v27
v_lshrrev_b32 v28, 9, v1
v_mul_u32_u24 v28, 4096, v28
v_bfe_u32 v29, v1, 4, 2
v_lshl_add_u32 v28, v29, 3, v28
v_lshl_add_u32 v29, v27, 7, v28
v_lshrrev_b32 v30, 1, v27
v_xor_b32 v6, 0, v30
v_lshl_add_u32 v6, v6, 5, v29
v_xor_b32 v7, 1, v30
v_lshl_add_u32 v7, v7, 5, v29
v_xor_b32 v8, 2, v30
v_lshl_add_u32 v8, v8, 5, v29
v_xor_b32 v9, 3, v30
v_lshl_add_u32 v9, v9, 5, v29
v_add_u32 v10, 16384, v1
s_mov_b32 s91, 0x57800000
s_lshl_b32 s42, s3, 12
s_mov_b32 s64, 0
s_waitcnt vmcnt(0)
buffer_store_dword v26, v25, s[12:15], s98 offen sc1
s_waitcnt lgkmcnt(0)
v_mfma_f32_16x16x32_bf16 v[64:67], a[128:131], v[32:35], v[224:227]
ds_read_b128 a[192:195], v244 offset:32768
v_mfma_f32_16x16x32_bf16 v[68:71], a[132:135], v[32:35], v[228:231]
ds_read_b128 a[196:199], v244 offset:33792
v_mfma_f32_16x16x32_bf16 v[76:79], a[136:139], v[36:39], v[224:227]
ds_read_b128 a[200:203], v244 offset:34816
v_mfma_f32_16x16x32_bf16 v[80:83], a[140:143], v[36:39], v[228:231]
ds_read_b128 a[204:207], v244 offset:35840
v_mfma_f32_16x16x32_bf16 v[88:91], a[144:147], v[40:43], v[224:227]
ds_read_b128 a[208:211], v244 offset:36864
v_mfma_f32_16x16x32_bf16 v[92:95], a[148:151], v[40:43], v[228:231]
ds_read_b128 a[212:215], v244 offset:37888
v_mfma_f32_16x16x32_bf16 v[100:103], a[152:155], v[44:47], v[224:227]
ds_read_b128 a[216:219], v244 offset:38912
v_mfma_f32_16x16x32_bf16 v[104:107], a[156:159], v[44:47], v[228:231]
ds_read_b128 a[220:223], v244 offset:39936
v_mfma_f32_16x16x32_bf16 v[112:115], a[160:163], v[48:51], v[224:227]
ds_read_b128 a[224:227], v244 offset:40960
v_mfma_f32_16x16x32_bf16 v[116:119], a[164:167], v[48:51], v[228:231]
ds_read_b128 a[228:231], v244 offset:41984
v_mfma_f32_16x16x32_bf16 v[124:127], a[168:171], v[52:55], v[224:227]
ds_read_b128 a[232:235], v244 offset:43008
v_mfma_f32_16x16x32_bf16 v[128:131], a[172:175], v[52:55], v[228:231]
ds_read_b128 a[236:239], v244 offset:44032
v_mfma_f32_16x16x32_bf16 v[136:139], a[176:179], v[56:59], v[224:227]
ds_read_b128 a[240:243], v244 offset:45056
v_mfma_f32_16x16x32_bf16 v[140:143], a[180:183], v[56:59], v[228:231]
ds_read_b128 a[244:247], v244 offset:46080
v_mfma_f32_16x16x32_bf16 v[148:151], a[184:187], v[60:63], v[224:227]
ds_read_b128 a[248:251], v244 offset:47104
v_mfma_f32_16x16x32_bf16 v[152:155], a[188:191], v[60:63], v[228:231]
ds_read_b128 a[252:255], v244 offset:48128
v_max3_f32 v163, v64, v65, v66
v_max3_f32 v167, v76, v77, v78
v_max3_f32 v171, v88, v89, v90
v_max3_f32 v175, v100, v101, v102
v_max3_f32 v179, v112, v113, v114
v_max3_f32 v183, v124, v125, v126
v_max3_f32 v187, v136, v137, v138
v_max3_f32 v191, v148, v149, v150
v_max3_f32 v163, v163, v67, v68
v_max3_f32 v167, v167, v79, v80
v_max3_f32 v171, v171, v91, v92
v_max3_f32 v175, v175, v103, v104
v_max3_f32 v179, v179, v115, v116
v_max3_f32 v183, v183, v127, v128
v_max3_f32 v187, v187, v139, v140
v_max3_f32 v191, v191, v151, v152
v_max3_f32 v163, v163, v69, v70
v_max3_f32 v167, v167, v81, v82
v_max3_f32 v171, v171, v93, v94
v_max3_f32 v175, v175, v105, v106
v_max3_f32 v179, v179, v117, v118
v_max3_f32 v183, v183, v129, v130
v_max3_f32 v187, v187, v141, v142
v_max3_f32 v191, v191, v153, v154
v_max_f32 v163, v163, v71
v_max_f32 v167, v167, v83
v_max_f32 v171, v171, v95
v_max_f32 v175, v175, v107
v_max_f32 v179, v179, v119
v_max_f32 v183, v183, v131
v_max_f32 v187, v187, v143
v_max_f32 v191, v191, v155
v_add_u32 v2, 0, v14
v_add_u32 v3, 64512, v14
v_add_u32 v4, 129024, v14
v_add_u32 v5, 193536, v14
s_waitcnt lgkmcnt(0)
s_barrier
fk_again:
s_mov_b64 s[58:59], 0
v_mov_b32 v162, v163
v_mov_b32 v166, v167
v_mov_b32 v170, v171
v_mov_b32 v174, v175
v_mov_b32 v178, v179
v_mov_b32 v182, v183
v_mov_b32 v186, v187
v_mov_b32 v190, v191
v_permlane32_swap_b32 v163, v162
v_permlane32_swap_b32 v167, v166
v_permlane32_swap_b32 v171, v170
v_permlane32_swap_b32 v175, v174
v_permlane32_swap_b32 v179, v178
v_permlane32_swap_b32 v183, v182
v_permlane32_swap_b32 v187, v186
v_permlane32_swap_b32 v191, v190
v_max_f32 v163, v163, v162
v_max_f32 v167, v167, v166
v_max_f32 v171, v171, v170
v_max_f32 v175, v175, v174
v_max_f32 v179, v179, v178
v_max_f32 v183, v183, v182
v_max_f32 v187, v187, v186
v_max_f32 v191, v191, v190
v_mov_b32 v162, v163
v_mov_b32 v166, v167
v_mov_b32 v170, v171
v_mov_b32 v174, v175
v_mov_b32 v178, v179
v_mov_b32 v182, v183
v_mov_b32 v186, v187
v_mov_b32 v190, v191
v_permlane16_swap_b32 v163, v162
v_permlane16_swap_b32 v167, v166
v_permlane16_swap_b32 v171, v170
v_permlane16_swap_b32 v175, v174
v_permlane16_swap_b32 v179, v178
v_permlane16_swap_b32 v183, v182
v_permlane16_swap_b32 v187, v186
v_permlane16_swap_b32 v191, v190
v_max_f32 v163, v163, v162
v_max_f32 v167, v167, v166
v_max_f32 v171, v171, v170
v_max_f32 v175, v175, v174
v_max_f32 v179, v179, v178
v_max_f32 v183, v183, v182
v_max_f32 v187, v187, v186
v_max_f32 v191, v191, v190
v_sub_f32 v160, 0, v163
v_sub_f32 v164, 0, v167
v_sub_f32 v168, 0, v171
v_sub_f32 v172, 0, v175
v_sub_f32 v176, 0, v179
v_sub_f32 v180, 0, v183
v_sub_f32 v184, 0, v187
v_sub_f32 v188, 0, v191
v_sub_f32 v161, 0, v163
v_sub_f32 v165, 0, v167
v_sub_f32 v169, 0, v171
v_sub_f32 v173, 0, v175
v_sub_f32 v177, 0, v179
v_sub_f32 v181, 0, v183
v_sub_f32 v185, 0, v187
v_sub_f32 v189, 0, v191
v_sub_f32 v162, 0, v163
v_sub_f32 v166, 0, v167
v_sub_f32 v170, 0, v171
v_sub_f32 v174, 0, v175
v_sub_f32 v178, 0, v179
v_sub_f32 v182, 0, v183
v_sub_f32 v186, 0, v187
v_sub_f32 v190, 0, v191
v_sub_f32 v163, 0, v163
v_sub_f32 v167, 0, v167
v_sub_f32 v171, 0, v171
v_sub_f32 v175, 0, v175
v_sub_f32 v179, 0, v179
v_sub_f32 v183, 0, v183
v_sub_f32 v187, 0, v187
v_sub_f32 v191, 0, v191
s_waitcnt lgkmcnt(0)
v_add_f32 v192, v64, v160
v_add_f32 v193, v65, v160
v_add_f32 v194, v66, v160
v_add_f32 v195, v67, v160
v_add_f32 v196, v68, v160
v_add_f32 v197, v69, v160
v_add_f32 v198, v70, v160
v_add_f32 v199, v71, v160
v_add_f32 v200, v76, v164
v_add_f32 v201, v77, v164
v_add_f32 v202, v78, v164
v_add_f32 v203, v79, v164
v_add_f32 v204, v80, v164
v_add_f32 v205, v81, v164
v_add_f32 v206, v82, v164
v_add_f32 v207, v83, v164
v_exp_f32 v192, v192
v_exp_f32 v193, v193
v_exp_f32 v194, v194
v_exp_f32 v195, v195
v_exp_f32 v196, v196
v_exp_f32 v197, v197
v_exp_f32 v198, v198
v_exp_f32 v199, v199
v_cvt_pk_bf16_f32 v192, v192, v193
v_cvt_pk_bf16_f32 v193, v194, v195
v_cvt_pk_bf16_f32 v194, v196, v197
v_cvt_pk_bf16_f32 v195, v198, v199
v_add_f32 v208, v88, v168
v_add_f32 v209, v89, v168
v_add_f32 v210, v90, v168
v_add_f32 v211, v91, v168
v_add_f32 v212, v92, v168
v_add_f32 v213, v93, v168
v_add_f32 v214, v94, v168
v_add_f32 v215, v95, v168
s_add_u32 m0, s42, 49152
v_exp_f32 v200, v200
v_exp_f32 v201, v201
v_exp_f32 v202, v202
v_exp_f32 v203, v203
v_exp_f32 v204, v204
v_exp_f32 v205, v205
v_exp_f32 v206, v206
v_exp_f32 v207, v207
v_cvt_pk_bf16_f32 v200, v200, v201
v_mfma_f32_16x16x32_bf16 v[64:67], a[192:195], v[192:195], 0
buffer_load_dwordx4 v14, s[20:23], s71 offen offset:0 lds
buffer_load_dwordx4 v15, s[20:23], s71 offen offset:1024 lds
v_cvt_pk_bf16_f32 v201, v202, v203
v_cvt_pk_bf16_f32 v202, v204, v205
v_cvt_pk_bf16_f32 v203, v206, v207
v_add_f32 v216, v100, v172
v_mfma_f32_16x16x32_bf16 v[68:71], a[196:199], v[192:195], 0
v_add_f32 v217, v101, v172
v_add_f32 v218, v102, v172
v_add_f32 v219, v103, v172
v_add_f32 v220, v104, v172
v_mfma_f32_16x16x32_bf16 v[72:75], v[240:243], v[192:195], 0
v_add_f32 v221, v105, v172
v_add_f32 v222, v106, v172
v_add_f32 v223, v107, v172
v_exp_f32 v208, v208
v_exp_f32 v209, v209
v_exp_f32 v210, v210
v_exp_f32 v211, v211
v_exp_f32 v212, v212
v_exp_f32 v213, v213
v_exp_f32 v214, v214
v_exp_f32 v215, v215
v_cvt_pk_bf16_f32 v208, v208, v209
v_mfma_f32_16x16x32_bf16 v[76:79], a[200:203], v[200:203], 0
buffer_load_dwordx4 v16, s[20:23], s71 offen offset:2048 lds
buffer_load_dwordx4 v17, s[20:23], s71 offen offset:3072 lds
s_add_u32 s71, s71, 0xe0000
v_cvt_pk_bf16_f32 v209, v210, v211
v_cvt_pk_bf16_f32 v210, v212, v213
v_cvt_pk_bf16_f32 v211, v214, v215
v_add_f32 v192, v112, v176
v_mfma_f32_16x16x32_bf16 v[80:83], a[204:207], v[200:203], 0
v_add_f32 v193, v113, v176
v_add_f32 v194, v114, v176
v_add_f32 v195, v115, v176
v_add_f32 v196, v116, v176
v_mfma_f32_16x16x32_bf16 v[84:87], v[240:243], v[200:203], 0
v_add_f32 v197, v117, v176
v_add_f32 v198, v118, v176
v_add_f32 v199, v119, v176
s_add_u32 m0, s42, 65536
v_exp_f32 v216, v216
v_exp_f32 v217, v217
v_exp_f32 v218, v218
v_exp_f32 v219, v219
v_exp_f32 v220, v220
v_exp_f32 v221, v221
v_exp_f32 v222, v222
v_exp_f32 v223, v223
v_cvt_pk_bf16_f32 v216, v216, v217
v_mfma_f32_16x16x32_bf16 v[88:91], a[208:211], v[208:211], 0
buffer_load_dwordx4 v14, s[20:23], s71 offen offset:0 lds
buffer_load_dwordx4 v15, s[20:23], s71 offen offset:1024 lds
v_cvt_pk_bf16_f32 v217, v218, v219
v_cvt_pk_bf16_f32 v218, v220, v221
v_cvt_pk_bf16_f32 v219, v222, v223
v_add_f32 v200, v124, v180
v_mfma_f32_16x16x32_bf16 v[92:95], a[212:215], v[208:211], 0
v_add_f32 v201, v125, v180
v_add_f32 v202, v126, v180
v_add_f32 v203, v127, v180
v_add_f32 v204, v128, v180
v_mfma_f32_16x16x32_bf16 v[96:99], v[240:243], v[208:211], 0
v_add_f32 v205, v129, v180
v_add_f32 v206, v130, v180
v_add_f32 v207, v131, v180
v_exp_f32 v192, v192
v_exp_f32 v193, v193
v_exp_f32 v194, v194
v_exp_f32 v195, v195
v_exp_f32 v196, v196
v_exp_f32 v197, v197
v_exp_f32 v198, v198
v_exp_f32 v199, v199
v_cvt_pk_bf16_f32 v192, v192, v193
v_mfma_f32_16x16x32_bf16 v[100:103], a[216:219], v[216:219], 0
buffer_load_dwordx4 v16, s[20:23], s71 offen offset:2048 lds
buffer_load_dwordx4 v17, s[20:23], s71 offen offset:3072 lds
s_add_u32 s71, s71, 0xe0000
v_cvt_pk_bf16_f32 v193, v194, v195
v_cvt_pk_bf16_f32 v194, v196, v197
v_cvt_pk_bf16_f32 v195, v198, v199
v_add_f32 v208, v136, v184
v_mfma_f32_16x16x32_bf16 v[104:107], a[220:223], v[216:219], 0
v_add_f32 v209, v137, v184
v_add_f32 v210, v138, v184
v_add_f32 v211, v139, v184
v_add_f32 v212, v140, v184
v_mfma_f32_16x16x32_bf16 v[108:111], v[240:243], v[216:219], 0
v_add_f32 v213, v141, v184
v_add_f32 v214, v142, v184
v_add_f32 v215, v143, v184
s_add_u32 m0, s42, 81920
v_exp_f32 v200, v200
v_exp_f32 v201, v201
v_exp_f32 v202, v202
v_exp_f32 v203, v203
v_exp_f32 v204, v204
v_exp_f32 v205, v205
v_exp_f32 v206, v206
v_exp_f32 v207, v207
v_cvt_pk_bf16_f32 v200, v200, v201
v_mfma_f32_16x16x32_bf16 v[112:115], a[224:227], v[192:195], 0
buffer_load_dwordx4 v14, s[20:23], s71 offen offset:0 lds
buffer_load_dwordx4 v15, s[20:23], s71 offen offset:1024 lds
v_cvt_pk_bf16_f32 v201, v202, v203
v_cvt_pk_bf16_f32 v202, v204, v205
v_cvt_pk_bf16_f32 v203, v206, v207
v_add_f32 v216, v148, v188
v_mfma_f32_16x16x32_bf16 v[116:119], a[228:231], v[192:195], 0
v_add_f32 v217, v149, v188
v_add_f32 v218, v150, v188
v_add_f32 v219, v151, v188
v_add_f32 v220, v152, v188
v_mfma_f32_16x16x32_bf16 v[120:123], v[240:243], v[192:195], 0
v_add_f32 v221, v153, v188
v_add_f32 v222, v154, v188
v_add_f32 v223, v155, v188
v_exp_f32 v208, v208
v_exp_f32 v209, v209
v_exp_f32 v210, v210
v_exp_f32 v211, v211
v_mfma_f32_16x16x32_bf16 v[192:195], a[128:131], v[36:39], v[164:167]
buffer_load_dwordx4 v16, s[20:23], s71 offen offset:2048 lds
buffer_load_dwordx4 v17, s[20:23], s71 offen offset:3072 lds
s_add_u32 s71, s71, 0xe0000
v_exp_f32 v212, v212
v_exp_f32 v213, v213
v_mfma_f32_16x16x32_bf16 v[196:199], a[132:135], v[36:39], v[164:167]
v_exp_f32 v214, v214
v_mfma_f32_16x16x32_bf16 v[124:127], a[232:235], v[200:203], 0
v_exp_f32 v215, v215
v_cvt_pk_bf16_f32 v208, v208, v209
v_mfma_f32_16x16x32_bf16 v[128:131], a[236:239], v[200:203], 0
v_cvt_pk_bf16_f32 v209, v210, v211
v_cvt_pk_bf16_f32 v210, v212, v213
v_mfma_f32_16x16x32_bf16 v[132:135], v[240:243], v[200:203], 0
v_cvt_pk_bf16_f32 v211, v214, v215
s_add_u32 m0, s42, 98304
v_exp_f32 v216, v216
v_exp_f32 v217, v217
v_exp_f32 v218, v218
v_exp_f32 v219, v219
v_mfma_f32_16x16x32_bf16 v[200:203], a[128:131], v[40:43], v[168:171]
buffer_load_dwordx4 v14, s[20:23], s71 offen offset:0 lds
buffer_load_dwordx4 v15, s[20:23], s71 offen offset:1024 lds
v_exp_f32 v220, v220
v_exp_f32 v221, v221
v_mfma_f32_16x16x32_bf16 v[204:207], a[132:135], v[40:43], v[168:171]
v_exp_f32 v222, v222
v_mfma_f32_16x16x32_bf16 v[136:139], a[240:243], v[208:211], 0
v_exp_f32 v223, v223
v_cvt_pk_bf16_f32 v216, v216, v217
v_mfma_f32_16x16x32_bf16 v[140:143], a[244:247], v[208:211], 0
v_cvt_pk_bf16_f32 v217, v218, v219
v_cvt_pk_bf16_f32 v218, v220, v221
v_mfma_f32_16x16x32_bf16 v[144:147], v[240:243], v[208:211], 0
v_cvt_pk_bf16_f32 v219, v222, v223
v_exp_f32 v192, v192
v_exp_f32 v193, v193
v_exp_f32 v194, v194
v_exp_f32 v195, v195
v_mfma_f32_16x16x32_bf16 v[208:211], a[128:131], v[44:47], v[172:175]
buffer_load_dwordx4 v16, s[20:23], s71 offen offset:2048 lds
buffer_load_dwordx4 v17, s[20:23], s71 offen offset:3072 lds
s_add_u32 s71, s71, 0xffd00000
v_exp_f32 v196, v196
v_exp_f32 v197, v197
v_mfma_f32_16x16x32_bf16 v[212:215], a[132:135], v[44:47], v[172:175]
v_exp_f32 v198, v198
v_mfma_f32_16x16x32_bf16 v[148:151], a[248:251], v[216:219], 0
v_exp_f32 v199, v199
v_cvt_pk_bf16_f32 v192, v192, v193
v_mfma_f32_16x16x32_bf16 v[152:155], a[252:255], v[216:219], 0
v_cvt_pk_bf16_f32 v193, v194, v195
v_cvt_pk_bf16_f32 v194, v196, v197
v_mfma_f32_16x16x32_bf16 v[156:159], v[240:243], v[216:219], 0
v_cvt_pk_bf16_f32 v195, v198, v199
v_exp_f32 v200, v200
v_mfma_f32_16x16x32_bf16 v[216:219], a[128:131], v[48:51], v[176:179]
v_exp_f32 v201, v201
v_exp_f32 v202, v202
v_mfma_f32_16x16x32_bf16 v[220:223], a[132:135], v[48:51], v[176:179]
v_exp_f32 v203, v203
v_exp_f32 v204, v204
v_mfma_f32_16x16x32_bf16 v[76:79], a[192:195], v[192:195], v[76:79]
v_exp_f32 v205, v205
v_exp_f32 v206, v206
v_exp_f32 v207, v207
v_mfma_f32_16x16x32_bf16 v[80:83], a[196:199], v[192:195], v[80:83]
v_cvt_pk_bf16_f32 v200, v200, v201
v_cvt_pk_bf16_f32 v201, v202, v203
v_mfma_f32_16x16x32_bf16 v[84:87], v[240:243], v[192:195], v[84:87]
v_cvt_pk_bf16_f32 v202, v204, v205
v_cvt_pk_bf16_f32 v203, v206, v207
v_exp_f32 v208, v208
v_mfma_f32_16x16x32_bf16 v[192:195], a[128:131], v[52:55], v[180:183]
v_exp_f32 v209, v209
v_exp_f32 v210, v210
v_mfma_f32_16x16x32_bf16 v[196:199], a[132:135], v[52:55], v[180:183]
v_exp_f32 v211, v211
v_exp_f32 v212, v212
v_mfma_f32_16x16x32_bf16 v[88:91], a[192:195], v[200:203], v[88:91]
v_exp_f32 v213, v213
v_exp_f32 v214, v214
v_exp_f32 v215, v215
v_mfma_f32_16x16x32_bf16 v[92:95], a[196:199], v[200:203], v[92:95]
v_cvt_pk_bf16_f32 v208, v208, v209
v_cvt_pk_bf16_f32 v209, v210, v211
v_mfma_f32_16x16x32_bf16 v[96:99], v[240:243], v[200:203], v[96:99]
v_cvt_pk_bf16_f32 v210, v212, v213
v_cvt_pk_bf16_f32 v211, v214, v215
v_exp_f32 v216, v216
v_mfma_f32_16x16x32_bf16 v[200:203], a[128:131], v[56:59], v[184:187]
v_exp_f32 v217, v217
v_exp_f32 v218, v218
v_mfma_f32_16x16x32_bf16 v[204:207], a[132:135], v[56:59], v[184:187]
v_exp_f32 v219, v219
PG16:
s_cbranch_execz PG19
v_exp_f32 v220, v220
v_mfma_f32_16x16x32_bf16 v[100:103], a[192:195], v[208:211], v[100:103]
v_exp_f32 v221, v221
v_exp_f32 v222, v222
v_exp_f32 v223, v223
v_mfma_f32_16x16x32_bf16 v[104:107], a[196:199], v[208:211], v[104:107]
v_cvt_pk_bf16_f32 v216, v216, v217
v_cvt_pk_bf16_f32 v217, v218, v219
v_mfma_f32_16x16x32_bf16 v[108:111], v[240:243], v[208:211], v[108:111]
v_cvt_pk_bf16_f32 v218, v220, v221
v_cvt_pk_bf16_f32 v219, v222, v223
v_exp_f32 v192, v192
v_mfma_f32_16x16x32_bf16 v[208:211], a[128:131], v[60:63], v[188:191]
v_exp_f32 v193, v193
v_exp_f32 v194, v194
v_mfma_f32_16x16x32_bf16 v[212:215], a[132:135], v[60:63], v[188:191]
v_exp_f32 v195, v195
v_exp_f32 v196, v196
v_mfma_f32_16x16x32_bf16 v[112:115], a[192:195], v[216:219], v[112:115]
v_exp_f32 v197, v197
v_exp_f32 v198, v198
v_exp_f32 v199, v199
v_mfma_f32_16x16x32_bf16 v[116:119], a[196:199], v[216:219], v[116:119]
v_cvt_pk_bf16_f32 v192, v192, v193
v_cvt_pk_bf16_f32 v193, v194, v195
v_mfma_f32_16x16x32_bf16 v[120:123], v[240:243], v[216:219], v[120:123]
v_cvt_pk_bf16_f32 v194, v196, v197
v_cvt_pk_bf16_f32 v195, v198, v199
v_exp_f32 v200, v200
v_mfma_f32_16x16x32_bf16 v[216:219], a[136:139], v[40:43], v[168:171]
v_exp_f32 v201, v201
v_exp_f32 v202, v202
v_mfma_f32_16x16x32_bf16 v[220:223], a[140:143], v[40:43], v[168:171]
v_exp_f32 v203, v203
v_exp_f32 v204, v204
v_mfma_f32_16x16x32_bf16 v[124:127], a[192:195], v[192:195], v[124:127]
v_exp_f32 v205, v205
v_exp_f32 v206, v206
v_exp_f32 v207, v207
v_mfma_f32_16x16x32_bf16 v[128:131], a[196:199], v[192:195], v[128:131]
v_cvt_pk_bf16_f32 v200, v200, v201
v_cvt_pk_bf16_f32 v201, v202, v203
v_mfma_f32_16x16x32_bf16 v[132:135], v[240:243], v[192:195], v[132:135]
v_cvt_pk_bf16_f32 v202, v204, v205
v_cvt_pk_bf16_f32 v203, v206, v207
v_exp_f32 v208, v208
v_mfma_f32_16x16x32_bf16 v[192:195], a[136:139], v[44:47], v[172:175]
buffer_load_dword v0, v24, s[12:15], s99 offen sc1
v_exp_f32 v209, v209
v_exp_f32 v210, v210
v_mfma_f32_16x16x32_bf16 v[196:199], a[140:143], v[44:47], v[172:175]
v_exp_f32 v211, v211
v_exp_f32 v212, v212
v_mfma_f32_16x16x32_bf16 v[136:139], a[192:195], v[200:203], v[136:139]
v_exp_f32 v213, v213
v_exp_f32 v214, v214
v_exp_f32 v215, v215
v_mfma_f32_16x16x32_bf16 v[140:143], a[196:199], v[200:203], v[140:143]
v_cvt_pk_bf16_f32 v208, v208, v209
v_cvt_pk_bf16_f32 v209, v210, v211
v_mfma_f32_16x16x32_bf16 v[144:147], v[240:243], v[200:203], v[144:147]
v_cvt_pk_bf16_f32 v210, v212, v213
v_cvt_pk_bf16_f32 v211, v214, v215
v_exp_f32 v216, v216
v_mfma_f32_16x16x32_bf16 v[200:203], a[136:139], v[48:51], v[176:179]
v_exp_f32 v217, v217
v_exp_f32 v218, v218
v_mfma_f32_16x16x32_bf16 v[204:207], a[140:143], v[48:51], v[176:179]
v_exp_f32 v219, v219
v_exp_f32 v220, v220
v_mfma_f32_16x16x32_bf16 v[148:151], a[192:195], v[208:211], v[148:151]
v_exp_f32 v221, v221
v_exp_f32 v222, v222
v_exp_f32 v223, v223
v_mfma_f32_16x16x32_bf16 v[152:155], a[196:199], v[208:211], v[152:155]
v_cvt_pk_bf16_f32 v216, v216, v217
v_cvt_pk_bf16_f32 v217, v218, v219
v_mfma_f32_16x16x32_bf16 v[156:159], v[240:243], v[208:211], v[156:159]
v_cvt_pk_bf16_f32 v218, v220, v221
v_cvt_pk_bf16_f32 v219, v222, v223
v_exp_f32 v192, v192
v_mfma_f32_16x16x32_bf16 v[208:211], a[136:139], v[52:55], v[180:183]
v_exp_f32 v193, v193
v_exp_f32 v194, v194
v_mfma_f32_16x16x32_bf16 v[212:215], a[140:143], v[52:55], v[180:183]
v_exp_f32 v195, v195
v_exp_f32 v196, v196
v_mfma_f32_16x16x32_bf16 v[88:91], a[200:203], v[216:219], v[88:91]
v_exp_f32 v197, v197
v_exp_f32 v198, v198
v_exp_f32 v199, v199
v_mfma_f32_16x16x32_bf16 v[92:95], a[204:207], v[216:219], v[92:95]
v_cvt_pk_bf16_f32 v192, v192, v193
v_cvt_pk_bf16_f32 v193, v194, v195
v_mfma_f32_16x16x32_bf16 v[96:99], v[240:243], v[216:219], v[96:99]
v_cvt_pk_bf16_f32 v194, v196, v197
v_cvt_pk_bf16_f32 v195, v198, v199
v_exp_f32 v200, v200
v_mfma_f32_16x16x32_bf16 v[216:219], a[136:139], v[56:59], v[184:187]
v_exp_f32 v201, v201
v_exp_f32 v202, v202
v_mfma_f32_16x16x32_bf16 v[220:223], a[140:143], v[56:59], v[184:187]
v_exp_f32 v203, v203
v_exp_f32 v204, v204
v_mfma_f32_16x16x32_bf16 v[100:103], a[200:203], v[192:195], v[100:103]
v_exp_f32 v205, v205
v_exp_f32 v206, v206
v_exp_f32 v207, v207
v_mfma_f32_16x16x32_bf16 v[104:107], a[204:207], v[192:195], v[104:107]
v_cvt_pk_bf16_f32 v200, v200, v201
v_cvt_pk_bf16_f32 v201, v202, v203
v_mfma_f32_16x16x32_bf16 v[108:111], v[240:243], v[192:195], v[108:111]
v_cvt_pk_bf16_f32 v202, v204, v205
v_cvt_pk_bf16_f32 v203, v206, v207
v_exp_f32 v208, v208
v_mfma_f32_16x16x32_bf16 v[192:195], a[136:139], v[60:63], v[188:191]
v_exp_f32 v209, v209
v_exp_f32 v210, v210
v_mfma_f32_16x16x32_bf16 v[196:199], a[140:143], v[60:63], v[188:191]
v_exp_f32 v211, v211
v_exp_f32 v212, v212
v_mfma_f32_16x16x32_bf16 v[112:115], a[200:203], v[200:203], v[112:115]
v_exp_f32 v213, v213
v_exp_f32 v214, v214
v_exp_f32 v215, v215
v_mfma_f32_16x16x32_bf16 v[116:119], a[204:207], v[200:203], v[116:119]
v_cvt_pk_bf16_f32 v208, v208, v209
v_cvt_pk_bf16_f32 v209, v210, v211
v_mfma_f32_16x16x32_bf16 v[120:123], v[240:243], v[200:203], v[120:123]
v_cvt_pk_bf16_f32 v210, v212, v213
v_cvt_pk_bf16_f32 v211, v214, v215
v_exp_f32 v216, v216
v_mfma_f32_16x16x32_bf16 v[200:203], a[144:147], v[44:47], v[172:175]
v_exp_f32 v217, v217
v_exp_f32 v218, v218
v_mfma_f32_16x16x32_bf16 v[204:207], a[148:151], v[44:47], v[172:175]
v_exp_f32 v219, v219
v_exp_f32 v220, v220
v_mfma_f32_16x16x32_bf16 v[124:127], a[200:203], v[208:211], v[124:127]
v_exp_f32 v221, v221
v_exp_f32 v222, v222
v_exp_f32 v223, v223
v_mfma_f32_16x16x32_bf16 v[128:131], a[204:207], v[208:211], v[128:131]
v_cvt_pk_bf16_f32 v216, v216, v217
v_cvt_pk_bf16_f32 v217, v218, v219
v_mfma_f32_16x16x32_bf16 v[132:135], v[240:243], v[208:211], v[132:135]
v_cvt_pk_bf16_f32 v218, v220, v221
v_cvt_pk_bf16_f32 v219, v222, v223
v_exp_f32 v192, v192
v_mfma_f32_16x16x32_bf16 v[208:211], a[144:147], v[48:51], v[176:179]
v_exp_f32 v193, v193
v_exp_f32 v194, v194
v_mfma_f32_16x16x32_bf16 v[212:215], a[148:151], v[48:51], v[176:179]
v_exp_f32 v195, v195
v_exp_f32 v196, v196
v_mfma_f32_16x16x32_bf16 v[136:139], a[200:203], v[216:219], v[136:139]
v_exp_f32 v197, v197
v_exp_f32 v198, v198
v_exp_f32 v199, v199
v_mfma_f32_16x16x32_bf16 v[140:143], a[204:207], v[216:219], v[140:143]
v_cvt_pk_bf16_f32 v192, v192, v193
v_cvt_pk_bf16_f32 v193, v194, v195
v_mfma_f32_16x16x32_bf16 v[144:147], v[240:243], v[216:219], v[144:147]
v_cvt_pk_bf16_f32 v194, v196, v197
v_cvt_pk_bf16_f32 v195, v198, v199
v_exp_f32 v200, v200
v_mfma_f32_16x16x32_bf16 v[216:219], a[144:147], v[52:55], v[180:183]
v_exp_f32 v201, v201
v_exp_f32 v202, v202
v_mfma_f32_16x16x32_bf16 v[220:223], a[148:151], v[52:55], v[180:183]
v_exp_f32 v203, v203
v_exp_f32 v204, v204
v_mfma_f32_16x16x32_bf16 v[148:151], a[200:203], v[192:195], v[148:151]
v_exp_f32 v205, v205
v_exp_f32 v206, v206
v_exp_f32 v207, v207
v_mfma_f32_16x16x32_bf16 v[152:155], a[204:207], v[192:195], v[152:155]
v_cvt_pk_bf16_f32 v200, v200, v201
v_cvt_pk_bf16_f32 v201, v202, v203
v_mfma_f32_16x16x32_bf16 v[156:159], v[240:243], v[192:195], v[156:159]
v_cvt_pk_bf16_f32 v202, v204, v205
v_cvt_pk_bf16_f32 v203, v206, v207
s_waitcnt vmcnt(0)
s_cmp_eq_u32 s62, 0
s_cselect_b32 s84, 0, 15
s_mov_b32 s86, 0
fk_sh_chk:
v_cmp_eq_u32 vcc, v26, v0
s_nop 1
s_andn2_b64 s[88:89], s[84:85], vcc
s_cbranch_scc0 fk_sh_ok
s_add_u32 s86, s86, 1
s_cmp_gt_u32 s86, 0x8000
s_cbranch_scc1 fk_sh_ok
s_sleep 2
fk_sh_ld:
buffer_load_dword v0, v24, s[12:15], s99 offen sc1
s_waitcnt vmcnt(0)
s_branch fk_sh_chk
fk_sh_ok:
s_add_u32 s46, s100, 12288
v_exp_f32 v208, v208
v_exp_f32 v209, v209
v_exp_f32 v210, v210
v_mfma_f32_16x16x32_bf16 v[192:195], a[144:147], v[56:59], v[184:187]
buffer_load_dwordx4 a[56:59], v1, s[12:15], s46 offen offset:2048 sc1
v_exp_f32 v211, v211
v_exp_f32 v212, v212
v_mfma_f32_16x16x32_bf16 v[196:199], a[148:151], v[56:59], v[184:187]
v_exp_f32 v213, v213
v_exp_f32 v214, v214
v_mfma_f32_16x16x32_bf16 v[100:103], a[208:211], v[200:203], v[100:103]
v_exp_f32 v215, v215
v_cvt_pk_bf16_f32 v208, v208, v209
v_mfma_f32_16x16x32_bf16 v[104:107], a[212:215], v[200:203], v[104:107]
v_cvt_pk_bf16_f32 v209, v210, v211
v_cvt_pk_bf16_f32 v210, v212, v213
v_mfma_f32_16x16x32_bf16 v[108:111], v[240:243], v[200:203], v[108:111]
v_cvt_pk_bf16_f32 v211, v214, v215
v_exp_f32 v216, v216
v_exp_f32 v217, v217
v_exp_f32 v218, v218
v_mfma_f32_16x16x32_bf16 v[200:203], a[144:147], v[60:63], v[188:191]
buffer_load_dwordx4 a[60:63], v1, s[12:15], s46 offen offset:3072 sc1
v_exp_f32 v219, v219
v_exp_f32 v220, v220
v_mfma_f32_16x16x32_bf16 v[204:207], a[148:151], v[60:63], v[188:191]
v_exp_f32 v221, v221
v_exp_f32 v222, v222
v_mfma_f32_16x16x32_bf16 v[112:115], a[208:211], v[208:211], v[112:115]
v_exp_f32 v223, v223
v_cvt_pk_bf16_f32 v216, v216, v217
v_mfma_f32_16x16x32_bf16 v[116:119], a[212:215], v[208:211], v[116:119]
v_cvt_pk_bf16_f32 v217, v218, v219
v_cvt_pk_bf16_f32 v218, v220, v221
v_mfma_f32_16x16x32_bf16 v[120:123], v[240:243], v[208:211], v[120:123]
v_cvt_pk_bf16_f32 v219, v222, v223
s_add_u32 m0, s42, 131072
v_exp_f32 v192, v192
v_exp_f32 v193, v193
v_exp_f32 v194, v194
v_exp_f32 v195, v195
v_mfma_f32_16x16x32_bf16 v[208:211], a[152:155], v[48:51], v[176:179]
buffer_load_dwordx4 v2, s[24:27], s72 offen offset:0 lds
buffer_load_dwordx4 a[120:123], v10, s[12:15], s46 offen offset:2048 sc1
v_exp_f32 v196, v196
v_exp_f32 v197, v197
v_mfma_f32_16x16x32_bf16 v[212:215], a[156:159], v[48:51], v[176:179]
v_exp_f32 v198, v198
v_mfma_f32_16x16x32_bf16 v[124:127], a[208:211], v[216:219], v[124:127]
v_exp_f32 v199, v199
v_cvt_pk_bf16_f32 v192, v192, v193
v_mfma_f32_16x16x32_bf16 v[128:131], a[212:215], v[216:219], v[128:131]
v_cvt_pk_bf16_f32 v193, v194, v195
v_cvt_pk_bf16_f32 v194, v196, v197
v_mfma_f32_16x16x32_bf16 v[132:135], v[240:243], v[216:219], v[132:135]
v_cvt_pk_bf16_f32 v195, v198, v199
v_exp_f32 v200, v200
v_exp_f32 v201, v201
v_exp_f32 v202, v202
v_mfma_f32_16x16x32_bf16 v[216:219], a[152:155], v[52:55], v[180:183]
buffer_load_dwordx4 a[124:127], v10, s[12:15], s46 offen offset:3072 sc1
v_exp_f32 v203, v203
v_exp_f32 v204, v204
v_mfma_f32_16x16x32_bf16 v[220:223], a[156:159], v[52:55], v[180:183]
v_exp_f32 v205, v205
v_exp_f32 v206, v206
v_mfma_f32_16x16x32_bf16 v[136:139], a[208:211], v[192:195], v[136:139]
v_exp_f32 v207, v207
v_cvt_pk_bf16_f32 v200, v200, v201
v_mfma_f32_16x16x32_bf16 v[140:143], a[212:215], v[192:195], v[140:143]
v_cvt_pk_bf16_f32 v201, v202, v203
v_cvt_pk_bf16_f32 v202, v204, v205
v_mfma_f32_16x16x32_bf16 v[144:147], v[240:243], v[192:195], v[144:147]
v_cvt_pk_bf16_f32 v203, v206, v207
v_exp_f32 v208, v208
v_exp_f32 v209, v209
v_exp_f32 v210, v210
v_mfma_f32_16x16x32_bf16 v[192:195], a[152:155], v[56:59], v[184:187]
buffer_load_dwordx4 v3, s[24:27], s72 offen offset:1024 lds
v_exp_f32 v211, v211
v_exp_f32 v212, v212
v_mfma_f32_16x16x32_bf16 v[196:199], a[156:159], v[56:59], v[184:187]
v_exp_f32 v213, v213
v_exp_f32 v214, v214
v_mfma_f32_16x16x32_bf16 v[148:151], a[208:211], v[200:203], v[148:151]
v_exp_f32 v215, v215
v_cvt_pk_bf16_f32 v208, v208, v209
v_mfma_f32_16x16x32_bf16 v[152:155], a[212:215], v[200:203], v[152:155]
v_cvt_pk_bf16_f32 v209, v210, v211
v_cvt_pk_bf16_f32 v210, v212, v213
v_mfma_f32_16x16x32_bf16 v[156:159], v[240:243], v[200:203], v[156:159]
v_cvt_pk_bf16_f32 v211, v214, v215
v_exp_f32 v216, v216
v_mfma_f32_16x16x32_bf16 v[200:203], a[152:155], v[60:63], v[188:191]
v_exp_f32 v217, v217
v_exp_f32 v218, v218
v_mfma_f32_16x16x32_bf16 v[204:207], a[156:159], v[60:63], v[188:191]
v_exp_f32 v219, v219
v_exp_f32 v220, v220
v_mfma_f32_16x16x32_bf16 v[112:115], a[216:219], v[208:211], v[112:115]
v_exp_f32 v221, v221
v_exp_f32 v222, v222
v_exp_f32 v223, v223
v_mfma_f32_16x16x32_bf16 v[116:119], a[220:223], v[208:211], v[116:119]
v_cvt_pk_bf16_f32 v216, v216, v217
v_cvt_pk_bf16_f32 v217, v218, v219
v_mfma_f32_16x16x32_bf16 v[120:123], v[240:243], v[208:211], v[120:123]
v_cvt_pk_bf16_f32 v218, v220, v221
v_cvt_pk_bf16_f32 v219, v222, v223
v_exp_f32 v192, v192
v_exp_f32 v193, v193
v_exp_f32 v194, v194
v_mfma_f32_16x16x32_bf16 v[208:211], a[160:163], v[52:55], v[180:183]
buffer_load_dwordx4 v4, s[24:27], s72 offen offset:2048 lds
v_exp_f32 v195, v195
v_exp_f32 v196, v196
v_mfma_f32_16x16x32_bf16 v[212:215], a[164:167], v[52:55], v[180:183]
v_exp_f32 v197, v197
v_exp_f32 v198, v198
v_mfma_f32_16x16x32_bf16 v[124:127], a[216:219], v[216:219], v[124:127]
v_exp_f32 v199, v199
v_cvt_pk_bf16_f32 v192, v192, v193
v_mfma_f32_16x16x32_bf16 v[128:131], a[220:223], v[216:219], v[128:131]
v_cvt_pk_bf16_f32 v193, v194, v195
v_cvt_pk_bf16_f32 v194, v196, v197
v_mfma_f32_16x16x32_bf16 v[132:135], v[240:243], v[216:219], v[132:135]
v_cvt_pk_bf16_f32 v195, v198, v199
v_exp_f32 v200, v200
v_mfma_f32_16x16x32_bf16 v[216:219], a[160:163], v[56:59], v[184:187]
v_exp_f32 v201, v201
v_exp_f32 v202, v202
v_mfma_f32_16x16x32_bf16 v[220:223], a[164:167], v[56:59], v[184:187]
v_exp_f32 v203, v203
v_exp_f32 v204, v204
v_mfma_f32_16x16x32_bf16 v[136:139], a[216:219], v[192:195], v[136:139]
v_exp_f32 v205, v205
v_exp_f32 v206, v206
v_exp_f32 v207, v207
v_mfma_f32_16x16x32_bf16 v[140:143], a[220:223], v[192:195], v[140:143]
v_cvt_pk_bf16_f32 v200, v200, v201
v_cvt_pk_bf16_f32 v201, v202, v203
v_mfma_f32_16x16x32_bf16 v[144:147], v[240:243], v[192:195], v[144:147]
v_cvt_pk_bf16_f32 v202, v204, v205
v_cvt_pk_bf16_f32 v203, v206, v207
v_exp_f32 v208, v208
v_exp_f32 v209, v209
v_exp_f32 v210, v210
v_exp_f32 v211, v211
v_mfma_f32_16x16x32_bf16 v[192:195], a[160:163], v[60:63], v[188:191]
buffer_load_dwordx4 v5, s[24:27], s72 offen offset:3072 lds
s_add_u32 s72, s72, 262144
buffer_load_dwordx4 a[48:51], v1, s[12:15], s46 offen offset:0 sc1
v_exp_f32 v212, v212
v_exp_f32 v213, v213
v_mfma_f32_16x16x32_bf16 v[196:199], a[164:167], v[60:63], v[188:191]
v_exp_f32 v214, v214
v_mfma_f32_16x16x32_bf16 v[148:151], a[216:219], v[200:203], v[148:151]
v_exp_f32 v215, v215
v_cvt_pk_bf16_f32 v208, v208, v209
v_mfma_f32_16x16x32_bf16 v[152:155], a[220:223], v[200:203], v[152:155]
v_cvt_pk_bf16_f32 v209, v210, v211
v_cvt_pk_bf16_f32 v210, v212, v213
v_mfma_f32_16x16x32_bf16 v[156:159], v[240:243], v[200:203], v[156:159]
v_cvt_pk_bf16_f32 v211, v214, v215
v_exp_f32 v216, v216
v_exp_f32 v217, v217
v_exp_f32 v218, v218
v_mfma_f32_16x16x32_bf16 v[200:203], a[168:171], v[56:59], v[184:187]
buffer_load_dwordx4 a[52:55], v1, s[12:15], s46 offen offset:1024 sc1
v_exp_f32 v219, v219
v_exp_f32 v220, v220
v_mfma_f32_16x16x32_bf16 v[204:207], a[172:175], v[56:59], v[184:187]
v_exp_f32 v221, v221
v_exp_f32 v222, v222
v_mfma_f32_16x16x32_bf16 v[124:127], a[224:227], v[208:211], v[124:127]
v_exp_f32 v223, v223
v_cvt_pk_bf16_f32 v216, v216, v217
v_mfma_f32_16x16x32_bf16 v[128:131], a[228:231], v[208:211], v[128:131]
v_cvt_pk_bf16_f32 v217, v218, v219
v_cvt_pk_bf16_f32 v218, v220, v221
v_mfma_f32_16x16x32_bf16 v[132:135], v[240:243], v[208:211], v[132:135]
v_cvt_pk_bf16_f32 v219, v222, v223
s_add_u32 m0, s42, 147456
v_exp_f32 v192, v192
v_exp_f32 v193, v193
v_exp_f32 v194, v194
v_exp_f32 v195, v195
v_mfma_f32_16x16x32_bf16 v[208:211], a[168:171], v[60:63], v[188:191]
buffer_load_dwordx4 v2, s[24:27], s72 offen offset:0 lds
buffer_load_dwordx4 a[112:115], v10, s[12:15], s46 offen offset:0 sc1
v_exp_f32 v196, v196
v_exp_f32 v197, v197
v_mfma_f32_16x16x32_bf16 v[212:215], a[172:175], v[60:63], v[188:191]
v_exp_f32 v198, v198
v_mfma_f32_16x16x32_bf16 v[136:139], a[224:227], v[216:219], v[136:139]
v_exp_f32 v199, v199
v_cvt_pk_bf16_f32 v192, v192, v193
v_mfma_f32_16x16x32_bf16 v[140:143], a[228:231], v[216:219], v[140:143]
v_cvt_pk_bf16_f32 v193, v194, v195
v_cvt_pk_bf16_f32 v194, v196, v197
v_mfma_f32_16x16x32_bf16 v[144:147], v[240:243], v[216:219], v[144:147]
v_cvt_pk_bf16_f32 v195, v198, v199
s_cmp_lg_u32 s62, 0
s_cbranch_scc1 fk_hv
v_mov_b32 v160, s101
v_mov_b32 v161, s101
v_mov_b32 v162, s101
v_mov_b32 v163, s101
v_mov_b32 v164, s101
v_mov_b32 v165, s101
v_mov_b32 v166, s101
v_mov_b32 v167, s101
v_mov_b32 v168, s101
v_mov_b32 v169, s101
v_mov_b32 v170, s101
v_mov_b32 v171, s101
v_mov_b32 v172, s101
v_mov_b32 v173, s101
v_mov_b32 v174, s101
v_mov_b32 v175, s101
v_mov_b32 v176, s101
v_mov_b32 v177, s101
v_mov_b32 v178, s101
v_mov_b32 v179, s101
v_mov_b32 v180, s101
v_mov_b32 v181, s101
v_mov_b32 v182, s101
v_mov_b32 v183, s101
v_mov_b32 v184, s101
v_mov_b32 v185, s101
v_mov_b32 v186, s101
v_mov_b32 v187, s101
fk_hv:
v_exp_f32 v200, v200
v_exp_f32 v201, v201
v_exp_f32 v202, v202
v_exp_f32 v203, v203
v_mfma_f32_16x16x32_bf16 v[216:219], a[176:179], v[60:63], v[188:191]
buffer_load_dwordx4 a[116:119], v10, s[12:15], s46 offen offset:1024 sc1
s_sub_u32 s46, s46, 4096
v_exp_f32 v204, v204
v_exp_f32 v205, v205
v_exp_f32 v206, v206
v_mfma_f32_16x16x32_bf16 v[220:223], a[180:183], v[60:63], v[188:191]
v_exp_f32 v207, v207
v_cvt_pk_bf16_f32 v200, v200, v201
v_cvt_pk_bf16_f32 v201, v202, v203
v_cvt_pk_bf16_f32 v202, v204, v205
v_mfma_f32_16x16x32_bf16 v[148:151], a[224:227], v[192:195], v[148:151]
v_cvt_pk_bf16_f32 v203, v206, v207
v_add_f32 v246, v232, v188
v_add_f32 v247, v233, v188
v_mfma_f32_16x16x32_bf16 v[152:155], a[228:231], v[192:195], v[152:155]
v_add_f32 v248, v234, v188
v_add_f32 v249, v235, v188
v_add_f32 v250, v236, v188
v_mfma_f32_16x16x32_bf16 v[156:159], v[240:243], v[192:195], v[156:159]
v_add_f32 v251, v237, v188
v_add_f32 v252, v238, v188
v_add_f32 v253, v239, v188
s_waitcnt vmcnt(8)
v_exp_f32 v208, v208
v_exp_f32 v209, v209
v_exp_f32 v210, v210
v_mfma_f32_16x16x32_bf16 v[192:195], a[56:59], v[60:63], v[246:249]
buffer_load_dwordx4 v3, s[24:27], s72 offen offset:1024 lds
v_exp_f32 v211, v211
v_exp_f32 v212, v212
v_mfma_f32_16x16x32_bf16 v[196:199], a[60:63], v[60:63], v[250:253]
v_exp_f32 v213, v213
v_exp_f32 v214, v214
v_mfma_f32_16x16x32_bf16 v[136:139], a[232:235], v[200:203], v[136:139]
v_exp_f32 v215, v215
v_cvt_pk_bf16_f32 v208, v208, v209
v_mfma_f32_16x16x32_bf16 v[140:143], a[236:239], v[200:203], v[140:143]
v_cvt_pk_bf16_f32 v209, v210, v211
v_cvt_pk_bf16_f32 v210, v212, v213
v_mfma_f32_16x16x32_bf16 v[144:147], v[240:243], v[200:203], v[144:147]
v_cvt_pk_bf16_f32 v211, v214, v215
v_exp_f32 v216, v216
v_mfma_f32_16x16x32_bf16 v[200:203], a[56:59], v[56:59], v[184:187]
v_exp_f32 v217, v217
v_exp_f32 v218, v218
v_mfma_f32_16x16x32_bf16 v[204:207], a[60:63], v[56:59], v[184:187]
v_exp_f32 v219, v219
v_exp_f32 v220, v220
v_mfma_f32_16x16x32_bf16 v[148:151], a[232:235], v[208:211], v[148:151]
v_exp_f32 v221, v221
v_exp_f32 v222, v222
v_exp_f32 v223, v223
v_mfma_f32_16x16x32_bf16 v[152:155], a[236:239], v[208:211], v[152:155]
v_cvt_pk_bf16_f32 v216, v216, v217
v_cvt_pk_bf16_f32 v217, v218, v219
v_mfma_f32_16x16x32_bf16 v[156:159], v[240:243], v[208:211], v[156:159]
v_cvt_pk_bf16_f32 v218, v220, v221
v_cvt_pk_bf16_f32 v219, v222, v223
v_exp_f32 v192, v192
v_exp_f32 v193, v193
v_exp_f32 v194, v194
v_mfma_f32_16x16x32_bf16 v[208:211], a[56:59], v[52:55], v[180:183]
buffer_load_dwordx4 v4, s[24:27], s72 offen offset:2048 lds
v_exp_f32 v195, v195
v_exp_f32 v196, v196
v_mfma_f32_16x16x32_bf16 v[212:215], a[60:63], v[52:55], v[180:183]
v_exp_f32 v197, v197
v_exp_f32 v198, v198
v_mfma_f32_16x16x32_bf16 v[148:151], a[240:243], v[216:219], v[148:151]
v_exp_f32 v199, v199
v_cvt_pk_bf16_f32 v192, v192, v193
v_mfma_f32_16x16x32_bf16 v[152:155], a[244:247], v[216:219], v[152:155]
v_cvt_pk_bf16_f32 v193, v194, v195
v_cvt_pk_bf16_f32 v194, v196, v197
v_mfma_f32_16x16x32_bf16 v[156:159], v[240:243], v[216:219], v[156:159]
v_cvt_pk_bf16_f32 v195, v198, v199
v_exp_f32 v200, v200
v_exp_f32 v201, v201
v_exp_f32 v202, v202
v_mfma_f32_16x16x32_bf16 v[216:219], a[56:59], v[48:51], v[176:179]
buffer_load_dwordx4 a[40:43], v1, s[12:15], s46 offen offset:2048 sc1
v_exp_f32 v203, v203
v_exp_f32 v204, v204
v_mfma_f32_16x16x32_bf16 v[220:223], a[60:63], v[48:51], v[176:179]
v_exp_f32 v205, v205
v_exp_f32 v206, v206
v_mfma_f32_16x16x32_bf16 v[148:151], a[120:123], v[192:195], v[148:151]
v_exp_f32 v207, v207
v_cvt_pk_bf16_f32 v200, v200, v201
v_mfma_f32_16x16x32_bf16 v[152:155], a[124:127], v[192:195], v[152:155]
v_cvt_pk_bf16_f32 v201, v202, v203
v_cvt_pk_bf16_f32 v202, v204, v205
v_mfma_f32_16x16x32_bf16 v[156:159], v[240:243], v[192:195], v[156:159]
v_cvt_pk_bf16_f32 v203, v206, v207
v_exp_f32 v208, v208
v_exp_f32 v209, v209
v_exp_f32 v210, v210
v_exp_f32 v211, v211
v_mfma_f32_16x16x32_bf16 v[192:195], a[56:59], v[44:47], v[172:175]
buffer_load_dwordx4 v5, s[24:27], s72 offen offset:3072 lds
s_add_u32 s72, s72, 262144
buffer_load_dwordx4 a[44:47], v1, s[12:15], s46 offen offset:3072 sc1
v_exp_f32 v212, v212
v_exp_f32 v213, v213
v_mfma_f32_16x16x32_bf16 v[196:199], a[60:63], v[44:47], v[172:175]
v_exp_f32 v214, v214
v_mfma_f32_16x16x32_bf16 v[136:139], a[120:123], v[200:203], v[136:139]
v_exp_f32 v215, v215
v_cvt_pk_bf16_f32 v208, v208, v209
v_mfma_f32_16x16x32_bf16 v[140:143], a[124:127], v[200:203], v[140:143]
v_cvt_pk_bf16_f32 v209, v210, v211
v_cvt_pk_bf16_f32 v210, v212, v213
v_mfma_f32_16x16x32_bf16 v[144:147], v[240:243], v[200:203], v[144:147]
v_cvt_pk_bf16_f32 v211, v214, v215
v_exp_f32 v216, v216
v_exp_f32 v217, v217
v_exp_f32 v218, v218
v_exp_f32 v219, v219
v_exp_f32 v220, v220
v_mfma_f32_16x16x32_bf16 v[200:203], a[56:59], v[40:43], v[168:171]
buffer_load_dwordx4 a[104:107], v10, s[12:15], s46 offen offset:2048 sc1
v_exp_f32 v221, v221
v_exp_f32 v222, v222
v_exp_f32 v223, v223
v_cvt_pk_bf16_f32 v216, v216, v217
v_cvt_pk_bf16_f32 v217, v218, v219
v_mfma_f32_16x16x32_bf16 v[204:207], a[60:63], v[40:43], v[168:171]
v_cvt_pk_bf16_f32 v218, v220, v221
v_cvt_pk_bf16_f32 v219, v222, v223
v_rcp_f32 v18, v156
v_cmp_ngt_f32 vcc, s91, v156
v_mul_f32 v148, v148, v18
v_mfma_f32_16x16x32_bf16 v[124:127], a[120:123], v[208:211], v[124:127]
v_mul_f32 v149, v149, v18
v_mul_f32 v150, v150, v18
v_mul_f32 v151, v151, v18
v_mul_f32 v152, v152, v18
v_mfma_f32_16x16x32_bf16 v[128:131], a[124:127], v[208:211], v[128:131]
v_mul_f32 v153, v153, v18
v_mul_f32 v154, v154, v18
v_mul_f32 v155, v155, v18
s_or_b64 s[58:59], s[58:59], vcc
v_cvt_pk_bf16_f32 v148, v148, v149
v_mfma_f32_16x16x32_bf16 v[132:135], v[240:243], v[208:211], v[132:135]
v_cvt_pk_bf16_f32 v149, v150, v151
v_cvt_pk_bf16_f32 v150, v152, v153
v_cvt_pk_bf16_f32 v151, v154, v155
buffer_store_dwordx4 v[148:151], v1, s[12:15], s96 offen offset:2048 sc1
s_add_u32 m0, s42, 0
v_exp_f32 v192, v192
v_exp_f32 v193, v193
v_exp_f32 v194, v194
v_exp_f32 v195, v195
v_mfma_f32_16x16x32_bf16 v[208:211], a[56:59], v[36:39], v[164:167]
buffer_load_dwordx4 v2, s[24:27], s72 offen offset:0 lds
buffer_load_dwordx4 a[108:111], v10, s[12:15], s46 offen offset:3072 sc1
v_exp_f32 v196, v196
v_exp_f32 v197, v197
v_mfma_f32_16x16x32_bf16 v[212:215], a[60:63], v[36:39], v[164:167]
v_exp_f32 v198, v198
v_mfma_f32_16x16x32_bf16 v[112:115], a[120:123], v[216:219], v[112:115]
v_exp_f32 v199, v199
v_cvt_pk_bf16_f32 v192, v192, v193
v_mfma_f32_16x16x32_bf16 v[116:119], a[124:127], v[216:219], v[116:119]
v_cvt_pk_bf16_f32 v193, v194, v195
v_cvt_pk_bf16_f32 v194, v196, v197
v_mfma_f32_16x16x32_bf16 v[120:123], v[240:243], v[216:219], v[120:123]
v_cvt_pk_bf16_f32 v195, v198, v199
v_exp_f32 v200, v200
v_mfma_f32_16x16x32_bf16 v[216:219], a[56:59], v[32:35], v[160:163]
v_exp_f32 v201, v201
v_exp_f32 v202, v202
v_exp_f32 v203, v203
v_exp_f32 v204, v204
v_mfma_f32_16x16x32_bf16 v[220:223], a[60:63], v[32:35], v[160:163]
v_exp_f32 v205, v205
v_exp_f32 v206, v206
v_exp_f32 v207, v207
v_cvt_pk_bf16_f32 v200, v200, v201
v_mfma_f32_16x16x32_bf16 v[100:103], a[120:123], v[192:195], v[100:103]
v_cvt_pk_bf16_f32 v201, v202, v203
v_cvt_pk_bf16_f32 v202, v204, v205
v_cvt_pk_bf16_f32 v203, v206, v207
v_add_f32 v246, v232, v184
v_mfma_f32_16x16x32_bf16 v[104:107], a[124:127], v[192:195], v[104:107]
v_add_f32 v247, v233, v184
v_add_f32 v248, v234, v184
v_add_f32 v249, v235, v184
v_add_f32 v250, v236, v184
v_mfma_f32_16x16x32_bf16 v[108:111], v[240:243], v[192:195], v[108:111]
v_add_f32 v251, v237, v184
v_add_f32 v252, v238, v184
v_add_f32 v253, v239, v184
s_waitcnt vmcnt(9)
v_exp_f32 v208, v208
v_exp_f32 v209, v209
v_exp_f32 v210, v210
v_mfma_f32_16x16x32_bf16 v[192:195], a[48:51], v[56:59], v[246:249]
buffer_load_dwordx4 v3, s[24:27], s72 offen offset:1024 lds
v_exp_f32 v211, v211
v_exp_f32 v212, v212
v_mfma_f32_16x16x32_bf16 v[196:199], a[52:55], v[56:59], v[250:253]
v_exp_f32 v213, v213
v_exp_f32 v214, v214
v_mfma_f32_16x16x32_bf16 v[88:91], a[120:123], v[200:203], v[88:91]
v_exp_f32 v215, v215
v_cvt_pk_bf16_f32 v208, v208, v209
v_mfma_f32_16x16x32_bf16 v[92:95], a[124:127], v[200:203], v[92:95]
v_cvt_pk_bf16_f32 v209, v210, v211
v_cvt_pk_bf16_f32 v210, v212, v213
v_mfma_f32_16x16x32_bf16 v[96:99], v[240:243], v[200:203], v[96:99]
v_cvt_pk_bf16_f32 v211, v214, v215
v_exp_f32 v216, v216
v_exp_f32 v217, v217
v_exp_f32 v218, v218
v_mfma_f32_16x16x32_bf16 v[200:203], a[48:51], v[52:55], v[180:183]
buffer_load_dwordx4 a[32:35], v1, s[12:15], s46 offen offset:0 sc1
v_exp_f32 v219, v219
v_exp_f32 v220, v220
v_mfma_f32_16x16x32_bf16 v[204:207], a[52:55], v[52:55], v[180:183]
v_exp_f32 v221, v221
v_exp_f32 v222, v222
v_mfma_f32_16x16x32_bf16 v[76:79], a[120:123], v[208:211], v[76:79]
v_exp_f32 v223, v223
v_cvt_pk_bf16_f32 v216, v216, v217
v_mfma_f32_16x16x32_bf16 v[80:83], a[124:127], v[208:211], v[80:83]
v_cvt_pk_bf16_f32 v217, v218, v219
v_cvt_pk_bf16_f32 v218, v220, v221
v_mfma_f32_16x16x32_bf16 v[84:87], v[240:243], v[208:211], v[84:87]
v_cvt_pk_bf16_f32 v219, v222, v223
v_exp_f32 v192, v192
v_exp_f32 v193, v193
v_exp_f32 v194, v194
v_exp_f32 v195, v195
v_mfma_f32_16x16x32_bf16 v[208:211], a[48:51], v[48:51], v[176:179]
buffer_load_dword v0, v24, s[12:15], s82 offen sc1
buffer_load_dwordx4 v4, s[24:27], s72 offen offset:2048 lds
buffer_load_dwordx4 a[36:39], v1, s[12:15], s46 offen offset:1024 sc1
v_exp_f32 v196, v196
v_exp_f32 v197, v197
v_mfma_f32_16x16x32_bf16 v[212:215], a[52:55], v[48:51], v[176:179]
v_exp_f32 v198, v198
v_mfma_f32_16x16x32_bf16 v[64:67], a[120:123], v[216:219], v[64:67]
v_exp_f32 v199, v199
v_cvt_pk_bf16_f32 v192, v192, v193
v_mfma_f32_16x16x32_bf16 v[68:71], a[124:127], v[216:219], v[68:71]
v_cvt_pk_bf16_f32 v193, v194, v195
PG17:
s_cbranch_execz PG20
v_cvt_pk_bf16_f32 v194, v196, v197
v_mfma_f32_16x16x32_bf16 v[72:75], v[240:243], v[216:219], v[72:75]
v_cvt_pk_bf16_f32 v195, v198, v199
v_exp_f32 v200, v200
v_exp_f32 v201, v201
v_exp_f32 v202, v202
v_mfma_f32_16x16x32_bf16 v[216:219], a[48:51], v[44:47], v[172:175]
buffer_load_dwordx4 a[96:99], v10, s[12:15], s46 offen offset:0 sc1
v_exp_f32 v203, v203
v_exp_f32 v204, v204
v_mfma_f32_16x16x32_bf16 v[220:223], a[52:55], v[44:47], v[172:175]
v_exp_f32 v205, v205
v_exp_f32 v206, v206
v_mfma_f32_16x16x32_bf16 v[136:139], a[112:115], v[192:195], v[136:139]
v_exp_f32 v207, v207
v_cvt_pk_bf16_f32 v200, v200, v201
v_mfma_f32_16x16x32_bf16 v[140:143], a[116:119], v[192:195], v[140:143]
v_cvt_pk_bf16_f32 v201, v202, v203
v_cvt_pk_bf16_f32 v202, v204, v205
v_mfma_f32_16x16x32_bf16 v[144:147], v[240:243], v[192:195], v[144:147]
v_cvt_pk_bf16_f32 v203, v206, v207
v_exp_f32 v208, v208
v_exp_f32 v209, v209
v_exp_f32 v210, v210
v_exp_f32 v211, v211
v_mfma_f32_16x16x32_bf16 v[192:195], a[48:51], v[40:43], v[168:171]
buffer_load_dwordx4 v5, s[24:27], s72 offen offset:3072 lds
s_add_u32 s72, s72, 262144
buffer_load_dwordx4 a[100:103], v10, s[12:15], s46 offen offset:1024 sc1
s_sub_u32 s46, s46, 4096
v_exp_f32 v212, v212
v_exp_f32 v213, v213
v_mfma_f32_16x16x32_bf16 v[196:199], a[52:55], v[40:43], v[168:171]
v_exp_f32 v214, v214
v_mfma_f32_16x16x32_bf16 v[124:127], a[112:115], v[200:203], v[124:127]
v_exp_f32 v215, v215
v_cvt_pk_bf16_f32 v208, v208, v209
v_mfma_f32_16x16x32_bf16 v[128:131], a[116:119], v[200:203], v[128:131]
v_cvt_pk_bf16_f32 v209, v210, v211
v_cvt_pk_bf16_f32 v210, v212, v213
v_mfma_f32_16x16x32_bf16 v[132:135], v[240:243], v[200:203], v[132:135]
v_cvt_pk_bf16_f32 v211, v214, v215
v_exp_f32 v216, v216
v_mfma_f32_16x16x32_bf16 v[200:203], a[48:51], v[36:39], v[164:167]
v_exp_f32 v217, v217
v_exp_f32 v218, v218
v_exp_f32 v219, v219
v_exp_f32 v220, v220
v_exp_f32 v221, v221
v_mfma_f32_16x16x32_bf16 v[204:207], a[52:55], v[36:39], v[164:167]
v_exp_f32 v222, v222
v_exp_f32 v223, v223
v_cvt_pk_bf16_f32 v216, v216, v217
v_cvt_pk_bf16_f32 v217, v218, v219
v_cvt_pk_bf16_f32 v218, v220, v221
v_cvt_pk_bf16_f32 v219, v222, v223
v_mfma_f32_16x16x32_bf16 v[112:115], a[112:115], v[208:211], v[112:115]
v_rcp_f32 v18, v144
v_cmp_ngt_f32 vcc, s91, v144
v_mul_f32 v136, v136, v18
v_mul_f32 v137, v137, v18
v_mul_f32 v138, v138, v18
v_mul_f32 v139, v139, v18
v_mfma_f32_16x16x32_bf16 v[116:119], a[116:119], v[208:211], v[116:119]
v_mul_f32 v140, v140, v18
v_mul_f32 v141, v141, v18
v_mul_f32 v142, v142, v18
v_mul_f32 v143, v143, v18
s_or_b64 s[58:59], s[58:59], vcc
v_cvt_pk_bf16_f32 v136, v136, v137
v_mfma_f32_16x16x32_bf16 v[120:123], v[240:243], v[208:211], v[120:123]
v_cvt_pk_bf16_f32 v137, v138, v139
v_cvt_pk_bf16_f32 v138, v140, v141
v_cvt_pk_bf16_f32 v139, v142, v143
buffer_store_dwordx4 v[136:139], v1, s[12:15], s96 offen offset:0 sc1
s_sub_u32 s96, s96, 4096
s_add_u32 m0, s42, 16384
v_exp_f32 v192, v192
v_exp_f32 v193, v193
v_exp_f32 v194, v194
v_exp_f32 v195, v195
v_exp_f32 v196, v196
v_exp_f32 v197, v197
v_mfma_f32_16x16x32_bf16 v[208:211], a[48:51], v[32:35], v[160:163]
buffer_load_dwordx4 v2, s[24:27], s72 offen offset:0 lds
buffer_load_dwordx4 a[24:27], v1, s[12:15], s46 offen offset:2048 sc1
v_exp_f32 v198, v198
v_exp_f32 v199, v199
v_cvt_pk_bf16_f32 v192, v192, v193
v_mfma_f32_16x16x32_bf16 v[212:215], a[52:55], v[32:35], v[160:163]
v_cvt_pk_bf16_f32 v193, v194, v195
v_cvt_pk_bf16_f32 v194, v196, v197
v_cvt_pk_bf16_f32 v195, v198, v199
v_mfma_f32_16x16x32_bf16 v[100:103], a[112:115], v[216:219], v[100:103]
v_add_f32 v246, v232, v180
v_add_f32 v247, v233, v180
v_add_f32 v248, v234, v180
v_mfma_f32_16x16x32_bf16 v[104:107], a[116:119], v[216:219], v[104:107]
v_add_f32 v249, v235, v180
v_add_f32 v250, v236, v180
v_add_f32 v251, v237, v180
v_mfma_f32_16x16x32_bf16 v[108:111], v[240:243], v[216:219], v[108:111]
v_add_f32 v252, v238, v180
v_add_f32 v253, v239, v180
s_waitcnt vmcnt(11)
v_exp_f32 v200, v200
v_exp_f32 v201, v201
v_exp_f32 v202, v202
v_mfma_f32_16x16x32_bf16 v[216:219], a[40:43], v[52:55], v[246:249]
buffer_load_dwordx4 a[28:31], v1, s[12:15], s46 offen offset:3072 sc1
v_exp_f32 v203, v203
v_exp_f32 v204, v204
v_mfma_f32_16x16x32_bf16 v[220:223], a[44:47], v[52:55], v[250:253]
v_exp_f32 v205, v205
v_exp_f32 v206, v206
v_mfma_f32_16x16x32_bf16 v[88:91], a[112:115], v[192:195], v[88:91]
v_exp_f32 v207, v207
v_cvt_pk_bf16_f32 v200, v200, v201
v_mfma_f32_16x16x32_bf16 v[92:95], a[116:119], v[192:195], v[92:95]
v_cvt_pk_bf16_f32 v201, v202, v203
v_cvt_pk_bf16_f32 v202, v204, v205
v_mfma_f32_16x16x32_bf16 v[96:99], v[240:243], v[192:195], v[96:99]
v_cvt_pk_bf16_f32 v203, v206, v207
v_exp_f32 v208, v208
v_exp_f32 v209, v209
v_exp_f32 v210, v210
v_exp_f32 v211, v211
v_mfma_f32_16x16x32_bf16 v[192:195], a[40:43], v[48:51], v[176:179]
buffer_load_dwordx4 v3, s[24:27], s72 offen offset:1024 lds
buffer_load_dwordx4 a[88:91], v10, s[12:15], s46 offen offset:2048 sc1
v_exp_f32 v212, v212
v_exp_f32 v213, v213
v_mfma_f32_16x16x32_bf16 v[196:199], a[44:47], v[48:51], v[176:179]
v_exp_f32 v214, v214
v_mfma_f32_16x16x32_bf16 v[76:79], a[112:115], v[200:203], v[76:79]
v_exp_f32 v215, v215
v_cvt_pk_bf16_f32 v208, v208, v209
v_mfma_f32_16x16x32_bf16 v[80:83], a[116:119], v[200:203], v[80:83]
v_cvt_pk_bf16_f32 v209, v210, v211
v_cvt_pk_bf16_f32 v210, v212, v213
v_mfma_f32_16x16x32_bf16 v[84:87], v[240:243], v[200:203], v[84:87]
v_cvt_pk_bf16_f32 v211, v214, v215
v_exp_f32 v216, v216
v_exp_f32 v217, v217
v_exp_f32 v218, v218
v_mfma_f32_16x16x32_bf16 v[200:203], a[40:43], v[44:47], v[172:175]
buffer_load_dwordx4 a[92:95], v10, s[12:15], s46 offen offset:3072 sc1
v_exp_f32 v219, v219
v_exp_f32 v220, v220
v_mfma_f32_16x16x32_bf16 v[204:207], a[44:47], v[44:47], v[172:175]
v_exp_f32 v221, v221
v_exp_f32 v222, v222
v_mfma_f32_16x16x32_bf16 v[64:67], a[112:115], v[208:211], v[64:67]
v_exp_f32 v223, v223
v_cvt_pk_bf16_f32 v216, v216, v217
v_mfma_f32_16x16x32_bf16 v[68:71], a[116:119], v[208:211], v[68:71]
v_cvt_pk_bf16_f32 v217, v218, v219
v_cvt_pk_bf16_f32 v218, v220, v221
v_mfma_f32_16x16x32_bf16 v[72:75], v[240:243], v[208:211], v[72:75]
v_cvt_pk_bf16_f32 v219, v222, v223
s_waitcnt vmcnt(12)
v_cmp_eq_u32 vcc, v26, v0
s_nop 1
s_andn2_b32 s67, s87, vcc_lo
s_cselect_b32 s67, 0x40000000, 0
s_add_u32 s69, s69, s67
v_exp_f32 v192, v192
v_exp_f32 v193, v193
v_exp_f32 v194, v194
v_exp_f32 v195, v195
v_exp_f32 v196, v196
v_mfma_f32_16x16x32_bf16 v[208:211], a[40:43], v[40:43], v[168:171]
buffer_load_dwordx4 v4, s[24:27], s72 offen offset:2048 lds
buffer_load_dwordx4 a[16:19], v1, s[12:15], s46 offen offset:0 sc1
buffer_load_dwordx4 a[176:179], v1, s[12:15], s69 offen offset:0 sc1
v_exp_f32 v197, v197
v_exp_f32 v198, v198
v_mfma_f32_16x16x32_bf16 v[212:215], a[44:47], v[40:43], v[168:171]
v_exp_f32 v199, v199
v_mfma_f32_16x16x32_bf16 v[124:127], a[104:107], v[216:219], v[124:127]
v_cvt_pk_bf16_f32 v192, v192, v193
v_cvt_pk_bf16_f32 v193, v194, v195
v_mfma_f32_16x16x32_bf16 v[128:131], a[108:111], v[216:219], v[128:131]
v_cvt_pk_bf16_f32 v194, v196, v197
v_mfma_f32_16x16x32_bf16 v[132:135], v[240:243], v[216:219], v[132:135]
v_cvt_pk_bf16_f32 v195, v198, v199
v_exp_f32 v200, v200
v_exp_f32 v201, v201
v_exp_f32 v202, v202
v_exp_f32 v203, v203
v_mfma_f32_16x16x32_bf16 v[216:219], a[40:43], v[36:39], v[164:167]
buffer_load_dwordx4 a[20:23], v1, s[12:15], s46 offen offset:1024 sc1
buffer_load_dwordx4 a[180:183], v1, s[12:15], s69 offen offset:1024 sc1
v_exp_f32 v204, v204
v_exp_f32 v205, v205
v_mfma_f32_16x16x32_bf16 v[220:223], a[44:47], v[36:39], v[164:167]
v_exp_f32 v206, v206
v_mfma_f32_16x16x32_bf16 v[112:115], a[104:107], v[192:195], v[112:115]
v_exp_f32 v207, v207
v_cvt_pk_bf16_f32 v200, v200, v201
v_mfma_f32_16x16x32_bf16 v[116:119], a[108:111], v[192:195], v[116:119]
v_cvt_pk_bf16_f32 v201, v202, v203
v_cvt_pk_bf16_f32 v202, v204, v205
v_mfma_f32_16x16x32_bf16 v[120:123], v[240:243], v[192:195], v[120:123]
v_cvt_pk_bf16_f32 v203, v206, v207
v_exp_f32 v208, v208
buffer_load_dwordx4 v5, s[24:27], s72 offen offset:3072 lds
s_add_u32 s72, s72, 262144
v_exp_f32 v209, v209
v_exp_f32 v210, v210
v_exp_f32 v211, v211
v_exp_f32 v212, v212
v_exp_f32 v213, v213
v_exp_f32 v214, v214
v_exp_f32 v215, v215
v_cvt_pk_bf16_f32 v208, v208, v209
v_cvt_pk_bf16_f32 v209, v210, v211
v_cvt_pk_bf16_f32 v210, v212, v213
v_cvt_pk_bf16_f32 v211, v214, v215
v_add_f32 v246, v232, v176
v_add_f32 v247, v233, v176
v_mfma_f32_16x16x32_bf16 v[192:195], a[40:43], v[32:35], v[160:163]
buffer_load_dwordx4 a[80:83], v10, s[12:15], s46 offen offset:0 sc1
buffer_load_dwordx4 a[184:187], v10, s[12:15], s69 offen offset:0 sc1
v_add_f32 v248, v234, v176
v_add_f32 v249, v235, v176
v_add_f32 v250, v236, v176
v_add_f32 v251, v237, v176
v_add_f32 v252, v238, v176
v_mfma_f32_16x16x32_bf16 v[196:199], a[44:47], v[32:35], v[160:163]
v_add_f32 v253, v239, v176
v_rcp_f32 v18, v132
v_cmp_ngt_f32 vcc, s91, v132
v_mul_f32 v124, v124, v18
v_mfma_f32_16x16x32_bf16 v[100:103], a[104:107], v[200:203], v[100:103]
v_mul_f32 v125, v125, v18
v_mul_f32 v126, v126, v18
v_mul_f32 v127, v127, v18
v_mul_f32 v128, v128, v18
v_mul_f32 v129, v129, v18
v_mfma_f32_16x16x32_bf16 v[104:107], a[108:111], v[200:203], v[104:107]
v_mul_f32 v130, v130, v18
v_mul_f32 v131, v131, v18
s_or_b64 s[58:59], s[58:59], vcc
v_cvt_pk_bf16_f32 v124, v124, v125
v_mfma_f32_16x16x32_bf16 v[108:111], v[240:243], v[200:203], v[108:111]
v_cvt_pk_bf16_f32 v125, v126, v127
v_cvt_pk_bf16_f32 v126, v128, v129
v_cvt_pk_bf16_f32 v127, v130, v131
buffer_store_dwordx4 v[124:127], v1, s[12:15], s96 offen offset:2048 sc1
s_waitcnt vmcnt(16)
v_exp_f32 v216, v216
v_exp_f32 v217, v217
v_exp_f32 v218, v218
v_exp_f32 v219, v219
v_mfma_f32_16x16x32_bf16 v[200:203], a[32:35], v[48:51], v[246:249]
buffer_load_dwordx4 a[84:87], v10, s[12:15], s46 offen offset:1024 sc1
s_sub_u32 s46, s46, 4096
buffer_load_dwordx4 a[188:191], v10, s[12:15], s69 offen offset:1024 sc1
s_add_u32 s69, s69, 0x38000
v_exp_f32 v220, v220
v_exp_f32 v221, v221
v_mfma_f32_16x16x32_bf16 v[204:207], a[36:39], v[48:51], v[250:253]
v_exp_f32 v222, v222
v_mfma_f32_16x16x32_bf16 v[88:91], a[104:107], v[208:211], v[88:91]
v_exp_f32 v223, v223
v_cvt_pk_bf16_f32 v216, v216, v217
v_mfma_f32_16x16x32_bf16 v[92:95], a[108:111], v[208:211], v[92:95]
v_cvt_pk_bf16_f32 v217, v218, v219
v_cvt_pk_bf16_f32 v218, v220, v221
v_mfma_f32_16x16x32_bf16 v[96:99], v[240:243], v[208:211], v[96:99]
v_cvt_pk_bf16_f32 v219, v222, v223
s_add_u32 m0, s42, 32768
v_exp_f32 v192, v192
v_exp_f32 v193, v193
v_exp_f32 v194, v194
v_exp_f32 v195, v195
v_exp_f32 v196, v196
v_mfma_f32_16x16x32_bf16 v[208:211], a[32:35], v[44:47], v[172:175]
buffer_load_dwordx4 v2, s[24:27], s72 offen offset:0 lds
buffer_load_dwordx4 a[8:11], v1, s[12:15], s46 offen offset:2048 sc1
buffer_load_dwordx4 a[192:195], v1, s[12:15], s69 offen offset:0 sc1
v_exp_f32 v197, v197
v_exp_f32 v198, v198
v_mfma_f32_16x16x32_bf16 v[212:215], a[36:39], v[44:47], v[172:175]
v_exp_f32 v199, v199
v_mfma_f32_16x16x32_bf16 v[76:79], a[104:107], v[216:219], v[76:79]
v_cvt_pk_bf16_f32 v192, v192, v193
v_cvt_pk_bf16_f32 v193, v194, v195
v_mfma_f32_16x16x32_bf16 v[80:83], a[108:111], v[216:219], v[80:83]
v_cvt_pk_bf16_f32 v194, v196, v197
v_mfma_f32_16x16x32_bf16 v[84:87], v[240:243], v[216:219], v[84:87]
v_cvt_pk_bf16_f32 v195, v198, v199
v_exp_f32 v200, v200
v_exp_f32 v201, v201
v_exp_f32 v202, v202
v_exp_f32 v203, v203
v_mfma_f32_16x16x32_bf16 v[216:219], a[32:35], v[40:43], v[168:171]
buffer_load_dwordx4 a[12:15], v1, s[12:15], s46 offen offset:3072 sc1
buffer_load_dwordx4 a[196:199], v1, s[12:15], s69 offen offset:1024 sc1
v_exp_f32 v204, v204
v_exp_f32 v205, v205
v_mfma_f32_16x16x32_bf16 v[220:223], a[36:39], v[40:43], v[168:171]
v_exp_f32 v206, v206
v_mfma_f32_16x16x32_bf16 v[64:67], a[104:107], v[192:195], v[64:67]
v_exp_f32 v207, v207
v_cvt_pk_bf16_f32 v200, v200, v201
v_mfma_f32_16x16x32_bf16 v[68:71], a[108:111], v[192:195], v[68:71]
v_cvt_pk_bf16_f32 v201, v202, v203
v_cvt_pk_bf16_f32 v202, v204, v205
v_mfma_f32_16x16x32_bf16 v[72:75], v[240:243], v[192:195], v[72:75]
v_cvt_pk_bf16_f32 v203, v206, v207
v_exp_f32 v208, v208
v_exp_f32 v209, v209
v_exp_f32 v210, v210
v_exp_f32 v211, v211
v_exp_f32 v212, v212
v_mfma_f32_16x16x32_bf16 v[192:195], a[32:35], v[36:39], v[164:167]
buffer_load_dwordx4 v3, s[24:27], s72 offen offset:1024 lds
buffer_load_dwordx4 a[72:75], v10, s[12:15], s46 offen offset:2048 sc1
buffer_load_dwordx4 a[200:203], v10, s[12:15], s69 offen offset:0 sc1
v_exp_f32 v213, v213
v_exp_f32 v214, v214
v_mfma_f32_16x16x32_bf16 v[196:199], a[36:39], v[36:39], v[164:167]
v_exp_f32 v215, v215
v_mfma_f32_16x16x32_bf16 v[112:115], a[96:99], v[200:203], v[112:115]
v_cvt_pk_bf16_f32 v208, v208, v209
v_cvt_pk_bf16_f32 v209, v210, v211
v_mfma_f32_16x16x32_bf16 v[116:119], a[100:103], v[200:203], v[116:119]
v_cvt_pk_bf16_f32 v210, v212, v213
v_mfma_f32_16x16x32_bf16 v[120:123], v[240:243], v[200:203], v[120:123]
v_cvt_pk_bf16_f32 v211, v214, v215
v_exp_f32 v216, v216
v_exp_f32 v217, v217
v_exp_f32 v218, v218
v_exp_f32 v219, v219
v_exp_f32 v220, v220
v_exp_f32 v221, v221
v_mfma_f32_16x16x32_bf16 v[200:203], a[32:35], v[32:35], v[160:163]
buffer_load_dwordx4 a[76:79], v10, s[12:15], s46 offen offset:3072 sc1
buffer_load_dwordx4 a[204:207], v10, s[12:15], s69 offen offset:1024 sc1
s_add_u32 s69, s69, 0x38000
v_exp_f32 v222, v222
v_exp_f32 v223, v223
v_cvt_pk_bf16_f32 v216, v216, v217
v_mfma_f32_16x16x32_bf16 v[204:207], a[36:39], v[32:35], v[160:163]
v_cvt_pk_bf16_f32 v217, v218, v219
v_cvt_pk_bf16_f32 v218, v220, v221
v_cvt_pk_bf16_f32 v219, v222, v223
v_mfma_f32_16x16x32_bf16 v[100:103], a[96:99], v[208:211], v[100:103]
v_add_f32 v246, v232, v172
v_add_f32 v247, v233, v172
v_add_f32 v248, v234, v172
v_mfma_f32_16x16x32_bf16 v[104:107], a[100:103], v[208:211], v[104:107]
v_add_f32 v249, v235, v172
v_add_f32 v250, v236, v172
v_add_f32 v251, v237, v172
v_mfma_f32_16x16x32_bf16 v[108:111], v[240:243], v[208:211], v[108:111]
v_add_f32 v252, v238, v172
v_add_f32 v253, v239, v172
s_waitcnt vmcnt(21)
v_exp_f32 v192, v192
v_exp_f32 v193, v193
v_exp_f32 v194, v194
v_exp_f32 v195, v195
v_exp_f32 v196, v196
v_exp_f32 v197, v197
v_exp_f32 v198, v198
v_exp_f32 v199, v199
v_cvt_pk_bf16_f32 v192, v192, v193
v_cvt_pk_bf16_f32 v193, v194, v195
v_cvt_pk_bf16_f32 v194, v196, v197
v_mfma_f32_16x16x32_bf16 v[208:211], a[24:27], v[44:47], v[246:249]
buffer_load_dwordx4 v4, s[24:27], s72 offen offset:2048 lds
buffer_load_dwordx4 a[0:3], v1, s[12:15], s46 offen offset:0 sc1
buffer_load_dwordx4 a[208:211], v1, s[12:15], s69 offen offset:0 sc1
v_cvt_pk_bf16_f32 v195, v198, v199
v_rcp_f32 v18, v120
v_cmp_ngt_f32 vcc, s91, v120
v_mul_f32 v112, v112, v18
v_mfma_f32_16x16x32_bf16 v[212:215], a[28:31], v[44:47], v[250:253]
v_mul_f32 v113, v113, v18
v_mul_f32 v114, v114, v18
v_mul_f32 v115, v115, v18
v_mul_f32 v116, v116, v18
v_mfma_f32_16x16x32_bf16 v[88:91], a[96:99], v[216:219], v[88:91]
v_mul_f32 v117, v117, v18
v_mul_f32 v118, v118, v18
v_mul_f32 v119, v119, v18
v_mfma_f32_16x16x32_bf16 v[92:95], a[100:103], v[216:219], v[92:95]
s_or_b64 s[58:59], s[58:59], vcc
v_cvt_pk_bf16_f32 v112, v112, v113
v_cvt_pk_bf16_f32 v113, v114, v115
v_cvt_pk_bf16_f32 v114, v116, v117
v_mfma_f32_16x16x32_bf16 v[96:99], v[240:243], v[216:219], v[96:99]
v_cvt_pk_bf16_f32 v115, v118, v119
v_exp_f32 v200, v200
v_exp_f32 v201, v201
v_exp_f32 v202, v202
v_exp_f32 v203, v203
v_mfma_f32_16x16x32_bf16 v[216:219], a[24:27], v[40:43], v[168:171]
buffer_store_dwordx4 v[112:115], v1, s[12:15], s96 offen offset:0 sc1
s_sub_u32 s96, s96, 4096
buffer_load_dwordx4 a[4:7], v1, s[12:15], s46 offen offset:1024 sc1
buffer_load_dwordx4 a[212:215], v1, s[12:15], s69 offen offset:1024 sc1
v_exp_f32 v204, v204
v_exp_f32 v205, v205
v_mfma_f32_16x16x32_bf16 v[220:223], a[28:31], v[40:43], v[168:171]
v_exp_f32 v206, v206
v_mfma_f32_16x16x32_bf16 v[76:79], a[96:99], v[192:195], v[76:79]
v_exp_f32 v207, v207
v_cvt_pk_bf16_f32 v200, v200, v201
v_mfma_f32_16x16x32_bf16 v[80:83], a[100:103], v[192:195], v[80:83]
v_cvt_pk_bf16_f32 v201, v202, v203
v_cvt_pk_bf16_f32 v202, v204, v205
v_mfma_f32_16x16x32_bf16 v[84:87], v[240:243], v[192:195], v[84:87]
v_cvt_pk_bf16_f32 v203, v206, v207
v_exp_f32 v208, v208
v_exp_f32 v209, v209
v_exp_f32 v210, v210
v_exp_f32 v211, v211
v_exp_f32 v212, v212
v_mfma_f32_16x16x32_bf16 v[192:195], a[24:27], v[36:39], v[164:167]
buffer_load_dwordx4 v5, s[24:27], s72 offen offset:3072 lds
s_add_u32 s72, s72, 262144
buffer_load_dwordx4 a[64:67], v10, s[12:15], s46 offen offset:0 sc1
buffer_load_dwordx4 a[216:219], v10, s[12:15], s69 offen offset:0 sc1
v_exp_f32 v213, v213
v_exp_f32 v214, v214
v_mfma_f32_16x16x32_bf16 v[196:199], a[28:31], v[36:39], v[164:167]
v_exp_f32 v215, v215
v_mfma_f32_16x16x32_bf16 v[64:67], a[96:99], v[200:203], v[64:67]
v_cvt_pk_bf16_f32 v208, v208, v209
v_cvt_pk_bf16_f32 v209, v210, v211
v_mfma_f32_16x16x32_bf16 v[68:71], a[100:103], v[200:203], v[68:71]
v_cvt_pk_bf16_f32 v210, v212, v213
v_mfma_f32_16x16x32_bf16 v[72:75], v[240:243], v[200:203], v[72:75]
v_cvt_pk_bf16_f32 v211, v214, v215
v_exp_f32 v216, v216
v_exp_f32 v217, v217
v_exp_f32 v218, v218
v_exp_f32 v219, v219
v_exp_f32 v220, v220
v_exp_f32 v221, v221
v_mfma_f32_16x16x32_bf16 v[200:203], a[24:27], v[32:35], v[160:163]
buffer_load_dwordx4 a[68:71], v10, s[12:15], s46 offen offset:1024 sc1
s_sub_u32 s46, s46, 4096
buffer_load_dwordx4 a[220:223], v10, s[12:15], s69 offen offset:1024 sc1
s_add_u32 s69, s69, 0x38000
v_exp_f32 v222, v222
v_exp_f32 v223, v223
v_cvt_pk_bf16_f32 v216, v216, v217
v_mfma_f32_16x16x32_bf16 v[204:207], a[28:31], v[32:35], v[160:163]
v_cvt_pk_bf16_f32 v217, v218, v219
v_cvt_pk_bf16_f32 v218, v220, v221
v_cvt_pk_bf16_f32 v219, v222, v223
v_mfma_f32_16x16x32_bf16 v[100:103], a[88:91], v[208:211], v[100:103]
v_add_f32 v246, v232, v168
v_add_f32 v247, v233, v168
v_add_f32 v248, v234, v168
v_mfma_f32_16x16x32_bf16 v[104:107], a[92:95], v[208:211], v[104:107]
v_add_f32 v249, v235, v168
v_add_f32 v250, v236, v168
v_add_f32 v251, v237, v168
v_mfma_f32_16x16x32_bf16 v[108:111], v[240:243], v[208:211], v[108:111]
v_add_f32 v252, v238, v168
v_add_f32 v253, v239, v168
s_waitcnt vmcnt(22)
v_exp_f32 v192, v192
v_exp_f32 v193, v193
v_exp_f32 v194, v194
v_mfma_f32_16x16x32_bf16 v[208:211], a[16:19], v[40:43], v[246:249]
buffer_load_dwordx4 a[224:227], v1, s[12:15], s69 offen offset:0 sc1
v_exp_f32 v195, v195
v_exp_f32 v196, v196
v_mfma_f32_16x16x32_bf16 v[212:215], a[20:23], v[40:43], v[250:253]
v_exp_f32 v197, v197
v_exp_f32 v198, v198
v_mfma_f32_16x16x32_bf16 v[88:91], a[88:91], v[216:219], v[88:91]
v_exp_f32 v199, v199
v_cvt_pk_bf16_f32 v192, v192, v193
v_mfma_f32_16x16x32_bf16 v[92:95], a[92:95], v[216:219], v[92:95]
v_cvt_pk_bf16_f32 v193, v194, v195
v_cvt_pk_bf16_f32 v194, v196, v197
v_mfma_f32_16x16x32_bf16 v[96:99], v[240:243], v[216:219], v[96:99]
v_cvt_pk_bf16_f32 v195, v198, v199
v_exp_f32 v200, v200
v_exp_f32 v201, v201
v_exp_f32 v202, v202
v_exp_f32 v203, v203
v_exp_f32 v204, v204
v_mfma_f32_16x16x32_bf16 v[216:219], a[16:19], v[36:39], v[164:167]
buffer_load_dwordx4 a[228:231], v1, s[12:15], s69 offen offset:1024 sc1
v_exp_f32 v205, v205
v_exp_f32 v206, v206
v_exp_f32 v207, v207
v_cvt_pk_bf16_f32 v200, v200, v201
v_cvt_pk_bf16_f32 v201, v202, v203
v_mfma_f32_16x16x32_bf16 v[220:223], a[20:23], v[36:39], v[164:167]
v_cvt_pk_bf16_f32 v202, v204, v205
v_cvt_pk_bf16_f32 v203, v206, v207
v_rcp_f32 v18, v108
v_cmp_ngt_f32 vcc, s91, v108
v_mul_f32 v100, v100, v18
v_mfma_f32_16x16x32_bf16 v[76:79], a[88:91], v[192:195], v[76:79]
v_mul_f32 v101, v101, v18
v_mul_f32 v102, v102, v18
v_mul_f32 v103, v103, v18
v_mul_f32 v104, v104, v18
v_mfma_f32_16x16x32_bf16 v[80:83], a[92:95], v[192:195], v[80:83]
v_mul_f32 v105, v105, v18
v_mul_f32 v106, v106, v18
v_mul_f32 v107, v107, v18
s_or_b64 s[58:59], s[58:59], vcc
v_cvt_pk_bf16_f32 v100, v100, v101
v_mfma_f32_16x16x32_bf16 v[84:87], v[240:243], v[192:195], v[84:87]
v_cvt_pk_bf16_f32 v101, v102, v103
v_cvt_pk_bf16_f32 v102, v104, v105
v_cvt_pk_bf16_f32 v103, v106, v107
v_exp_f32 v208, v208
v_exp_f32 v209, v209
v_exp_f32 v210, v210
v_exp_f32 v211, v211
v_mfma_f32_16x16x32_bf16 v[192:195], a[16:19], v[32:35], v[160:163]
buffer_store_dwordx4 v[100:103], v1, s[12:15], s96 offen offset:2048 sc1
buffer_load_dwordx4 a[232:235], v10, s[12:15], s69 offen offset:0 sc1
v_exp_f32 v212, v212
v_exp_f32 v213, v213
v_exp_f32 v214, v214
v_mfma_f32_16x16x32_bf16 v[196:199], a[20:23], v[32:35], v[160:163]
v_exp_f32 v215, v215
v_cvt_pk_bf16_f32 v208, v208, v209
v_cvt_pk_bf16_f32 v209, v210, v211
v_cvt_pk_bf16_f32 v210, v212, v213
v_mfma_f32_16x16x32_bf16 v[64:67], a[88:91], v[200:203], v[64:67]
v_cvt_pk_bf16_f32 v211, v214, v215
v_add_f32 v246, v232, v164
v_add_f32 v247, v233, v164
v_mfma_f32_16x16x32_bf16 v[68:71], a[92:95], v[200:203], v[68:71]
v_add_f32 v248, v234, v164
v_add_f32 v249, v235, v164
v_add_f32 v250, v236, v164
v_mfma_f32_16x16x32_bf16 v[72:75], v[240:243], v[200:203], v[72:75]
v_add_f32 v251, v237, v164
v_add_f32 v252, v238, v164
v_add_f32 v253, v239, v164
s_waitcnt vmcnt(16)
v_exp_f32 v216, v216
v_exp_f32 v217, v217
v_exp_f32 v218, v218
v_mfma_f32_16x16x32_bf16 v[200:203], a[8:11], v[36:39], v[246:249]
buffer_load_dwordx4 a[236:239], v10, s[12:15], s69 offen offset:1024 sc1
s_add_u32 s69, s69, 0xfff40000
v_exp_f32 v219, v219
v_exp_f32 v220, v220
v_mfma_f32_16x16x32_bf16 v[204:207], a[12:15], v[36:39], v[250:253]
v_exp_f32 v221, v221
v_exp_f32 v222, v222
v_mfma_f32_16x16x32_bf16 v[88:91], a[80:83], v[208:211], v[88:91]
v_exp_f32 v223, v223
v_cvt_pk_bf16_f32 v216, v216, v217
v_mfma_f32_16x16x32_bf16 v[92:95], a[84:87], v[208:211], v[92:95]
v_cvt_pk_bf16_f32 v217, v218, v219
v_cvt_pk_bf16_f32 v218, v220, v221
v_mfma_f32_16x16x32_bf16 v[96:99], v[240:243], v[208:211], v[96:99]
v_cvt_pk_bf16_f32 v219, v222, v223
v_exp_f32 v192, v192
v_mfma_f32_16x16x32_bf16 v[208:211], a[8:11], v[32:35], v[160:163]
v_exp_f32 v193, v193
v_exp_f32 v194, v194
v_exp_f32 v195, v195
v_exp_f32 v196, v196
v_mfma_f32_16x16x32_bf16 v[212:215], a[12:15], v[32:35], v[160:163]
v_exp_f32 v197, v197
v_exp_f32 v198, v198
v_exp_f32 v199, v199
v_cvt_pk_bf16_f32 v192, v192, v193
v_mfma_f32_16x16x32_bf16 v[76:79], a[80:83], v[216:219], v[76:79]
v_cvt_pk_bf16_f32 v193, v194, v195
v_cvt_pk_bf16_f32 v194, v196, v197
v_cvt_pk_bf16_f32 v195, v198, v199
v_add_f32 v246, v232, v160
v_mfma_f32_16x16x32_bf16 v[80:83], a[84:87], v[216:219], v[80:83]
v_add_f32 v247, v233, v160
v_add_f32 v248, v234, v160
v_add_f32 v249, v235, v160
v_add_f32 v250, v236, v160
v_mfma_f32_16x16x32_bf16 v[84:87], v[240:243], v[216:219], v[84:87]
v_add_f32 v251, v237, v160
v_add_f32 v252, v238, v160
v_add_f32 v253, v239, v160
s_waitcnt vmcnt(6)
v_exp_f32 v200, v200
v_mfma_f32_16x16x32_bf16 v[216:219], a[0:3], v[32:35], v[246:249]
v_exp_f32 v201, v201
v_exp_f32 v202, v202
v_exp_f32 v203, v203
v_exp_f32 v204, v204
v_exp_f32 v205, v205
v_mfma_f32_16x16x32_bf16 v[220:223], a[4:7], v[32:35], v[250:253]
v_exp_f32 v206, v206
v_exp_f32 v207, v207
v_cvt_pk_bf16_f32 v200, v200, v201
v_cvt_pk_bf16_f32 v201, v202, v203
v_cvt_pk_bf16_f32 v202, v204, v205
v_cvt_pk_bf16_f32 v203, v206, v207
v_mfma_f32_16x16x32_bf16 v[64:67], a[80:83], v[192:195], v[64:67]
v_rcp_f32 v18, v96
v_cmp_ngt_f32 vcc, s91, v96
v_mul_f32 v88, v88, v18
v_mul_f32 v89, v89, v18
v_mul_f32 v90, v90, v18
v_mul_f32 v91, v91, v18
v_mfma_f32_16x16x32_bf16 v[68:71], a[84:87], v[192:195], v[68:71]
v_mul_f32 v92, v92, v18
v_mul_f32 v93, v93, v18
v_mul_f32 v94, v94, v18
v_mul_f32 v95, v95, v18
s_or_b64 s[58:59], s[58:59], vcc
v_cvt_pk_bf16_f32 v88, v88, v89
v_mfma_f32_16x16x32_bf16 v[72:75], v[240:243], v[192:195], v[72:75]
v_cvt_pk_bf16_f32 v89, v90, v91
v_cvt_pk_bf16_f32 v90, v92, v93
v_cvt_pk_bf16_f32 v91, v94, v95
v_exp_f32 v208, v208
v_mfma_f32_16x16x32_bf16 v[76:79], a[72:75], v[200:203], v[76:79]
buffer_store_dwordx4 v[88:91], v1, s[12:15], s96 offen offset:0 sc1
s_sub_u32 s96, s96, 4096
v_exp_f32 v209, v209
v_exp_f32 v210, v210
v_exp_f32 v211, v211
v_exp_f32 v212, v212
v_mfma_f32_16x16x32_bf16 v[80:83], a[76:79], v[200:203], v[80:83]
v_exp_f32 v213, v213
v_exp_f32 v214, v214
v_exp_f32 v215, v215
v_cvt_pk_bf16_f32 v208, v208, v209
v_mfma_f32_16x16x32_bf16 v[84:87], v[240:243], v[200:203], v[84:87]
v_cvt_pk_bf16_f32 v209, v210, v211
v_cvt_pk_bf16_f32 v210, v212, v213
v_cvt_pk_bf16_f32 v211, v214, v215
v_exp_f32 v216, v216
s_nop 0
v_mfma_f32_16x16x32_bf16 v[64:67], a[72:75], v[208:211], v[64:67]
v_exp_f32 v217, v217
v_exp_f32 v218, v218
v_exp_f32 v219, v219
v_exp_f32 v220, v220
v_mfma_f32_16x16x32_bf16 v[68:71], a[76:79], v[208:211], v[68:71]
v_exp_f32 v221, v221
v_exp_f32 v222, v222
v_exp_f32 v223, v223
v_cvt_pk_bf16_f32 v216, v216, v217
v_mfma_f32_16x16x32_bf16 v[72:75], v[240:243], v[208:211], v[72:75]
v_cvt_pk_bf16_f32 v217, v218, v219
v_cvt_pk_bf16_f32 v218, v220, v221
v_cvt_pk_bf16_f32 v219, v222, v223
s_nop 1
v_mfma_f32_16x16x32_bf16 v[64:67], a[64:67], v[216:219], v[64:67]
v_mfma_f32_16x16x32_bf16 v[68:71], a[68:71], v[216:219], v[68:71]
v_mfma_f32_16x16x32_bf16 v[72:75], v[240:243], v[216:219], v[72:75]
v_rcp_f32 v18, v84
v_cmp_ngt_f32 vcc, s91, v84
v_mul_f32 v76, v76, v18
v_mul_f32 v77, v77, v18
v_mul_f32 v78, v78, v18
v_mul_f32 v79, v79, v18
v_mul_f32 v80, v80, v18
v_mul_f32 v81, v81, v18
v_mul_f32 v82, v82, v18
v_mul_f32 v83, v83, v18
s_or_b64 s[58:59], s[58:59], vcc
v_cvt_pk_bf16_f32 v76, v76, v77
v_cvt_pk_bf16_f32 v77, v78, v79
v_cvt_pk_bf16_f32 v78, v80, v81
v_cvt_pk_bf16_f32 v79, v82, v83
buffer_store_dwordx4 v[76:79], v1, s[12:15], s96 offen offset:2048 sc1
v_rcp_f32 v18, v72
v_cmp_ngt_f32 vcc, s91, v72
v_mul_f32 v64, v64, v18
v_mul_f32 v65, v65, v18
v_mul_f32 v66, v66, v18
v_mul_f32 v67, v67, v18
v_mul_f32 v68, v68, v18
v_mul_f32 v69, v69, v18
v_mul_f32 v70, v70, v18
v_mul_f32 v71, v71, v18
s_or_b64 s[58:59], s[58:59], vcc
v_cvt_pk_bf16_f32 v64, v64, v65
PG18:
s_cbranch_execz PG21
v_cvt_pk_bf16_f32 v65, v66, v67
v_cvt_pk_bf16_f32 v66, v68, v69
v_cvt_pk_bf16_f32 v67, v70, v71
buffer_store_dwordx4 v[64:67], v1, s[12:15], s96 offen offset:0 sc1
s_sub_u32 s96, s96, 4096
s_sub_u32 s69, s69, s67
s_cmp_lg_u64 s[58:59], 0
s_cbranch_scc1 fk_exact
fk_attdone:
s_cmp_lg_u32 s67, 0
s_cbranch_scc1 fk_hlate
fk_hok:
v_add_u32 v56, 65536, v6
v_add_u32 v60, 131072, v6
v_add_u32 v57, 65536, v7
v_add_u32 v61, 131072, v7
v_add_u32 v58, 65536, v8
v_add_u32 v62, 131072, v8
v_add_u32 v59, 65536, v9
v_add_u32 v63, 131072, v9
v_bfe_u32 v27, v1, 4, 4
v_bfe_u32 v28, v1, 8, 1
v_lshrrev_b32 v29, 9, v1
v_lshlrev_b32 v209, 5, v28
v_lshl_add_u32 v209, v29, 4, v209
v_lshl_add_u32 v210, v27, 11, v209
buffer_load_dwordx4 v[32:35], v210, s[28:31], s74 offen offset:0
buffer_load_dwordx4 v[36:39], v210, s[28:31], s74 offen offset:64
buffer_load_dwordx4 v[40:43], v210, s[28:31], s75 offen offset:0
buffer_load_dwordx4 v[44:47], v210, s[28:31], s75 offen offset:64
buffer_load_dwordx4 v[48:51], v209, s[32:35], s73 offen offset:0
buffer_load_dwordx4 v[52:55], v209, s[32:35], s73 offen offset:64
v_lshrrev_b32 v211, 5, v1
v_min_u32 v211, 6, v211
v_lshlrev_b32 v211, 10, v211
v_bfe_u32 v212, v1, 4, 1
v_lshl_add_u32 v211, v212, 7, v211
s_mul_i32 s44, s56, 7
s_add_u32 s44, s44, 4352
v_add_u32 v211, s44, v211
v_mov_b32 v64, 0
v_mov_b32 v65, 0
v_mov_b32 v66, 0
v_mov_b32 v67, 0
v_mov_b32 v68, 0
v_mov_b32 v69, 0
v_mov_b32 v70, 0
v_mov_b32 v71, 0
v_mov_b32 v72, 0
v_mov_b32 v73, 0
v_mov_b32 v74, 0
v_mov_b32 v75, 0
v_mov_b32 v76, 0
v_mov_b32 v77, 0
v_mov_b32 v78, 0
v_mov_b32 v79, 0
v_mov_b32 v80, 0
v_mov_b32 v81, 0
v_mov_b32 v82, 0
v_mov_b32 v83, 0
v_mov_b32 v84, 0
v_mov_b32 v85, 0
v_mov_b32 v86, 0
v_mov_b32 v87, 0
v_mov_b32 v88, 0
v_mov_b32 v89, 0
v_mov_b32 v90, 0
v_mov_b32 v91, 0
v_mov_b32 v92, 0
v_mov_b32 v93, 0
v_mov_b32 v94, 0
v_mov_b32 v95, 0
v_mov_b32 v96, 0
v_mov_b32 v97, 0
v_mov_b32 v98, 0
v_mov_b32 v99, 0
v_mov_b32 v100, 0
v_mov_b32 v101, 0
v_mov_b32 v102, 0
v_mov_b32 v103, 0
v_mov_b32 v104, 0
v_mov_b32 v105, 0
v_mov_b32 v106, 0
v_mov_b32 v107, 0
v_mov_b32 v108, 0
v_mov_b32 v109, 0
v_mov_b32 v110, 0
v_mov_b32 v111, 0
v_mov_b32 v112, 0
v_mov_b32 v113, 0
v_mov_b32 v114, 0
v_mov_b32 v115, 0
v_mov_b32 v116, 0
v_mov_b32 v117, 0
v_mov_b32 v118, 0
v_mov_b32 v119, 0
v_mov_b32 v120, 0
v_mov_b32 v121, 0
v_mov_b32 v122, 0
v_mov_b32 v123, 0
v_mov_b32 v124, 0
v_mov_b32 v125, 0
v_mov_b32 v126, 0
v_mov_b32 v127, 0
v_mov_b32 v0, v26
s_mov_b64 s[84:85], -1
s_barrier
ds_read_b64_tr_b16 a[0:1], v6 offset:49152
ds_read_b64_tr_b16 a[2:3], v6 offset:57344
ds_read_b64_tr_b16 a[16:17], v6 offset:51200
ds_read_b64_tr_b16 a[18:19], v6 offset:59392
ds_read_b64_tr_b16 a[4:5], v7 offset:49152
ds_read_b64_tr_b16 a[6:7], v7 offset:57344
ds_read_b64_tr_b16 a[20:21], v7 offset:51200
ds_read_b64_tr_b16 a[22:23], v7 offset:59392
ds_read_b64_tr_b16 a[8:9], v8 offset:49152
ds_read_b64_tr_b16 a[10:11], v8 offset:57344
ds_read_b64_tr_b16 a[24:25], v8 offset:51200
ds_read_b64_tr_b16 a[26:27], v8 offset:59392
ds_read_b64_tr_b16 a[12:13], v9 offset:49152
ds_read_b64_tr_b16 a[14:15], v9 offset:57344
ds_read_b64_tr_b16 a[28:29], v9 offset:51200
ds_read_b64_tr_b16 a[30:31], v9 offset:59392
fk_g2:
PG1037:
s_cbranch_execz PG22
s_waitcnt lgkmcnt(0)
s_waitcnt vmcnt(20)
s_mov_b32 s84, s87
s_mov_b32 s85, 0
s_mov_b32 s86, 0
fk_g2_a2_chk:
v_cmp_eq_u32 vcc, v26, v0
s_nop 1
s_andn2_b64 s[88:89], s[84:85], vcc
s_cbranch_scc0 fk_g2_a2_ok
s_add_u32 s86, s86, 1
s_cmp_gt_u32 s86, 0x8000
s_cbranch_scc1 fk_g2_a2_ok
s_sleep 4
fk_g2_a2_ld:
buffer_load_dword v0, v24, s[12:15], s82 offen sc1
s_waitcnt vmcnt(0)
s_branch fk_g2_a2_chk
fk_g2_a2_ok:
s_mov_b64 s[84:85], -1
v_mfma_f32_16x16x32_bf16 v[64:67], a[0:3], a[176:179], v[64:67]
ds_read_b64_tr_b16 a[32:33], v6 offset:50176
buffer_load_dwordx4 a[240:243], v1, s[12:15], s69 offen offset:0 sc1
v_mfma_f32_16x16x32_bf16 v[64:67], a[16:19], a[184:187], v[64:67]
ds_read_b64_tr_b16 a[34:35], v6 offset:58368
ds_read_b64_tr_b16 a[48:49], v6 offset:52224
v_mfma_f32_16x16x32_bf16 v[80:83], a[16:19], a[188:191], v[80:83]
ds_read_b64_tr_b16 a[50:51], v6 offset:60416
v_mfma_f32_16x16x32_bf16 v[80:83], a[0:3], a[180:183], v[80:83]
ds_read_b64_tr_b16 a[36:37], v7 offset:50176
buffer_load_dwordx4 a[244:247], v1, s[12:15], s69 offen offset:1024 sc1
v_mfma_f32_16x16x32_bf16 v[68:71], a[4:7], a[176:179], v[68:71]
ds_read_b64_tr_b16 a[38:39], v7 offset:58368
ds_read_b64_tr_b16 a[52:53], v7 offset:52224
v_mfma_f32_16x16x32_bf16 v[68:71], a[20:23], a[184:187], v[68:71]
ds_read_b64_tr_b16 a[54:55], v7 offset:60416
v_mfma_f32_16x16x32_bf16 v[84:87], a[20:23], a[188:191], v[84:87]
ds_read_b64_tr_b16 a[40:41], v8 offset:50176
buffer_load_dwordx4 a[248:251], v10, s[12:15], s69 offen offset:0 sc1
v_mfma_f32_16x16x32_bf16 v[84:87], a[4:7], a[180:183], v[84:87]
ds_read_b64_tr_b16 a[42:43], v8 offset:58368
ds_read_b64_tr_b16 a[56:57], v8 offset:52224
v_mfma_f32_16x16x32_bf16 v[72:75], a[8:11], a[176:179], v[72:75]
ds_read_b64_tr_b16 a[58:59], v8 offset:60416
v_mfma_f32_16x16x32_bf16 v[72:75], a[24:27], a[184:187], v[72:75]
ds_read_b64_tr_b16 a[44:45], v9 offset:50176
buffer_load_dwordx4 a[252:255], v10, s[12:15], s69 offen offset:1024 sc1
s_add_u32 s69, s69, 0x8000
v_mfma_f32_16x16x32_bf16 v[88:91], a[24:27], a[188:191], v[88:91]
ds_read_b64_tr_b16 a[46:47], v9 offset:58368
ds_read_b64_tr_b16 a[60:61], v9 offset:52224
v_mfma_f32_16x16x32_bf16 v[88:91], a[8:11], a[180:183], v[88:91]
ds_read_b64_tr_b16 a[62:63], v9 offset:60416
v_mfma_f32_16x16x32_bf16 v[76:79], a[12:15], a[176:179], v[76:79]
v_mfma_f32_16x16x32_bf16 v[76:79], a[28:31], a[184:187], v[76:79]
v_mfma_f32_16x16x32_bf16 v[92:95], a[28:31], a[188:191], v[92:95]
v_mfma_f32_16x16x32_bf16 v[92:95], a[12:15], a[180:183], v[92:95]
s_waitcnt vmcnt(20) lgkmcnt(0)
v_mfma_f32_16x16x32_bf16 v[96:99], a[32:35], a[176:179], v[96:99]
s_barrier
v_mfma_f32_16x16x32_bf16 v[96:99], a[48:51], a[184:187], v[96:99]
s_add_u32 m0, s42, 114688
ds_read_b64_tr_b16 a[0:1], v56 offset:0
buffer_load_dwordx4 v14, s[20:23], s71 offen offset:0 lds
v_mfma_f32_16x16x32_bf16 v[112:115], a[48:51], a[188:191], v[112:115]
ds_read_b64_tr_b16 a[2:3], v56 offset:8192
ds_read_b64_tr_b16 a[16:17], v56 offset:2048
v_mfma_f32_16x16x32_bf16 v[112:115], a[32:35], a[180:183], v[112:115]
ds_read_b64_tr_b16 a[18:19], v56 offset:10240
v_mfma_f32_16x16x32_bf16 v[100:103], a[36:39], a[176:179], v[100:103]
ds_read_b64_tr_b16 a[4:5], v57 offset:0
buffer_load_dwordx4 v15, s[20:23], s71 offen offset:1024 lds
v_mfma_f32_16x16x32_bf16 v[100:103], a[52:55], a[184:187], v[100:103]
ds_read_b64_tr_b16 a[6:7], v57 offset:8192
ds_read_b64_tr_b16 a[20:21], v57 offset:2048
v_mfma_f32_16x16x32_bf16 v[116:119], a[52:55], a[188:191], v[116:119]
ds_read_b64_tr_b16 a[22:23], v57 offset:10240
v_mfma_f32_16x16x32_bf16 v[116:119], a[36:39], a[180:183], v[116:119]
ds_read_b64_tr_b16 a[8:9], v58 offset:0
buffer_load_dwordx4 v16, s[20:23], s71 offen offset:2048 lds
v_mfma_f32_16x16x32_bf16 v[104:107], a[40:43], a[176:179], v[104:107]
ds_read_b64_tr_b16 a[10:11], v58 offset:8192
ds_read_b64_tr_b16 a[24:25], v58 offset:2048
v_mfma_f32_16x16x32_bf16 v[104:107], a[56:59], a[184:187], v[104:107]
ds_read_b64_tr_b16 a[26:27], v58 offset:10240
v_mfma_f32_16x16x32_bf16 v[120:123], a[56:59], a[188:191], v[120:123]
ds_read_b64_tr_b16 a[12:13], v59 offset:0
buffer_load_dwordx4 v17, s[20:23], s71 offen offset:3072 lds
s_add_u32 s71, s71, 0x20000
v_mfma_f32_16x16x32_bf16 v[120:123], a[40:43], a[180:183], v[120:123]
ds_read_b64_tr_b16 a[14:15], v59 offset:8192
ds_read_b64_tr_b16 a[28:29], v59 offset:2048
v_mfma_f32_16x16x32_bf16 v[108:111], a[44:47], a[176:179], v[108:111]
ds_read_b64_tr_b16 a[30:31], v59 offset:10240
v_mfma_f32_16x16x32_bf16 v[108:111], a[60:63], a[184:187], v[108:111]
v_mfma_f32_16x16x32_bf16 v[124:127], a[60:63], a[188:191], v[124:127]
v_mfma_f32_16x16x32_bf16 v[124:127], a[44:47], a[180:183], v[124:127]
s_waitcnt lgkmcnt(0)
v_mfma_f32_16x16x32_bf16 v[64:67], a[0:3], a[192:195], v[64:67]
ds_read_b64_tr_b16 a[32:33], v56 offset:1024
buffer_load_dwordx4 a[128:131], v1, s[12:15], s69 offen offset:0 sc1
v_mfma_f32_16x16x32_bf16 v[64:67], a[16:19], a[200:203], v[64:67]
ds_read_b64_tr_b16 a[34:35], v56 offset:9216
ds_read_b64_tr_b16 a[48:49], v56 offset:3072
v_mfma_f32_16x16x32_bf16 v[80:83], a[16:19], a[204:207], v[80:83]
ds_read_b64_tr_b16 a[50:51], v56 offset:11264
v_mfma_f32_16x16x32_bf16 v[80:83], a[0:3], a[196:199], v[80:83]
ds_read_b64_tr_b16 a[36:37], v57 offset:1024
buffer_load_dwordx4 a[132:135], v1, s[12:15], s69 offen offset:1024 sc1
v_mfma_f32_16x16x32_bf16 v[68:71], a[4:7], a[192:195], v[68:71]
ds_read_b64_tr_b16 a[38:39], v57 offset:9216
ds_read_b64_tr_b16 a[52:53], v57 offset:3072
v_mfma_f32_16x16x32_bf16 v[68:71], a[20:23], a[200:203], v[68:71]
ds_read_b64_tr_b16 a[54:55], v57 offset:11264
v_mfma_f32_16x16x32_bf16 v[84:87], a[20:23], a[204:207], v[84:87]
ds_read_b64_tr_b16 a[40:41], v58 offset:1024
buffer_load_dwordx4 a[136:139], v10, s[12:15], s69 offen offset:0 sc1
v_mfma_f32_16x16x32_bf16 v[84:87], a[4:7], a[196:199], v[84:87]
ds_read_b64_tr_b16 a[42:43], v58 offset:9216
ds_read_b64_tr_b16 a[56:57], v58 offset:3072
v_mfma_f32_16x16x32_bf16 v[72:75], a[8:11], a[192:195], v[72:75]
ds_read_b64_tr_b16 a[58:59], v58 offset:11264
v_mfma_f32_16x16x32_bf16 v[72:75], a[24:27], a[200:203], v[72:75]
ds_read_b64_tr_b16 a[44:45], v59 offset:1024
buffer_load_dwordx4 a[140:143], v10, s[12:15], s69 offen offset:1024 sc1
s_add_u32 s69, s69, 0x8000
v_mfma_f32_16x16x32_bf16 v[88:91], a[24:27], a[204:207], v[88:91]
ds_read_b64_tr_b16 a[46:47], v59 offset:9216
ds_read_b64_tr_b16 a[60:61], v59 offset:3072
v_mfma_f32_16x16x32_bf16 v[88:91], a[8:11], a[196:199], v[88:91]
ds_read_b64_tr_b16 a[62:63], v59 offset:11264
v_mfma_f32_16x16x32_bf16 v[76:79], a[12:15], a[192:195], v[76:79]
v_mfma_f32_16x16x32_bf16 v[76:79], a[28:31], a[200:203], v[76:79]
v_mfma_f32_16x16x32_bf16 v[92:95], a[28:31], a[204:207], v[92:95]
v_mfma_f32_16x16x32_bf16 v[92:95], a[12:15], a[196:199], v[92:95]
s_waitcnt vmcnt(20) lgkmcnt(0)
v_mfma_f32_16x16x32_bf16 v[96:99], a[32:35], a[192:195], v[96:99]
s_barrier
v_mfma_f32_16x16x32_bf16 v[96:99], a[48:51], a[200:203], v[96:99]
s_add_u32 m0, s42, 49152
ds_read_b64_tr_b16 a[0:1], v56 offset:16384
buffer_load_dwordx4 v14, s[20:23], s71 offen offset:0 lds
v_mfma_f32_16x16x32_bf16 v[112:115], a[48:51], a[204:207], v[112:115]
ds_read_b64_tr_b16 a[2:3], v56 offset:24576
ds_read_b64_tr_b16 a[16:17], v56 offset:18432
v_mfma_f32_16x16x32_bf16 v[112:115], a[32:35], a[196:199], v[112:115]
ds_read_b64_tr_b16 a[18:19], v56 offset:26624
v_mfma_f32_16x16x32_bf16 v[100:103], a[36:39], a[192:195], v[100:103]
ds_read_b64_tr_b16 a[4:5], v57 offset:16384
buffer_load_dwordx4 v15, s[20:23], s71 offen offset:1024 lds
v_mfma_f32_16x16x32_bf16 v[100:103], a[52:55], a[200:203], v[100:103]
ds_read_b64_tr_b16 a[6:7], v57 offset:24576
ds_read_b64_tr_b16 a[20:21], v57 offset:18432
v_mfma_f32_16x16x32_bf16 v[116:119], a[52:55], a[204:207], v[116:119]
ds_read_b64_tr_b16 a[22:23], v57 offset:26624
v_mfma_f32_16x16x32_bf16 v[116:119], a[36:39], a[196:199], v[116:119]
ds_read_b64_tr_b16 a[8:9], v58 offset:16384
buffer_load_dwordx4 v16, s[20:23], s71 offen offset:2048 lds
v_mfma_f32_16x16x32_bf16 v[104:107], a[40:43], a[192:195], v[104:107]
ds_read_b64_tr_b16 a[10:11], v58 offset:24576
ds_read_b64_tr_b16 a[24:25], v58 offset:18432
v_mfma_f32_16x16x32_bf16 v[104:107], a[56:59], a[200:203], v[104:107]
ds_read_b64_tr_b16 a[26:27], v58 offset:26624
v_mfma_f32_16x16x32_bf16 v[120:123], a[56:59], a[204:207], v[120:123]
ds_read_b64_tr_b16 a[12:13], v59 offset:16384
buffer_load_dwordx4 v17, s[20:23], s71 offen offset:3072 lds
s_add_u32 s71, s71, 0x20000
v_mfma_f32_16x16x32_bf16 v[120:123], a[40:43], a[196:199], v[120:123]
ds_read_b64_tr_b16 a[14:15], v59 offset:24576
ds_read_b64_tr_b16 a[28:29], v59 offset:18432
v_mfma_f32_16x16x32_bf16 v[108:111], a[44:47], a[192:195], v[108:111]
ds_read_b64_tr_b16 a[30:31], v59 offset:26624
v_mfma_f32_16x16x32_bf16 v[108:111], a[60:63], a[200:203], v[108:111]
v_mfma_f32_16x16x32_bf16 v[124:127], a[60:63], a[204:207], v[124:127]
v_mfma_f32_16x16x32_bf16 v[124:127], a[44:47], a[196:199], v[124:127]
s_waitcnt lgkmcnt(0)
v_mfma_f32_16x16x32_bf16 v[64:67], a[0:3], a[208:211], v[64:67]
ds_read_b64_tr_b16 a[32:33], v56 offset:17408
buffer_load_dwordx4 a[144:147], v1, s[12:15], s69 offen offset:0 sc1
v_mfma_f32_16x16x32_bf16 v[64:67], a[16:19], a[216:219], v[64:67]
ds_read_b64_tr_b16 a[34:35], v56 offset:25600
ds_read_b64_tr_b16 a[48:49], v56 offset:19456
v_mfma_f32_16x16x32_bf16 v[80:83], a[16:19], a[220:223], v[80:83]
ds_read_b64_tr_b16 a[50:51], v56 offset:27648
buffer_load_dwordx4 a[148:151], v1, s[12:15], s69 offen offset:1024 sc1
v_mfma_f32_16x16x32_bf16 v[80:83], a[0:3], a[212:215], v[80:83]
ds_read_b64_tr_b16 a[36:37], v57 offset:17408
v_mfma_f32_16x16x32_bf16 v[68:71], a[4:7], a[208:211], v[68:71]
ds_read_b64_tr_b16 a[38:39], v57 offset:25600
ds_read_b64_tr_b16 a[52:53], v57 offset:19456
v_mfma_f32_16x16x32_bf16 v[68:71], a[20:23], a[216:219], v[68:71]
buffer_load_dwordx4 a[152:155], v10, s[12:15], s69 offen offset:0 sc1
ds_read_b64_tr_b16 a[54:55], v57 offset:27648
v_mfma_f32_16x16x32_bf16 v[84:87], a[20:23], a[220:223], v[84:87]
ds_read_b64_tr_b16 a[40:41], v58 offset:17408
ds_read_b64_tr_b16 a[42:43], v58 offset:25600
v_mfma_f32_16x16x32_bf16 v[84:87], a[4:7], a[212:215], v[84:87]
buffer_load_dwordx4 a[156:159], v10, s[12:15], s69 offen offset:1024 sc1
s_add_u32 s69, s69, 0x10000
v_mfma_f32_16x16x32_bf16 v[72:75], a[8:11], a[208:211], v[72:75]
ds_read_b64_tr_b16 a[56:57], v58 offset:19456
ds_read_b64_tr_b16 a[58:59], v58 offset:27648
v_mfma_f32_16x16x32_bf16 v[72:75], a[24:27], a[216:219], v[72:75]
ds_read_b64_tr_b16 a[44:45], v59 offset:17408
s_add_u32 s47, s71, 0x80000
buffer_load_dword v212, v211, s[20:23], s47 offen
v_mfma_f32_16x16x32_bf16 v[88:91], a[24:27], a[220:223], v[88:91]
ds_read_b64_tr_b16 a[46:47], v59 offset:25600
ds_read_b64_tr_b16 a[60:61], v59 offset:19456
v_mfma_f32_16x16x32_bf16 v[88:91], a[8:11], a[212:215], v[88:91]
ds_read_b64_tr_b16 a[62:63], v59 offset:27648
v_mfma_f32_16x16x32_bf16 v[76:79], a[12:15], a[208:211], v[76:79]
v_mfma_f32_16x16x32_bf16 v[76:79], a[28:31], a[216:219], v[76:79]
v_mfma_f32_16x16x32_bf16 v[92:95], a[28:31], a[220:223], v[92:95]
v_mfma_f32_16x16x32_bf16 v[92:95], a[12:15], a[212:215], v[92:95]
s_waitcnt vmcnt(21) lgkmcnt(0)
v_mfma_f32_16x16x32_bf16 v[96:99], a[32:35], a[208:211], v[96:99]
s_barrier
v_mfma_f32_16x16x32_bf16 v[96:99], a[48:51], a[216:219], v[96:99]
s_add_u32 m0, s42, 65536
ds_read_b64_tr_b16 a[0:1], v56 offset:32768
buffer_load_dwordx4 v14, s[20:23], s71 offen offset:0 lds
v_mfma_f32_16x16x32_bf16 v[112:115], a[48:51], a[220:223], v[112:115]
ds_read_b64_tr_b16 a[2:3], v56 offset:40960
ds_read_b64_tr_b16 a[16:17], v56 offset:34816
v_mfma_f32_16x16x32_bf16 v[112:115], a[32:35], a[212:215], v[112:115]
ds_read_b64_tr_b16 a[18:19], v56 offset:43008
v_mfma_f32_16x16x32_bf16 v[100:103], a[36:39], a[208:211], v[100:103]
ds_read_b64_tr_b16 a[4:5], v57 offset:32768
buffer_load_dwordx4 v15, s[20:23], s71 offen offset:1024 lds
v_mfma_f32_16x16x32_bf16 v[100:103], a[52:55], a[216:219], v[100:103]
ds_read_b64_tr_b16 a[6:7], v57 offset:40960
ds_read_b64_tr_b16 a[20:21], v57 offset:34816
v_mfma_f32_16x16x32_bf16 v[116:119], a[52:55], a[220:223], v[116:119]
ds_read_b64_tr_b16 a[22:23], v57 offset:43008
v_mfma_f32_16x16x32_bf16 v[116:119], a[36:39], a[212:215], v[116:119]
ds_read_b64_tr_b16 a[8:9], v58 offset:32768
buffer_load_dwordx4 v16, s[20:23], s71 offen offset:2048 lds
v_mfma_f32_16x16x32_bf16 v[104:107], a[40:43], a[208:211], v[104:107]
ds_read_b64_tr_b16 a[10:11], v58 offset:40960
ds_read_b64_tr_b16 a[24:25], v58 offset:34816
v_mfma_f32_16x16x32_bf16 v[104:107], a[56:59], a[216:219], v[104:107]
ds_read_b64_tr_b16 a[26:27], v58 offset:43008
v_mfma_f32_16x16x32_bf16 v[120:123], a[56:59], a[220:223], v[120:123]
ds_read_b64_tr_b16 a[12:13], v59 offset:32768
buffer_load_dwordx4 v17, s[20:23], s71 offen offset:3072 lds
s_add_u32 s71, s71, 0x40000
v_mfma_f32_16x16x32_bf16 v[120:123], a[40:43], a[212:215], v[120:123]
ds_read_b64_tr_b16 a[14:15], v59 offset:40960
ds_read_b64_tr_b16 a[28:29], v59 offset:34816
v_mfma_f32_16x16x32_bf16 v[108:111], a[44:47], a[208:211], v[108:111]
ds_read_b64_tr_b16 a[30:31], v59 offset:43008
v_mfma_f32_16x16x32_bf16 v[108:111], a[60:63], a[216:219], v[108:111]
v_mfma_f32_16x16x32_bf16 v[124:127], a[60:63], a[220:223], v[124:127]
v_mfma_f32_16x16x32_bf16 v[124:127], a[44:47], a[212:215], v[124:127]
s_waitcnt lgkmcnt(0)
v_mfma_f32_16x16x32_bf16 v[64:67], a[0:3], a[224:227], v[64:67]
ds_read_b64_tr_b16 a[32:33], v56 offset:33792
buffer_load_dwordx4 a[160:163], v1, s[12:15], s69 offen offset:0 sc1
v_mfma_f32_16x16x32_bf16 v[64:67], a[16:19], a[232:235], v[64:67]
ds_read_b64_tr_b16 a[34:35], v56 offset:41984
ds_read_b64_tr_b16 a[48:49], v56 offset:35840
v_mfma_f32_16x16x32_bf16 v[80:83], a[16:19], a[236:239], v[80:83]
ds_read_b64_tr_b16 a[50:51], v56 offset:44032
v_mfma_f32_16x16x32_bf16 v[80:83], a[0:3], a[228:231], v[80:83]
ds_read_b64_tr_b16 a[36:37], v57 offset:33792
buffer_load_dwordx4 a[164:167], v1, s[12:15], s69 offen offset:1024 sc1
v_mfma_f32_16x16x32_bf16 v[68:71], a[4:7], a[224:227], v[68:71]
ds_read_b64_tr_b16 a[38:39], v57 offset:41984
ds_read_b64_tr_b16 a[52:53], v57 offset:35840
v_mfma_f32_16x16x32_bf16 v[68:71], a[20:23], a[232:235], v[68:71]
ds_read_b64_tr_b16 a[54:55], v57 offset:44032
v_mfma_f32_16x16x32_bf16 v[84:87], a[20:23], a[236:239], v[84:87]
ds_read_b64_tr_b16 a[40:41], v58 offset:33792
buffer_load_dwordx4 a[168:171], v10, s[12:15], s69 offen offset:0 sc1
v_mfma_f32_16x16x32_bf16 v[84:87], a[4:7], a[228:231], v[84:87]
ds_read_b64_tr_b16 a[42:43], v58 offset:41984
ds_read_b64_tr_b16 a[56:57], v58 offset:35840
v_mfma_f32_16x16x32_bf16 v[72:75], a[8:11], a[224:227], v[72:75]
ds_read_b64_tr_b16 a[58:59], v58 offset:44032
v_mfma_f32_16x16x32_bf16 v[72:75], a[24:27], a[232:235], v[72:75]
ds_read_b64_tr_b16 a[44:45], v59 offset:33792
buffer_load_dwordx4 a[172:175], v10, s[12:15], s69 offen offset:1024 sc1
s_add_u32 s69, s69, 0x8000
v_mfma_f32_16x16x32_bf16 v[88:91], a[24:27], a[236:239], v[88:91]
ds_read_b64_tr_b16 a[46:47], v59 offset:41984
ds_read_b64_tr_b16 a[60:61], v59 offset:35840
v_mfma_f32_16x16x32_bf16 v[88:91], a[8:11], a[228:231], v[88:91]
ds_read_b64_tr_b16 a[62:63], v59 offset:44032
v_mfma_f32_16x16x32_bf16 v[76:79], a[12:15], a[224:227], v[76:79]
v_mfma_f32_16x16x32_bf16 v[76:79], a[28:31], a[232:235], v[76:79]
v_mfma_f32_16x16x32_bf16 v[92:95], a[28:31], a[236:239], v[92:95]
v_mfma_f32_16x16x32_bf16 v[92:95], a[12:15], a[228:231], v[92:95]
s_waitcnt vmcnt(21) lgkmcnt(0)
v_mfma_f32_16x16x32_bf16 v[96:99], a[32:35], a[224:227], v[96:99]
s_barrier
v_mfma_f32_16x16x32_bf16 v[96:99], a[48:51], a[232:235], v[96:99]
s_add_u32 m0, s42, 81920
ds_read_b64_tr_b16 a[0:1], v56 offset:49152
buffer_load_dwordx4 v14, s[20:23], s71 offen offset:0 lds
v_mfma_f32_16x16x32_bf16 v[112:115], a[48:51], a[236:239], v[112:115]
ds_read_b64_tr_b16 a[2:3], v56 offset:57344
ds_read_b64_tr_b16 a[16:17], v56 offset:51200
v_mfma_f32_16x16x32_bf16 v[112:115], a[32:35], a[228:231], v[112:115]
ds_read_b64_tr_b16 a[18:19], v56 offset:59392
v_mfma_f32_16x16x32_bf16 v[100:103], a[36:39], a[224:227], v[100:103]
ds_read_b64_tr_b16 a[4:5], v57 offset:49152
buffer_load_dwordx4 v15, s[20:23], s71 offen offset:1024 lds
v_mfma_f32_16x16x32_bf16 v[100:103], a[52:55], a[232:235], v[100:103]
ds_read_b64_tr_b16 a[6:7], v57 offset:57344
ds_read_b64_tr_b16 a[20:21], v57 offset:51200
v_mfma_f32_16x16x32_bf16 v[116:119], a[52:55], a[236:239], v[116:119]
ds_read_b64_tr_b16 a[22:23], v57 offset:59392
v_mfma_f32_16x16x32_bf16 v[116:119], a[36:39], a[228:231], v[116:119]
ds_read_b64_tr_b16 a[8:9], v58 offset:49152
buffer_load_dwordx4 v16, s[20:23], s71 offen offset:2048 lds
v_mfma_f32_16x16x32_bf16 v[104:107], a[40:43], a[224:227], v[104:107]
ds_read_b64_tr_b16 a[10:11], v58 offset:57344
ds_read_b64_tr_b16 a[24:25], v58 offset:51200
v_mfma_f32_16x16x32_bf16 v[104:107], a[56:59], a[232:235], v[104:107]
ds_read_b64_tr_b16 a[26:27], v58 offset:59392
v_mfma_f32_16x16x32_bf16 v[120:123], a[56:59], a[236:239], v[120:123]
ds_read_b64_tr_b16 a[12:13], v59 offset:49152
buffer_load_dwordx4 v17, s[20:23], s71 offen offset:3072 lds
s_add_u32 s71, s71, 0x20000
v_mfma_f32_16x16x32_bf16 v[120:123], a[40:43], a[228:231], v[120:123]
ds_read_b64_tr_b16 a[14:15], v59 offset:57344
ds_read_b64_tr_b16 a[28:29], v59 offset:51200
v_mfma_f32_16x16x32_bf16 v[108:111], a[44:47], a[224:227], v[108:111]
ds_read_b64_tr_b16 a[30:31], v59 offset:59392
v_mfma_f32_16x16x32_bf16 v[108:111], a[60:63], a[232:235], v[108:111]
v_mfma_f32_16x16x32_bf16 v[124:127], a[60:63], a[236:239], v[124:127]
v_mfma_f32_16x16x32_bf16 v[124:127], a[44:47], a[228:231], v[124:127]
s_waitcnt lgkmcnt(0)
buffer_store_dword v26, v25, s[12:15], s65 offen sc1
v_mfma_f32_16x16x32_bf16 v[64:67], a[0:3], a[240:243], v[64:67]
ds_read_b64_tr_b16 a[32:33], v56 offset:50176
buffer_load_dwordx4 a[176:179], v1, s[12:15], s69 offen offset:0 sc1
v_mfma_f32_16x16x32_bf16 v[64:67], a[16:19], a[248:251], v[64:67]
ds_read_b64_tr_b16 a[34:35], v56 offset:58368
ds_read_b64_tr_b16 a[48:49], v56 offset:52224
v_mfma_f32_16x16x32_bf16 v[80:83], a[16:19], a[252:255], v[80:83]
ds_read_b64_tr_b16 a[50:51], v56 offset:60416
v_mfma_f32_16x16x32_bf16 v[80:83], a[0:3], a[244:247], v[80:83]
ds_read_b64_tr_b16 a[36:37], v57 offset:50176
buffer_load_dwordx4 a[180:183], v1, s[12:15], s69 offen offset:1024 sc1
v_mfma_f32_16x16x32_bf16 v[68:71], a[4:7], a[240:243], v[68:71]
ds_read_b64_tr_b16 a[38:39], v57 offset:58368
ds_read_b64_tr_b16 a[52:53], v57 offset:52224
v_mfma_f32_16x16x32_bf16 v[68:71], a[20:23], a[248:251], v[68:71]
ds_read_b64_tr_b16 a[54:55], v57 offset:60416
v_mfma_f32_16x16x32_bf16 v[84:87], a[20:23], a[252:255], v[84:87]
ds_read_b64_tr_b16 a[40:41], v58 offset:50176
buffer_load_dwordx4 a[184:187], v10, s[12:15], s69 offen offset:0 sc1
v_mfma_f32_16x16x32_bf16 v[84:87], a[4:7], a[244:247], v[84:87]
ds_read_b64_tr_b16 a[42:43], v58 offset:58368
ds_read_b64_tr_b16 a[56:57], v58 offset:52224
v_mfma_f32_16x16x32_bf16 v[72:75], a[8:11], a[240:243], v[72:75]
ds_read_b64_tr_b16 a[58:59], v58 offset:60416
v_mfma_f32_16x16x32_bf16 v[72:75], a[24:27], a[248:251], v[72:75]
ds_read_b64_tr_b16 a[44:45], v59 offset:50176
buffer_load_dwordx4 a[188:191], v10, s[12:15], s69 offen offset:1024 sc1
s_add_u32 s69, s69, 0x10000
v_mfma_f32_16x16x32_bf16 v[88:91], a[24:27], a[252:255], v[88:91]
ds_read_b64_tr_b16 a[46:47], v59 offset:58368
ds_read_b64_tr_b16 a[60:61], v59 offset:52224
v_mfma_f32_16x16x32_bf16 v[88:91], a[8:11], a[244:247], v[88:91]
ds_read_b64_tr_b16 a[62:63], v59 offset:60416
v_mfma_f32_16x16x32_bf16 v[76:79], a[12:15], a[240:243], v[76:79]
v_mfma_f32_16x16x32_bf16 v[76:79], a[28:31], a[248:251], v[76:79]
v_mfma_f32_16x16x32_bf16 v[92:95], a[28:31], a[252:255], v[92:95]
v_mfma_f32_16x16x32_bf16 v[92:95], a[12:15], a[244:247], v[92:95]
s_waitcnt vmcnt(22) lgkmcnt(0)
v_mfma_f32_16x16x32_bf16 v[96:99], a[32:35], a[240:243], v[96:99]
s_barrier
v_mfma_f32_16x16x32_bf16 v[96:99], a[48:51], a[248:251], v[96:99]
s_add_u32 m0, s42, 98304
ds_read_b64_tr_b16 a[0:1], v6 offset:49152
buffer_load_dwordx4 v14, s[20:23], s71 offen offset:0 lds
v_mfma_f32_16x16x32_bf16 v[112:115], a[48:51], a[252:255], v[112:115]
ds_read_b64_tr_b16 a[2:3], v6 offset:57344
ds_read_b64_tr_b16 a[16:17], v6 offset:51200
v_mfma_f32_16x16x32_bf16 v[112:115], a[32:35], a[244:247], v[112:115]
ds_read_b64_tr_b16 a[18:19], v6 offset:59392
v_mfma_f32_16x16x32_bf16 v[100:103], a[36:39], a[240:243], v[100:103]
ds_read_b64_tr_b16 a[4:5], v7 offset:49152
buffer_load_dwordx4 v15, s[20:23], s71 offen offset:1024 lds
v_mfma_f32_16x16x32_bf16 v[100:103], a[52:55], a[248:251], v[100:103]
ds_read_b64_tr_b16 a[6:7], v7 offset:57344
ds_read_b64_tr_b16 a[20:21], v7 offset:51200
v_mfma_f32_16x16x32_bf16 v[116:119], a[52:55], a[252:255], v[116:119]
ds_read_b64_tr_b16 a[22:23], v7 offset:59392
v_mfma_f32_16x16x32_bf16 v[116:119], a[36:39], a[244:247], v[116:119]
ds_read_b64_tr_b16 a[8:9], v8 offset:49152
buffer_load_dwordx4 v16, s[20:23], s71 offen offset:2048 lds
v_mfma_f32_16x16x32_bf16 v[104:107], a[40:43], a[240:243], v[104:107]
ds_read_b64_tr_b16 a[10:11], v8 offset:57344
ds_read_b64_tr_b16 a[24:25], v8 offset:51200
v_mfma_f32_16x16x32_bf16 v[104:107], a[56:59], a[248:251], v[104:107]
ds_read_b64_tr_b16 a[26:27], v8 offset:59392
v_mfma_f32_16x16x32_bf16 v[120:123], a[56:59], a[252:255], v[120:123]
ds_read_b64_tr_b16 a[12:13], v9 offset:49152
buffer_load_dwordx4 v17, s[20:23], s71 offen offset:3072 lds
s_add_u32 s71, s71, 0x40000
v_mfma_f32_16x16x32_bf16 v[120:123], a[40:43], a[244:247], v[120:123]
ds_read_b64_tr_b16 a[14:15], v9 offset:57344
ds_read_b64_tr_b16 a[28:29], v9 offset:51200
v_mfma_f32_16x16x32_bf16 v[108:111], a[44:47], a[240:243], v[108:111]
ds_read_b64_tr_b16 a[30:31], v9 offset:59392
v_mfma_f32_16x16x32_bf16 v[108:111], a[60:63], a[248:251], v[108:111]
v_mfma_f32_16x16x32_bf16 v[124:127], a[60:63], a[252:255], v[124:127]
v_mfma_f32_16x16x32_bf16 v[124:127], a[44:47], a[244:247], v[124:127]
s_waitcnt lgkmcnt(0)
v_mfma_f32_16x16x32_bf16 v[64:67], a[0:3], a[128:131], v[64:67]
ds_read_b64_tr_b16 a[32:33], v6 offset:50176
buffer_load_dwordx4 a[192:195], v1, s[12:15], s69 offen offset:0 sc1
v_mfma_f32_16x16x32_bf16 v[64:67], a[16:19], a[136:139], v[64:67]
ds_read_b64_tr_b16 a[34:35], v6 offset:58368
ds_read_b64_tr_b16 a[48:49], v6 offset:52224
v_mfma_f32_16x16x32_bf16 v[80:83], a[16:19], a[140:143], v[80:83]
ds_read_b64_tr_b16 a[50:51], v6 offset:60416
v_mfma_f32_16x16x32_bf16 v[80:83], a[0:3], a[132:135], v[80:83]
ds_read_b64_tr_b16 a[36:37], v7 offset:50176
buffer_load_dwordx4 a[196:199], v1, s[12:15], s69 offen offset:1024 sc1
v_mfma_f32_16x16x32_bf16 v[68:71], a[4:7], a[128:131], v[68:71]
ds_read_b64_tr_b16 a[38:39], v7 offset:58368
ds_read_b64_tr_b16 a[52:53], v7 offset:52224
v_mfma_f32_16x16x32_bf16 v[68:71], a[20:23], a[136:139], v[68:71]
ds_read_b64_tr_b16 a[54:55], v7 offset:60416
v_mfma_f32_16x16x32_bf16 v[84:87], a[20:23], a[140:143], v[84:87]
ds_read_b64_tr_b16 a[40:41], v8 offset:50176
buffer_load_dwordx4 a[200:203], v10, s[12:15], s69 offen offset:0 sc1
v_mfma_f32_16x16x32_bf16 v[84:87], a[4:7], a[132:135], v[84:87]
ds_read_b64_tr_b16 a[42:43], v8 offset:58368
ds_read_b64_tr_b16 a[56:57], v8 offset:52224
v_mfma_f32_16x16x32_bf16 v[72:75], a[8:11], a[128:131], v[72:75]
ds_read_b64_tr_b16 a[58:59], v8 offset:60416
v_mfma_f32_16x16x32_bf16 v[72:75], a[24:27], a[136:139], v[72:75]
ds_read_b64_tr_b16 a[44:45], v9 offset:50176
buffer_load_dwordx4 a[204:207], v10, s[12:15], s69 offen offset:1024 sc1
s_add_u32 s69, s69, 0x8000
v_mfma_f32_16x16x32_bf16 v[88:91], a[24:27], a[140:143], v[88:91]
ds_read_b64_tr_b16 a[46:47], v9 offset:58368
ds_read_b64_tr_b16 a[60:61], v9 offset:52224
v_mfma_f32_16x16x32_bf16 v[88:91], a[8:11], a[132:135], v[88:91]
ds_read_b64_tr_b16 a[62:63], v9 offset:60416
v_mfma_f32_16x16x32_bf16 v[76:79], a[12:15], a[128:131], v[76:79]
v_mfma_f32_16x16x32_bf16 v[76:79], a[28:31], a[136:139], v[76:79]
PG19:
s_cbranch_execz PG23
v_mfma_f32_16x16x32_bf16 v[92:95], a[28:31], a[140:143], v[92:95]
v_mfma_f32_16x16x32_bf16 v[92:95], a[12:15], a[132:135], v[92:95]
s_waitcnt vmcnt(21) lgkmcnt(0)
v_mfma_f32_16x16x32_bf16 v[96:99], a[32:35], a[128:131], v[96:99]
s_barrier
v_mfma_f32_16x16x32_bf16 v[96:99], a[48:51], a[136:139], v[96:99]
s_add_u32 m0, s42, 114688
ds_read_b64_tr_b16 a[0:1], v56 offset:0
buffer_load_dwordx4 v14, s[20:23], s71 offen offset:0 lds
v_mfma_f32_16x16x32_bf16 v[112:115], a[48:51], a[140:143], v[112:115]
ds_read_b64_tr_b16 a[2:3], v56 offset:8192
ds_read_b64_tr_b16 a[16:17], v56 offset:2048
v_mfma_f32_16x16x32_bf16 v[112:115], a[32:35], a[132:135], v[112:115]
ds_read_b64_tr_b16 a[18:19], v56 offset:10240
v_mfma_f32_16x16x32_bf16 v[100:103], a[36:39], a[128:131], v[100:103]
ds_read_b64_tr_b16 a[4:5], v57 offset:0
buffer_load_dwordx4 v15, s[20:23], s71 offen offset:1024 lds
v_mfma_f32_16x16x32_bf16 v[100:103], a[52:55], a[136:139], v[100:103]
ds_read_b64_tr_b16 a[6:7], v57 offset:8192
ds_read_b64_tr_b16 a[20:21], v57 offset:2048
v_mfma_f32_16x16x32_bf16 v[116:119], a[52:55], a[140:143], v[116:119]
ds_read_b64_tr_b16 a[22:23], v57 offset:10240
v_mfma_f32_16x16x32_bf16 v[116:119], a[36:39], a[132:135], v[116:119]
ds_read_b64_tr_b16 a[8:9], v58 offset:0
buffer_load_dwordx4 v16, s[20:23], s71 offen offset:2048 lds
v_mfma_f32_16x16x32_bf16 v[104:107], a[40:43], a[128:131], v[104:107]
ds_read_b64_tr_b16 a[10:11], v58 offset:8192
ds_read_b64_tr_b16 a[24:25], v58 offset:2048
v_mfma_f32_16x16x32_bf16 v[104:107], a[56:59], a[136:139], v[104:107]
ds_read_b64_tr_b16 a[26:27], v58 offset:10240
v_mfma_f32_16x16x32_bf16 v[120:123], a[56:59], a[140:143], v[120:123]
ds_read_b64_tr_b16 a[12:13], v59 offset:0
buffer_load_dwordx4 v17, s[20:23], s71 offen offset:3072 lds
s_add_u32 s71, s71, 0x20000
v_mfma_f32_16x16x32_bf16 v[120:123], a[40:43], a[132:135], v[120:123]
ds_read_b64_tr_b16 a[14:15], v59 offset:8192
ds_read_b64_tr_b16 a[28:29], v59 offset:2048
v_mfma_f32_16x16x32_bf16 v[108:111], a[44:47], a[128:131], v[108:111]
ds_read_b64_tr_b16 a[30:31], v59 offset:10240
v_mfma_f32_16x16x32_bf16 v[108:111], a[60:63], a[136:139], v[108:111]
v_mfma_f32_16x16x32_bf16 v[124:127], a[60:63], a[140:143], v[124:127]
v_mfma_f32_16x16x32_bf16 v[124:127], a[44:47], a[132:135], v[124:127]
s_waitcnt lgkmcnt(0)
v_mfma_f32_16x16x32_bf16 v[64:67], a[0:3], a[144:147], v[64:67]
ds_read_b64_tr_b16 a[32:33], v56 offset:1024
buffer_load_dwordx4 a[208:211], v1, s[12:15], s69 offen offset:0 sc1
v_mfma_f32_16x16x32_bf16 v[64:67], a[16:19], a[152:155], v[64:67]
ds_read_b64_tr_b16 a[34:35], v56 offset:9216
ds_read_b64_tr_b16 a[48:49], v56 offset:3072
v_mfma_f32_16x16x32_bf16 v[80:83], a[16:19], a[156:159], v[80:83]
ds_read_b64_tr_b16 a[50:51], v56 offset:11264
v_mfma_f32_16x16x32_bf16 v[80:83], a[0:3], a[148:151], v[80:83]
ds_read_b64_tr_b16 a[36:37], v57 offset:1024
buffer_load_dwordx4 a[212:215], v1, s[12:15], s69 offen offset:1024 sc1
v_mfma_f32_16x16x32_bf16 v[68:71], a[4:7], a[144:147], v[68:71]
ds_read_b64_tr_b16 a[38:39], v57 offset:9216
ds_read_b64_tr_b16 a[52:53], v57 offset:3072
v_mfma_f32_16x16x32_bf16 v[68:71], a[20:23], a[152:155], v[68:71]
ds_read_b64_tr_b16 a[54:55], v57 offset:11264
v_mfma_f32_16x16x32_bf16 v[84:87], a[20:23], a[156:159], v[84:87]
ds_read_b64_tr_b16 a[40:41], v58 offset:1024
buffer_load_dwordx4 a[216:219], v10, s[12:15], s69 offen offset:0 sc1
v_mfma_f32_16x16x32_bf16 v[84:87], a[4:7], a[148:151], v[84:87]
ds_read_b64_tr_b16 a[42:43], v58 offset:9216
ds_read_b64_tr_b16 a[56:57], v58 offset:3072
v_mfma_f32_16x16x32_bf16 v[72:75], a[8:11], a[144:147], v[72:75]
ds_read_b64_tr_b16 a[58:59], v58 offset:11264
v_mfma_f32_16x16x32_bf16 v[72:75], a[24:27], a[152:155], v[72:75]
ds_read_b64_tr_b16 a[44:45], v59 offset:1024
buffer_load_dwordx4 a[220:223], v10, s[12:15], s69 offen offset:1024 sc1
s_add_u32 s69, s69, 0x8000
v_mfma_f32_16x16x32_bf16 v[88:91], a[24:27], a[156:159], v[88:91]
ds_read_b64_tr_b16 a[46:47], v59 offset:9216
ds_read_b64_tr_b16 a[60:61], v59 offset:3072
v_mfma_f32_16x16x32_bf16 v[88:91], a[8:11], a[148:151], v[88:91]
ds_read_b64_tr_b16 a[62:63], v59 offset:11264
v_mfma_f32_16x16x32_bf16 v[76:79], a[12:15], a[144:147], v[76:79]
v_mfma_f32_16x16x32_bf16 v[76:79], a[28:31], a[152:155], v[76:79]
v_mfma_f32_16x16x32_bf16 v[92:95], a[28:31], a[156:159], v[92:95]
v_mfma_f32_16x16x32_bf16 v[92:95], a[12:15], a[148:151], v[92:95]
s_waitcnt vmcnt(21) lgkmcnt(0)
v_mfma_f32_16x16x32_bf16 v[96:99], a[32:35], a[144:147], v[96:99]
s_barrier
v_mfma_f32_16x16x32_bf16 v[96:99], a[48:51], a[152:155], v[96:99]
s_add_u32 m0, s42, 49152
ds_read_b64_tr_b16 a[0:1], v56 offset:16384
buffer_load_dwordx4 v14, s[20:23], s71 offen offset:0 lds
v_mfma_f32_16x16x32_bf16 v[112:115], a[48:51], a[156:159], v[112:115]
ds_read_b64_tr_b16 a[2:3], v56 offset:24576
ds_read_b64_tr_b16 a[16:17], v56 offset:18432
v_mfma_f32_16x16x32_bf16 v[112:115], a[32:35], a[148:151], v[112:115]
ds_read_b64_tr_b16 a[18:19], v56 offset:26624
v_mfma_f32_16x16x32_bf16 v[100:103], a[36:39], a[144:147], v[100:103]
ds_read_b64_tr_b16 a[4:5], v57 offset:16384
buffer_load_dwordx4 v15, s[20:23], s71 offen offset:1024 lds
v_mfma_f32_16x16x32_bf16 v[100:103], a[52:55], a[152:155], v[100:103]
ds_read_b64_tr_b16 a[6:7], v57 offset:24576
ds_read_b64_tr_b16 a[20:21], v57 offset:18432
v_mfma_f32_16x16x32_bf16 v[116:119], a[52:55], a[156:159], v[116:119]
ds_read_b64_tr_b16 a[22:23], v57 offset:26624
v_mfma_f32_16x16x32_bf16 v[116:119], a[36:39], a[148:151], v[116:119]
ds_read_b64_tr_b16 a[8:9], v58 offset:16384
buffer_load_dwordx4 v16, s[20:23], s71 offen offset:2048 lds
v_mfma_f32_16x16x32_bf16 v[104:107], a[40:43], a[144:147], v[104:107]
ds_read_b64_tr_b16 a[10:11], v58 offset:24576
ds_read_b64_tr_b16 a[24:25], v58 offset:18432
v_mfma_f32_16x16x32_bf16 v[104:107], a[56:59], a[152:155], v[104:107]
ds_read_b64_tr_b16 a[26:27], v58 offset:26624
v_mfma_f32_16x16x32_bf16 v[120:123], a[56:59], a[156:159], v[120:123]
ds_read_b64_tr_b16 a[12:13], v59 offset:16384
buffer_load_dwordx4 v17, s[20:23], s71 offen offset:3072 lds
s_add_u32 s71, s71, 0x20000
v_mfma_f32_16x16x32_bf16 v[120:123], a[40:43], a[148:151], v[120:123]
ds_read_b64_tr_b16 a[14:15], v59 offset:24576
ds_read_b64_tr_b16 a[28:29], v59 offset:18432
v_mfma_f32_16x16x32_bf16 v[108:111], a[44:47], a[144:147], v[108:111]
ds_read_b64_tr_b16 a[30:31], v59 offset:26624
v_mfma_f32_16x16x32_bf16 v[108:111], a[60:63], a[152:155], v[108:111]
v_mfma_f32_16x16x32_bf16 v[124:127], a[60:63], a[156:159], v[124:127]
v_mfma_f32_16x16x32_bf16 v[124:127], a[44:47], a[148:151], v[124:127]
s_waitcnt lgkmcnt(0)
v_mfma_f32_16x16x32_bf16 v[64:67], a[0:3], a[160:163], v[64:67]
ds_read_b64_tr_b16 a[32:33], v56 offset:17408
buffer_load_dwordx4 a[224:227], v1, s[12:15], s69 offen offset:0 sc1
v_mfma_f32_16x16x32_bf16 v[64:67], a[16:19], a[168:171], v[64:67]
ds_read_b64_tr_b16 a[34:35], v56 offset:25600
ds_read_b64_tr_b16 a[48:49], v56 offset:19456
v_mfma_f32_16x16x32_bf16 v[80:83], a[16:19], a[172:175], v[80:83]
ds_read_b64_tr_b16 a[50:51], v56 offset:27648
buffer_load_dwordx4 a[228:231], v1, s[12:15], s69 offen offset:1024 sc1
v_mfma_f32_16x16x32_bf16 v[80:83], a[0:3], a[164:167], v[80:83]
ds_read_b64_tr_b16 a[36:37], v57 offset:17408
v_mfma_f32_16x16x32_bf16 v[68:71], a[4:7], a[160:163], v[68:71]
ds_read_b64_tr_b16 a[38:39], v57 offset:25600
ds_read_b64_tr_b16 a[52:53], v57 offset:19456
v_mfma_f32_16x16x32_bf16 v[68:71], a[20:23], a[168:171], v[68:71]
buffer_load_dwordx4 a[232:235], v10, s[12:15], s69 offen offset:0 sc1
ds_read_b64_tr_b16 a[54:55], v57 offset:27648
v_mfma_f32_16x16x32_bf16 v[84:87], a[20:23], a[172:175], v[84:87]
ds_read_b64_tr_b16 a[40:41], v58 offset:17408
ds_read_b64_tr_b16 a[42:43], v58 offset:25600
v_mfma_f32_16x16x32_bf16 v[84:87], a[4:7], a[164:167], v[84:87]
buffer_load_dwordx4 a[236:239], v10, s[12:15], s69 offen offset:1024 sc1
s_add_u32 s69, s69, 0x10000
v_mfma_f32_16x16x32_bf16 v[72:75], a[8:11], a[160:163], v[72:75]
ds_read_b64_tr_b16 a[56:57], v58 offset:19456
ds_read_b64_tr_b16 a[58:59], v58 offset:27648
v_mfma_f32_16x16x32_bf16 v[72:75], a[24:27], a[168:171], v[72:75]
ds_read_b64_tr_b16 a[44:45], v59 offset:17408
s_add_u32 s47, s71, 0x80000
buffer_load_dword v212, v211, s[20:23], s47 offen
v_mfma_f32_16x16x32_bf16 v[88:91], a[24:27], a[172:175], v[88:91]
ds_read_b64_tr_b16 a[46:47], v59 offset:25600
ds_read_b64_tr_b16 a[60:61], v59 offset:19456
v_mfma_f32_16x16x32_bf16 v[88:91], a[8:11], a[164:167], v[88:91]
ds_read_b64_tr_b16 a[62:63], v59 offset:27648
v_mfma_f32_16x16x32_bf16 v[76:79], a[12:15], a[160:163], v[76:79]
v_mfma_f32_16x16x32_bf16 v[76:79], a[28:31], a[168:171], v[76:79]
v_mfma_f32_16x16x32_bf16 v[92:95], a[28:31], a[172:175], v[92:95]
v_mfma_f32_16x16x32_bf16 v[92:95], a[12:15], a[164:167], v[92:95]
s_waitcnt vmcnt(21) lgkmcnt(0)
v_mfma_f32_16x16x32_bf16 v[96:99], a[32:35], a[160:163], v[96:99]
s_barrier
v_mfma_f32_16x16x32_bf16 v[96:99], a[48:51], a[168:171], v[96:99]
s_add_u32 m0, s42, 65536
ds_read_b64_tr_b16 a[0:1], v56 offset:32768
buffer_load_dwordx4 v14, s[20:23], s71 offen offset:0 lds
v_mfma_f32_16x16x32_bf16 v[112:115], a[48:51], a[172:175], v[112:115]
ds_read_b64_tr_b16 a[2:3], v56 offset:40960
ds_read_b64_tr_b16 a[16:17], v56 offset:34816
v_mfma_f32_16x16x32_bf16 v[112:115], a[32:35], a[164:167], v[112:115]
ds_read_b64_tr_b16 a[18:19], v56 offset:43008
v_mfma_f32_16x16x32_bf16 v[100:103], a[36:39], a[160:163], v[100:103]
ds_read_b64_tr_b16 a[4:5], v57 offset:32768
buffer_load_dwordx4 v15, s[20:23], s71 offen offset:1024 lds
v_mfma_f32_16x16x32_bf16 v[100:103], a[52:55], a[168:171], v[100:103]
ds_read_b64_tr_b16 a[6:7], v57 offset:40960
ds_read_b64_tr_b16 a[20:21], v57 offset:34816
v_mfma_f32_16x16x32_bf16 v[116:119], a[52:55], a[172:175], v[116:119]
ds_read_b64_tr_b16 a[22:23], v57 offset:43008
v_mfma_f32_16x16x32_bf16 v[116:119], a[36:39], a[164:167], v[116:119]
ds_read_b64_tr_b16 a[8:9], v58 offset:32768
buffer_load_dwordx4 v16, s[20:23], s71 offen offset:2048 lds
v_mfma_f32_16x16x32_bf16 v[104:107], a[40:43], a[160:163], v[104:107]
ds_read_b64_tr_b16 a[10:11], v58 offset:40960
ds_read_b64_tr_b16 a[24:25], v58 offset:34816
v_mfma_f32_16x16x32_bf16 v[104:107], a[56:59], a[168:171], v[104:107]
ds_read_b64_tr_b16 a[26:27], v58 offset:43008
v_mfma_f32_16x16x32_bf16 v[120:123], a[56:59], a[172:175], v[120:123]
ds_read_b64_tr_b16 a[12:13], v59 offset:32768
buffer_load_dwordx4 v17, s[20:23], s71 offen offset:3072 lds
s_add_u32 s71, s71, 0x40000
v_mfma_f32_16x16x32_bf16 v[120:123], a[40:43], a[164:167], v[120:123]
ds_read_b64_tr_b16 a[14:15], v59 offset:40960
ds_read_b64_tr_b16 a[28:29], v59 offset:34816
v_mfma_f32_16x16x32_bf16 v[108:111], a[44:47], a[160:163], v[108:111]
ds_read_b64_tr_b16 a[30:31], v59 offset:43008
v_mfma_f32_16x16x32_bf16 v[108:111], a[60:63], a[168:171], v[108:111]
v_mfma_f32_16x16x32_bf16 v[124:127], a[60:63], a[172:175], v[124:127]
v_mfma_f32_16x16x32_bf16 v[124:127], a[44:47], a[164:167], v[124:127]
s_waitcnt lgkmcnt(0)
v_mfma_f32_16x16x32_bf16 v[64:67], a[0:3], a[176:179], v[64:67]
ds_read_b64_tr_b16 a[32:33], v56 offset:33792
buffer_load_dwordx4 a[240:243], v1, s[12:15], s69 offen offset:0 sc1
v_mfma_f32_16x16x32_bf16 v[64:67], a[16:19], a[184:187], v[64:67]
ds_read_b64_tr_b16 a[34:35], v56 offset:41984
ds_read_b64_tr_b16 a[48:49], v56 offset:35840
v_mfma_f32_16x16x32_bf16 v[80:83], a[16:19], a[188:191], v[80:83]
ds_read_b64_tr_b16 a[50:51], v56 offset:44032
v_mfma_f32_16x16x32_bf16 v[80:83], a[0:3], a[180:183], v[80:83]
ds_read_b64_tr_b16 a[36:37], v57 offset:33792
buffer_load_dwordx4 a[244:247], v1, s[12:15], s69 offen offset:1024 sc1
v_mfma_f32_16x16x32_bf16 v[68:71], a[4:7], a[176:179], v[68:71]
ds_read_b64_tr_b16 a[38:39], v57 offset:41984
ds_read_b64_tr_b16 a[52:53], v57 offset:35840
v_mfma_f32_16x16x32_bf16 v[68:71], a[20:23], a[184:187], v[68:71]
ds_read_b64_tr_b16 a[54:55], v57 offset:44032
v_mfma_f32_16x16x32_bf16 v[84:87], a[20:23], a[188:191], v[84:87]
ds_read_b64_tr_b16 a[40:41], v58 offset:33792
buffer_load_dwordx4 a[248:251], v10, s[12:15], s69 offen offset:0 sc1
v_mfma_f32_16x16x32_bf16 v[84:87], a[4:7], a[180:183], v[84:87]
ds_read_b64_tr_b16 a[42:43], v58 offset:41984
ds_read_b64_tr_b16 a[56:57], v58 offset:35840
v_mfma_f32_16x16x32_bf16 v[72:75], a[8:11], a[176:179], v[72:75]
ds_read_b64_tr_b16 a[58:59], v58 offset:44032
v_mfma_f32_16x16x32_bf16 v[72:75], a[24:27], a[184:187], v[72:75]
ds_read_b64_tr_b16 a[44:45], v59 offset:33792
buffer_load_dwordx4 a[252:255], v10, s[12:15], s69 offen offset:1024 sc1
s_add_u32 s69, s69, 0x8000
v_mfma_f32_16x16x32_bf16 v[88:91], a[24:27], a[188:191], v[88:91]
ds_read_b64_tr_b16 a[46:47], v59 offset:41984
ds_read_b64_tr_b16 a[60:61], v59 offset:35840
v_mfma_f32_16x16x32_bf16 v[88:91], a[8:11], a[180:183], v[88:91]
ds_read_b64_tr_b16 a[62:63], v59 offset:44032
v_mfma_f32_16x16x32_bf16 v[76:79], a[12:15], a[176:179], v[76:79]
v_mfma_f32_16x16x32_bf16 v[76:79], a[28:31], a[184:187], v[76:79]
v_mfma_f32_16x16x32_bf16 v[92:95], a[28:31], a[188:191], v[92:95]
v_mfma_f32_16x16x32_bf16 v[92:95], a[12:15], a[180:183], v[92:95]
s_waitcnt vmcnt(21) lgkmcnt(0)
v_mfma_f32_16x16x32_bf16 v[96:99], a[32:35], a[176:179], v[96:99]
s_barrier
v_mfma_f32_16x16x32_bf16 v[96:99], a[48:51], a[184:187], v[96:99]
s_add_u32 m0, s42, 81920
ds_read_b64_tr_b16 a[0:1], v56 offset:49152
buffer_load_dwordx4 v14, s[20:23], s71 offen offset:0 lds
v_mfma_f32_16x16x32_bf16 v[112:115], a[48:51], a[188:191], v[112:115]
ds_read_b64_tr_b16 a[2:3], v56 offset:57344
ds_read_b64_tr_b16 a[16:17], v56 offset:51200
v_mfma_f32_16x16x32_bf16 v[112:115], a[32:35], a[180:183], v[112:115]
ds_read_b64_tr_b16 a[18:19], v56 offset:59392
v_mfma_f32_16x16x32_bf16 v[100:103], a[36:39], a[176:179], v[100:103]
ds_read_b64_tr_b16 a[4:5], v57 offset:49152
buffer_load_dwordx4 v15, s[20:23], s71 offen offset:1024 lds
v_mfma_f32_16x16x32_bf16 v[100:103], a[52:55], a[184:187], v[100:103]
ds_read_b64_tr_b16 a[6:7], v57 offset:57344
ds_read_b64_tr_b16 a[20:21], v57 offset:51200
v_mfma_f32_16x16x32_bf16 v[116:119], a[52:55], a[188:191], v[116:119]
ds_read_b64_tr_b16 a[22:23], v57 offset:59392
v_mfma_f32_16x16x32_bf16 v[116:119], a[36:39], a[180:183], v[116:119]
ds_read_b64_tr_b16 a[8:9], v58 offset:49152
buffer_load_dwordx4 v16, s[20:23], s71 offen offset:2048 lds
v_mfma_f32_16x16x32_bf16 v[104:107], a[40:43], a[176:179], v[104:107]
ds_read_b64_tr_b16 a[10:11], v58 offset:57344
ds_read_b64_tr_b16 a[24:25], v58 offset:51200
v_mfma_f32_16x16x32_bf16 v[104:107], a[56:59], a[184:187], v[104:107]
ds_read_b64_tr_b16 a[26:27], v58 offset:59392
v_mfma_f32_16x16x32_bf16 v[120:123], a[56:59], a[188:191], v[120:123]
ds_read_b64_tr_b16 a[12:13], v59 offset:49152
buffer_load_dwordx4 v17, s[20:23], s71 offen offset:3072 lds
s_add_u32 s71, s71, 0x20000
v_mfma_f32_16x16x32_bf16 v[120:123], a[40:43], a[180:183], v[120:123]
ds_read_b64_tr_b16 a[14:15], v59 offset:57344
ds_read_b64_tr_b16 a[28:29], v59 offset:51200
v_mfma_f32_16x16x32_bf16 v[108:111], a[44:47], a[176:179], v[108:111]
ds_read_b64_tr_b16 a[30:31], v59 offset:59392
v_mfma_f32_16x16x32_bf16 v[108:111], a[60:63], a[184:187], v[108:111]
v_mfma_f32_16x16x32_bf16 v[124:127], a[60:63], a[188:191], v[124:127]
v_mfma_f32_16x16x32_bf16 v[124:127], a[44:47], a[180:183], v[124:127]
s_waitcnt lgkmcnt(0)
v_mfma_f32_16x16x32_bf16 v[64:67], a[0:3], a[192:195], v[64:67]
ds_read_b64_tr_b16 a[32:33], v56 offset:50176
buffer_load_dwordx4 a[128:131], v1, s[12:15], s69 offen offset:0 sc1
v_mfma_f32_16x16x32_bf16 v[64:67], a[16:19], a[200:203], v[64:67]
ds_read_b64_tr_b16 a[34:35], v56 offset:58368
ds_read_b64_tr_b16 a[48:49], v56 offset:52224
v_mfma_f32_16x16x32_bf16 v[80:83], a[16:19], a[204:207], v[80:83]
ds_read_b64_tr_b16 a[50:51], v56 offset:60416
v_mfma_f32_16x16x32_bf16 v[80:83], a[0:3], a[196:199], v[80:83]
ds_read_b64_tr_b16 a[36:37], v57 offset:50176
buffer_load_dwordx4 a[132:135], v1, s[12:15], s69 offen offset:1024 sc1
v_mfma_f32_16x16x32_bf16 v[68:71], a[4:7], a[192:195], v[68:71]
ds_read_b64_tr_b16 a[38:39], v57 offset:58368
ds_read_b64_tr_b16 a[52:53], v57 offset:52224
v_mfma_f32_16x16x32_bf16 v[68:71], a[20:23], a[200:203], v[68:71]
ds_read_b64_tr_b16 a[54:55], v57 offset:60416
v_mfma_f32_16x16x32_bf16 v[84:87], a[20:23], a[204:207], v[84:87]
ds_read_b64_tr_b16 a[40:41], v58 offset:50176
buffer_load_dwordx4 a[136:139], v10, s[12:15], s69 offen offset:0 sc1
v_mfma_f32_16x16x32_bf16 v[84:87], a[4:7], a[196:199], v[84:87]
ds_read_b64_tr_b16 a[42:43], v58 offset:58368
ds_read_b64_tr_b16 a[56:57], v58 offset:52224
v_mfma_f32_16x16x32_bf16 v[72:75], a[8:11], a[192:195], v[72:75]
ds_read_b64_tr_b16 a[58:59], v58 offset:60416
v_mfma_f32_16x16x32_bf16 v[72:75], a[24:27], a[200:203], v[72:75]
ds_read_b64_tr_b16 a[44:45], v59 offset:50176
buffer_load_dwordx4 a[140:143], v10, s[12:15], s69 offen offset:1024 sc1
s_add_u32 s69, s69, 0x10000
v_mfma_f32_16x16x32_bf16 v[88:91], a[24:27], a[204:207], v[88:91]
ds_read_b64_tr_b16 a[46:47], v59 offset:58368
ds_read_b64_tr_b16 a[60:61], v59 offset:52224
v_mfma_f32_16x16x32_bf16 v[88:91], a[8:11], a[196:199], v[88:91]
ds_read_b64_tr_b16 a[62:63], v59 offset:60416
v_mfma_f32_16x16x32_bf16 v[76:79], a[12:15], a[192:195], v[76:79]
v_mfma_f32_16x16x32_bf16 v[76:79], a[28:31], a[200:203], v[76:79]
v_mfma_f32_16x16x32_bf16 v[92:95], a[28:31], a[204:207], v[92:95]
v_mfma_f32_16x16x32_bf16 v[92:95], a[12:15], a[196:199], v[92:95]
s_waitcnt vmcnt(21) lgkmcnt(0)
v_mfma_f32_16x16x32_bf16 v[96:99], a[32:35], a[192:195], v[96:99]
s_barrier
v_mfma_f32_16x16x32_bf16 v[96:99], a[48:51], a[200:203], v[96:99]
s_add_u32 m0, s42, 98304
ds_read_b64_tr_b16 a[0:1], v6 offset:49152
buffer_load_dwordx4 v14, s[20:23], s71 offen offset:0 lds
v_mfma_f32_16x16x32_bf16 v[112:115], a[48:51], a[204:207], v[112:115]
ds_read_b64_tr_b16 a[2:3], v6 offset:57344
ds_read_b64_tr_b16 a[16:17], v6 offset:51200
v_mfma_f32_16x16x32_bf16 v[112:115], a[32:35], a[196:199], v[112:115]
ds_read_b64_tr_b16 a[18:19], v6 offset:59392
v_mfma_f32_16x16x32_bf16 v[100:103], a[36:39], a[192:195], v[100:103]
ds_read_b64_tr_b16 a[4:5], v7 offset:49152
buffer_load_dwordx4 v15, s[20:23], s71 offen offset:1024 lds
v_mfma_f32_16x16x32_bf16 v[100:103], a[52:55], a[200:203], v[100:103]
ds_read_b64_tr_b16 a[6:7], v7 offset:57344
ds_read_b64_tr_b16 a[20:21], v7 offset:51200
v_mfma_f32_16x16x32_bf16 v[116:119], a[52:55], a[204:207], v[116:119]
ds_read_b64_tr_b16 a[22:23], v7 offset:59392
v_mfma_f32_16x16x32_bf16 v[116:119], a[36:39], a[196:199], v[116:119]
ds_read_b64_tr_b16 a[8:9], v8 offset:49152
buffer_load_dwordx4 v16, s[20:23], s71 offen offset:2048 lds
v_mfma_f32_16x16x32_bf16 v[104:107], a[40:43], a[192:195], v[104:107]
ds_read_b64_tr_b16 a[10:11], v8 offset:57344
ds_read_b64_tr_b16 a[24:25], v8 offset:51200
v_mfma_f32_16x16x32_bf16 v[104:107], a[56:59], a[200:203], v[104:107]
ds_read_b64_tr_b16 a[26:27], v8 offset:59392
v_mfma_f32_16x16x32_bf16 v[120:123], a[56:59], a[204:207], v[120:123]
ds_read_b64_tr_b16 a[12:13], v9 offset:49152
buffer_load_dwordx4 v17, s[20:23], s71 offen offset:3072 lds
s_add_u32 s71, s71, 0x40000
v_mfma_f32_16x16x32_bf16 v[120:123], a[40:43], a[196:199], v[120:123]
ds_read_b64_tr_b16 a[14:15], v9 offset:57344
ds_read_b64_tr_b16 a[28:29], v9 offset:51200
v_mfma_f32_16x16x32_bf16 v[108:111], a[44:47], a[192:195], v[108:111]
ds_read_b64_tr_b16 a[30:31], v9 offset:59392
v_mfma_f32_16x16x32_bf16 v[108:111], a[60:63], a[200:203], v[108:111]
v_mfma_f32_16x16x32_bf16 v[124:127], a[60:63], a[204:207], v[124:127]
v_mfma_f32_16x16x32_bf16 v[124:127], a[44:47], a[196:199], v[124:127]
s_waitcnt lgkmcnt(0)
v_mfma_f32_16x16x32_bf16 v[64:67], a[0:3], a[208:211], v[64:67]
ds_read_b64_tr_b16 a[32:33], v6 offset:50176
buffer_load_dwordx4 a[144:147], v1, s[12:15], s69 offen offset:0 sc1
v_mfma_f32_16x16x32_bf16 v[64:67], a[16:19], a[216:219], v[64:67]
ds_read_b64_tr_b16 a[34:35], v6 offset:58368
ds_read_b64_tr_b16 a[48:49], v6 offset:52224
v_mfma_f32_16x16x32_bf16 v[80:83], a[16:19], a[220:223], v[80:83]
ds_read_b64_tr_b16 a[50:51], v6 offset:60416
v_mfma_f32_16x16x32_bf16 v[80:83], a[0:3], a[212:215], v[80:83]
ds_read_b64_tr_b16 a[36:37], v7 offset:50176
buffer_load_dwordx4 a[148:151], v1, s[12:15], s69 offen offset:1024 sc1
v_mfma_f32_16x16x32_bf16 v[68:71], a[4:7], a[208:211], v[68:71]
ds_read_b64_tr_b16 a[38:39], v7 offset:58368
ds_read_b64_tr_b16 a[52:53], v7 offset:52224
v_mfma_f32_16x16x32_bf16 v[68:71], a[20:23], a[216:219], v[68:71]
ds_read_b64_tr_b16 a[54:55], v7 offset:60416
v_mfma_f32_16x16x32_bf16 v[84:87], a[20:23], a[220:223], v[84:87]
ds_read_b64_tr_b16 a[40:41], v8 offset:50176
buffer_load_dwordx4 a[152:155], v10, s[12:15], s69 offen offset:0 sc1
v_mfma_f32_16x16x32_bf16 v[84:87], a[4:7], a[212:215], v[84:87]
ds_read_b64_tr_b16 a[42:43], v8 offset:58368
ds_read_b64_tr_b16 a[56:57], v8 offset:52224
v_mfma_f32_16x16x32_bf16 v[72:75], a[8:11], a[208:211], v[72:75]
ds_read_b64_tr_b16 a[58:59], v8 offset:60416
v_mfma_f32_16x16x32_bf16 v[72:75], a[24:27], a[216:219], v[72:75]
ds_read_b64_tr_b16 a[44:45], v9 offset:50176
buffer_load_dwordx4 a[156:159], v10, s[12:15], s69 offen offset:1024 sc1
s_add_u32 s69, s69, 0x8000
v_mfma_f32_16x16x32_bf16 v[88:91], a[24:27], a[220:223], v[88:91]
ds_read_b64_tr_b16 a[46:47], v9 offset:58368
ds_read_b64_tr_b16 a[60:61], v9 offset:52224
v_mfma_f32_16x16x32_bf16 v[88:91], a[8:11], a[212:215], v[88:91]
ds_read_b64_tr_b16 a[62:63], v9 offset:60416
v_mfma_f32_16x16x32_bf16 v[76:79], a[12:15], a[208:211], v[76:79]
v_mfma_f32_16x16x32_bf16 v[76:79], a[28:31], a[216:219], v[76:79]
v_mfma_f32_16x16x32_bf16 v[92:95], a[28:31], a[220:223], v[92:95]
v_mfma_f32_16x16x32_bf16 v[92:95], a[12:15], a[212:215], v[92:95]
s_waitcnt vmcnt(20) lgkmcnt(0)
v_mfma_f32_16x16x32_bf16 v[96:99], a[32:35], a[208:211], v[96:99]
s_barrier
v_mfma_f32_16x16x32_bf16 v[96:99], a[48:51], a[216:219], v[96:99]
s_add_u32 m0, s42, 114688
ds_read_b64_tr_b16 a[0:1], v56 offset:0
buffer_load_dwordx4 v14, s[20:23], s71 offen offset:0 lds
v_mfma_f32_16x16x32_bf16 v[112:115], a[48:51], a[220:223], v[112:115]
ds_read_b64_tr_b16 a[2:3], v56 offset:8192
ds_read_b64_tr_b16 a[16:17], v56 offset:2048
v_mfma_f32_16x16x32_bf16 v[112:115], a[32:35], a[212:215], v[112:115]
ds_read_b64_tr_b16 a[18:19], v56 offset:10240
v_mfma_f32_16x16x32_bf16 v[100:103], a[36:39], a[208:211], v[100:103]
ds_read_b64_tr_b16 a[4:5], v57 offset:0
buffer_load_dwordx4 v15, s[20:23], s71 offen offset:1024 lds
v_mfma_f32_16x16x32_bf16 v[100:103], a[52:55], a[216:219], v[100:103]
ds_read_b64_tr_b16 a[6:7], v57 offset:8192
ds_read_b64_tr_b16 a[20:21], v57 offset:2048
v_mfma_f32_16x16x32_bf16 v[116:119], a[52:55], a[220:223], v[116:119]
ds_read_b64_tr_b16 a[22:23], v57 offset:10240
v_mfma_f32_16x16x32_bf16 v[116:119], a[36:39], a[212:215], v[116:119]
ds_read_b64_tr_b16 a[8:9], v58 offset:0
buffer_load_dwordx4 v16, s[20:23], s71 offen offset:2048 lds
v_mfma_f32_16x16x32_bf16 v[104:107], a[40:43], a[208:211], v[104:107]
ds_read_b64_tr_b16 a[10:11], v58 offset:8192
ds_read_b64_tr_b16 a[24:25], v58 offset:2048
v_mfma_f32_16x16x32_bf16 v[104:107], a[56:59], a[216:219], v[104:107]
ds_read_b64_tr_b16 a[26:27], v58 offset:10240
v_mfma_f32_16x16x32_bf16 v[120:123], a[56:59], a[220:223], v[120:123]
ds_read_b64_tr_b16 a[12:13], v59 offset:0
buffer_load_dwordx4 v17, s[20:23], s71 offen offset:3072 lds
s_add_u32 s71, s71, 0x20000
v_mfma_f32_16x16x32_bf16 v[120:123], a[40:43], a[212:215], v[120:123]
ds_read_b64_tr_b16 a[14:15], v59 offset:8192
ds_read_b64_tr_b16 a[28:29], v59 offset:2048
v_mfma_f32_16x16x32_bf16 v[108:111], a[44:47], a[208:211], v[108:111]
ds_read_b64_tr_b16 a[30:31], v59 offset:10240
v_mfma_f32_16x16x32_bf16 v[108:111], a[60:63], a[216:219], v[108:111]
v_mfma_f32_16x16x32_bf16 v[124:127], a[60:63], a[220:223], v[124:127]
v_mfma_f32_16x16x32_bf16 v[124:127], a[44:47], a[212:215], v[124:127]
s_waitcnt lgkmcnt(0)
v_mfma_f32_16x16x32_bf16 v[64:67], a[0:3], a[224:227], v[64:67]
ds_read_b64_tr_b16 a[32:33], v56 offset:1024
buffer_load_dwordx4 a[160:163], v1, s[12:15], s69 offen offset:0 sc1
v_mfma_f32_16x16x32_bf16 v[64:67], a[16:19], a[232:235], v[64:67]
ds_read_b64_tr_b16 a[34:35], v56 offset:9216
ds_read_b64_tr_b16 a[48:49], v56 offset:3072
v_mfma_f32_16x16x32_bf16 v[80:83], a[16:19], a[236:239], v[80:83]
ds_read_b64_tr_b16 a[50:51], v56 offset:11264
v_mfma_f32_16x16x32_bf16 v[80:83], a[0:3], a[228:231], v[80:83]
ds_read_b64_tr_b16 a[36:37], v57 offset:1024
buffer_load_dwordx4 a[164:167], v1, s[12:15], s69 offen offset:1024 sc1
v_mfma_f32_16x16x32_bf16 v[68:71], a[4:7], a[224:227], v[68:71]
ds_read_b64_tr_b16 a[38:39], v57 offset:9216
ds_read_b64_tr_b16 a[52:53], v57 offset:3072
v_mfma_f32_16x16x32_bf16 v[68:71], a[20:23], a[232:235], v[68:71]
ds_read_b64_tr_b16 a[54:55], v57 offset:11264
v_mfma_f32_16x16x32_bf16 v[84:87], a[20:23], a[236:239], v[84:87]
ds_read_b64_tr_b16 a[40:41], v58 offset:1024
buffer_load_dwordx4 a[168:171], v10, s[12:15], s69 offen offset:0 sc1
v_mfma_f32_16x16x32_bf16 v[84:87], a[4:7], a[228:231], v[84:87]
ds_read_b64_tr_b16 a[42:43], v58 offset:9216
ds_read_b64_tr_b16 a[56:57], v58 offset:3072
v_mfma_f32_16x16x32_bf16 v[72:75], a[8:11], a[224:227], v[72:75]
ds_read_b64_tr_b16 a[58:59], v58 offset:11264
v_mfma_f32_16x16x32_bf16 v[72:75], a[24:27], a[232:235], v[72:75]
ds_read_b64_tr_b16 a[44:45], v59 offset:1024
buffer_load_dwordx4 a[172:175], v10, s[12:15], s69 offen offset:1024 sc1
s_add_u32 s69, s69, 0x8000
v_mfma_f32_16x16x32_bf16 v[88:91], a[24:27], a[236:239], v[88:91]
ds_read_b64_tr_b16 a[46:47], v59 offset:9216
ds_read_b64_tr_b16 a[60:61], v59 offset:3072
v_mfma_f32_16x16x32_bf16 v[88:91], a[8:11], a[228:231], v[88:91]
ds_read_b64_tr_b16 a[62:63], v59 offset:11264
v_mfma_f32_16x16x32_bf16 v[76:79], a[12:15], a[224:227], v[76:79]
v_mfma_f32_16x16x32_bf16 v[76:79], a[28:31], a[232:235], v[76:79]
v_mfma_f32_16x16x32_bf16 v[92:95], a[28:31], a[236:239], v[92:95]
v_mfma_f32_16x16x32_bf16 v[92:95], a[12:15], a[228:231], v[92:95]
s_waitcnt vmcnt(20) lgkmcnt(0)
v_mfma_f32_16x16x32_bf16 v[96:99], a[32:35], a[224:227], v[96:99]
s_barrier
v_mfma_f32_16x16x32_bf16 v[96:99], a[48:51], a[232:235], v[96:99]
s_add_u32 m0, s42, 49152
ds_read_b64_tr_b16 a[0:1], v56 offset:16384
buffer_load_dwordx4 v14, s[20:23], s71 offen offset:0 lds
v_mfma_f32_16x16x32_bf16 v[112:115], a[48:51], a[236:239], v[112:115]
ds_read_b64_tr_b16 a[2:3], v56 offset:24576
ds_read_b64_tr_b16 a[16:17], v56 offset:18432
v_mfma_f32_16x16x32_bf16 v[112:115], a[32:35], a[228:231], v[112:115]
ds_read_b64_tr_b16 a[18:19], v56 offset:26624
v_mfma_f32_16x16x32_bf16 v[100:103], a[36:39], a[224:227], v[100:103]
ds_read_b64_tr_b16 a[4:5], v57 offset:16384
buffer_load_dwordx4 v15, s[20:23], s71 offen offset:1024 lds
v_mfma_f32_16x16x32_bf16 v[100:103], a[52:55], a[232:235], v[100:103]
ds_read_b64_tr_b16 a[6:7], v57 offset:24576
ds_read_b64_tr_b16 a[20:21], v57 offset:18432
v_mfma_f32_16x16x32_bf16 v[116:119], a[52:55], a[236:239], v[116:119]
ds_read_b64_tr_b16 a[22:23], v57 offset:26624
v_mfma_f32_16x16x32_bf16 v[116:119], a[36:39], a[228:231], v[116:119]
ds_read_b64_tr_b16 a[8:9], v58 offset:16384
buffer_load_dwordx4 v16, s[20:23], s71 offen offset:2048 lds
v_mfma_f32_16x16x32_bf16 v[104:107], a[40:43], a[224:227], v[104:107]
ds_read_b64_tr_b16 a[10:11], v58 offset:24576
ds_read_b64_tr_b16 a[24:25], v58 offset:18432
v_mfma_f32_16x16x32_bf16 v[104:107], a[56:59], a[232:235], v[104:107]
ds_read_b64_tr_b16 a[26:27], v58 offset:26624
v_mfma_f32_16x16x32_bf16 v[120:123], a[56:59], a[236:239], v[120:123]
ds_read_b64_tr_b16 a[12:13], v59 offset:16384
buffer_load_dwordx4 v17, s[20:23], s71 offen offset:3072 lds
s_add_u32 s71, s71, 0x20000
v_mfma_f32_16x16x32_bf16 v[120:123], a[40:43], a[228:231], v[120:123]
ds_read_b64_tr_b16 a[14:15], v59 offset:24576
ds_read_b64_tr_b16 a[28:29], v59 offset:18432
v_mfma_f32_16x16x32_bf16 v[108:111], a[44:47], a[224:227], v[108:111]
ds_read_b64_tr_b16 a[30:31], v59 offset:26624
v_mfma_f32_16x16x32_bf16 v[108:111], a[60:63], a[232:235], v[108:111]
v_mfma_f32_16x16x32_bf16 v[124:127], a[60:63], a[236:239], v[124:127]
v_mfma_f32_16x16x32_bf16 v[124:127], a[44:47], a[228:231], v[124:127]
s_waitcnt lgkmcnt(0)
v_mfma_f32_16x16x32_bf16 v[64:67], a[0:3], a[240:243], v[64:67]
ds_read_b64_tr_b16 a[32:33], v56 offset:17408
buffer_load_dwordx4 a[176:179], v1, s[12:15], s69 offen offset:0 sc1
v_mfma_f32_16x16x32_bf16 v[64:67], a[16:19], a[248:251], v[64:67]
ds_read_b64_tr_b16 a[34:35], v56 offset:25600
ds_read_b64_tr_b16 a[48:49], v56 offset:19456
v_mfma_f32_16x16x32_bf16 v[80:83], a[16:19], a[252:255], v[80:83]
ds_read_b64_tr_b16 a[50:51], v56 offset:27648
buffer_load_dwordx4 a[180:183], v1, s[12:15], s69 offen offset:1024 sc1
PG20:
s_cbranch_execz fk_tret
v_mfma_f32_16x16x32_bf16 v[80:83], a[0:3], a[244:247], v[80:83]
ds_read_b64_tr_b16 a[36:37], v57 offset:17408
v_mfma_f32_16x16x32_bf16 v[68:71], a[4:7], a[240:243], v[68:71]
ds_read_b64_tr_b16 a[38:39], v57 offset:25600
ds_read_b64_tr_b16 a[52:53], v57 offset:19456
v_mfma_f32_16x16x32_bf16 v[68:71], a[20:23], a[248:251], v[68:71]
buffer_load_dwordx4 a[184:187], v10, s[12:15], s69 offen offset:0 sc1
ds_read_b64_tr_b16 a[54:55], v57 offset:27648
v_mfma_f32_16x16x32_bf16 v[84:87], a[20:23], a[252:255], v[84:87]
ds_read_b64_tr_b16 a[40:41], v58 offset:17408
ds_read_b64_tr_b16 a[42:43], v58 offset:25600
v_mfma_f32_16x16x32_bf16 v[84:87], a[4:7], a[244:247], v[84:87]
buffer_load_dwordx4 a[188:191], v10, s[12:15], s69 offen offset:1024 sc1
s_add_u32 s69, s69, 0x10000
v_mfma_f32_16x16x32_bf16 v[72:75], a[8:11], a[240:243], v[72:75]
ds_read_b64_tr_b16 a[56:57], v58 offset:19456
ds_read_b64_tr_b16 a[58:59], v58 offset:27648
v_mfma_f32_16x16x32_bf16 v[72:75], a[24:27], a[248:251], v[72:75]
ds_read_b64_tr_b16 a[44:45], v59 offset:17408
s_add_u32 s47, s71, 0x80000
buffer_load_dword v212, v211, s[20:23], s47 offen
v_mfma_f32_16x16x32_bf16 v[88:91], a[24:27], a[252:255], v[88:91]
ds_read_b64_tr_b16 a[46:47], v59 offset:25600
ds_read_b64_tr_b16 a[60:61], v59 offset:19456
v_mfma_f32_16x16x32_bf16 v[88:91], a[8:11], a[244:247], v[88:91]
ds_read_b64_tr_b16 a[62:63], v59 offset:27648
v_mfma_f32_16x16x32_bf16 v[76:79], a[12:15], a[240:243], v[76:79]
v_mfma_f32_16x16x32_bf16 v[76:79], a[28:31], a[248:251], v[76:79]
v_mfma_f32_16x16x32_bf16 v[92:95], a[28:31], a[252:255], v[92:95]
v_mfma_f32_16x16x32_bf16 v[92:95], a[12:15], a[244:247], v[92:95]
s_waitcnt vmcnt(21) lgkmcnt(0)
v_mfma_f32_16x16x32_bf16 v[96:99], a[32:35], a[240:243], v[96:99]
s_barrier
v_mfma_f32_16x16x32_bf16 v[96:99], a[48:51], a[248:251], v[96:99]
s_add_u32 m0, s42, 65536
ds_read_b64_tr_b16 a[0:1], v56 offset:32768
buffer_load_dwordx4 v14, s[20:23], s71 offen offset:0 lds
v_mfma_f32_16x16x32_bf16 v[112:115], a[48:51], a[252:255], v[112:115]
ds_read_b64_tr_b16 a[2:3], v56 offset:40960
ds_read_b64_tr_b16 a[16:17], v56 offset:34816
v_mfma_f32_16x16x32_bf16 v[112:115], a[32:35], a[244:247], v[112:115]
ds_read_b64_tr_b16 a[18:19], v56 offset:43008
v_mfma_f32_16x16x32_bf16 v[100:103], a[36:39], a[240:243], v[100:103]
ds_read_b64_tr_b16 a[4:5], v57 offset:32768
buffer_load_dwordx4 v15, s[20:23], s71 offen offset:1024 lds
v_mfma_f32_16x16x32_bf16 v[100:103], a[52:55], a[248:251], v[100:103]
ds_read_b64_tr_b16 a[6:7], v57 offset:40960
ds_read_b64_tr_b16 a[20:21], v57 offset:34816
v_mfma_f32_16x16x32_bf16 v[116:119], a[52:55], a[252:255], v[116:119]
ds_read_b64_tr_b16 a[22:23], v57 offset:43008
v_mfma_f32_16x16x32_bf16 v[116:119], a[36:39], a[244:247], v[116:119]
ds_read_b64_tr_b16 a[8:9], v58 offset:32768
buffer_load_dwordx4 v16, s[20:23], s71 offen offset:2048 lds
v_mfma_f32_16x16x32_bf16 v[104:107], a[40:43], a[240:243], v[104:107]
ds_read_b64_tr_b16 a[10:11], v58 offset:40960
ds_read_b64_tr_b16 a[24:25], v58 offset:34816
v_mfma_f32_16x16x32_bf16 v[104:107], a[56:59], a[248:251], v[104:107]
ds_read_b64_tr_b16 a[26:27], v58 offset:43008
v_mfma_f32_16x16x32_bf16 v[120:123], a[56:59], a[252:255], v[120:123]
ds_read_b64_tr_b16 a[12:13], v59 offset:32768
buffer_load_dwordx4 v17, s[20:23], s71 offen offset:3072 lds
s_add_u32 s71, s71, 0x40000
v_mfma_f32_16x16x32_bf16 v[120:123], a[40:43], a[244:247], v[120:123]
ds_read_b64_tr_b16 a[14:15], v59 offset:40960
ds_read_b64_tr_b16 a[28:29], v59 offset:34816
v_mfma_f32_16x16x32_bf16 v[108:111], a[44:47], a[240:243], v[108:111]
ds_read_b64_tr_b16 a[30:31], v59 offset:43008
v_mfma_f32_16x16x32_bf16 v[108:111], a[60:63], a[248:251], v[108:111]
v_mfma_f32_16x16x32_bf16 v[124:127], a[60:63], a[252:255], v[124:127]
v_mfma_f32_16x16x32_bf16 v[124:127], a[44:47], a[244:247], v[124:127]
s_waitcnt lgkmcnt(0)
v_mfma_f32_16x16x32_bf16 v[64:67], a[0:3], a[128:131], v[64:67]
ds_read_b64_tr_b16 a[32:33], v56 offset:33792
buffer_load_dwordx4 a[192:195], v1, s[12:15], s69 offen offset:0 sc1
v_mfma_f32_16x16x32_bf16 v[64:67], a[16:19], a[136:139], v[64:67]
ds_read_b64_tr_b16 a[34:35], v56 offset:41984
ds_read_b64_tr_b16 a[48:49], v56 offset:35840
v_mfma_f32_16x16x32_bf16 v[80:83], a[16:19], a[140:143], v[80:83]
ds_read_b64_tr_b16 a[50:51], v56 offset:44032
v_mfma_f32_16x16x32_bf16 v[80:83], a[0:3], a[132:135], v[80:83]
ds_read_b64_tr_b16 a[36:37], v57 offset:33792
buffer_load_dwordx4 a[196:199], v1, s[12:15], s69 offen offset:1024 sc1
v_mfma_f32_16x16x32_bf16 v[68:71], a[4:7], a[128:131], v[68:71]
ds_read_b64_tr_b16 a[38:39], v57 offset:41984
ds_read_b64_tr_b16 a[52:53], v57 offset:35840
v_mfma_f32_16x16x32_bf16 v[68:71], a[20:23], a[136:139], v[68:71]
ds_read_b64_tr_b16 a[54:55], v57 offset:44032
v_mfma_f32_16x16x32_bf16 v[84:87], a[20:23], a[140:143], v[84:87]
ds_read_b64_tr_b16 a[40:41], v58 offset:33792
buffer_load_dwordx4 a[200:203], v10, s[12:15], s69 offen offset:0 sc1
v_mfma_f32_16x16x32_bf16 v[84:87], a[4:7], a[132:135], v[84:87]
ds_read_b64_tr_b16 a[42:43], v58 offset:41984
ds_read_b64_tr_b16 a[56:57], v58 offset:35840
v_mfma_f32_16x16x32_bf16 v[72:75], a[8:11], a[128:131], v[72:75]
ds_read_b64_tr_b16 a[58:59], v58 offset:44032
v_mfma_f32_16x16x32_bf16 v[72:75], a[24:27], a[136:139], v[72:75]
ds_read_b64_tr_b16 a[44:45], v59 offset:33792
buffer_load_dwordx4 a[204:207], v10, s[12:15], s69 offen offset:1024 sc1
s_add_u32 s69, s69, 0x8000
v_mfma_f32_16x16x32_bf16 v[88:91], a[24:27], a[140:143], v[88:91]
ds_read_b64_tr_b16 a[46:47], v59 offset:41984
ds_read_b64_tr_b16 a[60:61], v59 offset:35840
v_mfma_f32_16x16x32_bf16 v[88:91], a[8:11], a[132:135], v[88:91]
ds_read_b64_tr_b16 a[62:63], v59 offset:44032
v_mfma_f32_16x16x32_bf16 v[76:79], a[12:15], a[128:131], v[76:79]
v_mfma_f32_16x16x32_bf16 v[76:79], a[28:31], a[136:139], v[76:79]
v_mfma_f32_16x16x32_bf16 v[92:95], a[28:31], a[140:143], v[92:95]
v_mfma_f32_16x16x32_bf16 v[92:95], a[12:15], a[132:135], v[92:95]
s_waitcnt vmcnt(21) lgkmcnt(0)
v_mfma_f32_16x16x32_bf16 v[96:99], a[32:35], a[128:131], v[96:99]
s_barrier
v_mfma_f32_16x16x32_bf16 v[96:99], a[48:51], a[136:139], v[96:99]
s_add_u32 m0, s42, 81920
ds_read_b64_tr_b16 a[0:1], v56 offset:49152
buffer_load_dwordx4 v14, s[20:23], s71 offen offset:0 lds
v_mfma_f32_16x16x32_bf16 v[112:115], a[48:51], a[140:143], v[112:115]
ds_read_b64_tr_b16 a[2:3], v56 offset:57344
ds_read_b64_tr_b16 a[16:17], v56 offset:51200
v_mfma_f32_16x16x32_bf16 v[112:115], a[32:35], a[132:135], v[112:115]
ds_read_b64_tr_b16 a[18:19], v56 offset:59392
v_mfma_f32_16x16x32_bf16 v[100:103], a[36:39], a[128:131], v[100:103]
ds_read_b64_tr_b16 a[4:5], v57 offset:49152
buffer_load_dwordx4 v15, s[20:23], s71 offen offset:1024 lds
v_mfma_f32_16x16x32_bf16 v[100:103], a[52:55], a[136:139], v[100:103]
ds_read_b64_tr_b16 a[6:7], v57 offset:57344
ds_read_b64_tr_b16 a[20:21], v57 offset:51200
v_mfma_f32_16x16x32_bf16 v[116:119], a[52:55], a[140:143], v[116:119]
ds_read_b64_tr_b16 a[22:23], v57 offset:59392
v_mfma_f32_16x16x32_bf16 v[116:119], a[36:39], a[132:135], v[116:119]
ds_read_b64_tr_b16 a[8:9], v58 offset:49152
buffer_load_dwordx4 v16, s[20:23], s71 offen offset:2048 lds
v_mfma_f32_16x16x32_bf16 v[104:107], a[40:43], a[128:131], v[104:107]
ds_read_b64_tr_b16 a[10:11], v58 offset:57344
ds_read_b64_tr_b16 a[24:25], v58 offset:51200
v_mfma_f32_16x16x32_bf16 v[104:107], a[56:59], a[136:139], v[104:107]
ds_read_b64_tr_b16 a[26:27], v58 offset:59392
v_mfma_f32_16x16x32_bf16 v[120:123], a[56:59], a[140:143], v[120:123]
ds_read_b64_tr_b16 a[12:13], v59 offset:49152
buffer_load_dwordx4 v17, s[20:23], s71 offen offset:3072 lds
s_add_u32 s71, s71, 0x20000
v_mfma_f32_16x16x32_bf16 v[120:123], a[40:43], a[132:135], v[120:123]
ds_read_b64_tr_b16 a[14:15], v59 offset:57344
ds_read_b64_tr_b16 a[28:29], v59 offset:51200
v_mfma_f32_16x16x32_bf16 v[108:111], a[44:47], a[128:131], v[108:111]
ds_read_b64_tr_b16 a[30:31], v59 offset:59392
v_mfma_f32_16x16x32_bf16 v[108:111], a[60:63], a[136:139], v[108:111]
v_mfma_f32_16x16x32_bf16 v[124:127], a[60:63], a[140:143], v[124:127]
v_mfma_f32_16x16x32_bf16 v[124:127], a[44:47], a[132:135], v[124:127]
s_waitcnt lgkmcnt(0)
v_mfma_f32_16x16x32_bf16 v[64:67], a[0:3], a[144:147], v[64:67]
ds_read_b64_tr_b16 a[32:33], v56 offset:50176
buffer_load_dwordx4 a[208:211], v1, s[12:15], s69 offen offset:0 sc1
v_mfma_f32_16x16x32_bf16 v[64:67], a[16:19], a[152:155], v[64:67]
ds_read_b64_tr_b16 a[34:35], v56 offset:58368
ds_read_b64_tr_b16 a[48:49], v56 offset:52224
v_mfma_f32_16x16x32_bf16 v[80:83], a[16:19], a[156:159], v[80:83]
ds_read_b64_tr_b16 a[50:51], v56 offset:60416
v_mfma_f32_16x16x32_bf16 v[80:83], a[0:3], a[148:151], v[80:83]
ds_read_b64_tr_b16 a[36:37], v57 offset:50176
buffer_load_dwordx4 a[212:215], v1, s[12:15], s69 offen offset:1024 sc1
v_mfma_f32_16x16x32_bf16 v[68:71], a[4:7], a[144:147], v[68:71]
ds_read_b64_tr_b16 a[38:39], v57 offset:58368
ds_read_b64_tr_b16 a[52:53], v57 offset:52224
v_mfma_f32_16x16x32_bf16 v[68:71], a[20:23], a[152:155], v[68:71]
ds_read_b64_tr_b16 a[54:55], v57 offset:60416
v_mfma_f32_16x16x32_bf16 v[84:87], a[20:23], a[156:159], v[84:87]
ds_read_b64_tr_b16 a[40:41], v58 offset:50176
buffer_load_dwordx4 a[216:219], v10, s[12:15], s69 offen offset:0 sc1
v_mfma_f32_16x16x32_bf16 v[84:87], a[4:7], a[148:151], v[84:87]
ds_read_b64_tr_b16 a[42:43], v58 offset:58368
ds_read_b64_tr_b16 a[56:57], v58 offset:52224
v_mfma_f32_16x16x32_bf16 v[72:75], a[8:11], a[144:147], v[72:75]
ds_read_b64_tr_b16 a[58:59], v58 offset:60416
v_mfma_f32_16x16x32_bf16 v[72:75], a[24:27], a[152:155], v[72:75]
ds_read_b64_tr_b16 a[44:45], v59 offset:50176
buffer_load_dwordx4 a[220:223], v10, s[12:15], s69 offen offset:1024 sc1
s_add_u32 s69, s69, 0x10000
v_mfma_f32_16x16x32_bf16 v[88:91], a[24:27], a[156:159], v[88:91]
ds_read_b64_tr_b16 a[46:47], v59 offset:58368
ds_read_b64_tr_b16 a[60:61], v59 offset:52224
v_mfma_f32_16x16x32_bf16 v[88:91], a[8:11], a[148:151], v[88:91]
ds_read_b64_tr_b16 a[62:63], v59 offset:60416
v_mfma_f32_16x16x32_bf16 v[76:79], a[12:15], a[144:147], v[76:79]
v_mfma_f32_16x16x32_bf16 v[76:79], a[28:31], a[152:155], v[76:79]
v_mfma_f32_16x16x32_bf16 v[92:95], a[28:31], a[156:159], v[92:95]
v_mfma_f32_16x16x32_bf16 v[92:95], a[12:15], a[148:151], v[92:95]
s_waitcnt vmcnt(21) lgkmcnt(0)
v_mfma_f32_16x16x32_bf16 v[96:99], a[32:35], a[144:147], v[96:99]
s_barrier
v_mfma_f32_16x16x32_bf16 v[96:99], a[48:51], a[152:155], v[96:99]
s_add_u32 m0, s42, 98304
ds_read_b64_tr_b16 a[0:1], v6 offset:49152
buffer_load_dwordx4 v14, s[20:23], s71 offen offset:0 lds
v_mfma_f32_16x16x32_bf16 v[112:115], a[48:51], a[156:159], v[112:115]
ds_read_b64_tr_b16 a[2:3], v6 offset:57344
ds_read_b64_tr_b16 a[16:17], v6 offset:51200
v_mfma_f32_16x16x32_bf16 v[112:115], a[32:35], a[148:151], v[112:115]
ds_read_b64_tr_b16 a[18:19], v6 offset:59392
v_mfma_f32_16x16x32_bf16 v[100:103], a[36:39], a[144:147], v[100:103]
ds_read_b64_tr_b16 a[4:5], v7 offset:49152
buffer_load_dwordx4 v15, s[20:23], s71 offen offset:1024 lds
v_mfma_f32_16x16x32_bf16 v[100:103], a[52:55], a[152:155], v[100:103]
ds_read_b64_tr_b16 a[6:7], v7 offset:57344
ds_read_b64_tr_b16 a[20:21], v7 offset:51200
v_mfma_f32_16x16x32_bf16 v[116:119], a[52:55], a[156:159], v[116:119]
ds_read_b64_tr_b16 a[22:23], v7 offset:59392
v_mfma_f32_16x16x32_bf16 v[116:119], a[36:39], a[148:151], v[116:119]
ds_read_b64_tr_b16 a[8:9], v8 offset:49152
buffer_load_dwordx4 v16, s[20:23], s71 offen offset:2048 lds
v_mfma_f32_16x16x32_bf16 v[104:107], a[40:43], a[144:147], v[104:107]
ds_read_b64_tr_b16 a[10:11], v8 offset:57344
ds_read_b64_tr_b16 a[24:25], v8 offset:51200
v_mfma_f32_16x16x32_bf16 v[104:107], a[56:59], a[152:155], v[104:107]
ds_read_b64_tr_b16 a[26:27], v8 offset:59392
v_mfma_f32_16x16x32_bf16 v[120:123], a[56:59], a[156:159], v[120:123]
ds_read_b64_tr_b16 a[12:13], v9 offset:49152
buffer_load_dwordx4 v17, s[20:23], s71 offen offset:3072 lds
s_add_u32 s71, s71, 0x40000
v_mfma_f32_16x16x32_bf16 v[120:123], a[40:43], a[148:151], v[120:123]
ds_read_b64_tr_b16 a[14:15], v9 offset:57344
ds_read_b64_tr_b16 a[28:29], v9 offset:51200
v_mfma_f32_16x16x32_bf16 v[108:111], a[44:47], a[144:147], v[108:111]
ds_read_b64_tr_b16 a[30:31], v9 offset:59392
v_mfma_f32_16x16x32_bf16 v[108:111], a[60:63], a[152:155], v[108:111]
v_mfma_f32_16x16x32_bf16 v[124:127], a[60:63], a[156:159], v[124:127]
v_mfma_f32_16x16x32_bf16 v[124:127], a[44:47], a[148:151], v[124:127]
s_waitcnt lgkmcnt(0)
v_mfma_f32_16x16x32_bf16 v[64:67], a[0:3], a[160:163], v[64:67]
ds_read_b64_tr_b16 a[32:33], v6 offset:50176
buffer_load_dwordx4 a[224:227], v1, s[12:15], s69 offen offset:0 sc1
v_mfma_f32_16x16x32_bf16 v[64:67], a[16:19], a[168:171], v[64:67]
ds_read_b64_tr_b16 a[34:35], v6 offset:58368
ds_read_b64_tr_b16 a[48:49], v6 offset:52224
v_mfma_f32_16x16x32_bf16 v[80:83], a[16:19], a[172:175], v[80:83]
ds_read_b64_tr_b16 a[50:51], v6 offset:60416
v_mfma_f32_16x16x32_bf16 v[80:83], a[0:3], a[164:167], v[80:83]
ds_read_b64_tr_b16 a[36:37], v7 offset:50176
buffer_load_dwordx4 a[228:231], v1, s[12:15], s69 offen offset:1024 sc1
v_mfma_f32_16x16x32_bf16 v[68:71], a[4:7], a[160:163], v[68:71]
ds_read_b64_tr_b16 a[38:39], v7 offset:58368
ds_read_b64_tr_b16 a[52:53], v7 offset:52224
v_mfma_f32_16x16x32_bf16 v[68:71], a[20:23], a[168:171], v[68:71]
ds_read_b64_tr_b16 a[54:55], v7 offset:60416
v_mfma_f32_16x16x32_bf16 v[84:87], a[20:23], a[172:175], v[84:87]
ds_read_b64_tr_b16 a[40:41], v8 offset:50176
buffer_load_dwordx4 a[232:235], v10, s[12:15], s69 offen offset:0 sc1
v_mfma_f32_16x16x32_bf16 v[84:87], a[4:7], a[164:167], v[84:87]
ds_read_b64_tr_b16 a[42:43], v8 offset:58368
ds_read_b64_tr_b16 a[56:57], v8 offset:52224
v_mfma_f32_16x16x32_bf16 v[72:75], a[8:11], a[160:163], v[72:75]
ds_read_b64_tr_b16 a[58:59], v8 offset:60416
v_mfma_f32_16x16x32_bf16 v[72:75], a[24:27], a[168:171], v[72:75]
ds_read_b64_tr_b16 a[44:45], v9 offset:50176
buffer_load_dwordx4 a[236:239], v10, s[12:15], s69 offen offset:1024 sc1
s_add_u32 s69, s69, 0x8000
v_mfma_f32_16x16x32_bf16 v[88:91], a[24:27], a[172:175], v[88:91]
ds_read_b64_tr_b16 a[46:47], v9 offset:58368
ds_read_b64_tr_b16 a[60:61], v9 offset:52224
v_mfma_f32_16x16x32_bf16 v[88:91], a[8:11], a[164:167], v[88:91]
ds_read_b64_tr_b16 a[62:63], v9 offset:60416
v_mfma_f32_16x16x32_bf16 v[76:79], a[12:15], a[160:163], v[76:79]
v_mfma_f32_16x16x32_bf16 v[76:79], a[28:31], a[168:171], v[76:79]
v_mfma_f32_16x16x32_bf16 v[92:95], a[28:31], a[172:175], v[92:95]
v_mfma_f32_16x16x32_bf16 v[92:95], a[12:15], a[164:167], v[92:95]
s_waitcnt vmcnt(20) lgkmcnt(0)
v_mfma_f32_16x16x32_bf16 v[96:99], a[32:35], a[160:163], v[96:99]
s_barrier
v_mfma_f32_16x16x32_bf16 v[96:99], a[48:51], a[168:171], v[96:99]
s_add_u32 m0, s42, 114688
ds_read_b64_tr_b16 a[0:1], v56 offset:0
buffer_load_dwordx4 v14, s[20:23], s71 offen offset:0 lds
v_mfma_f32_16x16x32_bf16 v[112:115], a[48:51], a[172:175], v[112:115]
ds_read_b64_tr_b16 a[2:3], v56 offset:8192
ds_read_b64_tr_b16 a[16:17], v56 offset:2048
v_mfma_f32_16x16x32_bf16 v[112:115], a[32:35], a[164:167], v[112:115]
ds_read_b64_tr_b16 a[18:19], v56 offset:10240
v_mfma_f32_16x16x32_bf16 v[100:103], a[36:39], a[160:163], v[100:103]
ds_read_b64_tr_b16 a[4:5], v57 offset:0
buffer_load_dwordx4 v15, s[20:23], s71 offen offset:1024 lds
v_mfma_f32_16x16x32_bf16 v[100:103], a[52:55], a[168:171], v[100:103]
ds_read_b64_tr_b16 a[6:7], v57 offset:8192
ds_read_b64_tr_b16 a[20:21], v57 offset:2048
v_mfma_f32_16x16x32_bf16 v[116:119], a[52:55], a[172:175], v[116:119]
ds_read_b64_tr_b16 a[22:23], v57 offset:10240
v_mfma_f32_16x16x32_bf16 v[116:119], a[36:39], a[164:167], v[116:119]
ds_read_b64_tr_b16 a[8:9], v58 offset:0
buffer_load_dwordx4 v16, s[20:23], s71 offen offset:2048 lds
v_mfma_f32_16x16x32_bf16 v[104:107], a[40:43], a[160:163], v[104:107]
ds_read_b64_tr_b16 a[10:11], v58 offset:8192
ds_read_b64_tr_b16 a[24:25], v58 offset:2048
v_mfma_f32_16x16x32_bf16 v[104:107], a[56:59], a[168:171], v[104:107]
ds_read_b64_tr_b16 a[26:27], v58 offset:10240
v_mfma_f32_16x16x32_bf16 v[120:123], a[56:59], a[172:175], v[120:123]
ds_read_b64_tr_b16 a[12:13], v59 offset:0
buffer_load_dwordx4 v17, s[20:23], s71 offen offset:3072 lds
s_add_u32 s71, s71, 0x20000
v_mfma_f32_16x16x32_bf16 v[120:123], a[40:43], a[164:167], v[120:123]
ds_read_b64_tr_b16 a[14:15], v59 offset:8192
ds_read_b64_tr_b16 a[28:29], v59 offset:2048
v_mfma_f32_16x16x32_bf16 v[108:111], a[44:47], a[160:163], v[108:111]
ds_read_b64_tr_b16 a[30:31], v59 offset:10240
v_mfma_f32_16x16x32_bf16 v[108:111], a[60:63], a[168:171], v[108:111]
v_mfma_f32_16x16x32_bf16 v[124:127], a[60:63], a[172:175], v[124:127]
v_mfma_f32_16x16x32_bf16 v[124:127], a[44:47], a[164:167], v[124:127]
s_waitcnt lgkmcnt(0)
v_mfma_f32_16x16x32_bf16 v[64:67], a[0:3], a[176:179], v[64:67]
ds_read_b64_tr_b16 a[32:33], v56 offset:1024
buffer_load_dwordx4 a[240:243], v1, s[12:15], s69 offen offset:0 sc1
v_mfma_f32_16x16x32_bf16 v[64:67], a[16:19], a[184:187], v[64:67]
ds_read_b64_tr_b16 a[34:35], v56 offset:9216
ds_read_b64_tr_b16 a[48:49], v56 offset:3072
v_mfma_f32_16x16x32_bf16 v[80:83], a[16:19], a[188:191], v[80:83]
ds_read_b64_tr_b16 a[50:51], v56 offset:11264
v_mfma_f32_16x16x32_bf16 v[80:83], a[0:3], a[180:183], v[80:83]
ds_read_b64_tr_b16 a[36:37], v57 offset:1024
buffer_load_dwordx4 a[244:247], v1, s[12:15], s69 offen offset:1024 sc1
v_mfma_f32_16x16x32_bf16 v[68:71], a[4:7], a[176:179], v[68:71]
ds_read_b64_tr_b16 a[38:39], v57 offset:9216
ds_read_b64_tr_b16 a[52:53], v57 offset:3072
v_mfma_f32_16x16x32_bf16 v[68:71], a[20:23], a[184:187], v[68:71]
ds_read_b64_tr_b16 a[54:55], v57 offset:11264
v_mfma_f32_16x16x32_bf16 v[84:87], a[20:23], a[188:191], v[84:87]
ds_read_b64_tr_b16 a[40:41], v58 offset:1024
buffer_load_dwordx4 a[248:251], v10, s[12:15], s69 offen offset:0 sc1
v_mfma_f32_16x16x32_bf16 v[84:87], a[4:7], a[180:183], v[84:87]
ds_read_b64_tr_b16 a[42:43], v58 offset:9216
ds_read_b64_tr_b16 a[56:57], v58 offset:3072
v_mfma_f32_16x16x32_bf16 v[72:75], a[8:11], a[176:179], v[72:75]
ds_read_b64_tr_b16 a[58:59], v58 offset:11264
v_mfma_f32_16x16x32_bf16 v[72:75], a[24:27], a[184:187], v[72:75]
ds_read_b64_tr_b16 a[44:45], v59 offset:1024
buffer_load_dwordx4 a[252:255], v10, s[12:15], s69 offen offset:1024 sc1
s_add_u32 s69, s69, 0x8000
v_mfma_f32_16x16x32_bf16 v[88:91], a[24:27], a[188:191], v[88:91]
ds_read_b64_tr_b16 a[46:47], v59 offset:9216
ds_read_b64_tr_b16 a[60:61], v59 offset:3072
v_mfma_f32_16x16x32_bf16 v[88:91], a[8:11], a[180:183], v[88:91]
ds_read_b64_tr_b16 a[62:63], v59 offset:11264
v_mfma_f32_16x16x32_bf16 v[76:79], a[12:15], a[176:179], v[76:79]
v_mfma_f32_16x16x32_bf16 v[76:79], a[28:31], a[184:187], v[76:79]
v_mfma_f32_16x16x32_bf16 v[92:95], a[28:31], a[188:191], v[92:95]
v_mfma_f32_16x16x32_bf16 v[92:95], a[12:15], a[180:183], v[92:95]
s_waitcnt vmcnt(20) lgkmcnt(0)
v_mfma_f32_16x16x32_bf16 v[96:99], a[32:35], a[176:179], v[96:99]
s_barrier
v_mfma_f32_16x16x32_bf16 v[96:99], a[48:51], a[184:187], v[96:99]
s_add_u32 m0, s42, 49152
ds_read_b64_tr_b16 a[0:1], v56 offset:16384
buffer_load_dwordx4 v14, s[20:23], s71 offen offset:0 lds
v_mfma_f32_16x16x32_bf16 v[112:115], a[48:51], a[188:191], v[112:115]
ds_read_b64_tr_b16 a[2:3], v56 offset:24576
ds_read_b64_tr_b16 a[16:17], v56 offset:18432
v_mfma_f32_16x16x32_bf16 v[112:115], a[32:35], a[180:183], v[112:115]
ds_read_b64_tr_b16 a[18:19], v56 offset:26624
v_mfma_f32_16x16x32_bf16 v[100:103], a[36:39], a[176:179], v[100:103]
ds_read_b64_tr_b16 a[4:5], v57 offset:16384
buffer_load_dwordx4 v15, s[20:23], s71 offen offset:1024 lds
v_mfma_f32_16x16x32_bf16 v[100:103], a[52:55], a[184:187], v[100:103]
ds_read_b64_tr_b16 a[6:7], v57 offset:24576
ds_read_b64_tr_b16 a[20:21], v57 offset:18432
v_mfma_f32_16x16x32_bf16 v[116:119], a[52:55], a[188:191], v[116:119]
ds_read_b64_tr_b16 a[22:23], v57 offset:26624
v_mfma_f32_16x16x32_bf16 v[116:119], a[36:39], a[180:183], v[116:119]
ds_read_b64_tr_b16 a[8:9], v58 offset:16384
buffer_load_dwordx4 v16, s[20:23], s71 offen offset:2048 lds
v_mfma_f32_16x16x32_bf16 v[104:107], a[40:43], a[176:179], v[104:107]
ds_read_b64_tr_b16 a[10:11], v58 offset:24576
ds_read_b64_tr_b16 a[24:25], v58 offset:18432
v_mfma_f32_16x16x32_bf16 v[104:107], a[56:59], a[184:187], v[104:107]
ds_read_b64_tr_b16 a[26:27], v58 offset:26624
v_mfma_f32_16x16x32_bf16 v[120:123], a[56:59], a[188:191], v[120:123]
ds_read_b64_tr_b16 a[12:13], v59 offset:16384
buffer_load_dwordx4 v17, s[20:23], s71 offen offset:3072 lds
s_add_u32 s71, s71, 0x20000
v_mfma_f32_16x16x32_bf16 v[120:123], a[40:43], a[180:183], v[120:123]
ds_read_b64_tr_b16 a[14:15], v59 offset:24576
ds_read_b64_tr_b16 a[28:29], v59 offset:18432
v_mfma_f32_16x16x32_bf16 v[108:111], a[44:47], a[176:179], v[108:111]
ds_read_b64_tr_b16 a[30:31], v59 offset:26624
v_mfma_f32_16x16x32_bf16 v[108:111], a[60:63], a[184:187], v[108:111]
v_mfma_f32_16x16x32_bf16 v[124:127], a[60:63], a[188:191], v[124:127]
v_mfma_f32_16x16x32_bf16 v[124:127], a[44:47], a[180:183], v[124:127]
s_waitcnt lgkmcnt(0)
v_mfma_f32_16x16x32_bf16 v[64:67], a[0:3], a[192:195], v[64:67]
ds_read_b64_tr_b16 a[32:33], v56 offset:17408
buffer_load_dwordx4 a[128:131], v1, s[12:15], s69 offen offset:0 sc1
v_mfma_f32_16x16x32_bf16 v[64:67], a[16:19], a[200:203], v[64:67]
ds_read_b64_tr_b16 a[34:35], v56 offset:25600
ds_read_b64_tr_b16 a[48:49], v56 offset:19456
v_mfma_f32_16x16x32_bf16 v[80:83], a[16:19], a[204:207], v[80:83]
ds_read_b64_tr_b16 a[50:51], v56 offset:27648
buffer_load_dwordx4 a[132:135], v1, s[12:15], s69 offen offset:1024 sc1
v_mfma_f32_16x16x32_bf16 v[80:83], a[0:3], a[196:199], v[80:83]
ds_read_b64_tr_b16 a[36:37], v57 offset:17408
v_mfma_f32_16x16x32_bf16 v[68:71], a[4:7], a[192:195], v[68:71]
ds_read_b64_tr_b16 a[38:39], v57 offset:25600
ds_read_b64_tr_b16 a[52:53], v57 offset:19456
v_mfma_f32_16x16x32_bf16 v[68:71], a[20:23], a[200:203], v[68:71]
buffer_load_dwordx4 a[136:139], v10, s[12:15], s69 offen offset:0 sc1
ds_read_b64_tr_b16 a[54:55], v57 offset:27648
v_mfma_f32_16x16x32_bf16 v[84:87], a[20:23], a[204:207], v[84:87]
ds_read_b64_tr_b16 a[40:41], v58 offset:17408
ds_read_b64_tr_b16 a[42:43], v58 offset:25600
v_mfma_f32_16x16x32_bf16 v[84:87], a[4:7], a[196:199], v[84:87]
buffer_load_dwordx4 a[140:143], v10, s[12:15], s69 offen offset:1024 sc1
s_add_u32 s69, s69, 0x10000
v_mfma_f32_16x16x32_bf16 v[72:75], a[8:11], a[192:195], v[72:75]
ds_read_b64_tr_b16 a[56:57], v58 offset:19456
ds_read_b64_tr_b16 a[58:59], v58 offset:27648
v_mfma_f32_16x16x32_bf16 v[72:75], a[24:27], a[200:203], v[72:75]
ds_read_b64_tr_b16 a[44:45], v59 offset:17408
buffer_load_dword v0, v24, s[12:15], s83 offen sc1
v_mfma_f32_16x16x32_bf16 v[88:91], a[24:27], a[204:207], v[88:91]
ds_read_b64_tr_b16 a[46:47], v59 offset:25600
ds_read_b64_tr_b16 a[60:61], v59 offset:19456
v_mfma_f32_16x16x32_bf16 v[88:91], a[8:11], a[196:199], v[88:91]
ds_read_b64_tr_b16 a[62:63], v59 offset:27648
v_mfma_f32_16x16x32_bf16 v[76:79], a[12:15], a[192:195], v[76:79]
v_mfma_f32_16x16x32_bf16 v[76:79], a[28:31], a[200:203], v[76:79]
v_mfma_f32_16x16x32_bf16 v[92:95], a[28:31], a[204:207], v[92:95]
v_mfma_f32_16x16x32_bf16 v[92:95], a[12:15], a[196:199], v[92:95]
s_waitcnt vmcnt(21) lgkmcnt(0)
v_mfma_f32_16x16x32_bf16 v[96:99], a[32:35], a[192:195], v[96:99]
s_barrier
v_mfma_f32_16x16x32_bf16 v[96:99], a[48:51], a[200:203], v[96:99]
s_add_u32 m0, s42, 65536
ds_read_b64_tr_b16 a[0:1], v56 offset:32768
buffer_load_dwordx4 v14, s[20:23], s71 offen offset:0 lds
v_mfma_f32_16x16x32_bf16 v[112:115], a[48:51], a[204:207], v[112:115]
ds_read_b64_tr_b16 a[2:3], v56 offset:40960
ds_read_b64_tr_b16 a[16:17], v56 offset:34816
v_mfma_f32_16x16x32_bf16 v[112:115], a[32:35], a[196:199], v[112:115]
ds_read_b64_tr_b16 a[18:19], v56 offset:43008
v_mfma_f32_16x16x32_bf16 v[100:103], a[36:39], a[192:195], v[100:103]
ds_read_b64_tr_b16 a[4:5], v57 offset:32768
buffer_load_dwordx4 v15, s[20:23], s71 offen offset:1024 lds
v_mfma_f32_16x16x32_bf16 v[100:103], a[52:55], a[200:203], v[100:103]
ds_read_b64_tr_b16 a[6:7], v57 offset:40960
ds_read_b64_tr_b16 a[20:21], v57 offset:34816
v_mfma_f32_16x16x32_bf16 v[116:119], a[52:55], a[204:207], v[116:119]
ds_read_b64_tr_b16 a[22:23], v57 offset:43008
v_mfma_f32_16x16x32_bf16 v[116:119], a[36:39], a[196:199], v[116:119]
ds_read_b64_tr_b16 a[8:9], v58 offset:32768
buffer_load_dwordx4 v16, s[20:23], s71 offen offset:2048 lds
v_mfma_f32_16x16x32_bf16 v[104:107], a[40:43], a[192:195], v[104:107]
ds_read_b64_tr_b16 a[10:11], v58 offset:40960
ds_read_b64_tr_b16 a[24:25], v58 offset:34816
v_mfma_f32_16x16x32_bf16 v[104:107], a[56:59], a[200:203], v[104:107]
ds_read_b64_tr_b16 a[26:27], v58 offset:43008
v_mfma_f32_16x16x32_bf16 v[120:123], a[56:59], a[204:207], v[120:123]
ds_read_b64_tr_b16 a[12:13], v59 offset:32768
buffer_load_dwordx4 v17, s[20:23], s71 offen offset:3072 lds
s_add_u32 s71, s71, 0x40000
v_mfma_f32_16x16x32_bf16 v[120:123], a[40:43], a[196:199], v[120:123]
ds_read_b64_tr_b16 a[14:15], v59 offset:40960
ds_read_b64_tr_b16 a[28:29], v59 offset:34816
v_mfma_f32_16x16x32_bf16 v[108:111], a[44:47], a[192:195], v[108:111]
ds_read_b64_tr_b16 a[30:31], v59 offset:43008
v_mfma_f32_16x16x32_bf16 v[108:111], a[60:63], a[200:203], v[108:111]
v_mfma_f32_16x16x32_bf16 v[124:127], a[60:63], a[204:207], v[124:127]
v_mfma_f32_16x16x32_bf16 v[124:127], a[44:47], a[196:199], v[124:127]
s_waitcnt lgkmcnt(0)
v_mfma_f32_16x16x32_bf16 v[64:67], a[0:3], a[208:211], v[64:67]
ds_read_b64_tr_b16 a[32:33], v56 offset:33792
buffer_load_dwordx4 a[144:147], v1, s[12:15], s69 offen offset:0 sc1
v_mfma_f32_16x16x32_bf16 v[64:67], a[16:19], a[216:219], v[64:67]
ds_read_b64_tr_b16 a[34:35], v56 offset:41984
ds_read_b64_tr_b16 a[48:49], v56 offset:35840
v_mfma_f32_16x16x32_bf16 v[80:83], a[16:19], a[220:223], v[80:83]
ds_read_b64_tr_b16 a[50:51], v56 offset:44032
v_mfma_f32_16x16x32_bf16 v[80:83], a[0:3], a[212:215], v[80:83]
ds_read_b64_tr_b16 a[36:37], v57 offset:33792
buffer_load_dwordx4 a[148:151], v1, s[12:15], s69 offen offset:1024 sc1
v_mfma_f32_16x16x32_bf16 v[68:71], a[4:7], a[208:211], v[68:71]
ds_read_b64_tr_b16 a[38:39], v57 offset:41984
ds_read_b64_tr_b16 a[52:53], v57 offset:35840
v_mfma_f32_16x16x32_bf16 v[68:71], a[20:23], a[216:219], v[68:71]
ds_read_b64_tr_b16 a[54:55], v57 offset:44032
v_mfma_f32_16x16x32_bf16 v[84:87], a[20:23], a[220:223], v[84:87]
ds_read_b64_tr_b16 a[40:41], v58 offset:33792
buffer_load_dwordx4 a[152:155], v10, s[12:15], s69 offen offset:0 sc1
v_mfma_f32_16x16x32_bf16 v[84:87], a[4:7], a[212:215], v[84:87]
ds_read_b64_tr_b16 a[42:43], v58 offset:41984
ds_read_b64_tr_b16 a[56:57], v58 offset:35840
v_mfma_f32_16x16x32_bf16 v[72:75], a[8:11], a[208:211], v[72:75]
ds_read_b64_tr_b16 a[58:59], v58 offset:44032
v_mfma_f32_16x16x32_bf16 v[72:75], a[24:27], a[216:219], v[72:75]
ds_read_b64_tr_b16 a[44:45], v59 offset:33792
buffer_load_dwordx4 a[156:159], v10, s[12:15], s69 offen offset:1024 sc1
s_add_u32 s69, s69, 0x8000
v_mfma_f32_16x16x32_bf16 v[88:91], a[24:27], a[220:223], v[88:91]
ds_read_b64_tr_b16 a[46:47], v59 offset:41984
ds_read_b64_tr_b16 a[60:61], v59 offset:35840
v_mfma_f32_16x16x32_bf16 v[88:91], a[8:11], a[212:215], v[88:91]
ds_read_b64_tr_b16 a[62:63], v59 offset:44032
v_mfma_f32_16x16x32_bf16 v[76:79], a[12:15], a[208:211], v[76:79]
v_mfma_f32_16x16x32_bf16 v[76:79], a[28:31], a[216:219], v[76:79]
v_mfma_f32_16x16x32_bf16 v[92:95], a[28:31], a[220:223], v[92:95]
v_mfma_f32_16x16x32_bf16 v[92:95], a[12:15], a[212:215], v[92:95]
s_waitcnt vmcnt(21) lgkmcnt(0)
v_mfma_f32_16x16x32_bf16 v[96:99], a[32:35], a[208:211], v[96:99]
s_barrier
v_mfma_f32_16x16x32_bf16 v[96:99], a[48:51], a[216:219], v[96:99]
s_add_u32 m0, s42, 81920
ds_read_b64_tr_b16 a[0:1], v56 offset:49152
buffer_load_dwordx4 v14, s[20:23], s71 offen offset:0 lds
v_mfma_f32_16x16x32_bf16 v[112:115], a[48:51], a[220:223], v[112:115]
ds_read_b64_tr_b16 a[2:3], v56 offset:57344
ds_read_b64_tr_b16 a[16:17], v56 offset:51200
v_mfma_f32_16x16x32_bf16 v[112:115], a[32:35], a[212:215], v[112:115]
ds_read_b64_tr_b16 a[18:19], v56 offset:59392
v_mfma_f32_16x16x32_bf16 v[100:103], a[36:39], a[208:211], v[100:103]
ds_read_b64_tr_b16 a[4:5], v57 offset:49152
buffer_load_dwordx4 v15, s[20:23], s71 offen offset:1024 lds
v_mfma_f32_16x16x32_bf16 v[100:103], a[52:55], a[216:219], v[100:103]
ds_read_b64_tr_b16 a[6:7], v57 offset:57344
ds_read_b64_tr_b16 a[20:21], v57 offset:51200
v_mfma_f32_16x16x32_bf16 v[116:119], a[52:55], a[220:223], v[116:119]
ds_read_b64_tr_b16 a[22:23], v57 offset:59392
v_mfma_f32_16x16x32_bf16 v[116:119], a[36:39], a[212:215], v[116:119]
ds_read_b64_tr_b16 a[8:9], v58 offset:49152
PG21:
s_cbranch_execz fk_tret
buffer_load_dwordx4 v16, s[20:23], s71 offen offset:2048 lds
v_mfma_f32_16x16x32_bf16 v[104:107], a[40:43], a[208:211], v[104:107]
ds_read_b64_tr_b16 a[10:11], v58 offset:57344
ds_read_b64_tr_b16 a[24:25], v58 offset:51200
v_mfma_f32_16x16x32_bf16 v[104:107], a[56:59], a[216:219], v[104:107]
ds_read_b64_tr_b16 a[26:27], v58 offset:59392
v_mfma_f32_16x16x32_bf16 v[120:123], a[56:59], a[220:223], v[120:123]
ds_read_b64_tr_b16 a[12:13], v59 offset:49152
buffer_load_dwordx4 v17, s[20:23], s71 offen offset:3072 lds
s_add_u32 s71, s71, 0x20000
v_mfma_f32_16x16x32_bf16 v[120:123], a[40:43], a[212:215], v[120:123]
ds_read_b64_tr_b16 a[14:15], v59 offset:57344
ds_read_b64_tr_b16 a[28:29], v59 offset:51200
v_mfma_f32_16x16x32_bf16 v[108:111], a[44:47], a[208:211], v[108:111]
ds_read_b64_tr_b16 a[30:31], v59 offset:59392
v_mfma_f32_16x16x32_bf16 v[108:111], a[60:63], a[216:219], v[108:111]
v_mfma_f32_16x16x32_bf16 v[124:127], a[60:63], a[220:223], v[124:127]
v_mfma_f32_16x16x32_bf16 v[124:127], a[44:47], a[212:215], v[124:127]
s_waitcnt lgkmcnt(0)
v_mfma_f32_16x16x32_bf16 v[64:67], a[0:3], a[224:227], v[64:67]
ds_read_b64_tr_b16 a[32:33], v56 offset:50176
buffer_load_dwordx4 a[160:163], v1, s[12:15], s69 offen offset:0 sc1
v_mfma_f32_16x16x32_bf16 v[64:67], a[16:19], a[232:235], v[64:67]
ds_read_b64_tr_b16 a[34:35], v56 offset:58368
ds_read_b64_tr_b16 a[48:49], v56 offset:52224
v_mfma_f32_16x16x32_bf16 v[80:83], a[16:19], a[236:239], v[80:83]
ds_read_b64_tr_b16 a[50:51], v56 offset:60416
v_mfma_f32_16x16x32_bf16 v[80:83], a[0:3], a[228:231], v[80:83]
ds_read_b64_tr_b16 a[36:37], v57 offset:50176
buffer_load_dwordx4 a[164:167], v1, s[12:15], s69 offen offset:1024 sc1
v_mfma_f32_16x16x32_bf16 v[68:71], a[4:7], a[224:227], v[68:71]
ds_read_b64_tr_b16 a[38:39], v57 offset:58368
ds_read_b64_tr_b16 a[52:53], v57 offset:52224
v_mfma_f32_16x16x32_bf16 v[68:71], a[20:23], a[232:235], v[68:71]
ds_read_b64_tr_b16 a[54:55], v57 offset:60416
v_mfma_f32_16x16x32_bf16 v[84:87], a[20:23], a[236:239], v[84:87]
ds_read_b64_tr_b16 a[40:41], v58 offset:50176
buffer_load_dwordx4 a[168:171], v10, s[12:15], s69 offen offset:0 sc1
v_mfma_f32_16x16x32_bf16 v[84:87], a[4:7], a[228:231], v[84:87]
ds_read_b64_tr_b16 a[42:43], v58 offset:58368
ds_read_b64_tr_b16 a[56:57], v58 offset:52224
v_mfma_f32_16x16x32_bf16 v[72:75], a[8:11], a[224:227], v[72:75]
ds_read_b64_tr_b16 a[58:59], v58 offset:60416
v_mfma_f32_16x16x32_bf16 v[72:75], a[24:27], a[232:235], v[72:75]
ds_read_b64_tr_b16 a[44:45], v59 offset:50176
buffer_load_dwordx4 a[172:175], v10, s[12:15], s69 offen offset:1024 sc1
s_add_u32 s69, s69, 0x0
v_mfma_f32_16x16x32_bf16 v[88:91], a[24:27], a[236:239], v[88:91]
ds_read_b64_tr_b16 a[46:47], v59 offset:58368
ds_read_b64_tr_b16 a[60:61], v59 offset:52224
v_mfma_f32_16x16x32_bf16 v[88:91], a[8:11], a[228:231], v[88:91]
ds_read_b64_tr_b16 a[62:63], v59 offset:60416
v_mfma_f32_16x16x32_bf16 v[76:79], a[12:15], a[224:227], v[76:79]
v_mfma_f32_16x16x32_bf16 v[76:79], a[28:31], a[232:235], v[76:79]
v_mfma_f32_16x16x32_bf16 v[92:95], a[28:31], a[236:239], v[92:95]
v_mfma_f32_16x16x32_bf16 v[92:95], a[12:15], a[228:231], v[92:95]
s_waitcnt vmcnt(21) lgkmcnt(0)
v_mfma_f32_16x16x32_bf16 v[96:99], a[32:35], a[224:227], v[96:99]
s_barrier
v_mfma_f32_16x16x32_bf16 v[96:99], a[48:51], a[232:235], v[96:99]
s_add_u32 m0, s42, 98304
ds_read_b64_tr_b16 a[0:1], v6 offset:49152
buffer_load_dwordx4 v14, s[20:23], s71 offen offset:0 lds
v_mfma_f32_16x16x32_bf16 v[112:115], a[48:51], a[236:239], v[112:115]
ds_read_b64_tr_b16 a[2:3], v6 offset:57344
ds_read_b64_tr_b16 a[16:17], v6 offset:51200
v_mfma_f32_16x16x32_bf16 v[112:115], a[32:35], a[228:231], v[112:115]
ds_read_b64_tr_b16 a[18:19], v6 offset:59392
v_mfma_f32_16x16x32_bf16 v[100:103], a[36:39], a[224:227], v[100:103]
ds_read_b64_tr_b16 a[4:5], v7 offset:49152
buffer_load_dwordx4 v15, s[20:23], s71 offen offset:1024 lds
v_mfma_f32_16x16x32_bf16 v[100:103], a[52:55], a[232:235], v[100:103]
ds_read_b64_tr_b16 a[6:7], v7 offset:57344
ds_read_b64_tr_b16 a[20:21], v7 offset:51200
v_mfma_f32_16x16x32_bf16 v[116:119], a[52:55], a[236:239], v[116:119]
ds_read_b64_tr_b16 a[22:23], v7 offset:59392
v_mfma_f32_16x16x32_bf16 v[116:119], a[36:39], a[228:231], v[116:119]
ds_read_b64_tr_b16 a[8:9], v8 offset:49152
buffer_load_dwordx4 v16, s[20:23], s71 offen offset:2048 lds
v_mfma_f32_16x16x32_bf16 v[104:107], a[40:43], a[224:227], v[104:107]
ds_read_b64_tr_b16 a[10:11], v8 offset:57344
ds_read_b64_tr_b16 a[24:25], v8 offset:51200
v_mfma_f32_16x16x32_bf16 v[104:107], a[56:59], a[232:235], v[104:107]
ds_read_b64_tr_b16 a[26:27], v8 offset:59392
v_mfma_f32_16x16x32_bf16 v[120:123], a[56:59], a[236:239], v[120:123]
ds_read_b64_tr_b16 a[12:13], v9 offset:49152
buffer_load_dwordx4 v17, s[20:23], s71 offen offset:3072 lds
s_add_u32 s71, s71, 0x0
v_mfma_f32_16x16x32_bf16 v[120:123], a[40:43], a[228:231], v[120:123]
ds_read_b64_tr_b16 a[14:15], v9 offset:57344
ds_read_b64_tr_b16 a[28:29], v9 offset:51200
v_mfma_f32_16x16x32_bf16 v[108:111], a[44:47], a[224:227], v[108:111]
ds_read_b64_tr_b16 a[30:31], v9 offset:59392
v_mfma_f32_16x16x32_bf16 v[108:111], a[60:63], a[232:235], v[108:111]
v_mfma_f32_16x16x32_bf16 v[124:127], a[60:63], a[236:239], v[124:127]
v_mfma_f32_16x16x32_bf16 v[124:127], a[44:47], a[228:231], v[124:127]
s_waitcnt lgkmcnt(0)
s_waitcnt vmcnt(20)
s_mov_b32 s86, 0
fk_g2_so_chk:
v_cmp_eq_u32 vcc, v26, v0
s_nop 1
s_andn2_b64 s[88:89], s[84:85], vcc
s_cbranch_scc0 fk_g2_so_ok
s_add_u32 s86, s86, 1
s_cmp_gt_u32 s86, 0x8000
s_cbranch_scc1 fk_g2_so_ok
s_sleep 2
fk_g2_so_ld:
buffer_load_dword v0, v24, s[12:15], s83 offen sc1
s_waitcnt vmcnt(0)
s_branch fk_g2_so_chk
fk_g2_so_ok:
v_mfma_f32_16x16x32_bf16 v[64:67], a[0:3], a[240:243], v[64:67]
ds_read_b64_tr_b16 a[32:33], v6 offset:50176
buffer_load_dwordx4 a[176:179], v1, s[12:15], s70 offen offset:0 sc1
v_mfma_f32_16x16x32_bf16 v[64:67], a[16:19], a[248:251], v[64:67]
ds_read_b64_tr_b16 a[34:35], v6 offset:58368
ds_read_b64_tr_b16 a[48:49], v6 offset:52224
v_mfma_f32_16x16x32_bf16 v[80:83], a[16:19], a[252:255], v[80:83]
ds_read_b64_tr_b16 a[50:51], v6 offset:60416
v_mfma_f32_16x16x32_bf16 v[80:83], a[0:3], a[244:247], v[80:83]
ds_read_b64_tr_b16 a[36:37], v7 offset:50176
buffer_load_dwordx4 a[180:183], v1, s[12:15], s70 offen offset:1024 sc1
v_mfma_f32_16x16x32_bf16 v[68:71], a[4:7], a[240:243], v[68:71]
ds_read_b64_tr_b16 a[38:39], v7 offset:58368
ds_read_b64_tr_b16 a[52:53], v7 offset:52224
v_mfma_f32_16x16x32_bf16 v[68:71], a[20:23], a[248:251], v[68:71]
ds_read_b64_tr_b16 a[54:55], v7 offset:60416
v_mfma_f32_16x16x32_bf16 v[84:87], a[20:23], a[252:255], v[84:87]
ds_read_b64_tr_b16 a[40:41], v8 offset:50176
buffer_load_dwordx4 a[184:187], v10, s[12:15], s70 offen offset:0 sc1
v_mfma_f32_16x16x32_bf16 v[84:87], a[4:7], a[244:247], v[84:87]
ds_read_b64_tr_b16 a[42:43], v8 offset:58368
ds_read_b64_tr_b16 a[56:57], v8 offset:52224
v_mfma_f32_16x16x32_bf16 v[72:75], a[8:11], a[240:243], v[72:75]
ds_read_b64_tr_b16 a[58:59], v8 offset:60416
v_mfma_f32_16x16x32_bf16 v[72:75], a[24:27], a[248:251], v[72:75]
ds_read_b64_tr_b16 a[44:45], v9 offset:50176
buffer_load_dwordx4 a[188:191], v10, s[12:15], s70 offen offset:1024 sc1
s_add_u32 s70, s70, 0x8000
v_mfma_f32_16x16x32_bf16 v[88:91], a[24:27], a[252:255], v[88:91]
ds_read_b64_tr_b16 a[46:47], v9 offset:58368
ds_read_b64_tr_b16 a[60:61], v9 offset:52224
v_mfma_f32_16x16x32_bf16 v[88:91], a[8:11], a[244:247], v[88:91]
ds_read_b64_tr_b16 a[62:63], v9 offset:60416
v_mfma_f32_16x16x32_bf16 v[76:79], a[12:15], a[240:243], v[76:79]
v_mfma_f32_16x16x32_bf16 v[76:79], a[28:31], a[248:251], v[76:79]
v_mfma_f32_16x16x32_bf16 v[92:95], a[28:31], a[252:255], v[92:95]
v_mfma_f32_16x16x32_bf16 v[92:95], a[12:15], a[244:247], v[92:95]
s_waitcnt vmcnt(20) lgkmcnt(0)
v_mfma_f32_16x16x32_bf16 v[96:99], a[32:35], a[240:243], v[96:99]
s_barrier
v_mfma_f32_16x16x32_bf16 v[96:99], a[48:51], a[248:251], v[96:99]
ds_read_b64_tr_b16 a[0:1], v56 offset:0
buffer_load_dwordx4 a[192:195], v1, s[12:15], s70 offen offset:0 sc1
v_mfma_f32_16x16x32_bf16 v[112:115], a[48:51], a[252:255], v[112:115]
ds_read_b64_tr_b16 a[2:3], v56 offset:8192
ds_read_b64_tr_b16 a[16:17], v56 offset:2048
v_mfma_f32_16x16x32_bf16 v[112:115], a[32:35], a[244:247], v[112:115]
ds_read_b64_tr_b16 a[18:19], v56 offset:10240
v_mfma_f32_16x16x32_bf16 v[100:103], a[36:39], a[240:243], v[100:103]
ds_read_b64_tr_b16 a[4:5], v57 offset:0
buffer_load_dwordx4 a[196:199], v1, s[12:15], s70 offen offset:1024 sc1
v_mfma_f32_16x16x32_bf16 v[100:103], a[52:55], a[248:251], v[100:103]
ds_read_b64_tr_b16 a[6:7], v57 offset:8192
ds_read_b64_tr_b16 a[20:21], v57 offset:2048
v_mfma_f32_16x16x32_bf16 v[116:119], a[52:55], a[252:255], v[116:119]
ds_read_b64_tr_b16 a[22:23], v57 offset:10240
v_mfma_f32_16x16x32_bf16 v[116:119], a[36:39], a[244:247], v[116:119]
ds_read_b64_tr_b16 a[8:9], v58 offset:0
buffer_load_dwordx4 a[200:203], v10, s[12:15], s70 offen offset:0 sc1
v_mfma_f32_16x16x32_bf16 v[104:107], a[40:43], a[240:243], v[104:107]
ds_read_b64_tr_b16 a[10:11], v58 offset:8192
ds_read_b64_tr_b16 a[24:25], v58 offset:2048
v_mfma_f32_16x16x32_bf16 v[104:107], a[56:59], a[248:251], v[104:107]
ds_read_b64_tr_b16 a[26:27], v58 offset:10240
v_mfma_f32_16x16x32_bf16 v[120:123], a[56:59], a[252:255], v[120:123]
ds_read_b64_tr_b16 a[12:13], v59 offset:0
buffer_load_dwordx4 a[204:207], v10, s[12:15], s70 offen offset:1024 sc1
s_add_u32 s70, s70, 0x8000
v_mfma_f32_16x16x32_bf16 v[120:123], a[40:43], a[244:247], v[120:123]
ds_read_b64_tr_b16 a[14:15], v59 offset:8192
ds_read_b64_tr_b16 a[28:29], v59 offset:2048
v_mfma_f32_16x16x32_bf16 v[108:111], a[44:47], a[240:243], v[108:111]
ds_read_b64_tr_b16 a[30:31], v59 offset:10240
v_mfma_f32_16x16x32_bf16 v[108:111], a[60:63], a[248:251], v[108:111]
v_mfma_f32_16x16x32_bf16 v[124:127], a[60:63], a[252:255], v[124:127]
v_mfma_f32_16x16x32_bf16 v[124:127], a[44:47], a[244:247], v[124:127]
s_waitcnt lgkmcnt(0)
v_mfma_f32_16x16x32_bf16 v[64:67], a[0:3], a[128:131], v[64:67]
ds_read_b64_tr_b16 a[32:33], v56 offset:1024
buffer_load_dwordx4 a[208:211], v1, s[12:15], s70 offen offset:0 sc1
v_mfma_f32_16x16x32_bf16 v[64:67], a[16:19], a[136:139], v[64:67]
ds_read_b64_tr_b16 a[34:35], v56 offset:9216
ds_read_b64_tr_b16 a[48:49], v56 offset:3072
v_mfma_f32_16x16x32_bf16 v[80:83], a[16:19], a[140:143], v[80:83]
ds_read_b64_tr_b16 a[50:51], v56 offset:11264
v_mfma_f32_16x16x32_bf16 v[80:83], a[0:3], a[132:135], v[80:83]
ds_read_b64_tr_b16 a[36:37], v57 offset:1024
buffer_load_dwordx4 a[212:215], v1, s[12:15], s70 offen offset:1024 sc1
v_mfma_f32_16x16x32_bf16 v[68:71], a[4:7], a[128:131], v[68:71]
ds_read_b64_tr_b16 a[38:39], v57 offset:9216
ds_read_b64_tr_b16 a[52:53], v57 offset:3072
v_mfma_f32_16x16x32_bf16 v[68:71], a[20:23], a[136:139], v[68:71]
ds_read_b64_tr_b16 a[54:55], v57 offset:11264
v_mfma_f32_16x16x32_bf16 v[84:87], a[20:23], a[140:143], v[84:87]
ds_read_b64_tr_b16 a[40:41], v58 offset:1024
buffer_load_dwordx4 a[216:219], v10, s[12:15], s70 offen offset:0 sc1
v_mfma_f32_16x16x32_bf16 v[84:87], a[4:7], a[132:135], v[84:87]
ds_read_b64_tr_b16 a[42:43], v58 offset:9216
ds_read_b64_tr_b16 a[56:57], v58 offset:3072
v_mfma_f32_16x16x32_bf16 v[72:75], a[8:11], a[128:131], v[72:75]
ds_read_b64_tr_b16 a[58:59], v58 offset:11264
v_mfma_f32_16x16x32_bf16 v[72:75], a[24:27], a[136:139], v[72:75]
ds_read_b64_tr_b16 a[44:45], v59 offset:1024
buffer_load_dwordx4 a[220:223], v10, s[12:15], s70 offen offset:1024 sc1
s_add_u32 s70, s70, 0x8000
v_mfma_f32_16x16x32_bf16 v[88:91], a[24:27], a[140:143], v[88:91]
ds_read_b64_tr_b16 a[46:47], v59 offset:9216
ds_read_b64_tr_b16 a[60:61], v59 offset:3072
v_mfma_f32_16x16x32_bf16 v[88:91], a[8:11], a[132:135], v[88:91]
ds_read_b64_tr_b16 a[62:63], v59 offset:11264
v_mfma_f32_16x16x32_bf16 v[76:79], a[12:15], a[128:131], v[76:79]
v_mfma_f32_16x16x32_bf16 v[76:79], a[28:31], a[136:139], v[76:79]
v_mfma_f32_16x16x32_bf16 v[92:95], a[28:31], a[140:143], v[92:95]
v_mfma_f32_16x16x32_bf16 v[92:95], a[12:15], a[132:135], v[92:95]
s_waitcnt vmcnt(20) lgkmcnt(0)
v_mfma_f32_16x16x32_bf16 v[96:99], a[32:35], a[128:131], v[96:99]
s_barrier
v_mfma_f32_16x16x32_bf16 v[96:99], a[48:51], a[136:139], v[96:99]
ds_read_b64_tr_b16 a[0:1], v56 offset:16384
buffer_load_dwordx4 a[224:227], v1, s[12:15], s70 offen offset:0 sc1
v_mfma_f32_16x16x32_bf16 v[112:115], a[48:51], a[140:143], v[112:115]
ds_read_b64_tr_b16 a[2:3], v56 offset:24576
ds_read_b64_tr_b16 a[16:17], v56 offset:18432
v_mfma_f32_16x16x32_bf16 v[112:115], a[32:35], a[132:135], v[112:115]
ds_read_b64_tr_b16 a[18:19], v56 offset:26624
v_mfma_f32_16x16x32_bf16 v[100:103], a[36:39], a[128:131], v[100:103]
ds_read_b64_tr_b16 a[4:5], v57 offset:16384
buffer_load_dwordx4 a[228:231], v1, s[12:15], s70 offen offset:1024 sc1
v_mfma_f32_16x16x32_bf16 v[100:103], a[52:55], a[136:139], v[100:103]
ds_read_b64_tr_b16 a[6:7], v57 offset:24576
ds_read_b64_tr_b16 a[20:21], v57 offset:18432
v_mfma_f32_16x16x32_bf16 v[116:119], a[52:55], a[140:143], v[116:119]
ds_read_b64_tr_b16 a[22:23], v57 offset:26624
v_mfma_f32_16x16x32_bf16 v[116:119], a[36:39], a[132:135], v[116:119]
ds_read_b64_tr_b16 a[8:9], v58 offset:16384
buffer_load_dwordx4 a[232:235], v10, s[12:15], s70 offen offset:0 sc1
v_mfma_f32_16x16x32_bf16 v[104:107], a[40:43], a[128:131], v[104:107]
ds_read_b64_tr_b16 a[10:11], v58 offset:24576
ds_read_b64_tr_b16 a[24:25], v58 offset:18432
v_mfma_f32_16x16x32_bf16 v[104:107], a[56:59], a[136:139], v[104:107]
ds_read_b64_tr_b16 a[26:27], v58 offset:26624
v_mfma_f32_16x16x32_bf16 v[120:123], a[56:59], a[140:143], v[120:123]
ds_read_b64_tr_b16 a[12:13], v59 offset:16384
buffer_load_dwordx4 a[236:239], v10, s[12:15], s70 offen offset:1024 sc1
s_add_u32 s70, s70, 0x8000
v_mfma_f32_16x16x32_bf16 v[120:123], a[40:43], a[132:135], v[120:123]
ds_read_b64_tr_b16 a[14:15], v59 offset:24576
ds_read_b64_tr_b16 a[28:29], v59 offset:18432
v_mfma_f32_16x16x32_bf16 v[108:111], a[44:47], a[128:131], v[108:111]
ds_read_b64_tr_b16 a[30:31], v59 offset:26624
v_mfma_f32_16x16x32_bf16 v[108:111], a[60:63], a[136:139], v[108:111]
v_mfma_f32_16x16x32_bf16 v[124:127], a[60:63], a[140:143], v[124:127]
v_mfma_f32_16x16x32_bf16 v[124:127], a[44:47], a[132:135], v[124:127]
s_waitcnt lgkmcnt(0)
v_mfma_f32_16x16x32_bf16 v[64:67], a[0:3], a[144:147], v[64:67]
ds_read_b64_tr_b16 a[32:33], v56 offset:17408
buffer_load_dwordx4 a[240:243], v1, s[12:15], s70 offen offset:0 sc1
v_mfma_f32_16x16x32_bf16 v[64:67], a[16:19], a[152:155], v[64:67]
ds_read_b64_tr_b16 a[34:35], v56 offset:25600
ds_read_b64_tr_b16 a[48:49], v56 offset:19456
v_mfma_f32_16x16x32_bf16 v[80:83], a[16:19], a[156:159], v[80:83]
ds_read_b64_tr_b16 a[50:51], v56 offset:27648
v_mfma_f32_16x16x32_bf16 v[80:83], a[0:3], a[148:151], v[80:83]
ds_read_b64_tr_b16 a[36:37], v57 offset:17408
buffer_load_dwordx4 a[244:247], v1, s[12:15], s70 offen offset:1024 sc1
v_mfma_f32_16x16x32_bf16 v[68:71], a[4:7], a[144:147], v[68:71]
ds_read_b64_tr_b16 a[38:39], v57 offset:25600
ds_read_b64_tr_b16 a[52:53], v57 offset:19456
v_mfma_f32_16x16x32_bf16 v[68:71], a[20:23], a[152:155], v[68:71]
ds_read_b64_tr_b16 a[54:55], v57 offset:27648
v_mfma_f32_16x16x32_bf16 v[84:87], a[20:23], a[156:159], v[84:87]
ds_read_b64_tr_b16 a[40:41], v58 offset:17408
buffer_load_dwordx4 a[248:251], v10, s[12:15], s70 offen offset:0 sc1
v_mfma_f32_16x16x32_bf16 v[84:87], a[4:7], a[148:151], v[84:87]
ds_read_b64_tr_b16 a[42:43], v58 offset:25600
ds_read_b64_tr_b16 a[56:57], v58 offset:19456
v_mfma_f32_16x16x32_bf16 v[72:75], a[8:11], a[144:147], v[72:75]
ds_read_b64_tr_b16 a[58:59], v58 offset:27648
v_mfma_f32_16x16x32_bf16 v[72:75], a[24:27], a[152:155], v[72:75]
ds_read_b64_tr_b16 a[44:45], v59 offset:17408
buffer_load_dwordx4 a[252:255], v10, s[12:15], s70 offen offset:1024 sc1
s_add_u32 s70, s70, 0x8000
v_mfma_f32_16x16x32_bf16 v[88:91], a[24:27], a[156:159], v[88:91]
ds_read_b64_tr_b16 a[46:47], v59 offset:25600
ds_read_b64_tr_b16 a[60:61], v59 offset:19456
v_mfma_f32_16x16x32_bf16 v[88:91], a[8:11], a[148:151], v[88:91]
ds_read_b64_tr_b16 a[62:63], v59 offset:27648
v_mfma_f32_16x16x32_bf16 v[76:79], a[12:15], a[144:147], v[76:79]
v_mfma_f32_16x16x32_bf16 v[76:79], a[28:31], a[152:155], v[76:79]
v_mfma_f32_16x16x32_bf16 v[92:95], a[28:31], a[156:159], v[92:95]
v_mfma_f32_16x16x32_bf16 v[92:95], a[12:15], a[148:151], v[92:95]
s_waitcnt vmcnt(20) lgkmcnt(0)
v_mfma_f32_16x16x32_bf16 v[96:99], a[32:35], a[144:147], v[96:99]
s_barrier
v_mfma_f32_16x16x32_bf16 v[96:99], a[48:51], a[152:155], v[96:99]
ds_read_b64_tr_b16 a[0:1], v56 offset:33792
buffer_load_dwordx4 a[128:131], v1, s[12:15], s70 offen offset:0 sc1
v_mfma_f32_16x16x32_bf16 v[112:115], a[48:51], a[156:159], v[112:115]
ds_read_b64_tr_b16 a[2:3], v56 offset:41984
ds_read_b64_tr_b16 a[16:17], v56 offset:35840
v_mfma_f32_16x16x32_bf16 v[112:115], a[32:35], a[148:151], v[112:115]
ds_read_b64_tr_b16 a[18:19], v56 offset:44032
v_mfma_f32_16x16x32_bf16 v[100:103], a[36:39], a[144:147], v[100:103]
ds_read_b64_tr_b16 a[4:5], v57 offset:33792
buffer_load_dwordx4 a[132:135], v1, s[12:15], s70 offen offset:1024 sc1
v_mfma_f32_16x16x32_bf16 v[100:103], a[52:55], a[152:155], v[100:103]
ds_read_b64_tr_b16 a[6:7], v57 offset:41984
ds_read_b64_tr_b16 a[20:21], v57 offset:35840
v_mfma_f32_16x16x32_bf16 v[116:119], a[52:55], a[156:159], v[116:119]
ds_read_b64_tr_b16 a[22:23], v57 offset:44032
v_mfma_f32_16x16x32_bf16 v[116:119], a[36:39], a[148:151], v[116:119]
ds_read_b64_tr_b16 a[8:9], v58 offset:33792
buffer_load_dwordx4 a[136:139], v10, s[12:15], s70 offen offset:0 sc1
v_mfma_f32_16x16x32_bf16 v[104:107], a[40:43], a[144:147], v[104:107]
ds_read_b64_tr_b16 a[10:11], v58 offset:41984
ds_read_b64_tr_b16 a[24:25], v58 offset:35840
v_mfma_f32_16x16x32_bf16 v[104:107], a[56:59], a[152:155], v[104:107]
ds_read_b64_tr_b16 a[26:27], v58 offset:44032
v_mfma_f32_16x16x32_bf16 v[120:123], a[56:59], a[156:159], v[120:123]
ds_read_b64_tr_b16 a[12:13], v59 offset:33792
buffer_load_dwordx4 a[140:143], v10, s[12:15], s70 offen offset:1024 sc1
s_add_u32 s70, s70, 0x8000
v_mfma_f32_16x16x32_bf16 v[120:123], a[40:43], a[148:151], v[120:123]
ds_read_b64_tr_b16 a[14:15], v59 offset:41984
ds_read_b64_tr_b16 a[28:29], v59 offset:35840
v_mfma_f32_16x16x32_bf16 v[108:111], a[44:47], a[144:147], v[108:111]
ds_read_b64_tr_b16 a[30:31], v59 offset:44032
v_mfma_f32_16x16x32_bf16 v[108:111], a[60:63], a[152:155], v[108:111]
v_mfma_f32_16x16x32_bf16 v[124:127], a[60:63], a[156:159], v[124:127]
v_mfma_f32_16x16x32_bf16 v[124:127], a[44:47], a[148:151], v[124:127]
s_waitcnt lgkmcnt(0)
v_mfma_f32_16x16x32_bf16 v[96:99], a[0:3], a[160:163], v[96:99]
ds_read_b64_tr_b16 a[32:33], v56 offset:32768
buffer_load_dwordx4 a[144:147], v1, s[12:15], s70 offen offset:0 sc1
v_mfma_f32_16x16x32_bf16 v[96:99], a[16:19], a[168:171], v[96:99]
ds_read_b64_tr_b16 a[34:35], v56 offset:40960
ds_read_b64_tr_b16 a[48:49], v56 offset:34816
v_mfma_f32_16x16x32_bf16 v[112:115], a[16:19], a[172:175], v[112:115]
ds_read_b64_tr_b16 a[50:51], v56 offset:43008
v_mfma_f32_16x16x32_bf16 v[112:115], a[0:3], a[164:167], v[112:115]
ds_read_b64_tr_b16 a[36:37], v57 offset:32768
buffer_load_dwordx4 a[148:151], v1, s[12:15], s70 offen offset:1024 sc1
v_mfma_f32_16x16x32_bf16 v[100:103], a[4:7], a[160:163], v[100:103]
ds_read_b64_tr_b16 a[38:39], v57 offset:40960
ds_read_b64_tr_b16 a[52:53], v57 offset:34816
v_mfma_f32_16x16x32_bf16 v[100:103], a[20:23], a[168:171], v[100:103]
ds_read_b64_tr_b16 a[54:55], v57 offset:43008
v_mfma_f32_16x16x32_bf16 v[116:119], a[20:23], a[172:175], v[116:119]
ds_read_b64_tr_b16 a[40:41], v58 offset:32768
buffer_load_dwordx4 a[152:155], v10, s[12:15], s70 offen offset:0 sc1
v_mfma_f32_16x16x32_bf16 v[116:119], a[4:7], a[164:167], v[116:119]
ds_read_b64_tr_b16 a[42:43], v58 offset:40960
ds_read_b64_tr_b16 a[56:57], v58 offset:34816
v_mfma_f32_16x16x32_bf16 v[104:107], a[8:11], a[160:163], v[104:107]
ds_read_b64_tr_b16 a[58:59], v58 offset:43008
v_mfma_f32_16x16x32_bf16 v[104:107], a[24:27], a[168:171], v[104:107]
ds_read_b64_tr_b16 a[44:45], v59 offset:32768
buffer_load_dwordx4 a[156:159], v10, s[12:15], s70 offen offset:1024 sc1
s_add_u32 s70, s70, 0x8000
v_mfma_f32_16x16x32_bf16 v[120:123], a[24:27], a[172:175], v[120:123]
ds_read_b64_tr_b16 a[46:47], v59 offset:40960
ds_read_b64_tr_b16 a[60:61], v59 offset:34816
v_mfma_f32_16x16x32_bf16 v[120:123], a[8:11], a[164:167], v[120:123]
ds_read_b64_tr_b16 a[62:63], v59 offset:43008
v_mfma_f32_16x16x32_bf16 v[108:111], a[12:15], a[160:163], v[108:111]
v_mfma_f32_16x16x32_bf16 v[108:111], a[28:31], a[168:171], v[108:111]
v_mfma_f32_16x16x32_bf16 v[124:127], a[28:31], a[172:175], v[124:127]
v_mfma_f32_16x16x32_bf16 v[124:127], a[12:15], a[164:167], v[124:127]
s_waitcnt lgkmcnt(0)
v_mfma_f32_16x16x32_bf16 v[64:67], a[32:35], a[160:163], v[64:67]
s_barrier
v_mfma_f32_16x16x32_bf16 v[64:67], a[48:51], a[168:171], v[64:67]
s_add_u32 m0, s42, 114688
ds_read_b64_tr_b16 a[0:1], v60 offset:0
buffer_load_dwordx4 v2, s[24:27], s72 offen offset:0 lds
ds_read_b64_tr_b16 a[2:3], v60 offset:8192
v_mfma_f32_16x16x32_bf16 v[80:83], a[48:51], a[172:175], v[80:83]
buffer_load_dwordx4 v3, s[24:27], s72 offen offset:1024 lds
ds_read_b64_tr_b16 a[16:17], v60 offset:1024
v_mfma_f32_16x16x32_bf16 v[80:83], a[32:35], a[164:167], v[80:83]
buffer_load_dwordx4 v4, s[24:27], s72 offen offset:2048 lds
ds_read_b64_tr_b16 a[18:19], v60 offset:9216
v_mfma_f32_16x16x32_bf16 v[68:71], a[36:39], a[160:163], v[68:71]
ds_read_b64_tr_b16 a[4:5], v61 offset:0
buffer_load_dwordx4 v5, s[24:27], s72 offen offset:3072 lds
s_add_u32 s72, s72, 262144
v_mfma_f32_16x16x32_bf16 v[68:71], a[52:55], a[168:171], v[68:71]
ds_read_b64_tr_b16 a[6:7], v61 offset:8192
s_nop 0
ds_read_b64_tr_b16 a[20:21], v61 offset:1024
v_mfma_f32_16x16x32_bf16 v[84:87], a[52:55], a[172:175], v[84:87]
ds_read_b64_tr_b16 a[22:23], v61 offset:9216
s_nop 0
v_mfma_f32_16x16x32_bf16 v[84:87], a[36:39], a[164:167], v[84:87]
ds_read_b64_tr_b16 a[8:9], v62 offset:0
s_nop 0
v_mfma_f32_16x16x32_bf16 v[72:75], a[40:43], a[160:163], v[72:75]
ds_read_b64_tr_b16 a[10:11], v62 offset:8192
ds_read_b64_tr_b16 a[24:25], v62 offset:1024
v_mfma_f32_16x16x32_bf16 v[72:75], a[56:59], a[168:171], v[72:75]
v_cvt_pk_bf16_f32 v96, v96, v97
v_cvt_pk_bf16_f32 v97, v98, v99
v_cvt_pk_bf16_f32 v98, v100, v101
v_cvt_pk_bf16_f32 v99, v102, v103
buffer_store_dwordx4 v[96:99], v1, s[12:15], s76 offen offset:0 sc1
ds_read_b64_tr_b16 a[26:27], v62 offset:9216
v_cvt_pk_bf16_f32 v104, v104, v105
v_cvt_pk_bf16_f32 v105, v106, v107
v_cvt_pk_bf16_f32 v106, v108, v109
v_cvt_pk_bf16_f32 v107, v110, v111
v_mfma_f32_16x16x32_bf16 v[88:91], a[56:59], a[172:175], v[88:91]
buffer_store_dwordx4 v[104:107], v1, s[12:15], s76 offen offset:1024 sc1
ds_read_b64_tr_b16 a[12:13], v63 offset:0
ds_read_b64_tr_b16 a[14:15], v63 offset:8192
v_mfma_f32_16x16x32_bf16 v[88:91], a[40:43], a[164:167], v[88:91]
v_cvt_pk_bf16_f32 v112, v112, v113
v_cvt_pk_bf16_f32 v113, v114, v115
v_cvt_pk_bf16_f32 v114, v116, v117
v_cvt_pk_bf16_f32 v115, v118, v119
buffer_store_dwordx4 v[112:115], v1, s[12:15], s76 offen offset:2048 sc1
ds_read_b64_tr_b16 a[28:29], v63 offset:1024
v_mfma_f32_16x16x32_bf16 v[76:79], a[44:47], a[160:163], v[76:79]
v_cvt_pk_bf16_f32 v120, v120, v121
v_cvt_pk_bf16_f32 v121, v122, v123
v_cvt_pk_bf16_f32 v122, v124, v125
v_cvt_pk_bf16_f32 v123, v126, v127
buffer_store_dwordx4 v[120:123], v1, s[12:15], s76 offen offset:3072 sc1
ds_read_b64_tr_b16 a[30:31], v63 offset:9216
v_mfma_f32_16x16x32_bf16 v[76:79], a[60:63], a[168:171], v[76:79]
v_mfma_f32_16x16x32_bf16 v[92:95], a[60:63], a[172:175], v[92:95]
v_mfma_f32_16x16x32_bf16 v[92:95], a[44:47], a[164:167], v[92:95]
s_nop 7
s_waitcnt vmcnt(32) lgkmcnt(0)
v_mfma_f32_16x16x32_bf16 v[128:131], a[0:3], a[176:179], 0
ds_read_b64_tr_b16 a[32:33], v60 offset:2048
ds_read_b64_tr_b16 a[34:35], v60 offset:10240
v_mfma_f32_16x16x32_bf16 v[128:131], a[16:19], a[184:187], v[128:131]
ds_read_b64_tr_b16 a[48:49], v60 offset:3072
v_mfma_f32_16x16x32_bf16 v[144:147], a[0:3], a[180:183], 0
ds_read_b64_tr_b16 a[50:51], v60 offset:11264
v_mfma_f32_16x16x32_bf16 v[144:147], a[16:19], a[188:191], v[144:147]
ds_read_b64_tr_b16 a[36:37], v61 offset:2048
ds_read_b64_tr_b16 a[38:39], v61 offset:10240
v_mfma_f32_16x16x32_bf16 v[132:135], a[4:7], a[176:179], 0
ds_read_b64_tr_b16 a[52:53], v61 offset:3072
v_mfma_f32_16x16x32_bf16 v[132:135], a[20:23], a[184:187], v[132:135]
ds_read_b64_tr_b16 a[54:55], v61 offset:11264
v_mfma_f32_16x16x32_bf16 v[148:151], a[4:7], a[180:183], 0
ds_read_b64_tr_b16 a[40:41], v62 offset:2048
ds_read_b64_tr_b16 a[42:43], v62 offset:10240
v_mfma_f32_16x16x32_bf16 v[148:151], a[20:23], a[188:191], v[148:151]
ds_read_b64_tr_b16 a[56:57], v62 offset:3072
v_mfma_f32_16x16x32_bf16 v[136:139], a[8:11], a[176:179], 0
ds_read_b64_tr_b16 a[58:59], v62 offset:11264
v_mfma_f32_16x16x32_bf16 v[136:139], a[24:27], a[184:187], v[136:139]
ds_read_b64_tr_b16 a[44:45], v63 offset:2048
ds_read_b64_tr_b16 a[46:47], v63 offset:10240
v_mfma_f32_16x16x32_bf16 v[152:155], a[8:11], a[180:183], 0
ds_read_b64_tr_b16 a[60:61], v63 offset:3072
v_mfma_f32_16x16x32_bf16 v[152:155], a[24:27], a[188:191], v[152:155]
ds_read_b64_tr_b16 a[62:63], v63 offset:11264
v_mfma_f32_16x16x32_bf16 v[140:143], a[12:15], a[176:179], 0
v_mfma_f32_16x16x32_bf16 v[140:143], a[28:31], a[184:187], v[140:143]
v_mfma_f32_16x16x32_bf16 v[156:159], a[12:15], a[180:183], 0
v_mfma_f32_16x16x32_bf16 v[156:159], a[28:31], a[188:191], v[156:159]
s_waitcnt vmcnt(28) lgkmcnt(0)
v_mfma_f32_16x16x32_bf16 v[128:131], a[32:35], a[192:195], v[128:131]
s_barrier
v_mfma_f32_16x16x32_bf16 v[128:131], a[48:51], a[200:203], v[128:131]
ds_read_b64_tr_b16 a[0:1], v60 offset:16384
ds_read_b64_tr_b16 a[2:3], v60 offset:24576
v_mfma_f32_16x16x32_bf16 v[144:147], a[48:51], a[204:207], v[144:147]
ds_read_b64_tr_b16 a[16:17], v60 offset:17408
v_mfma_f32_16x16x32_bf16 v[144:147], a[32:35], a[196:199], v[144:147]
ds_read_b64_tr_b16 a[18:19], v60 offset:25600
v_mfma_f32_16x16x32_bf16 v[132:135], a[36:39], a[192:195], v[132:135]
ds_read_b64_tr_b16 a[4:5], v61 offset:16384
ds_read_b64_tr_b16 a[6:7], v61 offset:24576
v_mfma_f32_16x16x32_bf16 v[132:135], a[52:55], a[200:203], v[132:135]
ds_read_b64_tr_b16 a[20:21], v61 offset:17408
v_mfma_f32_16x16x32_bf16 v[148:151], a[52:55], a[204:207], v[148:151]
ds_read_b64_tr_b16 a[22:23], v61 offset:25600
v_mfma_f32_16x16x32_bf16 v[148:151], a[36:39], a[196:199], v[148:151]
ds_read_b64_tr_b16 a[8:9], v62 offset:16384
ds_read_b64_tr_b16 a[10:11], v62 offset:24576
v_mfma_f32_16x16x32_bf16 v[136:139], a[40:43], a[192:195], v[136:139]
ds_read_b64_tr_b16 a[24:25], v62 offset:17408
v_mfma_f32_16x16x32_bf16 v[136:139], a[56:59], a[200:203], v[136:139]
ds_read_b64_tr_b16 a[26:27], v62 offset:25600
v_mfma_f32_16x16x32_bf16 v[152:155], a[56:59], a[204:207], v[152:155]
ds_read_b64_tr_b16 a[12:13], v63 offset:16384
ds_read_b64_tr_b16 a[14:15], v63 offset:24576
v_mfma_f32_16x16x32_bf16 v[152:155], a[40:43], a[196:199], v[152:155]
ds_read_b64_tr_b16 a[28:29], v63 offset:17408
v_mfma_f32_16x16x32_bf16 v[140:143], a[44:47], a[192:195], v[140:143]
ds_read_b64_tr_b16 a[30:31], v63 offset:25600
v_mfma_f32_16x16x32_bf16 v[140:143], a[60:63], a[200:203], v[140:143]
v_mfma_f32_16x16x32_bf16 v[156:159], a[60:63], a[204:207], v[156:159]
v_mfma_f32_16x16x32_bf16 v[156:159], a[44:47], a[196:199], v[156:159]
s_waitcnt vmcnt(24) lgkmcnt(0)
v_mfma_f32_16x16x32_bf16 v[128:131], a[0:3], a[208:211], v[128:131]
ds_read_b64_tr_b16 a[32:33], v60 offset:18432
buffer_load_dwordx4 a[160:163], v1, s[12:15], s70 offen offset:0 sc1
v_mfma_f32_16x16x32_bf16 v[128:131], a[16:19], a[216:219], v[128:131]
ds_read_b64_tr_b16 a[34:35], v60 offset:26624
ds_read_b64_tr_b16 a[48:49], v60 offset:19456
v_mfma_f32_16x16x32_bf16 v[144:147], a[16:19], a[220:223], v[144:147]
ds_read_b64_tr_b16 a[50:51], v60 offset:27648
v_mfma_f32_16x16x32_bf16 v[144:147], a[0:3], a[212:215], v[144:147]
ds_read_b64_tr_b16 a[36:37], v61 offset:18432
buffer_load_dwordx4 a[164:167], v1, s[12:15], s70 offen offset:1024 sc1
v_mfma_f32_16x16x32_bf16 v[132:135], a[4:7], a[208:211], v[132:135]
ds_read_b64_tr_b16 a[38:39], v61 offset:26624
ds_read_b64_tr_b16 a[52:53], v61 offset:19456
v_mfma_f32_16x16x32_bf16 v[132:135], a[20:23], a[216:219], v[132:135]
ds_read_b64_tr_b16 a[54:55], v61 offset:27648
v_mfma_f32_16x16x32_bf16 v[148:151], a[20:23], a[220:223], v[148:151]
ds_read_b64_tr_b16 a[40:41], v62 offset:18432
buffer_load_dwordx4 a[168:171], v10, s[12:15], s70 offen offset:0 sc1
v_mfma_f32_16x16x32_bf16 v[148:151], a[4:7], a[212:215], v[148:151]
PG22:
s_cbranch_execz fk_tret
ds_read_b64_tr_b16 a[42:43], v62 offset:26624
ds_read_b64_tr_b16 a[56:57], v62 offset:19456
v_mfma_f32_16x16x32_bf16 v[136:139], a[8:11], a[208:211], v[136:139]
ds_read_b64_tr_b16 a[58:59], v62 offset:27648
v_mfma_f32_16x16x32_bf16 v[136:139], a[24:27], a[216:219], v[136:139]
ds_read_b64_tr_b16 a[44:45], v63 offset:18432
buffer_load_dwordx4 a[172:175], v10, s[12:15], s70 offen offset:1024 sc1
s_add_u32 s70, s70, 0x8000
v_mfma_f32_16x16x32_bf16 v[152:155], a[24:27], a[220:223], v[152:155]
ds_read_b64_tr_b16 a[46:47], v63 offset:26624
ds_read_b64_tr_b16 a[60:61], v63 offset:19456
v_mfma_f32_16x16x32_bf16 v[152:155], a[8:11], a[212:215], v[152:155]
ds_read_b64_tr_b16 a[62:63], v63 offset:27648
v_mfma_f32_16x16x32_bf16 v[140:143], a[12:15], a[208:211], v[140:143]
v_mfma_f32_16x16x32_bf16 v[140:143], a[28:31], a[216:219], v[140:143]
v_mfma_f32_16x16x32_bf16 v[156:159], a[28:31], a[220:223], v[156:159]
v_mfma_f32_16x16x32_bf16 v[156:159], a[12:15], a[212:215], v[156:159]
s_waitcnt vmcnt(24) lgkmcnt(0)
v_mfma_f32_16x16x32_bf16 v[128:131], a[32:35], a[224:227], v[128:131]
s_barrier
v_mfma_f32_16x16x32_bf16 v[128:131], a[48:51], a[232:235], v[128:131]
ds_read_b64_tr_b16 a[0:1], v6 offset:0
buffer_load_dwordx4 a[176:179], v1, s[12:15], s70 offen offset:0 sc1
v_mfma_f32_16x16x32_bf16 v[144:147], a[48:51], a[236:239], v[144:147]
ds_read_b64_tr_b16 a[2:3], v6 offset:8192
ds_read_b64_tr_b16 a[16:17], v6 offset:1024
v_mfma_f32_16x16x32_bf16 v[144:147], a[32:35], a[228:231], v[144:147]
ds_read_b64_tr_b16 a[18:19], v6 offset:9216
v_mfma_f32_16x16x32_bf16 v[132:135], a[36:39], a[224:227], v[132:135]
ds_read_b64_tr_b16 a[4:5], v7 offset:0
buffer_load_dwordx4 a[180:183], v1, s[12:15], s70 offen offset:1024 sc1
v_mfma_f32_16x16x32_bf16 v[132:135], a[52:55], a[232:235], v[132:135]
ds_read_b64_tr_b16 a[6:7], v7 offset:8192
ds_read_b64_tr_b16 a[20:21], v7 offset:1024
v_mfma_f32_16x16x32_bf16 v[148:151], a[52:55], a[236:239], v[148:151]
ds_read_b64_tr_b16 a[22:23], v7 offset:9216
v_mfma_f32_16x16x32_bf16 v[148:151], a[36:39], a[228:231], v[148:151]
ds_read_b64_tr_b16 a[8:9], v8 offset:0
buffer_load_dwordx4 a[184:187], v10, s[12:15], s70 offen offset:0 sc1
v_mfma_f32_16x16x32_bf16 v[136:139], a[40:43], a[224:227], v[136:139]
ds_read_b64_tr_b16 a[10:11], v8 offset:8192
ds_read_b64_tr_b16 a[24:25], v8 offset:1024
v_mfma_f32_16x16x32_bf16 v[136:139], a[56:59], a[232:235], v[136:139]
ds_read_b64_tr_b16 a[26:27], v8 offset:9216
v_mfma_f32_16x16x32_bf16 v[152:155], a[56:59], a[236:239], v[152:155]
ds_read_b64_tr_b16 a[12:13], v9 offset:0
buffer_load_dwordx4 a[188:191], v10, s[12:15], s70 offen offset:1024 sc1
s_add_u32 s70, s70, 0x8000
v_mfma_f32_16x16x32_bf16 v[152:155], a[40:43], a[228:231], v[152:155]
ds_read_b64_tr_b16 a[14:15], v9 offset:8192
ds_read_b64_tr_b16 a[28:29], v9 offset:1024
v_mfma_f32_16x16x32_bf16 v[140:143], a[44:47], a[224:227], v[140:143]
ds_read_b64_tr_b16 a[30:31], v9 offset:9216
v_mfma_f32_16x16x32_bf16 v[140:143], a[60:63], a[232:235], v[140:143]
v_mfma_f32_16x16x32_bf16 v[156:159], a[60:63], a[236:239], v[156:159]
v_mfma_f32_16x16x32_bf16 v[156:159], a[44:47], a[228:231], v[156:159]
s_waitcnt vmcnt(24) lgkmcnt(0)
s_waitcnt vmcnt(8)
buffer_store_dword v26, v25, s[12:15], s80 offen sc1
v_mfma_f32_16x16x32_bf16 v[128:131], a[0:3], a[240:243], v[128:131]
ds_read_b64_tr_b16 a[32:33], v6 offset:2048
buffer_load_dwordx4 a[192:195], v1, s[12:15], s70 offen offset:0 sc1
v_mfma_f32_16x16x32_bf16 v[128:131], a[16:19], a[248:251], v[128:131]
ds_read_b64_tr_b16 a[34:35], v6 offset:10240
ds_read_b64_tr_b16 a[48:49], v6 offset:3072
v_mfma_f32_16x16x32_bf16 v[144:147], a[16:19], a[252:255], v[144:147]
ds_read_b64_tr_b16 a[50:51], v6 offset:11264
v_mfma_f32_16x16x32_bf16 v[144:147], a[0:3], a[244:247], v[144:147]
ds_read_b64_tr_b16 a[36:37], v7 offset:2048
buffer_load_dwordx4 a[196:199], v1, s[12:15], s70 offen offset:1024 sc1
v_mfma_f32_16x16x32_bf16 v[132:135], a[4:7], a[240:243], v[132:135]
ds_read_b64_tr_b16 a[38:39], v7 offset:10240
ds_read_b64_tr_b16 a[52:53], v7 offset:3072
v_mfma_f32_16x16x32_bf16 v[132:135], a[20:23], a[248:251], v[132:135]
ds_read_b64_tr_b16 a[54:55], v7 offset:11264
v_mfma_f32_16x16x32_bf16 v[148:151], a[20:23], a[252:255], v[148:151]
ds_read_b64_tr_b16 a[40:41], v8 offset:2048
buffer_load_dwordx4 a[200:203], v10, s[12:15], s70 offen offset:0 sc1
v_mfma_f32_16x16x32_bf16 v[148:151], a[4:7], a[244:247], v[148:151]
ds_read_b64_tr_b16 a[42:43], v8 offset:10240
ds_read_b64_tr_b16 a[56:57], v8 offset:3072
v_mfma_f32_16x16x32_bf16 v[136:139], a[8:11], a[240:243], v[136:139]
ds_read_b64_tr_b16 a[58:59], v8 offset:11264
v_mfma_f32_16x16x32_bf16 v[136:139], a[24:27], a[248:251], v[136:139]
ds_read_b64_tr_b16 a[44:45], v9 offset:2048
buffer_load_dwordx4 a[204:207], v10, s[12:15], s70 offen offset:1024 sc1
s_add_u32 s70, s70, 0x8000
v_mfma_f32_16x16x32_bf16 v[152:155], a[24:27], a[252:255], v[152:155]
ds_read_b64_tr_b16 a[46:47], v9 offset:10240
ds_read_b64_tr_b16 a[60:61], v9 offset:3072
v_mfma_f32_16x16x32_bf16 v[152:155], a[8:11], a[244:247], v[152:155]
ds_read_b64_tr_b16 a[62:63], v9 offset:11264
v_mfma_f32_16x16x32_bf16 v[140:143], a[12:15], a[240:243], v[140:143]
v_mfma_f32_16x16x32_bf16 v[140:143], a[28:31], a[248:251], v[140:143]
v_mfma_f32_16x16x32_bf16 v[156:159], a[28:31], a[252:255], v[156:159]
v_mfma_f32_16x16x32_bf16 v[156:159], a[12:15], a[244:247], v[156:159]
s_waitcnt lgkmcnt(0)
v_mfma_f32_16x16x32_bf16 v[128:131], a[32:35], a[128:131], v[128:131]
s_barrier
v_mfma_f32_16x16x32_bf16 v[128:131], a[48:51], a[136:139], v[128:131]
ds_read_b64_tr_b16 a[0:1], v6 offset:16384
buffer_load_dwordx4 a[208:211], v1, s[12:15], s70 offen offset:0 sc1
v_mfma_f32_16x16x32_bf16 v[144:147], a[48:51], a[140:143], v[144:147]
ds_read_b64_tr_b16 a[2:3], v6 offset:24576
ds_read_b64_tr_b16 a[16:17], v6 offset:17408
v_mfma_f32_16x16x32_bf16 v[144:147], a[32:35], a[132:135], v[144:147]
ds_read_b64_tr_b16 a[18:19], v6 offset:25600
v_mfma_f32_16x16x32_bf16 v[132:135], a[36:39], a[128:131], v[132:135]
ds_read_b64_tr_b16 a[4:5], v7 offset:16384
buffer_load_dwordx4 a[212:215], v1, s[12:15], s70 offen offset:1024 sc1
v_mfma_f32_16x16x32_bf16 v[132:135], a[52:55], a[136:139], v[132:135]
ds_read_b64_tr_b16 a[6:7], v7 offset:24576
ds_read_b64_tr_b16 a[20:21], v7 offset:17408
v_mfma_f32_16x16x32_bf16 v[148:151], a[52:55], a[140:143], v[148:151]
ds_read_b64_tr_b16 a[22:23], v7 offset:25600
v_mfma_f32_16x16x32_bf16 v[148:151], a[36:39], a[132:135], v[148:151]
ds_read_b64_tr_b16 a[8:9], v8 offset:16384
buffer_load_dwordx4 a[216:219], v10, s[12:15], s70 offen offset:0 sc1
v_mfma_f32_16x16x32_bf16 v[136:139], a[40:43], a[128:131], v[136:139]
ds_read_b64_tr_b16 a[10:11], v8 offset:24576
ds_read_b64_tr_b16 a[24:25], v8 offset:17408
v_mfma_f32_16x16x32_bf16 v[136:139], a[56:59], a[136:139], v[136:139]
ds_read_b64_tr_b16 a[26:27], v8 offset:25600
v_mfma_f32_16x16x32_bf16 v[152:155], a[56:59], a[140:143], v[152:155]
ds_read_b64_tr_b16 a[12:13], v9 offset:16384
buffer_load_dwordx4 a[220:223], v10, s[12:15], s70 offen offset:1024 sc1
s_add_u32 s70, s70, 0x8000
v_mfma_f32_16x16x32_bf16 v[152:155], a[40:43], a[132:135], v[152:155]
ds_read_b64_tr_b16 a[14:15], v9 offset:24576
ds_read_b64_tr_b16 a[28:29], v9 offset:17408
v_mfma_f32_16x16x32_bf16 v[140:143], a[44:47], a[128:131], v[140:143]
ds_read_b64_tr_b16 a[30:31], v9 offset:25600
v_mfma_f32_16x16x32_bf16 v[140:143], a[60:63], a[136:139], v[140:143]
v_mfma_f32_16x16x32_bf16 v[156:159], a[60:63], a[140:143], v[156:159]
v_mfma_f32_16x16x32_bf16 v[156:159], a[44:47], a[132:135], v[156:159]
s_waitcnt lgkmcnt(0)
v_mfma_f32_16x16x32_bf16 v[128:131], a[0:3], a[144:147], v[128:131]
s_add_u32 m0, s42, 49152
ds_read_b64_tr_b16 a[32:33], v6 offset:18432
buffer_load_dwordx4 v2, s[24:27], s72 offen offset:0 lds
v_mfma_f32_16x16x32_bf16 v[128:131], a[16:19], a[152:155], v[128:131]
ds_read_b64_tr_b16 a[34:35], v6 offset:26624
ds_read_b64_tr_b16 a[48:49], v6 offset:19456
v_mfma_f32_16x16x32_bf16 v[144:147], a[16:19], a[156:159], v[144:147]
ds_read_b64_tr_b16 a[50:51], v6 offset:27648
v_mfma_f32_16x16x32_bf16 v[144:147], a[0:3], a[148:151], v[144:147]
ds_read_b64_tr_b16 a[36:37], v7 offset:18432
buffer_load_dwordx4 v3, s[24:27], s72 offen offset:1024 lds
v_mfma_f32_16x16x32_bf16 v[132:135], a[4:7], a[144:147], v[132:135]
ds_read_b64_tr_b16 a[38:39], v7 offset:26624
ds_read_b64_tr_b16 a[52:53], v7 offset:19456
v_mfma_f32_16x16x32_bf16 v[132:135], a[20:23], a[152:155], v[132:135]
ds_read_b64_tr_b16 a[54:55], v7 offset:27648
v_mfma_f32_16x16x32_bf16 v[148:151], a[20:23], a[156:159], v[148:151]
ds_read_b64_tr_b16 a[40:41], v8 offset:18432
buffer_load_dwordx4 v4, s[24:27], s72 offen offset:2048 lds
v_mfma_f32_16x16x32_bf16 v[148:151], a[4:7], a[148:151], v[148:151]
ds_read_b64_tr_b16 a[42:43], v8 offset:26624
ds_read_b64_tr_b16 a[56:57], v8 offset:19456
v_mfma_f32_16x16x32_bf16 v[136:139], a[8:11], a[144:147], v[136:139]
ds_read_b64_tr_b16 a[58:59], v8 offset:27648
v_mfma_f32_16x16x32_bf16 v[136:139], a[24:27], a[152:155], v[136:139]
ds_read_b64_tr_b16 a[44:45], v9 offset:18432
buffer_load_dwordx4 v5, s[24:27], s72 offen offset:3072 lds
s_add_u32 s72, s72, 262144
v_mfma_f32_16x16x32_bf16 v[152:155], a[24:27], a[156:159], v[152:155]
ds_read_b64_tr_b16 a[46:47], v9 offset:26624
ds_read_b64_tr_b16 a[60:61], v9 offset:19456
v_mfma_f32_16x16x32_bf16 v[152:155], a[8:11], a[148:151], v[152:155]
ds_read_b64_tr_b16 a[62:63], v9 offset:27648
v_mfma_f32_16x16x32_bf16 v[140:143], a[12:15], a[144:147], v[140:143]
v_mfma_f32_16x16x32_bf16 v[140:143], a[28:31], a[152:155], v[140:143]
v_mfma_f32_16x16x32_bf16 v[156:159], a[28:31], a[156:159], v[156:159]
v_mfma_f32_16x16x32_bf16 v[156:159], a[12:15], a[148:151], v[156:159]
s_waitcnt vmcnt(17) lgkmcnt(0)
v_mfma_f32_16x16x32_bf16 v[128:131], a[32:35], a[160:163], v[128:131]
s_barrier
v_mfma_f32_16x16x32_bf16 v[128:131], a[48:51], a[168:171], v[128:131]
ds_read_b64_tr_b16 a[0:1], v6 offset:32768
buffer_load_dwordx4 a[224:227], v1, s[12:15], s70 offen offset:0 sc1
v_mfma_f32_16x16x32_bf16 v[144:147], a[48:51], a[172:175], v[144:147]
ds_read_b64_tr_b16 a[2:3], v6 offset:40960
ds_read_b64_tr_b16 a[16:17], v6 offset:33792
v_mfma_f32_16x16x32_bf16 v[144:147], a[32:35], a[164:167], v[144:147]
buffer_load_dwordx4 a[228:231], v1, s[12:15], s70 offen offset:1024 sc1
ds_read_b64_tr_b16 a[18:19], v6 offset:41984
v_mfma_f32_16x16x32_bf16 v[132:135], a[36:39], a[160:163], v[132:135]
ds_read_b64_tr_b16 a[4:5], v7 offset:32768
buffer_load_dwordx4 a[232:235], v10, s[12:15], s70 offen offset:0 sc1
v_mfma_f32_16x16x32_bf16 v[132:135], a[52:55], a[168:171], v[132:135]
ds_read_b64_tr_b16 a[6:7], v7 offset:40960
ds_read_b64_tr_b16 a[20:21], v7 offset:33792
v_mfma_f32_16x16x32_bf16 v[148:151], a[52:55], a[172:175], v[148:151]
buffer_load_dwordx4 a[236:239], v10, s[12:15], s70 offen offset:1024 sc1
s_add_u32 s70, s70, 0x8000
ds_read_b64_tr_b16 a[22:23], v7 offset:41984
v_mfma_f32_16x16x32_bf16 v[148:151], a[36:39], a[164:167], v[148:151]
ds_read_b64_tr_b16 a[8:9], v8 offset:32768
buffer_load_dwordx4 a[240:243], v1, s[12:15], s70 offen offset:0 sc1
v_mfma_f32_16x16x32_bf16 v[136:139], a[40:43], a[160:163], v[136:139]
ds_read_b64_tr_b16 a[10:11], v8 offset:40960
ds_read_b64_tr_b16 a[24:25], v8 offset:33792
v_mfma_f32_16x16x32_bf16 v[136:139], a[56:59], a[168:171], v[136:139]
buffer_load_dwordx4 a[244:247], v1, s[12:15], s70 offen offset:1024 sc1
ds_read_b64_tr_b16 a[26:27], v8 offset:41984
v_mfma_f32_16x16x32_bf16 v[152:155], a[56:59], a[172:175], v[152:155]
ds_read_b64_tr_b16 a[12:13], v9 offset:32768
buffer_load_dwordx4 a[248:251], v10, s[12:15], s70 offen offset:0 sc1
v_mfma_f32_16x16x32_bf16 v[152:155], a[40:43], a[164:167], v[152:155]
ds_read_b64_tr_b16 a[14:15], v9 offset:40960
ds_read_b64_tr_b16 a[28:29], v9 offset:33792
v_mfma_f32_16x16x32_bf16 v[140:143], a[44:47], a[160:163], v[140:143]
buffer_load_dwordx4 a[252:255], v10, s[12:15], s70 offen offset:1024 sc1
s_add_u32 s70, s70, 0x8000
ds_read_b64_tr_b16 a[30:31], v9 offset:41984
v_mfma_f32_16x16x32_bf16 v[140:143], a[60:63], a[168:171], v[140:143]
v_mfma_f32_16x16x32_bf16 v[156:159], a[60:63], a[172:175], v[156:159]
v_mfma_f32_16x16x32_bf16 v[156:159], a[44:47], a[164:167], v[156:159]
s_waitcnt vmcnt(21) lgkmcnt(0)
v_mfma_f32_16x16x32_bf16 v[128:131], a[0:3], a[176:179], v[128:131]
s_add_u32 m0, s42, 65536
ds_read_b64_tr_b16 a[32:33], v6 offset:34816
buffer_load_dwordx4 v2, s[24:27], s72 offen offset:0 lds
ds_read_b64_tr_b16 a[34:35], v6 offset:43008
v_mfma_f32_16x16x32_bf16 v[128:131], a[16:19], a[184:187], v[128:131]
buffer_load_dwordx4 v3, s[24:27], s72 offen offset:1024 lds
ds_read_b64_tr_b16 a[48:49], v6 offset:35840
v_mfma_f32_16x16x32_bf16 v[144:147], a[16:19], a[188:191], v[144:147]
buffer_load_dwordx4 v4, s[24:27], s72 offen offset:2048 lds
ds_read_b64_tr_b16 a[50:51], v6 offset:44032
buffer_load_dwordx4 v5, s[24:27], s72 offen offset:3072 lds
s_add_u32 s72, s72, 262144
v_mfma_f32_16x16x32_bf16 v[144:147], a[0:3], a[180:183], v[144:147]
ds_read_b64_tr_b16 a[36:37], v7 offset:34816
s_mov_b32 s90, 0xffff0000
v_mfma_f32_16x16x32_bf16 v[132:135], a[4:7], a[176:179], v[132:135]
ds_read_b64_tr_b16 a[38:39], v7 offset:43008
s_mov_b32 s91, 0xbfb8aa3b
ds_read_b64_tr_b16 a[52:53], v7 offset:35840
v_mfma_f32_16x16x32_bf16 v[132:135], a[20:23], a[184:187], v[132:135]
v_permlane16_swap_b32 v32, v34
v_mfma_f32_16x16x32_bf16 v[148:151], a[20:23], a[188:191], v[148:151]
ds_read_b64_tr_b16 a[54:55], v7 offset:44032
ds_read_b64_tr_b16 a[40:41], v8 offset:34816
v_permlane16_swap_b32 v33, v35
v_mfma_f32_16x16x32_bf16 v[148:151], a[4:7], a[180:183], v[148:151]
ds_read_b64_tr_b16 a[42:43], v8 offset:43008
v_permlane16_swap_b32 v36, v38
v_mfma_f32_16x16x32_bf16 v[136:139], a[8:11], a[176:179], v[136:139]
ds_read_b64_tr_b16 a[56:57], v8 offset:35840
v_permlane16_swap_b32 v37, v39
v_permlane16_swap_b32 v40, v42
v_mfma_f32_16x16x32_bf16 v[136:139], a[24:27], a[184:187], v[136:139]
ds_read_b64_tr_b16 a[58:59], v8 offset:44032
ds_read_b64_tr_b16 a[44:45], v9 offset:34816
v_permlane16_swap_b32 v41, v43
v_mfma_f32_16x16x32_bf16 v[152:155], a[24:27], a[188:191], v[152:155]
ds_read_b64_tr_b16 a[46:47], v9 offset:43008
v_permlane16_swap_b32 v44, v46
v_mfma_f32_16x16x32_bf16 v[152:155], a[8:11], a[180:183], v[152:155]
ds_read_b64_tr_b16 a[60:61], v9 offset:35840
v_permlane16_swap_b32 v45, v47
v_mfma_f32_16x16x32_bf16 v[140:143], a[12:15], a[176:179], v[140:143]
ds_read_b64_tr_b16 a[62:63], v9 offset:44032
v_mfma_f32_16x16x32_bf16 v[140:143], a[28:31], a[184:187], v[140:143]
v_mfma_f32_16x16x32_bf16 v[156:159], a[28:31], a[188:191], v[156:159]
v_mfma_f32_16x16x32_bf16 v[156:159], a[12:15], a[180:183], v[156:159]
s_waitcnt vmcnt(20) lgkmcnt(0)
v_mfma_f32_16x16x32_bf16 v[128:131], a[32:35], a[192:195], v[128:131]
s_barrier
v_mfma_f32_16x16x32_bf16 v[128:131], a[48:51], a[200:203], v[128:131]
ds_read_b64_tr_b16 a[0:1], v56 offset:49152
buffer_load_dwordx4 a[128:131], v1, s[12:15], s70 offen offset:0 sc1
ds_read_b64_tr_b16 a[2:3], v56 offset:57344
v_mfma_f32_16x16x32_bf16 v[144:147], a[48:51], a[204:207], v[144:147]
buffer_load_dwordx4 a[132:135], v1, s[12:15], s70 offen offset:1024 sc1
ds_read_b64_tr_b16 a[16:17], v56 offset:50176
v_mfma_f32_16x16x32_bf16 v[144:147], a[32:35], a[196:199], v[144:147]
buffer_load_dwordx4 a[136:139], v10, s[12:15], s70 offen offset:0 sc1
ds_read_b64_tr_b16 a[18:19], v56 offset:58368
buffer_load_dwordx4 a[140:143], v10, s[12:15], s70 offen offset:1024 sc1
s_add_u32 s70, s70, 0x8000
v_mfma_f32_16x16x32_bf16 v[132:135], a[36:39], a[192:195], v[132:135]
ds_read_b64_tr_b16 a[4:5], v57 offset:49152
v_permlane16_swap_b32 v48, v50
v_mfma_f32_16x16x32_bf16 v[132:135], a[52:55], a[200:203], v[132:135]
ds_read_b64_tr_b16 a[6:7], v57 offset:57344
v_permlane16_swap_b32 v49, v51
v_mfma_f32_16x16x32_bf16 v[148:151], a[52:55], a[204:207], v[148:151]
ds_read_b64_tr_b16 a[20:21], v57 offset:50176
v_permlane16_swap_b32 v52, v54
v_mfma_f32_16x16x32_bf16 v[148:151], a[36:39], a[196:199], v[148:151]
ds_read_b64_tr_b16 a[22:23], v57 offset:58368
ds_read_b64_tr_b16 a[8:9], v58 offset:49152
v_permlane16_swap_b32 v53, v55
v_mfma_f32_16x16x32_bf16 v[136:139], a[40:43], a[192:195], v[136:139]
ds_read_b64_tr_b16 a[10:11], v58 offset:57344
v_lshlrev_b32 v192, 16, v48
v_mfma_f32_16x16x32_bf16 v[136:139], a[56:59], a[200:203], v[136:139]
ds_read_b64_tr_b16 a[24:25], v58 offset:50176
v_and_b32 v193, s90, v48
v_lshlrev_b32 v194, 16, v49
v_mfma_f32_16x16x32_bf16 v[152:155], a[56:59], a[204:207], v[152:155]
ds_read_b64_tr_b16 a[26:27], v58 offset:58368
ds_read_b64_tr_b16 a[12:13], v59 offset:49152
v_and_b32 v195, s90, v49
v_mfma_f32_16x16x32_bf16 v[152:155], a[40:43], a[196:199], v[152:155]
ds_read_b64_tr_b16 a[14:15], v59 offset:57344
v_lshlrev_b32 v196, 16, v50
v_mfma_f32_16x16x32_bf16 v[140:143], a[44:47], a[192:195], v[140:143]
ds_read_b64_tr_b16 a[28:29], v59 offset:50176
v_and_b32 v197, s90, v50
v_mfma_f32_16x16x32_bf16 v[140:143], a[60:63], a[200:203], v[140:143]
ds_read_b64_tr_b16 a[30:31], v59 offset:58368
v_mfma_f32_16x16x32_bf16 v[156:159], a[60:63], a[204:207], v[156:159]
v_mfma_f32_16x16x32_bf16 v[156:159], a[44:47], a[196:199], v[156:159]
s_waitcnt vmcnt(20) lgkmcnt(0)
v_mfma_f32_16x16x32_bf16 v[128:131], a[0:3], a[208:211], v[128:131]
ds_read_b64_tr_b16 a[32:33], v56 offset:51200
buffer_load_dwordx4 a[144:147], v1, s[12:15], s70 offen offset:0 sc1
ds_read_b64_tr_b16 a[34:35], v56 offset:59392
v_mfma_f32_16x16x32_bf16 v[128:131], a[16:19], a[216:219], v[128:131]
buffer_load_dwordx4 a[148:151], v1, s[12:15], s70 offen offset:1024 sc1
ds_read_b64_tr_b16 a[48:49], v56 offset:52224
buffer_load_dwordx4 a[152:155], v10, s[12:15], s70 offen offset:0 sc1
v_mfma_f32_16x16x32_bf16 v[144:147], a[16:19], a[220:223], v[144:147]
ds_read_b64_tr_b16 a[50:51], v56 offset:60416
buffer_load_dwordx4 a[156:159], v10, s[12:15], s70 offen offset:1024 sc1
s_add_u32 s70, s70, 0x8000
v_mfma_f32_16x16x32_bf16 v[144:147], a[0:3], a[212:215], v[144:147]
ds_read_b64_tr_b16 a[36:37], v57 offset:51200
buffer_load_dword v0, v25, s[12:15], s81 offen sc1
ds_read_b64_tr_b16 a[38:39], v57 offset:59392
v_mfma_f32_16x16x32_bf16 v[132:135], a[4:7], a[208:211], v[132:135]
v_lshlrev_b32 v198, 16, v51
v_mfma_f32_16x16x32_bf16 v[132:135], a[20:23], a[216:219], v[132:135]
ds_read_b64_tr_b16 a[52:53], v57 offset:52224
v_and_b32 v199, s90, v51
v_lshlrev_b32 v200, 16, v52
v_mfma_f32_16x16x32_bf16 v[148:151], a[20:23], a[220:223], v[148:151]
ds_read_b64_tr_b16 a[54:55], v57 offset:60416
ds_read_b64_tr_b16 a[40:41], v58 offset:51200
v_and_b32 v201, s90, v52
v_mfma_f32_16x16x32_bf16 v[148:151], a[4:7], a[212:215], v[148:151]
ds_read_b64_tr_b16 a[42:43], v58 offset:59392
v_lshlrev_b32 v202, 16, v53
v_mfma_f32_16x16x32_bf16 v[136:139], a[8:11], a[208:211], v[136:139]
ds_read_b64_tr_b16 a[56:57], v58 offset:52224
v_and_b32 v203, s90, v53
v_lshlrev_b32 v204, 16, v54
v_mfma_f32_16x16x32_bf16 v[136:139], a[24:27], a[216:219], v[136:139]
ds_read_b64_tr_b16 a[58:59], v58 offset:60416
ds_read_b64_tr_b16 a[44:45], v59 offset:51200
v_and_b32 v205, s90, v54
v_mfma_f32_16x16x32_bf16 v[152:155], a[24:27], a[220:223], v[152:155]
ds_read_b64_tr_b16 a[46:47], v59 offset:59392
v_lshlrev_b32 v206, 16, v55
v_mfma_f32_16x16x32_bf16 v[152:155], a[8:11], a[212:215], v[152:155]
ds_read_b64_tr_b16 a[60:61], v59 offset:52224
v_and_b32 v207, s90, v55
v_mfma_f32_16x16x32_bf16 v[140:143], a[12:15], a[208:211], v[140:143]
ds_read_b64_tr_b16 a[62:63], v59 offset:60416
v_mfma_f32_16x16x32_bf16 v[140:143], a[28:31], a[216:219], v[140:143]
v_mfma_f32_16x16x32_bf16 v[156:159], a[28:31], a[220:223], v[156:159]
v_mfma_f32_16x16x32_bf16 v[156:159], a[12:15], a[212:215], v[156:159]
s_waitcnt vmcnt(17) lgkmcnt(0)
v_mfma_f32_16x16x32_bf16 v[128:131], a[32:35], a[224:227], v[128:131]
s_barrier
v_mfma_f32_16x16x32_bf16 v[128:131], a[48:51], a[232:235], v[128:131]
ds_read_b64_tr_b16 a[0:1], v6 offset:49152
buffer_load_dwordx4 a[160:163], v1, s[12:15], s70 offen offset:0 sc1
ds_read_b64_tr_b16 a[2:3], v6 offset:57344
v_mfma_f32_16x16x32_bf16 v[144:147], a[48:51], a[236:239], v[144:147]
buffer_load_dwordx4 a[164:167], v1, s[12:15], s70 offen offset:1024 sc1
ds_read_b64_tr_b16 a[16:17], v6 offset:50176
v_mfma_f32_16x16x32_bf16 v[144:147], a[32:35], a[228:231], v[144:147]
buffer_load_dwordx4 a[168:171], v10, s[12:15], s70 offen offset:0 sc1
ds_read_b64_tr_b16 a[18:19], v6 offset:58368
buffer_load_dwordx4 a[172:175], v10, s[12:15], s70 offen offset:1024 sc1
s_add_u32 s70, s70, 0x8000
v_mfma_f32_16x16x32_bf16 v[132:135], a[36:39], a[224:227], v[132:135]
ds_read_b64_tr_b16 a[4:5], v7 offset:49152
v_add_f32 v64, v64, v192
v_mfma_f32_16x16x32_bf16 v[132:135], a[52:55], a[232:235], v[132:135]
ds_read_b64_tr_b16 a[6:7], v7 offset:57344
v_add_f32 v65, v65, v193
v_mfma_f32_16x16x32_bf16 v[148:151], a[52:55], a[236:239], v[148:151]
ds_read_b64_tr_b16 a[20:21], v7 offset:50176
v_add_f32 v66, v66, v194
v_mfma_f32_16x16x32_bf16 v[148:151], a[36:39], a[228:231], v[148:151]
ds_read_b64_tr_b16 a[22:23], v7 offset:58368
ds_read_b64_tr_b16 a[8:9], v8 offset:49152
v_add_f32 v67, v67, v195
v_mfma_f32_16x16x32_bf16 v[136:139], a[40:43], a[224:227], v[136:139]
ds_read_b64_tr_b16 a[10:11], v8 offset:57344
v_add_f32 v68, v68, v196
v_mfma_f32_16x16x32_bf16 v[136:139], a[56:59], a[232:235], v[136:139]
ds_read_b64_tr_b16 a[24:25], v8 offset:50176
v_add_f32 v69, v69, v197
v_add_f32 v70, v70, v198
v_mfma_f32_16x16x32_bf16 v[152:155], a[56:59], a[236:239], v[152:155]
ds_read_b64_tr_b16 a[26:27], v8 offset:58368
ds_read_b64_tr_b16 a[12:13], v9 offset:49152
v_add_f32 v71, v71, v199
v_mfma_f32_16x16x32_bf16 v[152:155], a[40:43], a[228:231], v[152:155]
ds_read_b64_tr_b16 a[14:15], v9 offset:57344
v_add_f32 v72, v72, v200
v_mfma_f32_16x16x32_bf16 v[140:143], a[44:47], a[224:227], v[140:143]
ds_read_b64_tr_b16 a[28:29], v9 offset:50176
v_add_f32 v73, v73, v201
v_mfma_f32_16x16x32_bf16 v[140:143], a[60:63], a[232:235], v[140:143]
ds_read_b64_tr_b16 a[30:31], v9 offset:58368
v_mfma_f32_16x16x32_bf16 v[156:159], a[60:63], a[236:239], v[156:159]
v_mfma_f32_16x16x32_bf16 v[156:159], a[44:47], a[228:231], v[156:159]
s_waitcnt vmcnt(17) lgkmcnt(0)
v_mfma_f32_16x16x32_bf16 v[128:131], a[0:3], a[240:243], v[128:131]
ds_read_b64_tr_b16 a[32:33], v6 offset:51200
v_add_f32 v74, v74, v202
v_mfma_f32_16x16x32_bf16 v[128:131], a[16:19], a[248:251], v[128:131]
ds_read_b64_tr_b16 a[34:35], v6 offset:59392
v_add_f32 v75, v75, v203
v_mfma_f32_16x16x32_bf16 v[144:147], a[16:19], a[252:255], v[144:147]
ds_read_b64_tr_b16 a[48:49], v6 offset:52224
v_add_f32 v76, v76, v204
v_add_f32 v77, v77, v205
v_mfma_f32_16x16x32_bf16 v[144:147], a[0:3], a[244:247], v[144:147]
ds_read_b64_tr_b16 a[50:51], v6 offset:60416
ds_read_b64_tr_b16 a[36:37], v7 offset:51200
v_add_f32 v78, v78, v206
v_mfma_f32_16x16x32_bf16 v[132:135], a[4:7], a[240:243], v[132:135]
ds_read_b64_tr_b16 a[38:39], v7 offset:59392
v_add_f32 v79, v79, v207
v_mfma_f32_16x16x32_bf16 v[132:135], a[20:23], a[248:251], v[132:135]
ds_read_b64_tr_b16 a[52:53], v7 offset:52224
v_add_f32 v80, v80, v192
v_mfma_f32_16x16x32_bf16 v[148:151], a[20:23], a[252:255], v[148:151]
ds_read_b64_tr_b16 a[54:55], v7 offset:60416
ds_read_b64_tr_b16 a[40:41], v8 offset:51200
v_add_f32 v81, v81, v193
v_mfma_f32_16x16x32_bf16 v[148:151], a[4:7], a[244:247], v[148:151]
ds_read_b64_tr_b16 a[42:43], v8 offset:59392
v_add_f32 v82, v82, v194
v_mfma_f32_16x16x32_bf16 v[136:139], a[8:11], a[240:243], v[136:139]
ds_read_b64_tr_b16 a[56:57], v8 offset:52224
v_add_f32 v83, v83, v195
v_add_f32 v84, v84, v196
v_mfma_f32_16x16x32_bf16 v[136:139], a[24:27], a[248:251], v[136:139]
ds_read_b64_tr_b16 a[58:59], v8 offset:60416
ds_read_b64_tr_b16 a[44:45], v9 offset:51200
v_add_f32 v85, v85, v197
v_mfma_f32_16x16x32_bf16 v[152:155], a[24:27], a[252:255], v[152:155]
ds_read_b64_tr_b16 a[46:47], v9 offset:59392
v_add_f32 v86, v86, v198
v_mfma_f32_16x16x32_bf16 v[152:155], a[8:11], a[244:247], v[152:155]
ds_read_b64_tr_b16 a[60:61], v9 offset:52224
v_add_f32 v87, v87, v199
v_mfma_f32_16x16x32_bf16 v[140:143], a[12:15], a[240:243], v[140:143]
ds_read_b64_tr_b16 a[62:63], v9 offset:60416
v_mfma_f32_16x16x32_bf16 v[140:143], a[28:31], a[248:251], v[140:143]
v_mfma_f32_16x16x32_bf16 v[156:159], a[28:31], a[252:255], v[156:159]
v_mfma_f32_16x16x32_bf16 v[156:159], a[12:15], a[244:247], v[156:159]
s_waitcnt vmcnt(9) lgkmcnt(0)
v_mfma_f32_16x16x32_bf16 v[128:131], a[32:35], a[128:131], v[128:131]
s_barrier
v_mfma_f32_16x16x32_bf16 v[128:131], a[48:51], a[136:139], v[128:131]
ds_read_b64_tr_b16 a[0:1], v56 offset:0
v_add_f32 v88, v88, v200
v_mfma_f32_16x16x32_bf16 v[144:147], a[48:51], a[140:143], v[144:147]
ds_read_b64_tr_b16 a[2:3], v56 offset:8192
v_add_f32 v89, v89, v201
v_mfma_f32_16x16x32_bf16 v[144:147], a[32:35], a[132:135], v[144:147]
ds_read_b64_tr_b16 a[16:17], v56 offset:1024
v_add_f32 v90, v90, v202
v_add_f32 v91, v91, v203
v_mfma_f32_16x16x32_bf16 v[132:135], a[36:39], a[128:131], v[132:135]
ds_read_b64_tr_b16 a[18:19], v56 offset:9216
ds_read_b64_tr_b16 a[4:5], v57 offset:0
v_add_f32 v92, v92, v204
v_mfma_f32_16x16x32_bf16 v[132:135], a[52:55], a[136:139], v[132:135]
ds_read_b64_tr_b16 a[6:7], v57 offset:8192
v_add_f32 v93, v93, v205
v_mfma_f32_16x16x32_bf16 v[148:151], a[52:55], a[140:143], v[148:151]
ds_read_b64_tr_b16 a[20:21], v57 offset:1024
v_add_f32 v94, v94, v206
v_mfma_f32_16x16x32_bf16 v[148:151], a[36:39], a[132:135], v[148:151]
ds_read_b64_tr_b16 a[22:23], v57 offset:9216
ds_read_b64_tr_b16 a[8:9], v58 offset:0
v_add_f32 v95, v95, v207
v_mfma_f32_16x16x32_bf16 v[136:139], a[40:43], a[128:131], v[136:139]
ds_read_b64_tr_b16 a[10:11], v58 offset:8192
v_lshlrev_b32 v96, 16, v32
v_mfma_f32_16x16x32_bf16 v[136:139], a[56:59], a[136:139], v[136:139]
ds_read_b64_tr_b16 a[24:25], v58 offset:1024
v_and_b32 v97, s90, v32
v_lshlrev_b32 v98, 16, v33
v_mfma_f32_16x16x32_bf16 v[152:155], a[56:59], a[140:143], v[152:155]
ds_read_b64_tr_b16 a[26:27], v58 offset:9216
ds_read_b64_tr_b16 a[12:13], v59 offset:0
v_and_b32 v99, s90, v33
v_mfma_f32_16x16x32_bf16 v[152:155], a[40:43], a[132:135], v[152:155]
ds_read_b64_tr_b16 a[14:15], v59 offset:8192
v_lshlrev_b32 v100, 16, v34
v_mfma_f32_16x16x32_bf16 v[140:143], a[44:47], a[128:131], v[140:143]
ds_read_b64_tr_b16 a[28:29], v59 offset:1024
v_and_b32 v101, s90, v34
v_mfma_f32_16x16x32_bf16 v[140:143], a[60:63], a[136:139], v[140:143]
ds_read_b64_tr_b16 a[30:31], v59 offset:9216
v_mfma_f32_16x16x32_bf16 v[156:159], a[60:63], a[140:143], v[156:159]
v_mfma_f32_16x16x32_bf16 v[156:159], a[44:47], a[132:135], v[156:159]
s_waitcnt vmcnt(5) lgkmcnt(0)
s_waitcnt vmcnt(4)
s_mov_b32 s86, 0
fk_g2_sp_chk:
v_cmp_eq_u32 vcc, v26, v0
s_nop 1
s_andn2_b64 s[88:89], s[84:85], vcc
s_cbranch_scc0 fk_g2_sp_ok
s_add_u32 s86, s86, 1
s_cmp_gt_u32 s86, 0x8000
s_cbranch_scc1 fk_g2_sp_ok
s_sleep 2
fk_g2_sp_ld:
buffer_load_dword v0, v25, s[12:15], s81 offen sc1
s_waitcnt vmcnt(0)
s_branch fk_g2_sp_chk
fk_g2_sp_ok:
v_mfma_f32_16x16x32_bf16 v[128:131], a[0:3], a[144:147], v[128:131]
ds_read_b64_tr_b16 a[32:33], v56 offset:2048
buffer_load_dwordx4 v[164:167], v1, s[12:15], s78 offen offset:0 sc1
ds_read_b64_tr_b16 a[34:35], v56 offset:10240
v_mfma_f32_16x16x32_bf16 v[128:131], a[16:19], a[152:155], v[128:131]
buffer_load_dwordx4 v[172:175], v1, s[12:15], s78 offen offset:1024 sc1
ds_read_b64_tr_b16 a[48:49], v56 offset:3072
v_mfma_f32_16x16x32_bf16 v[144:147], a[16:19], a[156:159], v[144:147]
buffer_load_dwordx4 v[180:183], v1, s[12:15], s78 offen offset:2048 sc1
ds_read_b64_tr_b16 a[50:51], v56 offset:11264
buffer_load_dwordx4 v[188:191], v1, s[12:15], s78 offen offset:3072 sc1
v_mfma_f32_16x16x32_bf16 v[144:147], a[0:3], a[148:151], v[144:147]
ds_read_b64_tr_b16 a[36:37], v57 offset:2048
v_lshlrev_b32 v102, 16, v35
v_mfma_f32_16x16x32_bf16 v[132:135], a[4:7], a[144:147], v[132:135]
ds_read_b64_tr_b16 a[38:39], v57 offset:10240
v_and_b32 v103, s90, v35
v_mfma_f32_16x16x32_bf16 v[132:135], a[20:23], a[152:155], v[132:135]
ds_read_b64_tr_b16 a[52:53], v57 offset:3072
v_lshlrev_b32 v104, 16, v36
v_mfma_f32_16x16x32_bf16 v[148:151], a[20:23], a[156:159], v[148:151]
ds_read_b64_tr_b16 a[54:55], v57 offset:11264
ds_read_b64_tr_b16 a[40:41], v58 offset:2048
v_and_b32 v105, s90, v36
v_mfma_f32_16x16x32_bf16 v[148:151], a[4:7], a[148:151], v[148:151]
ds_read_b64_tr_b16 a[42:43], v58 offset:10240
v_lshlrev_b32 v106, 16, v37
v_mfma_f32_16x16x32_bf16 v[136:139], a[8:11], a[144:147], v[136:139]
ds_read_b64_tr_b16 a[56:57], v58 offset:3072
v_and_b32 v107, s90, v37
v_lshlrev_b32 v108, 16, v38
v_mfma_f32_16x16x32_bf16 v[136:139], a[24:27], a[152:155], v[136:139]
ds_read_b64_tr_b16 a[58:59], v58 offset:11264
ds_read_b64_tr_b16 a[44:45], v59 offset:2048
v_and_b32 v109, s90, v38
v_mfma_f32_16x16x32_bf16 v[152:155], a[24:27], a[156:159], v[152:155]
ds_read_b64_tr_b16 a[46:47], v59 offset:10240
v_lshlrev_b32 v110, 16, v39
v_mfma_f32_16x16x32_bf16 v[152:155], a[8:11], a[148:151], v[152:155]
ds_read_b64_tr_b16 a[60:61], v59 offset:3072
v_and_b32 v111, s90, v39
PG23:
s_cbranch_execz fk_tret
v_mfma_f32_16x16x32_bf16 v[140:143], a[12:15], a[144:147], v[140:143]
ds_read_b64_tr_b16 a[62:63], v59 offset:11264
v_mfma_f32_16x16x32_bf16 v[140:143], a[28:31], a[152:155], v[140:143]
v_mfma_f32_16x16x32_bf16 v[156:159], a[28:31], a[156:159], v[156:159]
v_mfma_f32_16x16x32_bf16 v[156:159], a[12:15], a[148:151], v[156:159]
s_waitcnt vmcnt(4) lgkmcnt(0)
v_mfma_f32_16x16x32_bf16 v[128:131], a[32:35], a[160:163], v[128:131]
s_barrier
v_mfma_f32_16x16x32_bf16 v[128:131], a[48:51], a[168:171], v[128:131]
v_lshlrev_b32 v112, 16, v40
v_and_b32 v113, s90, v40
v_mfma_f32_16x16x32_bf16 v[144:147], a[48:51], a[172:175], v[144:147]
v_lshlrev_b32 v114, 16, v41
v_mfma_f32_16x16x32_bf16 v[144:147], a[32:35], a[164:167], v[144:147]
v_and_b32 v115, s90, v41
v_mfma_f32_16x16x32_bf16 v[132:135], a[36:39], a[160:163], v[132:135]
v_lshlrev_b32 v116, 16, v42
v_and_b32 v117, s90, v42
v_mfma_f32_16x16x32_bf16 v[132:135], a[52:55], a[168:171], v[132:135]
v_lshlrev_b32 v118, 16, v43
v_mfma_f32_16x16x32_bf16 v[148:151], a[52:55], a[172:175], v[148:151]
v_and_b32 v119, s90, v43
v_mfma_f32_16x16x32_bf16 v[148:151], a[36:39], a[164:167], v[148:151]
v_lshlrev_b32 v120, 16, v44
v_and_b32 v121, s90, v44
v_mfma_f32_16x16x32_bf16 v[136:139], a[40:43], a[160:163], v[136:139]
v_lshlrev_b32 v122, 16, v45
v_mfma_f32_16x16x32_bf16 v[136:139], a[56:59], a[168:171], v[136:139]
v_and_b32 v123, s90, v45
v_mfma_f32_16x16x32_bf16 v[152:155], a[56:59], a[172:175], v[152:155]
v_lshlrev_b32 v124, 16, v46
v_and_b32 v125, s90, v46
v_mfma_f32_16x16x32_bf16 v[152:155], a[40:43], a[164:167], v[152:155]
v_lshlrev_b32 v126, 16, v47
v_mfma_f32_16x16x32_bf16 v[140:143], a[44:47], a[160:163], v[140:143]
v_and_b32 v127, s90, v47
v_mfma_f32_16x16x32_bf16 v[140:143], a[60:63], a[168:171], v[140:143]
v_mfma_f32_16x16x32_bf16 v[156:159], a[60:63], a[172:175], v[156:159]
v_mfma_f32_16x16x32_bf16 v[156:159], a[44:47], a[164:167], v[156:159]
s_mov_b32 s88, 0xbfb8aa3b
s_mov_b32 s89, 0xbfb8aa3b
s_mov_b32 s58, 1.0
s_mov_b32 s59, 1.0
s_waitcnt vmcnt(3)
v_lshlrev_b32 v160, 16, v164
v_and_b32 v161, s90, v164
v_lshlrev_b32 v162, 16, v165
v_and_b32 v163, s90, v165
v_lshlrev_b32 v164, 16, v166
v_and_b32 v165, s90, v166
v_lshlrev_b32 v166, 16, v167
v_and_b32 v167, s90, v167
v_pk_add_f32 v[64:65], v[64:65], v[160:161]
v_pk_add_f32 v[66:67], v[66:67], v[162:163]
v_pk_add_f32 v[68:69], v[68:69], v[164:165]
v_pk_add_f32 v[70:71], v[70:71], v[166:167]
v_pk_mul_f32 v[160:161], v[64:65], s[88:89]
v_pk_mul_f32 v[162:163], v[66:67], s[88:89]
v_pk_mul_f32 v[164:165], v[68:69], s[88:89]
v_pk_mul_f32 v[166:167], v[70:71], s[88:89]
v_exp_f32 v160, v160
v_exp_f32 v161, v161
v_exp_f32 v162, v162
v_exp_f32 v163, v163
v_exp_f32 v164, v164
v_exp_f32 v165, v165
v_exp_f32 v166, v166
v_exp_f32 v167, v167
v_pk_mul_f32 v[64:65], v[64:65], v[128:129]
v_pk_mul_f32 v[66:67], v[66:67], v[130:131]
v_pk_mul_f32 v[68:69], v[68:69], v[132:133]
v_pk_mul_f32 v[70:71], v[70:71], v[134:135]
v_pk_add_f32 v[160:161], v[160:161], s[58:59]
v_pk_add_f32 v[162:163], v[162:163], s[58:59]
v_pk_add_f32 v[164:165], v[164:165], s[58:59]
v_pk_add_f32 v[166:167], v[166:167], s[58:59]
v_rcp_f32 v160, v160
v_rcp_f32 v161, v161
v_rcp_f32 v162, v162
v_rcp_f32 v163, v163
v_rcp_f32 v164, v164
v_rcp_f32 v165, v165
v_rcp_f32 v166, v166
v_rcp_f32 v167, v167
v_pk_fma_f32 v[64:65], v[64:65], v[160:161], v[96:97]
v_pk_fma_f32 v[66:67], v[66:67], v[162:163], v[98:99]
v_pk_fma_f32 v[68:69], v[68:69], v[164:165], v[100:101]
v_pk_fma_f32 v[70:71], v[70:71], v[166:167], v[102:103]
v_cvt_pk_bf16_f32 v64, v64, v65
v_cvt_pk_bf16_f32 v65, v66, v67
v_cvt_pk_bf16_f32 v66, v68, v69
v_cvt_pk_bf16_f32 v67, v70, v71
s_nop 0
v_permlane16_swap_b32 v64, v66
v_permlane16_swap_b32 v65, v67
buffer_store_dwordx4 v[64:67], v210, s[36:39], s74 offen offset:0 sc1
s_waitcnt vmcnt(3)
v_lshlrev_b32 v168, 16, v172
v_and_b32 v169, s90, v172
v_lshlrev_b32 v170, 16, v173
v_and_b32 v171, s90, v173
v_lshlrev_b32 v172, 16, v174
v_and_b32 v173, s90, v174
v_lshlrev_b32 v174, 16, v175
v_and_b32 v175, s90, v175
v_pk_add_f32 v[72:73], v[72:73], v[168:169]
v_pk_add_f32 v[74:75], v[74:75], v[170:171]
v_pk_add_f32 v[76:77], v[76:77], v[172:173]
v_pk_add_f32 v[78:79], v[78:79], v[174:175]
v_pk_mul_f32 v[168:169], v[72:73], s[88:89]
v_pk_mul_f32 v[170:171], v[74:75], s[88:89]
v_pk_mul_f32 v[172:173], v[76:77], s[88:89]
v_pk_mul_f32 v[174:175], v[78:79], s[88:89]
v_exp_f32 v168, v168
v_exp_f32 v169, v169
v_exp_f32 v170, v170
v_exp_f32 v171, v171
v_exp_f32 v172, v172
v_exp_f32 v173, v173
v_exp_f32 v174, v174
v_exp_f32 v175, v175
v_pk_mul_f32 v[72:73], v[72:73], v[136:137]
v_pk_mul_f32 v[74:75], v[74:75], v[138:139]
v_pk_mul_f32 v[76:77], v[76:77], v[140:141]
v_pk_mul_f32 v[78:79], v[78:79], v[142:143]
v_pk_add_f32 v[168:169], v[168:169], s[58:59]
v_pk_add_f32 v[170:171], v[170:171], s[58:59]
v_pk_add_f32 v[172:173], v[172:173], s[58:59]
v_pk_add_f32 v[174:175], v[174:175], s[58:59]
v_rcp_f32 v168, v168
v_rcp_f32 v169, v169
v_rcp_f32 v170, v170
v_rcp_f32 v171, v171
v_rcp_f32 v172, v172
v_rcp_f32 v173, v173
v_rcp_f32 v174, v174
v_rcp_f32 v175, v175
v_pk_fma_f32 v[72:73], v[72:73], v[168:169], v[104:105]
v_pk_fma_f32 v[74:75], v[74:75], v[170:171], v[106:107]
v_pk_fma_f32 v[76:77], v[76:77], v[172:173], v[108:109]
v_pk_fma_f32 v[78:79], v[78:79], v[174:175], v[110:111]
v_cvt_pk_bf16_f32 v72, v72, v73
v_cvt_pk_bf16_f32 v73, v74, v75
v_cvt_pk_bf16_f32 v74, v76, v77
v_cvt_pk_bf16_f32 v75, v78, v79
s_nop 0
v_permlane16_swap_b32 v72, v74
v_permlane16_swap_b32 v73, v75
buffer_store_dwordx4 v[72:75], v210, s[36:39], s74 offen offset:64 sc1
s_waitcnt vmcnt(3)
v_lshlrev_b32 v176, 16, v180
v_and_b32 v177, s90, v180
v_lshlrev_b32 v178, 16, v181
v_and_b32 v179, s90, v181
v_lshlrev_b32 v180, 16, v182
v_and_b32 v181, s90, v182
v_lshlrev_b32 v182, 16, v183
v_and_b32 v183, s90, v183
v_pk_add_f32 v[80:81], v[80:81], v[176:177]
v_pk_add_f32 v[82:83], v[82:83], v[178:179]
v_pk_add_f32 v[84:85], v[84:85], v[180:181]
v_pk_add_f32 v[86:87], v[86:87], v[182:183]
v_pk_mul_f32 v[176:177], v[80:81], s[88:89]
v_pk_mul_f32 v[178:179], v[82:83], s[88:89]
v_pk_mul_f32 v[180:181], v[84:85], s[88:89]
v_pk_mul_f32 v[182:183], v[86:87], s[88:89]
v_exp_f32 v176, v176
v_exp_f32 v177, v177
v_exp_f32 v178, v178
v_exp_f32 v179, v179
v_exp_f32 v180, v180
v_exp_f32 v181, v181
v_exp_f32 v182, v182
v_exp_f32 v183, v183
v_pk_mul_f32 v[80:81], v[80:81], v[144:145]
v_pk_mul_f32 v[82:83], v[82:83], v[146:147]
v_pk_mul_f32 v[84:85], v[84:85], v[148:149]
v_pk_mul_f32 v[86:87], v[86:87], v[150:151]
v_pk_add_f32 v[176:177], v[176:177], s[58:59]
v_pk_add_f32 v[178:179], v[178:179], s[58:59]
v_pk_add_f32 v[180:181], v[180:181], s[58:59]
v_pk_add_f32 v[182:183], v[182:183], s[58:59]
v_rcp_f32 v176, v176
v_rcp_f32 v177, v177
v_rcp_f32 v178, v178
v_rcp_f32 v179, v179
v_rcp_f32 v180, v180
v_rcp_f32 v181, v181
v_rcp_f32 v182, v182
v_rcp_f32 v183, v183
v_pk_fma_f32 v[80:81], v[80:81], v[176:177], v[112:113]
v_pk_fma_f32 v[82:83], v[82:83], v[178:179], v[114:115]
v_pk_fma_f32 v[84:85], v[84:85], v[180:181], v[116:117]
v_pk_fma_f32 v[86:87], v[86:87], v[182:183], v[118:119]
v_cvt_pk_bf16_f32 v80, v80, v81
v_cvt_pk_bf16_f32 v81, v82, v83
v_cvt_pk_bf16_f32 v82, v84, v85
v_cvt_pk_bf16_f32 v83, v86, v87
s_nop 0
v_permlane16_swap_b32 v80, v82
v_permlane16_swap_b32 v81, v83
buffer_store_dwordx4 v[80:83], v210, s[36:39], s75 offen offset:0 sc1
s_waitcnt vmcnt(3)
v_lshlrev_b32 v184, 16, v188
v_and_b32 v185, s90, v188
v_lshlrev_b32 v186, 16, v189
v_and_b32 v187, s90, v189
v_lshlrev_b32 v188, 16, v190
v_and_b32 v189, s90, v190
v_lshlrev_b32 v190, 16, v191
v_and_b32 v191, s90, v191
v_pk_add_f32 v[88:89], v[88:89], v[184:185]
v_pk_add_f32 v[90:91], v[90:91], v[186:187]
v_pk_add_f32 v[92:93], v[92:93], v[188:189]
v_pk_add_f32 v[94:95], v[94:95], v[190:191]
v_pk_mul_f32 v[184:185], v[88:89], s[88:89]
v_pk_mul_f32 v[186:187], v[90:91], s[88:89]
v_pk_mul_f32 v[188:189], v[92:93], s[88:89]
v_pk_mul_f32 v[190:191], v[94:95], s[88:89]
v_exp_f32 v184, v184
v_exp_f32 v185, v185
v_exp_f32 v186, v186
v_exp_f32 v187, v187
v_exp_f32 v188, v188
v_exp_f32 v189, v189
v_exp_f32 v190, v190
v_exp_f32 v191, v191
v_pk_mul_f32 v[88:89], v[88:89], v[152:153]
v_pk_mul_f32 v[90:91], v[90:91], v[154:155]
v_pk_mul_f32 v[92:93], v[92:93], v[156:157]
v_pk_mul_f32 v[94:95], v[94:95], v[158:159]
v_pk_add_f32 v[184:185], v[184:185], s[58:59]
v_pk_add_f32 v[186:187], v[186:187], s[58:59]
v_pk_add_f32 v[188:189], v[188:189], s[58:59]
v_pk_add_f32 v[190:191], v[190:191], s[58:59]
v_rcp_f32 v184, v184
v_rcp_f32 v185, v185
v_rcp_f32 v186, v186
v_rcp_f32 v187, v187
v_rcp_f32 v188, v188
v_rcp_f32 v189, v189
v_rcp_f32 v190, v190
v_rcp_f32 v191, v191
v_pk_fma_f32 v[88:89], v[88:89], v[184:185], v[120:121]
v_pk_fma_f32 v[90:91], v[90:91], v[186:187], v[122:123]
v_pk_fma_f32 v[92:93], v[92:93], v[188:189], v[124:125]
v_pk_fma_f32 v[94:95], v[94:95], v[190:191], v[126:127]
v_cvt_pk_bf16_f32 v88, v88, v89
v_cvt_pk_bf16_f32 v89, v90, v91
v_cvt_pk_bf16_f32 v90, v92, v93
v_cvt_pk_bf16_f32 v91, v94, v95
s_nop 0
v_permlane16_swap_b32 v88, v90
v_permlane16_swap_b32 v89, v91
buffer_store_dwordx4 v[88:91], v210, s[36:39], s75 offen offset:64 sc1
s_endpgm
fk_cold:
fk_hlate:
s_mov_b32 s84, s87
s_mov_b32 s86, 0
s_branch fk_sH_ld
fk_sH_chk:
v_cmp_eq_u32 vcc, v26, v0
s_nop 1
s_andn2_b64 s[88:89], s[84:85], vcc
s_cbranch_scc0 fk_sH_ok
s_add_u32 s86, s86, 1
s_cmp_gt_u32 s86, 0x8000
s_cbranch_scc1 fk_sH_ok
s_sleep 4
fk_sH_ld:
buffer_load_dword v0, v24, s[12:15], s82 offen sc1
s_waitcnt vmcnt(0)
s_branch fk_sH_chk
fk_sH_ok:
s_sub_u32 s69, s69, -98304
buffer_load_dwordx4 a[176:179], v1, s[12:15], s69 offen offset:0 sc1
buffer_load_dwordx4 a[180:183], v1, s[12:15], s69 offen offset:1024 sc1
buffer_load_dwordx4 a[184:187], v10, s[12:15], s69 offen offset:0 sc1
buffer_load_dwordx4 a[188:191], v10, s[12:15], s69 offen offset:1024 sc1
s_add_u32 s69, s69, 0x38000
buffer_load_dwordx4 a[192:195], v1, s[12:15], s69 offen offset:0 sc1
buffer_load_dwordx4 a[196:199], v1, s[12:15], s69 offen offset:1024 sc1
buffer_load_dwordx4 a[200:203], v10, s[12:15], s69 offen offset:0 sc1
buffer_load_dwordx4 a[204:207], v10, s[12:15], s69 offen offset:1024 sc1
s_add_u32 s69, s69, 0x38000
buffer_load_dwordx4 a[208:211], v1, s[12:15], s69 offen offset:0 sc1
buffer_load_dwordx4 a[212:215], v1, s[12:15], s69 offen offset:1024 sc1
buffer_load_dwordx4 a[216:219], v10, s[12:15], s69 offen offset:0 sc1
buffer_load_dwordx4 a[220:223], v10, s[12:15], s69 offen offset:1024 sc1
s_add_u32 s69, s69, 0x38000
buffer_load_dwordx4 a[224:227], v1, s[12:15], s69 offen offset:0 sc1
buffer_load_dwordx4 a[228:231], v1, s[12:15], s69 offen offset:1024 sc1
buffer_load_dwordx4 a[232:235], v10, s[12:15], s69 offen offset:0 sc1
buffer_load_dwordx4 a[236:239], v10, s[12:15], s69 offen offset:1024 sc1
s_add_u32 s69, s69, 0xfff40000
s_waitcnt vmcnt(0)
s_branch fk_hok
fk_exact:
s_cmp_lg_u32 s64, 0
s_cbranch_scc1 fk_attdone
s_mov_b32 s64, 1
s_waitcnt vmcnt(0)
s_and_b32 s46, s3, 1
s_lshl_b32 s46, s46, 18
s_add_u32 s46, s46, s66
buffer_load_dwordx4 a[128:131], v1, s[12:15], s46 offen offset:0 sc1
buffer_load_dwordx4 a[192:195], v10, s[12:15], s46 offen offset:0 sc1
buffer_load_dwordx4 a[132:135], v1, s[12:15], s46 offen offset:1024 sc1
buffer_load_dwordx4 a[196:199], v10, s[12:15], s46 offen offset:1024 sc1
buffer_load_dwordx4 a[136:139], v1, s[12:15], s46 offen offset:2048 sc1
buffer_load_dwordx4 a[200:203], v10, s[12:15], s46 offen offset:2048 sc1
buffer_load_dwordx4 a[140:143], v1, s[12:15], s46 offen offset:3072 sc1
buffer_load_dwordx4 a[204:207], v10, s[12:15], s46 offen offset:3072 sc1
s_add_u32 s46, s46, 4096
buffer_load_dwordx4 a[144:147], v1, s[12:15], s46 offen offset:0 sc1
buffer_load_dwordx4 a[208:211], v10, s[12:15], s46 offen offset:0 sc1
buffer_load_dwordx4 a[148:151], v1, s[12:15], s46 offen offset:1024 sc1
buffer_load_dwordx4 a[212:215], v10, s[12:15], s46 offen offset:1024 sc1
buffer_load_dwordx4 a[152:155], v1, s[12:15], s46 offen offset:2048 sc1
buffer_load_dwordx4 a[216:219], v10, s[12:15], s46 offen offset:2048 sc1
buffer_load_dwordx4 a[156:159], v1, s[12:15], s46 offen offset:3072 sc1
buffer_load_dwordx4 a[220:223], v10, s[12:15], s46 offen offset:3072 sc1
s_add_u32 s46, s46, 4096
buffer_load_dwordx4 a[160:163], v1, s[12:15], s46 offen offset:0 sc1
buffer_load_dwordx4 a[224:227], v10, s[12:15], s46 offen offset:0 sc1
buffer_load_dwordx4 a[164:167], v1, s[12:15], s46 offen offset:1024 sc1
buffer_load_dwordx4 a[228:231], v10, s[12:15], s46 offen offset:1024 sc1
buffer_load_dwordx4 a[168:171], v1, s[12:15], s46 offen offset:2048 sc1
buffer_load_dwordx4 a[232:235], v10, s[12:15], s46 offen offset:2048 sc1
buffer_load_dwordx4 a[172:175], v1, s[12:15], s46 offen offset:3072 sc1
buffer_load_dwordx4 a[236:239], v10, s[12:15], s46 offen offset:3072 sc1
s_add_u32 s46, s46, 4096
buffer_load_dwordx4 a[176:179], v1, s[12:15], s46 offen offset:0 sc1
buffer_load_dwordx4 a[240:243], v10, s[12:15], s46 offen offset:0 sc1
buffer_load_dwordx4 a[180:183], v1, s[12:15], s46 offen offset:1024 sc1
buffer_load_dwordx4 a[244:247], v10, s[12:15], s46 offen offset:1024 sc1
buffer_load_dwordx4 a[184:187], v1, s[12:15], s46 offen offset:2048 sc1
buffer_load_dwordx4 a[248:251], v10, s[12:15], s46 offen offset:2048 sc1
buffer_load_dwordx4 a[188:191], v1, s[12:15], s46 offen offset:3072 sc1
buffer_load_dwordx4 a[252:255], v10, s[12:15], s46 offen offset:3072 sc1
s_add_u32 s46, s46, 4096
s_sub_u32 s72, s72, 1310720
s_sub_u32 s71, s71, -393216
s_sub_u32 s69, s69, -98304
s_add_u32 s96, s96, 16384
s_cmp_eq_u32 s62, 0
s_cselect_b32 s46, s101, 0
v_mov_b32 v246, s46
v_mov_b32 v247, s46
v_mov_b32 v248, s46
v_mov_b32 v249, s46
s_waitcnt vmcnt(0)
v_mfma_f32_16x16x32_bf16 v[64:67], a[128:131], v[32:35], v[224:227]
v_mfma_f32_16x16x32_bf16 v[68:71], a[132:135], v[32:35], v[228:231]
v_mfma_f32_16x16x32_bf16 v[76:79], a[136:139], v[36:39], v[224:227]
v_mfma_f32_16x16x32_bf16 v[80:83], a[140:143], v[36:39], v[228:231]
v_mfma_f32_16x16x32_bf16 v[88:91], a[144:147], v[40:43], v[224:227]
v_mfma_f32_16x16x32_bf16 v[92:95], a[148:151], v[40:43], v[228:231]
v_mfma_f32_16x16x32_bf16 v[100:103], a[152:155], v[44:47], v[224:227]
v_mfma_f32_16x16x32_bf16 v[104:107], a[156:159], v[44:47], v[228:231]
v_mfma_f32_16x16x32_bf16 v[112:115], a[160:163], v[48:51], v[224:227]
v_mfma_f32_16x16x32_bf16 v[116:119], a[164:167], v[48:51], v[228:231]
v_mfma_f32_16x16x32_bf16 v[124:127], a[168:171], v[52:55], v[224:227]
v_mfma_f32_16x16x32_bf16 v[128:131], a[172:175], v[52:55], v[228:231]
v_mfma_f32_16x16x32_bf16 v[136:139], a[176:179], v[56:59], v[224:227]
v_mfma_f32_16x16x32_bf16 v[140:143], a[180:183], v[56:59], v[228:231]
v_mfma_f32_16x16x32_bf16 v[148:151], a[184:187], v[60:63], v[224:227]
v_mfma_f32_16x16x32_bf16 v[152:155], a[188:191], v[60:63], v[228:231]
v_max3_f32 v163, v64, v65, v66
v_max3_f32 v163, v163, v67, v68
v_max3_f32 v163, v163, v69, v70
v_max_f32 v163, v163, v71
v_max3_f32 v167, v76, v77, v78
v_max3_f32 v167, v167, v79, v80
v_max3_f32 v167, v167, v81, v82
v_max_f32 v167, v167, v83
v_max3_f32 v171, v88, v89, v90
v_max3_f32 v171, v171, v91, v92
v_max3_f32 v171, v171, v93, v94
v_max_f32 v171, v171, v95
v_max3_f32 v175, v100, v101, v102
v_max3_f32 v175, v175, v103, v104
v_max3_f32 v175, v175, v105, v106
v_max_f32 v175, v175, v107
v_max3_f32 v179, v112, v113, v114
v_max3_f32 v179, v179, v115, v116
v_max3_f32 v179, v179, v117, v118
v_max_f32 v179, v179, v119
v_max3_f32 v183, v124, v125, v126
v_max3_f32 v183, v183, v127, v128
v_max3_f32 v183, v183, v129, v130
v_max_f32 v183, v183, v131
v_max3_f32 v187, v136, v137, v138
v_max3_f32 v187, v187, v139, v140
v_max3_f32 v187, v187, v141, v142
v_max_f32 v187, v187, v143
v_max3_f32 v191, v148, v149, v150
v_max3_f32 v191, v191, v151, v152
v_max3_f32 v191, v191, v153, v154
v_max_f32 v191, v191, v155
v_mfma_f32_16x16x32_bf16 v[192:195], a[0:3], v[32:35], v[232:235]
v_mfma_f32_16x16x32_bf16 v[196:199], a[4:7], v[32:35], v[236:239]
v_mfma_f32_16x16x32_bf16 v[200:203], a[8:11], v[32:35], v[246:249]
v_mfma_f32_16x16x32_bf16 v[204:207], a[12:15], v[32:35], v[246:249]
v_mfma_f32_16x16x32_bf16 v[208:211], a[16:19], v[32:35], v[246:249]
v_mfma_f32_16x16x32_bf16 v[212:215], a[20:23], v[32:35], v[246:249]
v_mfma_f32_16x16x32_bf16 v[216:219], a[24:27], v[32:35], v[246:249]
v_mfma_f32_16x16x32_bf16 v[220:223], a[28:31], v[32:35], v[246:249]
s_nop 0
v_max3_f32 v163, v163, v192, v193
v_max3_f32 v163, v163, v194, v195
v_max3_f32 v163, v163, v196, v197
v_max3_f32 v163, v163, v198, v199
v_max3_f32 v163, v163, v200, v201
v_max3_f32 v163, v163, v202, v203
v_max3_f32 v163, v163, v204, v205
v_max3_f32 v163, v163, v206, v207
v_max3_f32 v163, v163, v208, v209
v_max3_f32 v163, v163, v210, v211
v_max3_f32 v163, v163, v212, v213
v_max3_f32 v163, v163, v214, v215
v_max3_f32 v163, v163, v216, v217
v_max3_f32 v163, v163, v218, v219
v_max3_f32 v163, v163, v220, v221
v_max3_f32 v163, v163, v222, v223
v_mfma_f32_16x16x32_bf16 v[192:195], a[32:35], v[32:35], v[246:249]
v_mfma_f32_16x16x32_bf16 v[196:199], a[36:39], v[32:35], v[246:249]
v_mfma_f32_16x16x32_bf16 v[200:203], a[40:43], v[32:35], v[246:249]
v_mfma_f32_16x16x32_bf16 v[204:207], a[44:47], v[32:35], v[246:249]
v_mfma_f32_16x16x32_bf16 v[208:211], a[48:51], v[32:35], v[246:249]
v_mfma_f32_16x16x32_bf16 v[212:215], a[52:55], v[32:35], v[246:249]
v_mfma_f32_16x16x32_bf16 v[216:219], a[56:59], v[32:35], v[246:249]
v_mfma_f32_16x16x32_bf16 v[220:223], a[60:63], v[32:35], v[246:249]
s_nop 0
v_max3_f32 v163, v163, v192, v193
v_max3_f32 v163, v163, v194, v195
v_max3_f32 v163, v163, v196, v197
v_max3_f32 v163, v163, v198, v199
v_max3_f32 v163, v163, v200, v201
v_max3_f32 v163, v163, v202, v203
v_max3_f32 v163, v163, v204, v205
v_max3_f32 v163, v163, v206, v207
v_max3_f32 v163, v163, v208, v209
v_max3_f32 v163, v163, v210, v211
v_max3_f32 v163, v163, v212, v213
v_max3_f32 v163, v163, v214, v215
v_max3_f32 v163, v163, v216, v217
v_max3_f32 v163, v163, v218, v219
v_max3_f32 v163, v163, v220, v221
v_max3_f32 v163, v163, v222, v223
v_mfma_f32_16x16x32_bf16 v[192:195], a[128:131], v[36:39], 0
v_mfma_f32_16x16x32_bf16 v[196:199], a[132:135], v[36:39], 0
v_mfma_f32_16x16x32_bf16 v[200:203], a[8:11], v[36:39], v[232:235]
v_mfma_f32_16x16x32_bf16 v[204:207], a[12:15], v[36:39], v[236:239]
v_mfma_f32_16x16x32_bf16 v[208:211], a[16:19], v[36:39], v[246:249]
v_mfma_f32_16x16x32_bf16 v[212:215], a[20:23], v[36:39], v[246:249]
v_mfma_f32_16x16x32_bf16 v[216:219], a[24:27], v[36:39], v[246:249]
v_mfma_f32_16x16x32_bf16 v[220:223], a[28:31], v[36:39], v[246:249]
s_nop 0
v_max3_f32 v167, v167, v192, v193
v_max3_f32 v167, v167, v194, v195
v_max3_f32 v167, v167, v196, v197
v_max3_f32 v167, v167, v198, v199
v_max3_f32 v167, v167, v200, v201
v_max3_f32 v167, v167, v202, v203
v_max3_f32 v167, v167, v204, v205
v_max3_f32 v167, v167, v206, v207
v_max3_f32 v167, v167, v208, v209
v_max3_f32 v167, v167, v210, v211
v_max3_f32 v167, v167, v212, v213
v_max3_f32 v167, v167, v214, v215
v_max3_f32 v167, v167, v216, v217
v_max3_f32 v167, v167, v218, v219
v_max3_f32 v167, v167, v220, v221
v_max3_f32 v167, v167, v222, v223
v_mfma_f32_16x16x32_bf16 v[192:195], a[32:35], v[36:39], v[246:249]
v_mfma_f32_16x16x32_bf16 v[196:199], a[36:39], v[36:39], v[246:249]
v_mfma_f32_16x16x32_bf16 v[200:203], a[40:43], v[36:39], v[246:249]
v_mfma_f32_16x16x32_bf16 v[204:207], a[44:47], v[36:39], v[246:249]
v_mfma_f32_16x16x32_bf16 v[208:211], a[48:51], v[36:39], v[246:249]
v_mfma_f32_16x16x32_bf16 v[212:215], a[52:55], v[36:39], v[246:249]
v_mfma_f32_16x16x32_bf16 v[216:219], a[56:59], v[36:39], v[246:249]
v_mfma_f32_16x16x32_bf16 v[220:223], a[60:63], v[36:39], v[246:249]
s_nop 0
v_max3_f32 v167, v167, v192, v193
v_max3_f32 v167, v167, v194, v195
v_max3_f32 v167, v167, v196, v197
v_max3_f32 v167, v167, v198, v199
v_max3_f32 v167, v167, v200, v201
v_max3_f32 v167, v167, v202, v203
v_max3_f32 v167, v167, v204, v205
v_max3_f32 v167, v167, v206, v207
v_max3_f32 v167, v167, v208, v209
v_max3_f32 v167, v167, v210, v211
v_max3_f32 v167, v167, v212, v213
v_max3_f32 v167, v167, v214, v215
v_max3_f32 v167, v167, v216, v217
v_max3_f32 v167, v167, v218, v219
v_max3_f32 v167, v167, v220, v221
v_max3_f32 v167, v167, v222, v223
v_mfma_f32_16x16x32_bf16 v[192:195], a[128:131], v[40:43], 0
v_mfma_f32_16x16x32_bf16 v[196:199], a[132:135], v[40:43], 0
v_mfma_f32_16x16x32_bf16 v[200:203], a[136:139], v[40:43], 0
v_mfma_f32_16x16x32_bf16 v[204:207], a[140:143], v[40:43], 0
v_mfma_f32_16x16x32_bf16 v[208:211], a[16:19], v[40:43], v[232:235]
v_mfma_f32_16x16x32_bf16 v[212:215], a[20:23], v[40:43], v[236:239]
v_mfma_f32_16x16x32_bf16 v[216:219], a[24:27], v[40:43], v[246:249]
v_mfma_f32_16x16x32_bf16 v[220:223], a[28:31], v[40:43], v[246:249]
s_nop 0
v_max3_f32 v171, v171, v192, v193
v_max3_f32 v171, v171, v194, v195
v_max3_f32 v171, v171, v196, v197
v_max3_f32 v171, v171, v198, v199
v_max3_f32 v171, v171, v200, v201
v_max3_f32 v171, v171, v202, v203
v_max3_f32 v171, v171, v204, v205
v_max3_f32 v171, v171, v206, v207
v_max3_f32 v171, v171, v208, v209
v_max3_f32 v171, v171, v210, v211
v_max3_f32 v171, v171, v212, v213
v_max3_f32 v171, v171, v214, v215
v_max3_f32 v171, v171, v216, v217
v_max3_f32 v171, v171, v218, v219
v_max3_f32 v171, v171, v220, v221
v_max3_f32 v171, v171, v222, v223
v_mfma_f32_16x16x32_bf16 v[192:195], a[32:35], v[40:43], v[246:249]
v_mfma_f32_16x16x32_bf16 v[196:199], a[36:39], v[40:43], v[246:249]
v_mfma_f32_16x16x32_bf16 v[200:203], a[40:43], v[40:43], v[246:249]
v_mfma_f32_16x16x32_bf16 v[204:207], a[44:47], v[40:43], v[246:249]
v_mfma_f32_16x16x32_bf16 v[208:211], a[48:51], v[40:43], v[246:249]
v_mfma_f32_16x16x32_bf16 v[212:215], a[52:55], v[40:43], v[246:249]
v_mfma_f32_16x16x32_bf16 v[216:219], a[56:59], v[40:43], v[246:249]
v_mfma_f32_16x16x32_bf16 v[220:223], a[60:63], v[40:43], v[246:249]
s_nop 0
v_max3_f32 v171, v171, v192, v193
v_max3_f32 v171, v171, v194, v195
v_max3_f32 v171, v171, v196, v197
v_max3_f32 v171, v171, v198, v199
v_max3_f32 v171, v171, v200, v201
v_max3_f32 v171, v171, v202, v203
v_max3_f32 v171, v171, v204, v205
v_max3_f32 v171, v171, v206, v207
v_max3_f32 v171, v171, v208, v209
v_max3_f32 v171, v171, v210, v211
v_max3_f32 v171, v171, v212, v213
v_max3_f32 v171, v171, v214, v215
v_max3_f32 v171, v171, v216, v217
v_max3_f32 v171, v171, v218, v219
v_max3_f32 v171, v171, v220, v221
v_max3_f32 v171, v171, v222, v223
v_mfma_f32_16x16x32_bf16 v[192:195], a[128:131], v[44:47], 0
v_mfma_f32_16x16x32_bf16 v[196:199], a[132:135], v[44:47], 0
v_mfma_f32_16x16x32_bf16 v[200:203], a[136:139], v[44:47], 0
v_mfma_f32_16x16x32_bf16 v[204:207], a[140:143], v[44:47], 0
v_mfma_f32_16x16x32_bf16 v[208:211], a[144:147], v[44:47], 0
v_mfma_f32_16x16x32_bf16 v[212:215], a[148:151], v[44:47], 0
v_mfma_f32_16x16x32_bf16 v[216:219], a[24:27], v[44:47], v[232:235]
v_mfma_f32_16x16x32_bf16 v[220:223], a[28:31], v[44:47], v[236:239]
s_nop 0
v_max3_f32 v175, v175, v192, v193
v_max3_f32 v175, v175, v194, v195
v_max3_f32 v175, v175, v196, v197
v_max3_f32 v175, v175, v198, v199
v_max3_f32 v175, v175, v200, v201
v_max3_f32 v175, v175, v202, v203
v_max3_f32 v175, v175, v204, v205
v_max3_f32 v175, v175, v206, v207
v_max3_f32 v175, v175, v208, v209
v_max3_f32 v175, v175, v210, v211
v_max3_f32 v175, v175, v212, v213
v_max3_f32 v175, v175, v214, v215
v_max3_f32 v175, v175, v216, v217
v_max3_f32 v175, v175, v218, v219
v_max3_f32 v175, v175, v220, v221
v_max3_f32 v175, v175, v222, v223
v_mfma_f32_16x16x32_bf16 v[192:195], a[32:35], v[44:47], v[246:249]
v_mfma_f32_16x16x32_bf16 v[196:199], a[36:39], v[44:47], v[246:249]
v_mfma_f32_16x16x32_bf16 v[200:203], a[40:43], v[44:47], v[246:249]
v_mfma_f32_16x16x32_bf16 v[204:207], a[44:47], v[44:47], v[246:249]
v_mfma_f32_16x16x32_bf16 v[208:211], a[48:51], v[44:47], v[246:249]
v_mfma_f32_16x16x32_bf16 v[212:215], a[52:55], v[44:47], v[246:249]
v_mfma_f32_16x16x32_bf16 v[216:219], a[56:59], v[44:47], v[246:249]
v_mfma_f32_16x16x32_bf16 v[220:223], a[60:63], v[44:47], v[246:249]
s_nop 0
v_max3_f32 v175, v175, v192, v193
v_max3_f32 v175, v175, v194, v195
v_max3_f32 v175, v175, v196, v197
v_max3_f32 v175, v175, v198, v199
v_max3_f32 v175, v175, v200, v201
v_max3_f32 v175, v175, v202, v203
v_max3_f32 v175, v175, v204, v205
v_max3_f32 v175, v175, v206, v207
v_max3_f32 v175, v175, v208, v209
v_max3_f32 v175, v175, v210, v211
v_max3_f32 v175, v175, v212, v213
v_max3_f32 v175, v175, v214, v215
v_max3_f32 v175, v175, v216, v217
v_max3_f32 v175, v175, v218, v219
v_max3_f32 v175, v175, v220, v221
v_max3_f32 v175, v175, v222, v223
v_mfma_f32_16x16x32_bf16 v[192:195], a[128:131], v[48:51], 0
v_mfma_f32_16x16x32_bf16 v[196:199], a[132:135], v[48:51], 0
v_mfma_f32_16x16x32_bf16 v[200:203], a[136:139], v[48:51], 0
v_mfma_f32_16x16x32_bf16 v[204:207], a[140:143], v[48:51], 0
v_mfma_f32_16x16x32_bf16 v[208:211], a[144:147], v[48:51], 0
v_mfma_f32_16x16x32_bf16 v[212:215], a[148:151], v[48:51], 0
v_mfma_f32_16x16x32_bf16 v[216:219], a[152:155], v[48:51], 0
v_mfma_f32_16x16x32_bf16 v[220:223], a[156:159], v[48:51], 0
s_nop 0
v_max3_f32 v179, v179, v192, v193
v_max3_f32 v179, v179, v194, v195
v_max3_f32 v179, v179, v196, v197
v_max3_f32 v179, v179, v198, v199
v_max3_f32 v179, v179, v200, v201
v_max3_f32 v179, v179, v202, v203
v_max3_f32 v179, v179, v204, v205
v_max3_f32 v179, v179, v206, v207
v_max3_f32 v179, v179, v208, v209
v_max3_f32 v179, v179, v210, v211
v_max3_f32 v179, v179, v212, v213
v_max3_f32 v179, v179, v214, v215
v_max3_f32 v179, v179, v216, v217
v_max3_f32 v179, v179, v218, v219
v_max3_f32 v179, v179, v220, v221
v_max3_f32 v179, v179, v222, v223
v_mfma_f32_16x16x32_bf16 v[192:195], a[32:35], v[48:51], v[232:235]
v_mfma_f32_16x16x32_bf16 v[196:199], a[36:39], v[48:51], v[236:239]
v_mfma_f32_16x16x32_bf16 v[200:203], a[40:43], v[48:51], v[246:249]
v_mfma_f32_16x16x32_bf16 v[204:207], a[44:47], v[48:51], v[246:249]
v_mfma_f32_16x16x32_bf16 v[208:211], a[48:51], v[48:51], v[246:249]
v_mfma_f32_16x16x32_bf16 v[212:215], a[52:55], v[48:51], v[246:249]
v_mfma_f32_16x16x32_bf16 v[216:219], a[56:59], v[48:51], v[246:249]
v_mfma_f32_16x16x32_bf16 v[220:223], a[60:63], v[48:51], v[246:249]
s_nop 0
v_max3_f32 v179, v179, v192, v193
v_max3_f32 v179, v179, v194, v195
v_max3_f32 v179, v179, v196, v197
v_max3_f32 v179, v179, v198, v199
v_max3_f32 v179, v179, v200, v201
v_max3_f32 v179, v179, v202, v203
v_max3_f32 v179, v179, v204, v205
v_max3_f32 v179, v179, v206, v207
v_max3_f32 v179, v179, v208, v209
v_max3_f32 v179, v179, v210, v211
v_max3_f32 v179, v179, v212, v213
v_max3_f32 v179, v179, v214, v215
v_max3_f32 v179, v179, v216, v217
v_max3_f32 v179, v179, v218, v219
v_max3_f32 v179, v179, v220, v221
v_max3_f32 v179, v179, v222, v223
v_mfma_f32_16x16x32_bf16 v[192:195], a[128:131], v[52:55], 0
v_mfma_f32_16x16x32_bf16 v[196:199], a[132:135], v[52:55], 0
v_mfma_f32_16x16x32_bf16 v[200:203], a[136:139], v[52:55], 0
v_mfma_f32_16x16x32_bf16 v[204:207], a[140:143], v[52:55], 0
v_mfma_f32_16x16x32_bf16 v[208:211], a[144:147], v[52:55], 0
v_mfma_f32_16x16x32_bf16 v[212:215], a[148:151], v[52:55], 0
v_mfma_f32_16x16x32_bf16 v[216:219], a[152:155], v[52:55], 0
v_mfma_f32_16x16x32_bf16 v[220:223], a[156:159], v[52:55], 0
s_nop 0
v_max3_f32 v183, v183, v192, v193
v_max3_f32 v183, v183, v194, v195
v_max3_f32 v183, v183, v196, v197
v_max3_f32 v183, v183, v198, v199
v_max3_f32 v183, v183, v200, v201
v_max3_f32 v183, v183, v202, v203
v_max3_f32 v183, v183, v204, v205
v_max3_f32 v183, v183, v206, v207
v_max3_f32 v183, v183, v208, v209
v_max3_f32 v183, v183, v210, v211
v_max3_f32 v183, v183, v212, v213
v_max3_f32 v183, v183, v214, v215
v_max3_f32 v183, v183, v216, v217
v_max3_f32 v183, v183, v218, v219
v_max3_f32 v183, v183, v220, v221
v_max3_f32 v183, v183, v222, v223
v_mfma_f32_16x16x32_bf16 v[192:195], a[160:163], v[52:55], 0
v_mfma_f32_16x16x32_bf16 v[196:199], a[164:167], v[52:55], 0
v_mfma_f32_16x16x32_bf16 v[200:203], a[40:43], v[52:55], v[232:235]
v_mfma_f32_16x16x32_bf16 v[204:207], a[44:47], v[52:55], v[236:239]
v_mfma_f32_16x16x32_bf16 v[208:211], a[48:51], v[52:55], v[246:249]
v_mfma_f32_16x16x32_bf16 v[212:215], a[52:55], v[52:55], v[246:249]
v_mfma_f32_16x16x32_bf16 v[216:219], a[56:59], v[52:55], v[246:249]
v_mfma_f32_16x16x32_bf16 v[220:223], a[60:63], v[52:55], v[246:249]
s_nop 0
v_max3_f32 v183, v183, v192, v193
v_max3_f32 v183, v183, v194, v195
v_max3_f32 v183, v183, v196, v197
v_max3_f32 v183, v183, v198, v199
v_max3_f32 v183, v183, v200, v201
v_max3_f32 v183, v183, v202, v203
v_max3_f32 v183, v183, v204, v205
v_max3_f32 v183, v183, v206, v207
v_max3_f32 v183, v183, v208, v209
v_max3_f32 v183, v183, v210, v211
v_max3_f32 v183, v183, v212, v213
v_max3_f32 v183, v183, v214, v215
v_max3_f32 v183, v183, v216, v217
v_max3_f32 v183, v183, v218, v219
v_max3_f32 v183, v183, v220, v221
v_max3_f32 v183, v183, v222, v223
v_mfma_f32_16x16x32_bf16 v[192:195], a[128:131], v[56:59], 0
v_mfma_f32_16x16x32_bf16 v[196:199], a[132:135], v[56:59], 0
v_mfma_f32_16x16x32_bf16 v[200:203], a[136:139], v[56:59], 0
v_mfma_f32_16x16x32_bf16 v[204:207], a[140:143], v[56:59], 0
v_mfma_f32_16x16x32_bf16 v[208:211], a[144:147], v[56:59], 0
v_mfma_f32_16x16x32_bf16 v[212:215], a[148:151], v[56:59], 0
v_mfma_f32_16x16x32_bf16 v[216:219], a[152:155], v[56:59], 0
v_mfma_f32_16x16x32_bf16 v[220:223], a[156:159], v[56:59], 0
s_nop 0
v_max3_f32 v187, v187, v192, v193
v_max3_f32 v187, v187, v194, v195
v_max3_f32 v187, v187, v196, v197
v_max3_f32 v187, v187, v198, v199
v_max3_f32 v187, v187, v200, v201
v_max3_f32 v187, v187, v202, v203
v_max3_f32 v187, v187, v204, v205
v_max3_f32 v187, v187, v206, v207
v_max3_f32 v187, v187, v208, v209
v_max3_f32 v187, v187, v210, v211
v_max3_f32 v187, v187, v212, v213
v_max3_f32 v187, v187, v214, v215
v_max3_f32 v187, v187, v216, v217
v_max3_f32 v187, v187, v218, v219
v_max3_f32 v187, v187, v220, v221
v_max3_f32 v187, v187, v222, v223
v_mfma_f32_16x16x32_bf16 v[192:195], a[160:163], v[56:59], 0
v_mfma_f32_16x16x32_bf16 v[196:199], a[164:167], v[56:59], 0
v_mfma_f32_16x16x32_bf16 v[200:203], a[168:171], v[56:59], 0
v_mfma_f32_16x16x32_bf16 v[204:207], a[172:175], v[56:59], 0
v_mfma_f32_16x16x32_bf16 v[208:211], a[48:51], v[56:59], v[232:235]
v_mfma_f32_16x16x32_bf16 v[212:215], a[52:55], v[56:59], v[236:239]
v_mfma_f32_16x16x32_bf16 v[216:219], a[56:59], v[56:59], v[246:249]
v_mfma_f32_16x16x32_bf16 v[220:223], a[60:63], v[56:59], v[246:249]
s_nop 0
v_max3_f32 v187, v187, v192, v193
v_max3_f32 v187, v187, v194, v195
v_max3_f32 v187, v187, v196, v197
v_max3_f32 v187, v187, v198, v199
v_max3_f32 v187, v187, v200, v201
v_max3_f32 v187, v187, v202, v203
v_max3_f32 v187, v187, v204, v205
v_max3_f32 v187, v187, v206, v207
v_max3_f32 v187, v187, v208, v209
v_max3_f32 v187, v187, v210, v211
v_max3_f32 v187, v187, v212, v213
v_max3_f32 v187, v187, v214, v215
v_max3_f32 v187, v187, v216, v217
v_max3_f32 v187, v187, v218, v219
v_max3_f32 v187, v187, v220, v221
v_max3_f32 v187, v187, v222, v223
v_mfma_f32_16x16x32_bf16 v[192:195], a[128:131], v[60:63], 0
v_mfma_f32_16x16x32_bf16 v[196:199], a[132:135], v[60:63], 0
v_mfma_f32_16x16x32_bf16 v[200:203], a[136:139], v[60:63], 0
v_mfma_f32_16x16x32_bf16 v[204:207], a[140:143], v[60:63], 0
v_mfma_f32_16x16x32_bf16 v[208:211], a[144:147], v[60:63], 0
v_mfma_f32_16x16x32_bf16 v[212:215], a[148:151], v[60:63], 0
v_mfma_f32_16x16x32_bf16 v[216:219], a[152:155], v[60:63], 0
v_mfma_f32_16x16x32_bf16 v[220:223], a[156:159], v[60:63], 0
s_nop 0
v_max3_f32 v191, v191, v192, v193
v_max3_f32 v191, v191, v194, v195
v_max3_f32 v191, v191, v196, v197
v_max3_f32 v191, v191, v198, v199
v_max3_f32 v191, v191, v200, v201
v_max3_f32 v191, v191, v202, v203
v_max3_f32 v191, v191, v204, v205
v_max3_f32 v191, v191, v206, v207
v_max3_f32 v191, v191, v208, v209
v_max3_f32 v191, v191, v210, v211
v_max3_f32 v191, v191, v212, v213
v_max3_f32 v191, v191, v214, v215
v_max3_f32 v191, v191, v216, v217
v_max3_f32 v191, v191, v218, v219
v_max3_f32 v191, v191, v220, v221
v_max3_f32 v191, v191, v222, v223
v_mfma_f32_16x16x32_bf16 v[192:195], a[160:163], v[60:63], 0
v_mfma_f32_16x16x32_bf16 v[196:199], a[164:167], v[60:63], 0
v_mfma_f32_16x16x32_bf16 v[200:203], a[168:171], v[60:63], 0
v_mfma_f32_16x16x32_bf16 v[204:207], a[172:175], v[60:63], 0
v_mfma_f32_16x16x32_bf16 v[208:211], a[176:179], v[60:63], 0
v_mfma_f32_16x16x32_bf16 v[212:215], a[180:183], v[60:63], 0
v_mfma_f32_16x16x32_bf16 v[216:219], a[56:59], v[60:63], v[232:235]
v_mfma_f32_16x16x32_bf16 v[220:223], a[60:63], v[60:63], v[236:239]
s_nop 0
v_max3_f32 v191, v191, v192, v193
v_max3_f32 v191, v191, v194, v195
v_max3_f32 v191, v191, v196, v197
v_max3_f32 v191, v191, v198, v199
v_max3_f32 v191, v191, v200, v201
v_max3_f32 v191, v191, v202, v203
v_max3_f32 v191, v191, v204, v205
v_max3_f32 v191, v191, v206, v207
v_max3_f32 v191, v191, v208, v209
v_max3_f32 v191, v191, v210, v211
v_max3_f32 v191, v191, v212, v213
v_max3_f32 v191, v191, v214, v215
v_max3_f32 v191, v191, v216, v217
v_max3_f32 v191, v191, v218, v219
v_max3_f32 v191, v191, v220, v221
v_max3_f32 v191, v191, v222, v223
s_nop 4
s_branch fk_again
fk_end:
s_endpgm
.section .rodata,"a"
.p2align 6
.amdhsa_kernel recurrent_scan__sliding_block__dense_activation_squared_relu__prompt_kernel
  .amdhsa_next_free_vgpr 512
  .amdhsa_next_free_sgpr 102
  .amdhsa_accum_offset 256
  .amdhsa_group_segment_fixed_size 0
  .amdhsa_kernarg_size 88
  .amdhsa_user_sgpr_count 2
  .amdhsa_user_sgpr_kernarg_segment_ptr 1
  .amdhsa_system_sgpr_workgroup_id_x 1
.end_amdhsa_kernel
```
